```python
import torch

def _softmax(x, axis=-1):
    return torch.softmax(x, dim=axis)
def _gelu(x):
    return torch.nn.functional.gelu(x, approximate="tanh")
def _silu(x):
    return torch.nn.functional.silu(x)
def _sigmoid(x):
    return torch.sigmoid(x)
def _layernorm(x, axis=-1, eps=1e-5):
    m = x.mean(dim=axis, keepdim=True)
    v = x.var(dim=axis, keepdim=True, unbiased=False)
    return (x - m) / torch.sqrt(v + eps)
def _scatter_add(tgt, idx, src, axis=0):
    return tgt.clone().index_add_(axis, idx, src)
def _segment_sum(src, seg, n):
    out = torch.zeros((n,) + src.shape[1:], dtype=src.dtype)
    return out.index_add_(0, seg, src)
def _pad(x, pw):
    flat = tuple(v for pair in reversed(pw) for v in pair)
    return torch.nn.functional.pad(x, flat)

kernel_name = 'sequential_preLN__linear_kernel_hedgehog__glu_gated_reglu__prompt'

def setup_inputs():

    _w = (lambda a: (lambda t: t.to(torch.bfloat16) if t.is_floating_point() else t)(torch.as_tensor(a)))
    def _A_setup():
        B, S, D, H = 1, 2048, 576, 32
        Dh = D // H
        return {
            "x": _w((lambda *s: torch.randn(*s, dtype=torch.bfloat16) * 0.05)(B, S, D)),
            "wqkv": _w((lambda *s: torch.randn(*s, dtype=torch.bfloat16) * 0.2)(D, 3 * D)),
            "w_phi": _w((lambda *s: torch.randn(*s, dtype=torch.bfloat16) * 0.2)(H, Dh, Dh) * (Dh ** -0.5)),
            "wo": _w((lambda *s: torch.randn(*s, dtype=torch.bfloat16) * 0.05)(D, D)),
        }
    _A_in = _A_setup()

    def _B_setup():
        B, S, D, F = 1, 2048, 576, 4608
        return {
            "x": _w((lambda *s: torch.randn(*s, dtype=torch.bfloat16) * 0.05)(B, S, D)),
            "W_gate": _w((lambda *s: torch.randn(*s, dtype=torch.bfloat16) * 0.4)(D, F) * (2.0 / D) ** 0.5),
            "W_up": _w((lambda *s: torch.randn(*s, dtype=torch.bfloat16) * 0.4)(D, F) * (2.0 / D) ** 0.5),
            "W_down": _w((lambda *s: torch.randn(*s, dtype=torch.bfloat16) * 0.4)(F, D) * (1.0 / F) ** 0.5),
        }
    _B_in = _B_setup()

    return {
        "A_x": _A_in["x"],
        "A_wqkv": _A_in["wqkv"],
        "A_w_phi": _A_in["w_phi"],
        "A_wo": _A_in["wo"],
        "B_x": _B_in["x"],
        "B_W_gate": _B_in["W_gate"],
        "B_W_up": _B_in["W_up"],
        "B_W_down": _B_in["W_down"],
    }

def reference(A_x, A_wqkv, A_w_phi, A_wo, B_x, B_W_gate, B_W_up, B_W_down):
    def _A_ref(x, wqkv, w_phi, wo):
        B, S, D = x.shape
        H = 32; Dh = D // H
        qkv = (lambda x, *d: x.permute(*d))((x @ wqkv).reshape(B, S, 3, H, Dh), 2, 0, 3, 1, 4)
        q, k, v = qkv[0], qkv[1], qkv[2]
        pq = torch.einsum("bhsd,hdf->bhsf", q, w_phi)
        pk = torch.einsum("bhsd,hdf->bhsf", k, w_phi)
        phi_q = torch.concatenate([_softmax(pq, axis=-1), _softmax(-pq, axis=-1)], axis=-1)
        phi_k = torch.concatenate([_softmax(pk, axis=-1), _softmax(-pk, axis=-1)], axis=-1)
        kv = torch.einsum("bhsf,bhsd->bhfd", phi_k, v)
        z  = torch.einsum("bhsf->bhf", phi_k)
        num = torch.einsum("bhqf,bhfd->bhqd", phi_q, kv)
        den = torch.einsum("bhqf,bhf->bhq", phi_q, z)[..., None] + 1e-6
        o = num / den
        return (lambda x, *d: x.permute(*d))(o, 0, 2, 1, 3).reshape(B, S, D) @ wo

    def _B_ref(x, W_gate, W_up, W_down):
        gate = torch.einsum("bsd,df->bsf", x, W_gate)
        up = torch.einsum("bsd,df->bsf", x, W_up)
        gate = gate * (lambda x, dt: x.to(dt))(gate > 0, gate.dtype)
        h = gate * up
        return torch.einsum("bsf,fd->bsd", h, W_down)

    x = A_x
    h = x + _A_ref(_layernorm(x, axis=-1), A_wqkv, A_w_phi, A_wo)
    h2 = h + _B_ref(_layernorm(h, axis=-1), B_W_gate, B_W_up, B_W_down)
    return h2
```

```asm
; @launch grid=(256,1,1) block=(256,1,1) lds=163840
.amdgcn_target "amdgcn-amd-amdhsa--gfx950"
.text
.globl sequential_preLN__linear_kernel_hedgehog__glu_gated_reglu__prompt_kernel
.p2align 8
.type sequential_preLN__linear_kernel_hedgehog__glu_gated_reglu__prompt_kernel,@function
sequential_preLN__linear_kernel_hedgehog__glu_gated_reglu__prompt_kernel:
    s_cmp_ge_u32 s2, 256
    s_cbranch_scc1 sequential_preLN__linear_kernel_hedgehog__glu_gated_reglu__prompt_kernel_end
    s_load_dwordx2 s[4:5], s[0:1], 0
    s_load_dwordx2 s[8:9], s[0:1], 8
    s_load_dwordx2 s[12:13], s[0:1], 16
    s_load_dwordx2 s[16:17], s[0:1], 24
    s_load_dwordx2 s[20:21], s[0:1], 40
    s_load_dwordx2 s[24:25], s[0:1], 48
    s_load_dwordx2 s[28:29], s[0:1], 56
    s_load_dwordx2 s[32:33], s[0:1], 64
    s_load_dwordx2 s[40:41], s[0:1], 72
    s_load_dwordx2 s[36:37], s[0:1], 80
    s_mov_b32 s6, 2359296
    s_mov_b32 s7, 0x20000
    s_mov_b32 s10, 1990656
    s_mov_b32 s11, 0x20000
    s_mov_b32 s14, 20736
    s_mov_b32 s15, 0x20000
    s_mov_b32 s18, 663552
    s_mov_b32 s19, 0x20000
    s_mov_b32 s22, 5308416
    s_mov_b32 s23, 0x20000
    s_mov_b32 s26, 5308416
    s_mov_b32 s27, 0x20000
    s_mov_b32 s30, 5308416
    s_mov_b32 s31, 0x20000
    s_mov_b32 s34, 2359296
    s_mov_b32 s35, 0x20000
    s_mov_b32 s38, 67108864
    s_mov_b32 s39, 0x20000
    s_mov_b32 s42, 256
    s_mov_b32 s43, 0x20000
    s_mov_b32 s46, 5308416
    s_mov_b32 s47, 0x20000
    v_lshrrev_b32 v1, 6, v0
    v_and_b32 v0, 63, v0
    v_readfirstlane_b32 s48, v1
    s_and_b32 s50, s2, 7
    s_lshr_b32 s51, s2, 3
    s_lshl_b32 s49, s48, 10
    s_lshl_b32 s52, s2, 9
    s_lshl_b32 s80, s48, 7
    s_add_u32 s52, s52, s80
    s_lshr_b32 s54, s50, 1
    s_and_b32 s55, s50, 1
    s_lshr_b32 s56, s51, 3
    s_and_b32 s57, s51, 7
    v_mov_b32 v139, v0
    v_lshlrev_b32 v234, 4, v0
    s_lshr_b32 s96, s50, 1
    s_lshl_b32 s96, s96, 2
    s_lshr_b32 s97, s51, 3
    s_add_u32 s58, s96, s97
    s_and_b32 s96, s50, 1
    s_lshl_b32 s96, s96, 3
    s_and_b32 s97, s51, 7
    s_add_u32 s59, s96, s97
    s_lshl_b32 s76, s48, 13
    s_mul_i32 s77, s48, 5120
    s_lshl_b32 s96, s58, 2
    s_add_u32 s96, s96, s48
    s_mul_i32 s86, s96, 36864
    s_movk_i32 s98, 1152
    v_lshrrev_b32 v208, 3, v139
    v_and_b32 v209, 7, v139
    v_lshrrev_b32 v210, 4, v139
    v_xor_b32 v209, v209, v210
    v_lshlrev_b32 v210, 4, v209
    v_mad_u32_u24 v128, v208, s98, v210
    v_xor_b32 v129, 64, v128
    v_add_u32 v129, 8192, v129
    s_mul_i32 s99, s59, 72
    s_and_b32 s99, s99, -16
    s_mul_i32 s97, s48, 110592
    s_add_u32 s87, s99, s97
    s_movk_i32 s98, 3456
    v_add_u32 v208, 0, v139
    v_mul_u32_u24 v209, 6554, v208
    v_lshrrev_b32 v209, 16, v209
    v_mul_u32_u24 v210, 10, v209
    v_sub_u32 v208, v208, v210
    v_bfe_u32 v210, v209, 2, 2
    v_lshlrev_b32 v210, 3, v210
    v_bfe_u32 v211, v209, 4, 1
    v_lshl_add_u32 v210, v211, 2, v210
    v_and_b32 v211, 3, v209
    v_add_u32 v210, v210, v211
    v_mul_lo_u32 v132, v210, s98
    v_lshl_add_u32 v132, v208, 4, v132
    v_cmp_lt_u32 vcc, 4, v208
    v_add_u32 v209, 1072, v132
    s_nop 0
    v_cndmask_b32 v132, v132, v209, vcc
    v_add_u32 v208, 64, v139
    v_mul_u32_u24 v209, 6554, v208
    v_lshrrev_b32 v209, 16, v209
    v_mul_u32_u24 v210, 10, v209
    v_sub_u32 v208, v208, v210
    v_bfe_u32 v210, v209, 2, 2
    v_lshlrev_b32 v210, 3, v210
    v_bfe_u32 v211, v209, 4, 1
    v_lshl_add_u32 v210, v211, 2, v210
    v_and_b32 v211, 3, v209
    v_add_u32 v210, v210, v211
    v_mul_lo_u32 v133, v210, s98
    v_lshl_add_u32 v133, v208, 4, v133
    v_cmp_lt_u32 vcc, 4, v208
    v_add_u32 v209, 1072, v133
    s_nop 0
    v_cndmask_b32 v133, v133, v209, vcc
    v_subrev_u32 v133, 1024, v133
    v_add_u32 v208, 128, v139
    v_mul_u32_u24 v209, 6554, v208
    v_lshrrev_b32 v209, 16, v209
    v_mul_u32_u24 v210, 10, v209
    v_sub_u32 v208, v208, v210
    v_bfe_u32 v210, v209, 2, 2
    v_lshlrev_b32 v210, 3, v210
    v_bfe_u32 v211, v209, 4, 1
    v_lshl_add_u32 v210, v211, 2, v210
    v_and_b32 v211, 3, v209
    v_add_u32 v210, v210, v211
    v_mul_lo_u32 v134, v210, s98
    v_lshl_add_u32 v134, v208, 4, v134
    v_cmp_lt_u32 vcc, 4, v208
    v_add_u32 v209, 1072, v134
    s_nop 0
    v_cndmask_b32 v134, v134, v209, vcc
    v_subrev_u32 v134, 2048, v134
    v_add_u32 v208, 192, v139
    v_mul_u32_u24 v209, 6554, v208
    v_lshrrev_b32 v209, 16, v209
    v_mul_u32_u24 v210, 10, v209
    v_sub_u32 v208, v208, v210
    v_bfe_u32 v210, v209, 2, 2
    v_lshlrev_b32 v210, 3, v210
    v_bfe_u32 v211, v209, 4, 1
    v_lshl_add_u32 v210, v211, 2, v210
    v_and_b32 v211, 3, v209
    v_add_u32 v210, v210, v211
    v_mul_lo_u32 v135, v210, s98
    v_lshl_add_u32 v135, v208, 4, v135
    v_cmp_lt_u32 vcc, 4, v208
    v_add_u32 v209, 1072, v135
    s_nop 0
    v_cndmask_b32 v135, v135, v209, vcc
    v_subrev_u32 v135, 3072, v135
    v_add_u32 v208, 256, v139
    v_mul_u32_u24 v209, 6554, v208
    v_lshrrev_b32 v209, 16, v209
    v_mul_u32_u24 v210, 10, v209
    v_sub_u32 v208, v208, v210
    v_bfe_u32 v210, v209, 2, 2
    v_lshlrev_b32 v210, 3, v210
    v_bfe_u32 v211, v209, 4, 1
    v_lshl_add_u32 v210, v211, 2, v210
    v_and_b32 v211, 3, v209
    v_add_u32 v210, v210, v211
    v_mul_lo_u32 v136, v210, s98
    v_lshl_add_u32 v136, v208, 4, v136
    v_cmp_lt_u32 vcc, 4, v208
    v_add_u32 v209, 1072, v136
    s_nop 0
    v_cndmask_b32 v136, v136, v209, vcc
    s_waitcnt lgkmcnt(0)
    s_cmp_gt_u32 s48, 1
    s_cbranch_scc1 sequential_preLN__linear_kernel_hedgehog__glu_gated_reglu__prompt_kernel_w_1
    s_mul_i32 s96, s59, 1296
    s_add_u32 s96, s96, s49
    s_add_u32 m0, s49, 159744
    s_nop 0
    buffer_load_dwordx4 v234, s[12:15], s96 offen lds
sequential_preLN__linear_kernel_hedgehog__glu_gated_reglu__prompt_kernel_w_1:
    s_xor_b32 s96, s51, s50
    s_and_b32 s96, s96, 1
    s_lshr_b32 s97, s51, 2
    s_or_b32 s96, s96, s97
    s_or_b32 s96, s96, s48
    s_lshl_b32 s97, s50, 1
    s_lshr_b32 s99, s51, 1
    s_add_u32 s97, s97, s99
    s_add_u32 s99, s97, 1
    s_cmp_eq_u32 s96, 0
    s_cselect_b32 s53, s99, 0
    s_cbranch_scc0 sequential_preLN__linear_kernel_hedgehog__glu_gated_reglu__prompt_kernel_w_5
    v_mov_b32 v4, 0
    v_lshlrev_b32 v1, 7, v0
    s_lshl_b32 s97, s97, 13
    buffer_store_dword v4, v1, s[36:39], s97 offen sc1
    s_mov_b32 s97, 40828928
    buffer_load_dword v233, off, s[36:39], s97 sc1
sequential_preLN__linear_kernel_hedgehog__glu_gated_reglu__prompt_kernel_w_5:
    s_lshr_b32 s97, s59, 3
    s_xor_b32 s97, s97, s59
    s_and_b32 s97, s97, 1
    s_cbranch_scc1 sequential_preLN__linear_kernel_hedgehog__glu_gated_reglu__prompt_kernel_w_4
    s_lshr_b32 s97, s51, 1
    s_lshl_b32 s97, s97, 2
    s_add_u32 s97, s97, s48
    s_mul_i32 s97, s97, 31104
    v_min_u32 v208, 26, v139
    v_mul_u32_u24 v208, 1152, v208
    buffer_load_dword v255, v208, s[8:11], s97 offen offset:512
sequential_preLN__linear_kernel_hedgehog__glu_gated_reglu__prompt_kernel_l4_7:
    s_cmp_eq_u32 s48, 3
    s_cbranch_scc1 sequential_preLN__linear_kernel_hedgehog__glu_gated_reglu__prompt_kernel_w_2
    s_cmp_eq_u32 s48, 2
    s_cbranch_scc1 sequential_preLN__linear_kernel_hedgehog__glu_gated_reglu__prompt_kernel_w_3
    s_cmp_eq_u32 s48, 1
    s_cbranch_scc1 sequential_preLN__linear_kernel_hedgehog__glu_gated_reglu__prompt_kernel_w_6
    v_min_u32 v208, 60, v139
    v_lshlrev_b32 v208, 7, v208
    s_xor_b32 s97, s2, 0
    s_mul_i32 s97, s97, 7808
    buffer_load_dword v255, v208, s[8:11], s97 offen offset:0
    s_xor_b32 s97, s2, 8
    s_mul_i32 s97, s97, 7808
    buffer_load_dword v255, v208, s[8:11], s97 offen offset:0
    s_branch sequential_preLN__linear_kernel_hedgehog__glu_gated_reglu__prompt_kernel_w_4
sequential_preLN__linear_kernel_hedgehog__glu_gated_reglu__prompt_kernel_w_6:
    v_lshrrev_b32 v208, 3, v139
    v_mul_u32_u24 v208, 1152, v208
    v_and_b32 v209, 7, v139
    v_min_u32 v209, 6, v209
    v_lshl_add_u32 v208, v209, 7, v208
    s_lshl_b32 s97, s58, 4
    s_add_u32 s97, s97, s59
    s_xor_b32 s97, s97, 0
    s_mul_i32 s97, s97, 9216
    buffer_load_dword v255, v208, s[4:7], s97 offen offset:256
    s_lshl_b32 s97, s58, 4
    s_add_u32 s97, s97, s59
    s_xor_b32 s97, s97, 1
    s_mul_i32 s97, s97, 9216
    buffer_load_dword v255, v208, s[4:7], s97 offen offset:256
    s_branch sequential_preLN__linear_kernel_hedgehog__glu_gated_reglu__prompt_kernel_w_4
sequential_preLN__linear_kernel_hedgehog__glu_gated_reglu__prompt_kernel_w_2:
    s_getpc_b64 s[100:101]
sequential_preLN__linear_kernel_hedgehog__glu_gated_reglu__prompt_kernel_pc:
    s_add_u32 s100, s100, sequential_preLN__linear_kernel_hedgehog__glu_gated_reglu__prompt_kernel_body-sequential_preLN__linear_kernel_hedgehog__glu_gated_reglu__prompt_kernel_pc
    s_addc_u32 s101, s101, 0
    s_lshr_b32 s97, s51, 1
    s_mul_i32 s97, s97, 4352
    v_min_u32 v208, 33, v139
    v_lshl_add_u32 v208, v208, 7, s97
    v_min_u32 v208, 65664, v208
    global_load_dword v255, v208, s[100:101]
    s_branch sequential_preLN__linear_kernel_hedgehog__glu_gated_reglu__prompt_kernel_w_4
sequential_preLN__linear_kernel_hedgehog__glu_gated_reglu__prompt_kernel_w_3:
    v_min_u32 v208, 20, v139
    v_lshlrev_b32 v208, 7, v208
    s_xor_b32 s97, s2, 0
    s_mul_i32 s97, s97, 2688
    buffer_load_dword v255, v208, s[16:19], s97 offen
    s_xor_b32 s97, s2, 8
    s_mul_i32 s97, s97, 2688
    buffer_load_dword v255, v208, s[16:19], s97 offen
sequential_preLN__linear_kernel_hedgehog__glu_gated_reglu__prompt_kernel_w_4:
    s_add_u32 m0, s76, 0
    s_add_u32 s96, s86, 0
    buffer_load_dwordx4 v128, s[4:7], s96 offen offset:0 lds
    buffer_load_dwordx4 v129, s[4:7], s96 offen offset:1024 lds
    s_add_u32 s96, s86, 16384
    buffer_load_dwordx4 v128, s[4:7], s96 offen offset:2048 lds
    buffer_load_dwordx4 v129, s[4:7], s96 offen offset:3072 lds
    s_add_u32 m0, s76, 4096
    s_add_u32 s96, s86, 128
    buffer_load_dwordx4 v128, s[4:7], s96 offen offset:0 lds
    buffer_load_dwordx4 v129, s[4:7], s96 offen offset:1024 lds
    s_add_u32 s96, s86, 16512
    buffer_load_dwordx4 v128, s[4:7], s96 offen offset:2048 lds
    buffer_load_dwordx4 v129, s[4:7], s96 offen offset:3072 lds
    s_add_u32 s96, s87, 1152
    s_add_u32 m0, s77, 32768
    s_nop 0
    buffer_load_dwordx4 v132, s[8:11], s96 offen offset:0 lds
    buffer_load_dwordx4 v133, s[8:11], s96 offen offset:1024 lds
    buffer_load_dwordx4 v134, s[8:11], s96 offen offset:2048 lds
    buffer_load_dwordx4 v135, s[8:11], s96 offen offset:3072 lds
    s_add_u32 m0, s77, 36864
    s_nop 0
    buffer_load_dwordx4 v136, s[8:11], s96 offen offset:0 lds
    s_branch sequential_preLN__linear_kernel_hedgehog__glu_gated_reglu__prompt_kernel_body
.p2align 12
sequential_preLN__linear_kernel_hedgehog__glu_gated_reglu__prompt_kernel_body:
    v_and_b32 v208, 15, v139
    v_lshrrev_b32 v209, 4, v139
    v_lshrrev_b32 v210, 1, v208
    v_xor_b32 v209, v209, v210
    v_lshlrev_b32 v208, 7, v208
    v_lshl_add_u32 v208, v209, 4, v208
    v_add_u32 v130, s76, v208
    v_xor_b32 v131, 64, v130
    v_lshrrev_b32 v208, 2, v139
    v_mul_u32_u24 v208, 160, v208
    s_and_b32 s97, s59, 1
    s_lshl_b32 s97, s97, 3
    v_add_u32 v208, s97, v208
    v_and_b32 v209, 3, v139
    v_lshl_add_u32 v137, v209, 3, v208
    v_cmp_eq_u32 vcc, 1, v209
    v_add_u32 v210, 32, v208
    v_add_u32 v211, 112, v208
    v_cndmask_b32 v138, v210, v211, vcc
    v_mov_b32 v76, 0x3f803f80
    v_mov_b32 v77, 0x3f803f80
    v_mov_b32 v78, 0x3f803f80
    v_mov_b32 v79, 0x3f803f80
    s_mul_i32 s97, s48, 40
    v_add_u32 v251, s97, v137
    s_movk_i32 s98, 3456
    v_add_u32 v208, 0, v139
    v_mul_u32_u24 v209, 13108, v208
    v_lshrrev_b32 v209, 16, v209
    v_mul_u32_u24 v210, 5, v209
    v_sub_u32 v208, v208, v210
    v_bfe_u32 v210, v209, 2, 2
    v_lshlrev_b32 v210, 3, v210
    v_bfe_u32 v211, v209, 4, 1
    v_lshl_add_u32 v210, v211, 2, v210
    v_and_b32 v211, 3, v209
    v_add_u32 v210, v210, v211
    v_and_b32 v211, 32, v209
    v_add_u32 v210, v210, v211
    v_mul_lo_u32 v235, v210, s98
    v_lshl_add_u32 v235, v208, 4, v235
    v_add_u32 v208, 64, v139
    v_mul_u32_u24 v209, 13108, v208
    v_lshrrev_b32 v209, 16, v209
    v_mul_u32_u24 v210, 5, v209
    v_sub_u32 v208, v208, v210
    v_bfe_u32 v210, v209, 2, 2
    v_lshlrev_b32 v210, 3, v210
    v_bfe_u32 v211, v209, 4, 1
    v_lshl_add_u32 v210, v211, 2, v210
    v_and_b32 v211, 3, v209
    v_add_u32 v210, v210, v211
    v_and_b32 v211, 32, v209
    v_add_u32 v210, v210, v211
    v_mul_lo_u32 v236, v210, s98
    v_lshl_add_u32 v236, v208, 4, v236
    v_subrev_u32 v236, 1024, v236
    v_add_u32 v208, 128, v139
    v_mul_u32_u24 v209, 13108, v208
    v_lshrrev_b32 v209, 16, v209
    v_mul_u32_u24 v210, 5, v209
    v_sub_u32 v208, v208, v210
    v_bfe_u32 v210, v209, 2, 2
    v_lshlrev_b32 v210, 3, v210
    v_bfe_u32 v211, v209, 4, 1
    v_lshl_add_u32 v210, v211, 2, v210
    v_and_b32 v211, 3, v209
    v_add_u32 v210, v210, v211
    v_and_b32 v211, 32, v209
    v_add_u32 v210, v210, v211
    v_mul_lo_u32 v237, v210, s98
    v_lshl_add_u32 v237, v208, 4, v237
    v_subrev_u32 v237, 2048, v237
    v_add_u32 v208, 192, v139
    v_mul_u32_u24 v209, 13108, v208
    v_lshrrev_b32 v209, 16, v209
    v_mul_u32_u24 v210, 5, v209
    v_sub_u32 v208, v208, v210
    v_bfe_u32 v210, v209, 2, 2
    v_lshlrev_b32 v210, 3, v210
    v_bfe_u32 v211, v209, 4, 1
    v_lshl_add_u32 v210, v211, 2, v210
    v_and_b32 v211, 3, v209
    v_add_u32 v210, v210, v211
    v_and_b32 v211, 32, v209
    v_add_u32 v210, v210, v211
    v_mul_lo_u32 v238, v210, s98
    v_lshl_add_u32 v238, v208, 4, v238
    v_subrev_u32 v238, 3072, v238
    v_add_u32 v208, 256, v139
    v_mul_u32_u24 v209, 13108, v208
    v_lshrrev_b32 v209, 16, v209
    v_mul_u32_u24 v210, 5, v209
    v_sub_u32 v208, v208, v210
    v_bfe_u32 v210, v209, 2, 2
    v_lshlrev_b32 v210, 3, v210
    v_bfe_u32 v211, v209, 4, 1
    v_lshl_add_u32 v210, v211, 2, v210
    v_and_b32 v211, 3, v209
    v_add_u32 v210, v210, v211
    v_and_b32 v211, 32, v209
    v_add_u32 v210, v210, v211
    v_mul_lo_u32 v239, v210, s98
    v_lshl_add_u32 v239, v208, 4, v239
    s_lshl_b32 s97, s48, 6
    v_add_u32 v208, s97, v139
    v_mul_u32_u24 v209, 13108, v208
    v_lshrrev_b32 v209, 16, v209
    v_mul_u32_u24 v210, 5, v209
    v_sub_u32 v208, v208, v210
    v_bfe_u32 v210, v209, 2, 2
    v_lshlrev_b32 v210, 3, v210
    v_bfe_u32 v211, v209, 4, 1
    v_lshl_add_u32 v210, v211, 2, v210
    v_and_b32 v211, 3, v209
    v_add_u32 v210, v210, v211
    v_and_b32 v211, 32, v209
    v_add_u32 v210, v210, v211
    v_mul_lo_u32 v248, v210, s98
    v_lshl_add_u32 v248, v208, 4, v248
    v_and_b32 v208, 15, v139
    v_lshrrev_b32 v209, 2, v208
    v_lshrrev_b32 v210, 4, v139
    v_cmp_eq_u32 s[80:81], v209, v210
    v_and_b32 v209, 1, v208
    v_cmp_eq_u32 s[82:83], 1, v209
    v_and_b32 v209, 2, v208
    v_cmp_eq_u32 s[84:85], 2, v209
    s_lshl_b32 s97, s48, 7
    s_add_u32 s97, s97, 162048
    v_lshl_add_u32 v254, v208, 2, s97
    s_lshl_b32 s97, s48, 5
    v_add_u32 v209, s97, v208
    v_mul_u32_u24 v209, 288, v209
    v_mad_u32_u24 v240, v210, 48, v209
    v_lshl_add_u32 v241, v210, 3, v209
    v_lshrrev_b32 v211, 2, v139
    v_mul_u32_u24 v211, 288, v211
    v_and_b32 v209, 3, v139
    v_lshl_add_u32 v211, v209, 3, v211
    s_lshr_b32 s99, s48, 1
    s_mul_i32 s97, s99, 96
    v_add_u32 v242, s97, v211
    s_lshl_b32 s97, s99, 5
    s_and_b32 s98, s48, 1
    s_cmp_eq_u32 s98, 1
    s_cselect_b32 s97, 64, s97
    v_add_u32 v243, s97, v211
    s_lshl_b32 s97, s99, 1
    v_add_u32 v209, s97, v208
    s_mul_i32 s97, s99, 18
    s_sub_u32 s97, 12, s97
    v_add_u32 v210, s97, v208
    s_lshl_b32 s97, s99, 1
    s_add_u32 s97, s97, 4
    v_subrev_u32 v211, s97, v208
    v_cmp_gt_u32 vcc, 2, v211
    v_mov_b32 v211, 0x100000
    s_nop 0
    v_cndmask_b32 v210, v211, v210, vcc
    v_cmp_ne_u32 vcc, 8, v208
    s_nop 1
    v_cndmask_b32 v210, 18, v210, vcc
    s_cmp_eq_u32 s98, 1
    s_cselect_b64 vcc, -1, 0
    v_cndmask_b32 v209, v209, v210, vcc
    s_mul_i32 s97, s99, 19
    v_add_u32 v209, s97, v209
    v_mul_u32_u24 v209, 96, v209
    v_lshrrev_b32 v210, 4, v139
    v_lshl_add_u32 v253, v210, 3, v209
    s_lshl_b32 s97, s59, 4
    s_add_u32 s97, s97, s58
    s_lshl_b32 s97, s97, 12
    s_add_u32 s78, s97, 131072
    v_mov_b32 v150, 0
    v_mov_b32 v151, 0
    v_mov_b32 v187, 0
    v_mov_b32 v191, 0
    v_mov_b32 v195, 0
    v_mov_b32 v158, 0
    v_mov_b32 v159, 0
    v_mov_b32 v199, 0
    v_mov_b32 v203, 0
    v_mov_b32 v207, 0
    v_lshrrev_b32 v210, 4, v139
    v_lshlrev_b32 v210, 4, v210
    v_add_u32 v250, 162560, v210
    s_lshl_b32 s97, s48, 6
    v_add_u32 v252, s97, v250
    s_lshl_b32 s89, s48, 3
    v_lshrrev_b32 v226, 3, v139
    v_add_u32 v226, s89, v226
    v_and_b32 v227, 6, v226
    v_and_b32 v228, 7, v139
    v_xor_b32 v227, v227, v228
    v_lshlrev_b32 v227, 4, v227
    v_bfe_u32 v228, v226, 2, 2
    v_lshlrev_b32 v228, 3, v228
    v_bfe_u32 v229, v226, 4, 1
    v_lshl_add_u32 v228, v229, 2, v228
    v_and_b32 v229, 3, v226
    v_add_u32 v228, v228, v229
    v_lshrrev_b32 v229, 2, v139
    v_bfe_u32 v249, v229, 1, 2
    v_xor_b32 v249, s48, v249
    v_lshlrev_b32 v249, 5, v249
    v_lshl_add_u32 v249, v229, 7, v249
    v_and_b32 v229, 3, v139
    v_lshl_add_u32 v249, v229, 3, v249
    v_add_u32 v249, 57344, v249
    s_add_u32 s89, s2, 0
    s_mov_b32 s46, 5308416
    s_mul_i32 s97, s89, 3641
    s_lshr_b32 s97, s97, 16
    s_mul_i32 s98, s97, 18
    s_sub_u32 s89, s89, s98
    s_and_b32 s98, s97, 1
    s_cmp_eq_u32 s98, 0
    s_cselect_b32 s44, s20, s24
    s_cselect_b32 s45, s21, s25
    s_lshl_b32 s99, s89, 1
    s_add_u32 s98, s98, s99
    s_lshr_b32 s97, s97, 1
    s_lshl_b32 s99, s97, 2
    s_add_u32 s99, s99, s48
    s_mul_i32 s99, s99, 36
    s_add_u32 s98, s98, s99
    s_lshl_b32 s98, s98, 10
    s_add_u32 s79, s98, 38797312
    s_lshr_b32 s98, s97, 1
    s_mul_i32 s98, s98, 2304
    s_and_b32 s97, s97, 1
    s_lshl_b32 s97, s97, 7
    s_add_u32 s97, s97, s98
    s_add_u32 s97, s97, 2048
    s_cmp_lt_u32 s89, 16
    s_cselect_b64 vcc, -1, 0
    s_mul_i32 s98, s89, 294912
    s_add_u32 s97, s97, s98
    v_cndmask_b32 v246, v228, v226, vcc
    v_mul_u32_u24 v246, 9216, v246
    v_add_u32 v246, v246, v227
    v_add_u32 v246, s97, v246
    s_add_u32 s89, s2, 256
    s_mov_b32 s14, 5308416
    s_cmp_lt_u32 s89, 432
    s_cbranch_scc1 rp_w_12
    s_sub_u32 s89, s89, 432
    s_mul_i32 s98, s48, 18
    s_add_u32 s98, s98, s89
    s_lshl_b32 s98, s98, 10
    s_add_u32 s98, s98, 40697856
    s_cmp_lt_u32 s89, 18
    s_cselect_b32 s3, s98, 0x7000000
    s_mov_b32 s12, s16
    s_mov_b32 s13, s17
    s_mov_b32 s14, 663552
    v_lshrrev_b32 v231, 4, v226
    v_and_b32 v229, 3, v226
    v_lshl_add_u32 v231, v231, 2, v229
    v_bfe_u32 v229, v226, 2, 2
    v_lshl_add_u32 v247, v229, 3, v231
    v_lshrrev_b32 v230, 1, v229
    v_lshl_add_u32 v247, v230, 1, v247
    v_lshrrev_b32 v230, 1, v231
    v_lshl_add_u32 v230, v229, 2, v230
    v_mul_u32_u24 v230, 18, v230
    v_and_b32 v231, 1, v231
    v_add3_u32 v230, v230, v231, 16
    s_mul_i32 s97, s89, 36
    s_sub_u32 s98, s89, 16
    s_mul_i32 s98, s98, 288
    s_cmp_lt_u32 s89, 16
    s_cselect_b32 s97, s97, s98
    s_cselect_b64 vcc, -1, 0
    s_mul_i32 s97, s97, 1152
    s_add_u32 s97, s97, 1024
    v_cndmask_b32 v247, v230, v247, vcc
    v_mul_u32_u24 v247, 1152, v247
    v_add_u32 v247, v247, v227
    s_branch rp_d_11
rp_w_12:
    s_cmp_lt_u32 s89, 288
    s_cbranch_scc1 rp_n_10
    s_sub_u32 s89, s89, 288
    s_mul_i32 s97, s89, 36864
    s_add_u32 s97, s97, 1024
    s_mul_i32 s98, s48, 147456
    s_lshl_b32 s99, s89, 10
    s_add_u32 s98, s98, s99
    s_add_u32 s98, s98, 40108032
    s_cmp_lt_u32 s89, 144
    s_cselect_b32 s3, s98, 0x7000000
    s_mov_b32 s12, s28
    s_mov_b32 s13, s29
    v_mul_u32_u24 v247, 1152, v226
    v_add_u32 v247, v247, v227
    s_branch rp_d_11
rp_n_10:
    s_mul_i32 s97, s89, 3641
    s_lshr_b32 s97, s97, 16
    s_mul_i32 s98, s97, 18
    s_sub_u32 s89, s89, s98
    s_and_b32 s98, s97, 1
    s_cmp_eq_u32 s98, 0
    s_cselect_b32 s12, s20, s24
    s_cselect_b32 s13, s21, s25
    s_lshl_b32 s99, s89, 1
    s_add_u32 s98, s98, s99
    s_lshr_b32 s97, s97, 1
    s_lshl_b32 s99, s97, 2
    s_add_u32 s99, s99, s48
    s_mul_i32 s99, s99, 36
    s_add_u32 s98, s98, s99
    s_lshl_b32 s98, s98, 10
    s_add_u32 s3, s98, 38797312
    s_lshr_b32 s98, s97, 1
    s_mul_i32 s98, s98, 2304
    s_and_b32 s97, s97, 1
    s_lshl_b32 s97, s97, 7
    s_add_u32 s97, s97, s98
    s_add_u32 s97, s97, 2048
    s_cmp_lt_u32 s89, 16
    s_cselect_b64 vcc, -1, 0
    s_mul_i32 s98, s89, 294912
    s_add_u32 s97, s97, s98
    v_cndmask_b32 v247, v228, v226, vcc
    v_mul_u32_u24 v247, 9216, v247
    v_add_u32 v247, v247, v227
rp_d_11:
    v_add_u32 v247, s97, v247
    s_add_u32 m0, s76, 53248
    s_add_u32 s96, s86, 256
    buffer_load_dwordx4 v128, s[4:7], s96 offen offset:0 lds
    buffer_load_dwordx4 v129, s[4:7], s96 offen offset:1024 lds
    s_add_u32 s96, s86, 16640
    buffer_load_dwordx4 v128, s[4:7], s96 offen offset:2048 lds
    buffer_load_dwordx4 v129, s[4:7], s96 offen offset:3072 lds
    s_add_u32 m0, s76, 57344
    s_add_u32 s96, s86, 384
    buffer_load_dwordx4 v128, s[4:7], s96 offen offset:0 lds
    buffer_load_dwordx4 v129, s[4:7], s96 offen offset:1024 lds
    s_add_u32 s96, s86, 16768
    buffer_load_dwordx4 v128, s[4:7], s96 offen offset:2048 lds
    buffer_load_dwordx4 v129, s[4:7], s96 offen offset:3072 lds
    s_add_u32 s96, s87, 443520
    s_add_u32 m0, s77, 86016
    s_nop 0
    buffer_load_dwordx4 v132, s[8:11], s96 offen offset:0 lds
    buffer_load_dwordx4 v133, s[8:11], s96 offen offset:1024 lds
    buffer_load_dwordx4 v134, s[8:11], s96 offen offset:2048 lds
    buffer_load_dwordx4 v135, s[8:11], s96 offen offset:3072 lds
    s_add_u32 m0, s77, 90112
    s_nop 0
    buffer_load_dwordx4 v136, s[8:11], s96 offen offset:0 lds
    s_mov_b64 exec, 0
    s_branch sequential_preLN__linear_kernel_hedgehog__glu_gated_reglu__prompt_kernel_hop0_0
sequential_preLN__linear_kernel_hedgehog__glu_gated_reglu__prompt_kernel_hopback0:
    s_mov_b64 exec, -1
    s_waitcnt vmcnt(13)
    s_barrier
    s_cmp_eq_u32 s53, 0
    s_cbranch_scc1 sequential_preLN__linear_kernel_hedgehog__glu_gated_reglu__prompt_kernel_nr_13
    v_add_u32 v208, 1, v233
    v_max_u32 v208, 1, v208
    s_lshl_b32 s96, s53, 2
    s_sub_u32 s96, s96, 4
    s_mov_b64 exec, 1
    buffer_store_dword v208, off, s[40:43], s96 sc1
    s_mov_b32 s96, 0x7000000
    s_cmp_eq_u32 s53, 1
    s_cselect_b32 s96, 40828928, s96
    buffer_store_dword v208, off, s[36:39], s96 sc1
    s_mov_b64 exec, -1
sequential_preLN__linear_kernel_hedgehog__glu_gated_reglu__prompt_kernel_nr_13:
    ds_read_b128 a[0:3], v130 offset:0
    ds_read_b128 a[4:7], v130 offset:2048
    ds_read_b64_tr_b16 v[80:81], v137 offset:32768
    ds_read_b64_tr_b16 v[82:83], v137 offset:35328
    ds_read_b64_tr_b16 v[84:85], v137 offset:32808
    ds_read_b64_tr_b16 v[86:87], v137 offset:35368
    ds_read_b64_tr_b16 v[88:89], v138 offset:32768
    ds_read_b64_tr_b16 v[90:91], v138 offset:35328
    ds_read_b64_tr_b16 v[92:93], v137 offset:32848
    ds_read_b64_tr_b16 v[94:95], v137 offset:35408
    s_waitcnt lgkmcnt(4)
    v_mfma_f32_16x16x32_bf16 v[0:3], v[80:83], a[0:3], 0
    ds_read_b64_tr_b16 v[96:97], v137 offset:32888
    ds_read_b64_tr_b16 v[98:99], v137 offset:35448
    v_mfma_f32_16x16x32_bf16 v[4:7], v[80:83], a[4:7], 0
    ds_read_b64_tr_b16 v[100:101], v251 offset:32768
    ds_read_b64_tr_b16 v[102:103], v251 offset:35328
    v_mfma_f32_16x16x32_bf16 v[12:15], v[84:87], a[0:3], 0
    s_add_u32 m0, s76, 106496
    s_add_u32 s96, s86, 512
    buffer_load_dwordx4 v128, s[4:7], s96 offen offset:0 lds
    v_mfma_f32_16x16x32_bf16 v[16:19], v[84:87], a[4:7], 0
    v_mfma_f32_16x16x32_bf16 v[60:63], v[76:79], a[0:3], 0
    buffer_load_dwordx4 v129, s[4:7], s96 offen offset:1024 lds
    v_bfe_u32 v208, v139, 3, 1
    v_mfma_f32_16x16x32_bf16 v[68:71], a[0:3], a[0:3], 0
    ds_read_b128 a[8:11], v131 offset:0
    ds_read_b128 a[12:15], v131 offset:2048
    s_waitcnt lgkmcnt(6)
    v_mfma_f32_16x16x32_bf16 v[24:27], v[88:91], a[0:3], 0
    ds_read_b64_tr_b16 v[80:81], v137 offset:37888
    ds_read_b64_tr_b16 v[82:83], v137 offset:40448
    v_mfma_f32_16x16x32_bf16 v[28:31], v[88:91], a[4:7], 0
    v_cmp_eq_u32 s[90:91], 1, v208
    v_bfe_u32 v209, v139, 2, 1
    v_mfma_f32_16x16x32_bf16 v[32:35], v[88:91], v[76:79], 0
    ds_read_b64_tr_b16 v[84:85], v137 offset:37928
    ds_read_b64_tr_b16 v[86:87], v137 offset:40488
    v_mfma_f32_16x16x32_bf16 v[36:39], v[92:95], a[0:3], 0
    s_add_u32 s96, s86, 16896
    buffer_load_dwordx4 v128, s[4:7], s96 offen offset:2048 lds
    v_mfma_f32_16x16x32_bf16 v[40:43], v[92:95], a[4:7], 0
    v_mul_u32_u24 v209, 18, v209
    v_and_b32 v210, 3, v139
    v_mfma_f32_16x16x32_bf16 v[64:67], v[76:79], a[4:7], 0
    v_cmp_eq_u32 s[92:93], 0, v210
    v_lshl_add_u32 v209, v210, 1, v209
    v_mfma_f32_16x16x32_bf16 v[72:75], a[4:7], a[4:7], 0
    ds_read_b64_tr_b16 v[88:89], v138 offset:37888
    ds_read_b64_tr_b16 v[90:91], v138 offset:40448
    s_waitcnt lgkmcnt(8)
    v_mfma_f32_16x16x32_bf16 v[48:51], v[96:99], a[0:3], 0
    buffer_load_dwordx4 v129, s[4:7], s96 offen offset:3072 lds
    v_add_u32 v209, 159744, v209
    v_mfma_f32_16x16x32_bf16 v[52:55], v[96:99], a[4:7], 0
    ds_read_b64_tr_b16 v[92:93], v137 offset:37968
    ds_read_b64_tr_b16 v[94:95], v137 offset:40528
    v_mfma_f32_16x16x32_bf16 v[8:11], v[100:103], v[76:79], 0
    ds_read_b64_tr_b16 v[96:97], v137 offset:38008
    ds_read_b64_tr_b16 v[98:99], v137 offset:40568
    s_waitcnt lgkmcnt(6)
    v_mfma_f32_16x16x32_bf16 v[0:3], v[80:83], a[8:11], v[0:3]
    s_add_u32 m0, s76, 110592
    s_add_u32 s96, s86, 640
    buffer_load_dwordx4 v128, s[4:7], s96 offen offset:0 lds
    v_mfma_f32_16x16x32_bf16 v[4:7], v[80:83], a[12:15], v[4:7]
    ds_read_b64_tr_b16 v[100:101], v251 offset:37888
    ds_read_b64_tr_b16 v[102:103], v251 offset:40448
    v_mfma_f32_16x16x32_bf16 v[12:15], v[84:87], a[8:11], v[12:15]
    v_lshrrev_b32 v210, 4, v139
    v_cmp_eq_u32 s[94:95], 0, v210
    v_mfma_f32_16x16x32_bf16 v[16:19], v[84:87], a[12:15], v[16:19]
    v_mul_u32_u24 v210, 144, v210
    v_mul_u32_u24 v211, 720, v208
    v_mfma_f32_16x16x32_bf16 v[60:63], v[76:79], a[8:11], v[60:63]
    buffer_load_dwordx4 v129, s[4:7], s96 offen offset:1024 lds
    v_add3_u32 v210, v210, v211, v209
    v_mfma_f32_16x16x32_bf16 v[68:71], a[8:11], a[8:11], v[68:71]
    ds_read_b128 a[16:19], v130 offset:4096
    ds_read_b128 a[20:23], v130 offset:6144
    s_waitcnt lgkmcnt(6)
    v_mfma_f32_16x16x32_bf16 v[24:27], v[88:91], a[8:11], v[24:27]
    ds_read_b64_tr_b16 v[80:81], v137 offset:43008
    ds_read_b64_tr_b16 v[82:83], v137 offset:45568
    v_mfma_f32_16x16x32_bf16 v[28:31], v[88:91], a[12:15], v[28:31]
    v_mul_u32_u24 v211, 72, v208
    v_add_u32 v211, v211, v209
    v_mfma_f32_16x16x32_bf16 v[32:35], v[88:91], v[76:79], v[32:35]
    ds_read_b64_tr_b16 v[84:85], v137 offset:43048
    ds_read_b64_tr_b16 v[86:87], v137 offset:45608
    v_mfma_f32_16x16x32_bf16 v[36:39], v[92:95], a[8:11], v[36:39]
    s_add_u32 s96, s86, 17024
    buffer_load_dwordx4 v128, s[4:7], s96 offen offset:2048 lds
    v_mfma_f32_16x16x32_bf16 v[40:43], v[92:95], a[12:15], v[40:43]
    ds_read_u16 v160, v210 offset:0
    ds_read_u16 v161, v210 offset:36
    v_mfma_f32_16x16x32_bf16 v[64:67], v[76:79], a[12:15], v[64:67]
    ds_read_u16 v162, v210 offset:72
    ds_read_u16 v163, v210 offset:108
    v_mfma_f32_16x16x32_bf16 v[72:75], a[12:15], a[12:15], v[72:75]
    ds_read_b64_tr_b16 v[88:89], v138 offset:43008
    ds_read_b64_tr_b16 v[90:91], v138 offset:45568
    s_waitcnt lgkmcnt(12)
    v_mfma_f32_16x16x32_bf16 v[48:51], v[96:99], a[8:11], v[48:51]
    buffer_load_dwordx4 v129, s[4:7], s96 offen offset:3072 lds
    ds_read_u16 v164, v211 offset:576
    v_mfma_f32_16x16x32_bf16 v[52:55], v[96:99], a[12:15], v[52:55]
    ds_read_b64_tr_b16 v[92:93], v137 offset:43088
    ds_read_b64_tr_b16 v[94:95], v137 offset:45648
    v_mfma_f32_16x16x32_bf16 v[8:11], v[100:103], v[76:79], v[8:11]
    ds_read_b64_tr_b16 v[96:97], v137 offset:43128
    ds_read_b64_tr_b16 v[98:99], v137 offset:45688
    s_waitcnt lgkmcnt(11)
    v_mfma_f32_16x16x32_bf16 v[0:3], v[80:83], a[16:19], v[0:3]
    s_add_u32 s96, s87, 885888
    s_add_u32 m0, s77, 139264
    s_nop 0
    buffer_load_dwordx4 v132, s[8:11], s96 offen offset:0 lds
    v_mfma_f32_16x16x32_bf16 v[4:7], v[80:83], a[20:23], v[4:7]
    ds_read_b64_tr_b16 v[100:101], v251 offset:43008
    ds_read_b64_tr_b16 v[102:103], v251 offset:45568
    v_mfma_f32_16x16x32_bf16 v[12:15], v[84:87], a[16:19], v[12:15]
    ds_read_u16 v165, v211 offset:612
    ds_read_u16 v166, v210 offset:8
    v_mfma_f32_16x16x32_bf16 v[16:19], v[84:87], a[20:23], v[16:19]
    ds_read_u16 v167, v210 offset:44
    ds_read_u16 v168, v210 offset:80
    v_mfma_f32_16x16x32_bf16 v[60:63], v[76:79], a[16:19], v[60:63]
    buffer_load_dwordx4 v133, s[8:11], s96 offen offset:1024 lds
    ds_read_u16 v169, v210 offset:116
    v_mfma_f32_16x16x32_bf16 v[68:71], a[16:19], a[16:19], v[68:71]
    ds_read_b128 a[24:27], v131 offset:4096
    ds_read_b128 a[28:31], v131 offset:6144
    s_waitcnt lgkmcnt(11)
    v_mfma_f32_16x16x32_bf16 v[24:27], v[88:91], a[16:19], v[24:27]
    ds_read_b64_tr_b16 v[80:81], v137 offset:48128
    ds_read_b64_tr_b16 v[82:83], v137 offset:50688
    v_mfma_f32_16x16x32_bf16 v[28:31], v[88:91], a[20:23], v[28:31]
    ds_read_u16 v170, v211 offset:584
    ds_read_u16 v171, v211 offset:620
    v_mfma_f32_16x16x32_bf16 v[32:35], v[88:91], v[76:79], v[32:35]
    ds_read_b64_tr_b16 v[84:85], v137 offset:48168
    ds_read_b64_tr_b16 v[86:87], v137 offset:50728
    v_mfma_f32_16x16x32_bf16 v[36:39], v[92:95], a[16:19], v[36:39]
    buffer_load_dwordx4 v134, s[8:11], s96 offen offset:2048 lds
    ds_read_u16 v172, v210 offset:16
    v_mfma_f32_16x16x32_bf16 v[40:43], v[92:95], a[20:23], v[40:43]
    ds_read_u16 v173, v210 offset:52
    ds_read_u16 v174, v210 offset:88
    v_mfma_f32_16x16x32_bf16 v[64:67], v[76:79], a[20:23], v[64:67]
    ds_read_u16 v175, v210 offset:124
    ds_read_u16 v176, v211 offset:592
    v_mfma_f32_16x16x32_bf16 v[72:75], a[20:23], a[20:23], v[72:75]
    ds_read_b64_tr_b16 v[88:89], v138 offset:48128
    ds_read_b64_tr_b16 v[90:91], v138 offset:50688
    s_waitcnt lgkmcnt(14)
    v_mfma_f32_16x16x32_bf16 v[48:51], v[96:99], a[16:19], v[48:51]
    buffer_load_dwordx4 v135, s[8:11], s96 offen offset:3072 lds
    ds_read_u16 v177, v211 offset:628
    v_mfma_f32_16x16x32_bf16 v[52:55], v[96:99], a[20:23], v[52:55]
    ds_read_b64_tr_b16 v[92:93], v137 offset:48208
    ds_read_b64_tr_b16 v[94:95], v137 offset:50768
    v_mfma_f32_16x16x32_bf16 v[8:11], v[100:103], v[76:79], v[8:11]
    ds_read_b64_tr_b16 v[96:97], v137 offset:48248
    ds_read_b64_tr_b16 v[98:99], v137 offset:50808
    s_waitcnt lgkmcnt(12)
    v_mfma_f32_16x16x32_bf16 v[0:3], v[80:83], a[24:27], v[0:3]
    s_add_u32 m0, s77, 143360
    s_nop 0
    buffer_load_dwordx4 v136, s[8:11], s96 offen offset:0 lds
    v_mfma_f32_16x16x32_bf16 v[4:7], v[80:83], a[28:31], v[4:7]
    ds_read_b64_tr_b16 v[100:101], v251 offset:48128
    ds_read_b64_tr_b16 v[102:103], v251 offset:50688
    v_mfma_f32_16x16x32_bf16 v[12:15], v[84:87], a[24:27], v[12:15]
    v_lshl_or_b32 v212, v161, 16, v160
    v_lshl_or_b32 v213, v163, 16, v162
    v_mfma_f32_16x16x32_bf16 v[16:19], v[84:87], a[28:31], v[16:19]
    v_lshl_or_b32 v214, v165, 16, v164
    v_lshl_or_b32 v215, v167, 16, v166
    v_mfma_f32_16x16x32_bf16 v[60:63], v[76:79], a[24:27], v[60:63]
    v_lshl_or_b32 v216, v169, 16, v168
    v_lshl_or_b32 v217, v171, 16, v170
    v_mfma_f32_16x16x32_bf16 v[68:71], a[24:27], a[24:27], v[68:71]
    s_waitcnt vmcnt(13)
    s_waitcnt lgkmcnt(0)
    s_barrier
    v_mfma_f32_16x16x32_bf16 v[24:27], v[88:91], a[24:27], v[24:27]
    v_add_u32 v130, 53248, v130
    v_add_u32 v131, 53248, v131
    v_mfma_f32_16x16x32_bf16 v[28:31], v[88:91], a[28:31], v[28:31]
    ds_read_b128 a[32:35], v130 offset:0
    ds_read_b128 a[36:39], v130 offset:2048
    v_mfma_f32_16x16x32_bf16 v[32:35], v[88:91], v[76:79], v[32:35]
    v_add_u32 v137, 86016, v137
    v_add_u32 v138, 86016, v138
    v_mfma_f32_16x16x32_bf16 v[36:39], v[92:95], a[24:27], v[36:39]
    v_add_u32 v251, 86016, v251
    ds_read_b64_tr_b16 v[80:81], v137 offset:0
    v_mfma_f32_16x16x32_bf16 v[40:43], v[92:95], a[28:31], v[40:43]
    ds_read_b64_tr_b16 v[82:83], v137 offset:2560
    ds_read_b64_tr_b16 v[84:85], v137 offset:40
    v_mfma_f32_16x16x32_bf16 v[64:67], v[76:79], a[28:31], v[64:67]
    ds_read_b64_tr_b16 v[86:87], v137 offset:2600
    s_add_u32 m0, s76, 0
    s_add_u32 s96, s86, 768
    buffer_load_dwordx4 v128, s[4:7], s96 offen offset:0 lds
    v_mfma_f32_16x16x32_bf16 v[72:75], a[28:31], a[28:31], v[72:75]
    ds_read_b64_tr_b16 v[88:89], v138 offset:0
    ds_read_b64_tr_b16 v[90:91], v138 offset:2560
    v_mfma_f32_16x16x32_bf16 v[48:51], v[96:99], a[24:27], v[48:51]
    buffer_load_dwordx4 v129, s[4:7], s96 offen offset:1024 lds
    v_lshl_or_b32 v218, v173, 16, v172
    v_mfma_f32_16x16x32_bf16 v[52:55], v[96:99], a[28:31], v[52:55]
    ds_read_b64_tr_b16 v[92:93], v137 offset:80
    ds_read_b64_tr_b16 v[94:95], v137 offset:2640
    v_mfma_f32_16x16x32_bf16 v[8:11], v[100:103], v[76:79], v[8:11]
    ds_read_b64_tr_b16 v[96:97], v137 offset:120
    ds_read_b64_tr_b16 v[98:99], v137 offset:2680
    s_waitcnt lgkmcnt(6)
    v_mfma_f32_16x16x32_bf16 v[0:3], v[80:83], a[32:35], v[0:3]
    s_add_u32 s96, s86, 17152
    buffer_load_dwordx4 v128, s[4:7], s96 offen offset:2048 lds
    v_mfma_f32_16x16x32_bf16 v[4:7], v[80:83], a[36:39], v[4:7]
    ds_read_b64_tr_b16 v[100:101], v251 offset:0
    ds_read_b64_tr_b16 v[102:103], v251 offset:2560
    v_mfma_f32_16x16x32_bf16 v[12:15], v[84:87], a[32:35], v[12:15]
    v_lshl_or_b32 v219, v175, 16, v174
    v_lshl_or_b32 v220, v177, 16, v176
    v_mfma_f32_16x16x32_bf16 v[16:19], v[84:87], a[36:39], v[16:19]
    v_cndmask_b32 v218, 0, v218, s[92:93]
    v_cndmask_b32 v219, 0, v219, s[92:93]
    v_mfma_f32_16x16x32_bf16 v[60:63], v[76:79], a[32:35], v[60:63]
    buffer_load_dwordx4 v129, s[4:7], s96 offen offset:3072 lds
    v_cndmask_b32 v220, 0, v220, s[92:93]
    v_mfma_f32_16x16x32_bf16 v[68:71], a[32:35], a[32:35], v[68:71]
    ds_read_b128 a[40:43], v131 offset:0
    ds_read_b128 a[44:47], v131 offset:2048
    s_waitcnt lgkmcnt(6)
    v_mfma_f32_16x16x32_bf16 v[24:27], v[88:91], a[32:35], v[24:27]
    ds_read_b64_tr_b16 v[80:81], v137 offset:5120
    ds_read_b64_tr_b16 v[82:83], v137 offset:7680
    v_mfma_f32_16x16x32_bf16 v[28:31], v[88:91], a[36:39], v[28:31]
    v_cndmask_b32 v104, v212, 0, s[90:91]
    v_cndmask_b32 v106, 0, v212, s[90:91]
    v_mfma_f32_16x16x32_bf16 v[32:35], v[88:91], v[76:79], v[32:35]
    ds_read_b64_tr_b16 v[84:85], v137 offset:5160
    ds_read_b64_tr_b16 v[86:87], v137 offset:7720
    v_mfma_f32_16x16x32_bf16 v[36:39], v[92:95], a[32:35], v[36:39]
    s_add_u32 m0, s76, 4096
    s_add_u32 s96, s86, 896
    buffer_load_dwordx4 v128, s[4:7], s96 offen offset:0 lds
    v_mfma_f32_16x16x32_bf16 v[40:43], v[92:95], a[36:39], v[40:43]
    v_cndmask_b32 v105, v213, 0, s[90:91]
    v_cndmask_b32 v107, 0, v213, s[90:91]
    v_mfma_f32_16x16x32_bf16 v[64:67], v[76:79], a[36:39], v[64:67]
    v_cndmask_b32 v214, 0, v214, s[94:95]
    v_cndmask_b32 v108, v214, 0, s[90:91]
    v_mfma_f32_16x16x32_bf16 v[72:75], a[36:39], a[36:39], v[72:75]
    ds_read_b64_tr_b16 v[88:89], v138 offset:5120
    ds_read_b64_tr_b16 v[90:91], v138 offset:7680
    s_waitcnt lgkmcnt(8)
    v_mfma_f32_16x16x32_bf16 v[48:51], v[96:99], a[32:35], v[48:51]
    buffer_load_dwordx4 v129, s[4:7], s96 offen offset:1024 lds
    v_cndmask_b32 v109, 0, v214, s[90:91]
    v_mfma_f32_16x16x32_bf16 v[52:55], v[96:99], a[36:39], v[52:55]
    ds_read_b64_tr_b16 v[92:93], v137 offset:5200
    ds_read_b64_tr_b16 v[94:95], v137 offset:7760
    v_mfma_f32_16x16x32_bf16 v[8:11], v[100:103], v[76:79], v[8:11]
    ds_read_b64_tr_b16 v[96:97], v137 offset:5240
sequential_preLN__linear_kernel_hedgehog__glu_gated_reglu__prompt_kernel_hop0_0:
    s_cbranch_execz sequential_preLN__linear_kernel_hedgehog__glu_gated_reglu__prompt_kernel_hop0_1
    ds_read_b64_tr_b16 v[98:99], v137 offset:7800
    s_waitcnt lgkmcnt(6)
    v_mfma_f32_16x16x32_bf16 v[0:3], v[80:83], a[40:43], v[0:3]
    v_mov_b32 v110, 0
    v_mov_b32 v111, 0
    v_mfma_f32_16x16x32_bf16 v[4:7], v[80:83], a[44:47], v[4:7]
    ds_read_b64_tr_b16 v[100:101], v251 offset:5120
    ds_read_b64_tr_b16 v[102:103], v251 offset:7680
    v_mfma_f32_16x16x32_bf16 v[12:15], v[84:87], a[40:43], v[12:15]
    s_add_u32 s96, s86, 17280
    buffer_load_dwordx4 v128, s[4:7], s96 offen offset:2048 lds
    v_mfma_f32_16x16x32_bf16 v[16:19], v[84:87], a[44:47], v[16:19]
    v_cndmask_b32 v112, v215, 0, s[90:91]
    v_cndmask_b32 v114, 0, v215, s[90:91]
    v_mfma_f32_16x16x32_bf16 v[60:63], v[76:79], a[40:43], v[60:63]
    v_cndmask_b32 v113, v216, 0, s[90:91]
    v_cndmask_b32 v115, 0, v216, s[90:91]
    v_mfma_f32_16x16x32_bf16 v[68:71], a[40:43], a[40:43], v[68:71]
    ds_read_b128 a[48:51], v130 offset:4096
    ds_read_b128 a[52:55], v130 offset:6144
    s_waitcnt lgkmcnt(6)
    v_mfma_f32_16x16x32_bf16 v[24:27], v[88:91], a[40:43], v[24:27]
    ds_read_b64_tr_b16 v[80:81], v137 offset:10240
    ds_read_b64_tr_b16 v[82:83], v137 offset:12800
    v_mfma_f32_16x16x32_bf16 v[28:31], v[88:91], a[44:47], v[28:31]
    buffer_load_dwordx4 v129, s[4:7], s96 offen offset:3072 lds
    v_cndmask_b32 v217, 0, v217, s[94:95]
    v_mfma_f32_16x16x32_bf16 v[32:35], v[88:91], v[76:79], v[32:35]
    ds_read_b64_tr_b16 v[84:85], v137 offset:10280
    ds_read_b64_tr_b16 v[86:87], v137 offset:12840
    v_mfma_f32_16x16x32_bf16 v[36:39], v[92:95], a[40:43], v[36:39]
    v_cndmask_b32 v116, v217, 0, s[90:91]
    v_cndmask_b32 v117, 0, v217, s[90:91]
    v_mfma_f32_16x16x32_bf16 v[40:43], v[92:95], a[44:47], v[40:43]
    v_mov_b32 v118, 0
    v_mov_b32 v119, 0
    v_mfma_f32_16x16x32_bf16 v[64:67], v[76:79], a[44:47], v[64:67]
    v_cndmask_b32 v120, v218, 0, s[90:91]
    v_cndmask_b32 v122, 0, v218, s[90:91]
    v_mfma_f32_16x16x32_bf16 v[72:75], a[44:47], a[44:47], v[72:75]
    ds_read_b64_tr_b16 v[88:89], v138 offset:10240
    ds_read_b64_tr_b16 v[90:91], v138 offset:12800
    s_waitcnt lgkmcnt(8)
    v_mfma_f32_16x16x32_bf16 v[48:51], v[96:99], a[40:43], v[48:51]
    s_add_u32 s96, s87, 1328256
    s_add_u32 m0, s77, 32768
    s_nop 0
    buffer_load_dwordx4 v132, s[8:11], s96 offen offset:0 lds
    v_mfma_f32_16x16x32_bf16 v[52:55], v[96:99], a[44:47], v[52:55]
    ds_read_b64_tr_b16 v[92:93], v137 offset:10320
    ds_read_b64_tr_b16 v[94:95], v137 offset:12880
    v_mfma_f32_16x16x32_bf16 v[8:11], v[100:103], v[76:79], v[8:11]
    ds_read_b64_tr_b16 v[96:97], v137 offset:10360
    ds_read_b64_tr_b16 v[98:99], v137 offset:12920
    s_waitcnt lgkmcnt(6)
    v_mfma_f32_16x16x32_bf16 v[0:3], v[80:83], a[48:51], v[0:3]
    buffer_load_dwordx4 v133, s[8:11], s96 offen offset:1024 lds
    v_cndmask_b32 v121, v219, 0, s[90:91]
    v_mfma_f32_16x16x32_bf16 v[4:7], v[80:83], a[52:55], v[4:7]
    ds_read_b64_tr_b16 v[100:101], v251 offset:10240
    ds_read_b64_tr_b16 v[102:103], v251 offset:12800
    v_mfma_f32_16x16x32_bf16 v[12:15], v[84:87], a[48:51], v[12:15]
    v_cndmask_b32 v123, 0, v219, s[90:91]
    v_cndmask_b32 v220, 0, v220, s[94:95]
    v_mfma_f32_16x16x32_bf16 v[16:19], v[84:87], a[52:55], v[16:19]
    v_cndmask_b32 v124, v220, 0, s[90:91]
    v_cndmask_b32 v125, 0, v220, s[90:91]
    v_mfma_f32_16x16x32_bf16 v[60:63], v[76:79], a[48:51], v[60:63]
    v_mov_b32 v126, 0
    v_mov_b32 v127, 0
    v_mfma_f32_16x16x32_bf16 v[68:71], a[48:51], a[48:51], v[68:71]
    ds_read_b128 a[56:59], v131 offset:4096
    ds_read_b128 a[60:63], v131 offset:6144
    s_waitcnt lgkmcnt(6)
    v_mfma_f32_16x16x32_bf16 v[24:27], v[88:91], a[48:51], v[24:27]
    ds_read_b64_tr_b16 v[80:81], v137 offset:15360
    ds_read_b64_tr_b16 v[82:83], v137 offset:17920
    v_mfma_f32_16x16x32_bf16 v[28:31], v[88:91], a[52:55], v[28:31]
    buffer_load_dwordx4 v134, s[8:11], s96 offen offset:2048 lds
    v_cmp_gt_u32 vcc, 8, v139
    v_mfma_f32_16x16x32_bf16 v[32:35], v[88:91], v[76:79], v[32:35]
    ds_read_b64_tr_b16 v[84:85], v137 offset:15400
    ds_read_b64_tr_b16 v[86:87], v137 offset:17960
    v_mfma_f32_16x16x32_bf16 v[36:39], v[92:95], a[48:51], v[36:39]
    v_mov_b32 v212, 0x1000000
    v_cndmask_b32 v212, v212, v234, vcc
    v_mfma_f32_16x16x32_bf16 v[40:43], v[92:95], a[52:55], v[40:43]
    buffer_load_dwordx4 v135, s[8:11], s96 offen offset:3072 lds
    s_lshl_b32 s97, s58, 1
    s_add_u32 s97, s97, s48
    s_add_u32 s98, s58, 32
    s_cmp_lt_u32 s48, 2
    s_cselect_b32 s97, s97, s98
    s_mul_i32 s98, s59, 36
    s_add_u32 s97, s97, s98
    s_mul_i32 s97, s97, 1152
    v_mfma_f32_16x16x32_bf16 v[64:67], v[76:79], a[52:55], v[64:67]
    buffer_load_dwordx4 v[216:219], v234, s[16:19], s97 offen
    buffer_load_dwordx4 v[220:223], v212, s[16:19], s97 offen offset:1024
    v_mfma_f32_16x16x32_bf16 v[72:75], a[52:55], a[52:55], v[72:75]
    ds_read_b64_tr_b16 v[88:89], v138 offset:15360
    ds_read_b64_tr_b16 v[90:91], v138 offset:17920
    s_waitcnt lgkmcnt(8)
    v_mfma_f32_16x16x32_bf16 v[48:51], v[96:99], a[48:51], v[48:51]
    v_lshrrev_b32 v213, 4, v139
    v_cmp_eq_u32 s[94:95], 2, v213
    v_mfma_f32_16x16x32_bf16 v[52:55], v[96:99], a[52:55], v[52:55]
    ds_read_b64_tr_b16 v[92:93], v137 offset:15440
    ds_read_b64_tr_b16 v[94:95], v137 offset:18000
    v_mfma_f32_16x16x32_bf16 v[8:11], v[100:103], v[76:79], v[8:11]
    ds_read_b64_tr_b16 v[96:97], v137 offset:15480
    ds_read_b64_tr_b16 v[98:99], v137 offset:18040
    s_waitcnt lgkmcnt(6)
    v_mfma_f32_16x16x32_bf16 v[0:3], v[80:83], a[56:59], v[0:3]
    s_add_u32 m0, s77, 36864
    s_nop 0
    buffer_load_dwordx4 v136, s[8:11], s96 offen offset:0 lds
    v_mfma_f32_16x16x32_bf16 v[4:7], v[80:83], a[60:63], v[4:7]
    ds_read_b64_tr_b16 v[100:101], v251 offset:15360
    ds_read_b64_tr_b16 v[102:103], v251 offset:17920
    v_mfma_f32_16x16x32_bf16 v[12:15], v[84:87], a[56:59], v[12:15]
    v_mfma_f32_16x16x32_bf16 v[16:19], v[84:87], a[60:63], v[16:19]
    v_mfma_f32_16x16x32_bf16 v[60:63], v[76:79], a[56:59], v[60:63]
    v_mfma_f32_16x16x32_bf16 v[68:71], a[56:59], a[56:59], v[68:71]
    s_waitcnt vmcnt(15)
    s_waitcnt lgkmcnt(0)
    s_barrier
    v_mfma_f32_16x16x32_bf16 v[24:27], v[88:91], a[56:59], v[24:27]
    v_add_u32 v130, 53248, v130
    v_add_u32 v131, 53248, v131
    v_mfma_f32_16x16x32_bf16 v[28:31], v[88:91], a[60:63], v[28:31]
    ds_read_b128 a[64:67], v130 offset:0
    ds_read_b128 a[68:71], v130 offset:2048
    v_mfma_f32_16x16x32_bf16 v[32:35], v[88:91], v[76:79], v[32:35]
    v_add_u32 v137, 53248, v137
    v_add_u32 v138, 53248, v138
    v_mfma_f32_16x16x32_bf16 v[36:39], v[92:95], a[56:59], v[36:39]
    v_add_u32 v251, 53248, v251
    ds_read_b64_tr_b16 v[80:81], v137 offset:0
    v_mfma_f32_16x16x32_bf16 v[40:43], v[92:95], a[60:63], v[40:43]
    ds_read_b64_tr_b16 v[82:83], v137 offset:2560
    ds_read_b64_tr_b16 v[84:85], v137 offset:40
    v_mfma_f32_16x16x32_bf16 v[64:67], v[76:79], a[60:63], v[64:67]
    ds_read_b64_tr_b16 v[86:87], v137 offset:2600
    s_add_u32 m0, s49, 57344
    s_nop 0
    buffer_load_dwordx4 v246, s[44:47], 0 offen lds
    v_mfma_f32_16x16x32_bf16 v[72:75], a[60:63], a[60:63], v[72:75]
    ds_read_b64_tr_b16 v[88:89], v138 offset:0
    ds_read_b64_tr_b16 v[90:91], v138 offset:2560
    v_mfma_f32_16x16x32_bf16 v[48:51], v[96:99], a[56:59], v[48:51]
    s_add_u32 m0, s49, 65536
    s_nop 0
    buffer_load_dwordx4 v247, s[12:15], 0 offen lds
    v_mfma_f32_16x16x32_bf16 v[52:55], v[96:99], a[60:63], v[52:55]
    ds_read_b64_tr_b16 v[92:93], v137 offset:80
    ds_read_b64_tr_b16 v[94:95], v137 offset:2640
    v_mfma_f32_16x16x32_bf16 v[8:11], v[100:103], v[76:79], v[8:11]
    ds_read_b64_tr_b16 v[96:97], v137 offset:120
    ds_read_b64_tr_b16 v[98:99], v137 offset:2680
    s_waitcnt lgkmcnt(6)
    v_mfma_f32_16x16x32_bf16 v[0:3], v[80:83], a[64:67], v[0:3]
    v_mfma_f32_16x16x32_bf16 v[4:7], v[80:83], a[68:71], v[4:7]
    ds_read_b64_tr_b16 v[100:101], v251 offset:0
    ds_read_b64_tr_b16 v[102:103], v251 offset:2560
    v_mfma_f32_16x16x32_bf16 v[12:15], v[84:87], a[64:67], v[12:15]
    s_add_u32 m0, s76, 53248
    s_add_u32 s96, s86, 1024
    buffer_load_dwordx4 v128, s[4:7], s96 offen offset:0 lds
    v_mfma_f32_16x16x32_bf16 v[16:19], v[84:87], a[68:71], v[16:19]
    v_mfma_f32_16x16x32_bf16 v[60:63], v[76:79], a[64:67], v[60:63]
    v_mfma_f32_16x16x32_bf16 v[68:71], a[64:67], a[64:67], v[68:71]
    ds_read_b128 a[72:75], v131 offset:0
    ds_read_b128 a[76:79], v131 offset:2048
    s_waitcnt lgkmcnt(6)
    v_mfma_f32_16x16x32_bf16 v[24:27], v[88:91], a[64:67], v[24:27]
    ds_read_b64_tr_b16 v[80:81], v137 offset:5120
    ds_read_b64_tr_b16 v[82:83], v137 offset:7680
    v_mfma_f32_16x16x32_bf16 v[28:31], v[88:91], a[68:71], v[28:31]
    buffer_load_dwordx4 v129, s[4:7], s96 offen offset:1024 lds
    v_mfma_f32_16x16x32_bf16 v[32:35], v[88:91], v[76:79], v[32:35]
    ds_read_b64_tr_b16 v[84:85], v137 offset:5160
    ds_read_b64_tr_b16 v[86:87], v137 offset:7720
    v_mfma_f32_16x16x32_bf16 v[36:39], v[92:95], a[64:67], v[36:39]
    v_mfma_f32_16x16x32_bf16 v[40:43], v[92:95], a[68:71], v[40:43]
    v_mfma_f32_16x16x32_bf16 v[64:67], v[76:79], a[68:71], v[64:67]
    v_mfma_f32_16x16x32_bf16 v[72:75], a[68:71], a[68:71], v[72:75]
    ds_read_b64_tr_b16 v[88:89], v138 offset:5120
    ds_read_b64_tr_b16 v[90:91], v138 offset:7680
    s_waitcnt lgkmcnt(8)
    v_mfma_f32_16x16x32_bf16 v[48:51], v[96:99], a[64:67], v[48:51]
    s_add_u32 s96, s86, 17408
    buffer_load_dwordx4 v128, s[4:7], s96 offen offset:2048 lds
    v_mfma_f32_16x16x32_bf16 v[52:55], v[96:99], a[68:71], v[52:55]
    ds_read_b64_tr_b16 v[92:93], v137 offset:5200
    ds_read_b64_tr_b16 v[94:95], v137 offset:7760
    v_mfma_f32_16x16x32_bf16 v[8:11], v[100:103], v[76:79], v[8:11]
    ds_read_b64_tr_b16 v[96:97], v137 offset:5240
    ds_read_b64_tr_b16 v[98:99], v137 offset:7800
    s_waitcnt lgkmcnt(6)
    v_mfma_f32_16x16x32_bf16 v[0:3], v[80:83], a[72:75], v[0:3]
    v_mfma_f32_16x16x32_bf16 v[4:7], v[80:83], a[76:79], v[4:7]
    ds_read_b64_tr_b16 v[100:101], v251 offset:5120
    ds_read_b64_tr_b16 v[102:103], v251 offset:7680
    v_mfma_f32_16x16x32_bf16 v[12:15], v[84:87], a[72:75], v[12:15]
    buffer_load_dwordx4 v129, s[4:7], s96 offen offset:3072 lds
    v_mfma_f32_16x16x32_bf16 v[16:19], v[84:87], a[76:79], v[16:19]
    v_mfma_f32_16x16x32_bf16 v[60:63], v[76:79], a[72:75], v[60:63]
    v_mfma_f32_16x16x32_bf16 v[68:71], a[72:75], a[72:75], v[68:71]
    ds_read_b128 a[80:83], v130 offset:4096
    ds_read_b128 a[84:87], v130 offset:6144
    s_waitcnt lgkmcnt(6)
    v_mfma_f32_16x16x32_bf16 v[24:27], v[88:91], a[72:75], v[24:27]
    ds_read_b64_tr_b16 v[80:81], v137 offset:10240
    ds_read_b64_tr_b16 v[82:83], v137 offset:12800
    v_mfma_f32_16x16x32_bf16 v[28:31], v[88:91], a[76:79], v[28:31]
    s_add_u32 s96, s87, 1770624
    s_add_u32 m0, s77, 86016
    s_nop 0
    buffer_load_dwordx4 v132, s[8:11], s96 offen offset:0 lds
    v_mfma_f32_16x16x32_bf16 v[32:35], v[88:91], v[76:79], v[32:35]
    ds_read_b64_tr_b16 v[84:85], v137 offset:10280
    ds_read_b64_tr_b16 v[86:87], v137 offset:12840
    v_mfma_f32_16x16x32_bf16 v[36:39], v[92:95], a[72:75], v[36:39]
    v_mfma_f32_16x16x32_bf16 v[40:43], v[92:95], a[76:79], v[40:43]
    v_mfma_f32_16x16x32_bf16 v[64:67], v[76:79], a[76:79], v[64:67]
    v_mfma_f32_16x16x32_bf16 v[72:75], a[76:79], a[76:79], v[72:75]
    ds_read_b64_tr_b16 v[88:89], v138 offset:10240
    ds_read_b64_tr_b16 v[90:91], v138 offset:12800
    s_waitcnt lgkmcnt(8)
    v_mfma_f32_16x16x32_bf16 v[48:51], v[96:99], a[72:75], v[48:51]
    buffer_load_dwordx4 v133, s[8:11], s96 offen offset:1024 lds
    v_mfma_f32_16x16x32_bf16 v[52:55], v[96:99], a[76:79], v[52:55]
    ds_read_b64_tr_b16 v[92:93], v137 offset:10320
    ds_read_b64_tr_b16 v[94:95], v137 offset:12880
    v_mfma_f32_16x16x32_bf16 v[8:11], v[100:103], v[76:79], v[8:11]
    ds_read_b64_tr_b16 v[96:97], v137 offset:10360
    ds_read_b64_tr_b16 v[98:99], v137 offset:12920
    s_waitcnt lgkmcnt(6)
    v_mfma_f32_16x16x32_bf16 v[0:3], v[80:83], a[80:83], v[0:3]
    v_mfma_f32_16x16x32_bf16 v[4:7], v[80:83], a[84:87], v[4:7]
    ds_read_b64_tr_b16 v[100:101], v251 offset:10240
    ds_read_b64_tr_b16 v[102:103], v251 offset:12800
    v_mfma_f32_16x16x32_bf16 v[12:15], v[84:87], a[80:83], v[12:15]
    v_mfma_f32_16x16x32_bf16 v[16:19], v[84:87], a[84:87], v[16:19]
    buffer_load_dwordx4 v134, s[8:11], s96 offen offset:2048 lds
    v_mfma_f32_16x16x32_bf16 v[60:63], v[76:79], a[80:83], v[60:63]
    v_mfma_f32_16x16x32_bf16 v[68:71], a[80:83], a[80:83], v[68:71]
    ds_read_b128 a[88:91], v131 offset:4096
    ds_read_b128 a[92:95], v131 offset:6144
    s_waitcnt lgkmcnt(6)
    v_mfma_f32_16x16x32_bf16 v[24:27], v[88:91], a[80:83], v[24:27]
    ds_read_b64_tr_b16 v[80:81], v137 offset:15360
    ds_read_b64_tr_b16 v[82:83], v137 offset:17920
    v_mfma_f32_16x16x32_bf16 v[28:31], v[88:91], a[84:87], v[28:31]
    v_mfma_f32_16x16x32_bf16 v[32:35], v[88:91], v[76:79], v[32:35]
    ds_read_b64_tr_b16 v[84:85], v137 offset:15400
    ds_read_b64_tr_b16 v[86:87], v137 offset:17960
    v_mfma_f32_16x16x32_bf16 v[36:39], v[92:95], a[80:83], v[36:39]
    buffer_load_dwordx4 v135, s[8:11], s96 offen offset:3072 lds
    v_mfma_f32_16x16x32_bf16 v[40:43], v[92:95], a[84:87], v[40:43]
    v_mfma_f32_16x16x32_bf16 v[64:67], v[76:79], a[84:87], v[64:67]
    v_mfma_f32_16x16x32_bf16 v[72:75], a[84:87], a[84:87], v[72:75]
    ds_read_b64_tr_b16 v[88:89], v138 offset:15360
    ds_read_b64_tr_b16 v[90:91], v138 offset:17920
    s_waitcnt lgkmcnt(8)
    v_mfma_f32_16x16x32_bf16 v[48:51], v[96:99], a[80:83], v[48:51]
    v_mfma_f32_16x16x32_bf16 v[52:55], v[96:99], a[84:87], v[52:55]
    ds_read_b64_tr_b16 v[92:93], v137 offset:15440
    ds_read_b64_tr_b16 v[94:95], v137 offset:18000
    v_mfma_f32_16x16x32_bf16 v[8:11], v[100:103], v[76:79], v[8:11]
    ds_read_b64_tr_b16 v[96:97], v137 offset:15480
    ds_read_b64_tr_b16 v[98:99], v137 offset:18040
    s_waitcnt lgkmcnt(6)
    v_mfma_f32_16x16x32_bf16 v[0:3], v[80:83], a[88:91], v[0:3]
    s_add_u32 m0, s77, 90112
    s_nop 0
    buffer_load_dwordx4 v136, s[8:11], s96 offen offset:0 lds
    v_mfma_f32_16x16x32_bf16 v[4:7], v[80:83], a[92:95], v[4:7]
    ds_read_b64_tr_b16 v[100:101], v251 offset:15360
    ds_read_b64_tr_b16 v[102:103], v251 offset:17920
    v_mfma_f32_16x16x32_bf16 v[12:15], v[84:87], a[88:91], v[12:15]
    v_mfma_f32_16x16x32_bf16 v[16:19], v[84:87], a[92:95], v[16:19]
    v_mfma_f32_16x16x32_bf16 v[60:63], v[76:79], a[88:91], v[60:63]
    v_mfma_f32_16x16x32_bf16 v[68:71], a[88:91], a[88:91], v[68:71]
    s_waitcnt vmcnt(11)
    s_waitcnt lgkmcnt(0)
    s_barrier
    v_mfma_f32_16x16x32_bf16 v[24:27], v[88:91], a[88:91], v[24:27]
    v_subrev_u32 v130, 106496, v130
    v_subrev_u32 v131, 106496, v131
    v_mfma_f32_16x16x32_bf16 v[28:31], v[88:91], a[92:95], v[28:31]
    ds_read_b128 a[96:99], v130 offset:0
    ds_read_b128 a[100:103], v130 offset:2048
    v_mfma_f32_16x16x32_bf16 v[32:35], v[88:91], v[76:79], v[32:35]
    v_subrev_u32 v137, 106496, v137
    v_subrev_u32 v138, 106496, v138
    v_mfma_f32_16x16x32_bf16 v[36:39], v[92:95], a[88:91], v[36:39]
    v_subrev_u32 v251, 106496, v251
    ds_read_b64_tr_b16 v[80:81], v137 offset:0
    v_mfma_f32_16x16x32_bf16 v[40:43], v[92:95], a[92:95], v[40:43]
    ds_read_b64_tr_b16 v[82:83], v137 offset:2560
    ds_read_b64_tr_b16 v[84:85], v137 offset:40
    v_mfma_f32_16x16x32_bf16 v[64:67], v[76:79], a[92:95], v[64:67]
    ds_read_b64_tr_b16 v[86:87], v137 offset:2600
    s_mul_i32 s96, s48, 110592
    s_add_u32 s87, s87, s96
    v_mfma_f32_16x16x32_bf16 v[72:75], a[92:95], a[92:95], v[72:75]
    ds_read_b64_tr_b16 v[88:89], v138 offset:0
    ds_read_b64_tr_b16 v[90:91], v138 offset:2560
    v_mfma_f32_16x16x32_bf16 v[48:51], v[96:99], a[88:91], v[48:51]
    s_lshl_b32 s96, s48, 6
    s_lshl_b32 s89, s51, 1
    s_add_u32 s96, s96, s89
    s_add_u32 s96, s96, s55
    v_lshrrev_b32 v226, 3, v139
    v_and_b32 v227, 7, v139
    v_lshl_add_u32 v227, v227, 1, 0
    v_mul_u32_u24 v226, 9216, v226
    v_lshl_add_u32 v226, v227, 7, v226
    s_cmp_ge_u32 s96, 72
    s_cselect_b32 s44, s24, s20
    s_cselect_b32 s45, s25, s21
    s_cselect_b32 s89, 72, 0
    s_sub_u32 s96, s96, s89
    s_mul_i32 s96, s96, 73728
    s_mul_i32 s89, s54, 2304
    s_add_u32 s89, s89, s96
    buffer_load_dword v255, v226, s[44:47], s89 offen
    v_mfma_f32_16x16x32_bf16 v[52:55], v[96:99], a[92:95], v[52:55]
    ds_read_b64_tr_b16 v[92:93], v137 offset:80
    ds_read_b64_tr_b16 v[94:95], v137 offset:2640
    v_mfma_f32_16x16x32_bf16 v[8:11], v[100:103], v[76:79], v[8:11]
    ds_read_b64_tr_b16 v[96:97], v137 offset:120
    ds_read_b64_tr_b16 v[98:99], v137 offset:2680
    s_waitcnt lgkmcnt(6)
    v_mfma_f32_16x16x32_bf16 v[0:3], v[80:83], a[96:99], v[0:3]
    v_mov_b32 v224, 0
    v_dot2c_f32_bf16 v224, v216, v76
    v_mfma_f32_16x16x32_bf16 v[4:7], v[80:83], a[100:103], v[4:7]
    ds_read_b64_tr_b16 v[100:101], v251 offset:0
    ds_read_b64_tr_b16 v[102:103], v251 offset:2560
    v_mfma_f32_16x16x32_bf16 v[12:15], v[84:87], a[96:99], v[12:15]
    v_dot2c_f32_bf16 v224, v217, v76
    v_dot2c_f32_bf16 v224, v218, v76
    v_mfma_f32_16x16x32_bf16 v[16:19], v[84:87], a[100:103], v[16:19]
    v_dot2c_f32_bf16 v224, v219, v76
    v_dot2c_f32_bf16 v224, v220, v76
    v_mfma_f32_16x16x32_bf16 v[60:63], v[76:79], a[96:99], v[60:63]
    v_dot2c_f32_bf16 v224, v221, v76
    v_dot2c_f32_bf16 v224, v222, v76
    v_mfma_f32_16x16x32_bf16 v[68:71], a[96:99], a[96:99], v[68:71]
    ds_read_b128 a[104:107], v131 offset:0
    ds_read_b128 a[108:111], v131 offset:2048
    s_waitcnt lgkmcnt(6)
    v_mfma_f32_16x16x32_bf16 v[24:27], v[88:91], a[96:99], v[24:27]
    ds_read_b64_tr_b16 v[80:81], v137 offset:5120
    ds_read_b64_tr_b16 v[82:83], v137 offset:7680
    v_mfma_f32_16x16x32_bf16 v[28:31], v[88:91], a[100:103], v[28:31]
    v_dot2c_f32_bf16 v224, v223, v76
    s_nop 2
    v_add_f32_dpp v224, v224, v224 quad_perm:[1,0,3,2] row_mask:0xf bank_mask:0xf
    v_mfma_f32_16x16x32_bf16 v[32:35], v[88:91], v[76:79], v[32:35]
    ds_read_b64_tr_b16 v[84:85], v137 offset:5160
    ds_read_b64_tr_b16 v[86:87], v137 offset:7720
    v_mfma_f32_16x16x32_bf16 v[36:39], v[92:95], a[96:99], v[36:39]
    v_add_f32_dpp v224, v224, v224 quad_perm:[2,3,0,1] row_mask:0xf bank_mask:0xf
    s_nop 1
    v_add_f32_dpp v224, v224, v224 row_half_mirror row_mask:0xf bank_mask:0xf
    v_mfma_f32_16x16x32_bf16 v[40:43], v[92:95], a[100:103], v[40:43]
    s_nop 0
    v_add_f32_dpp v224, v224, v224 row_mirror row_mask:0xf bank_mask:0xf
    v_mov_b32 v225, v224
    v_mfma_f32_16x16x32_bf16 v[64:67], v[76:79], a[100:103], v[64:67]
    s_nop 0
    v_permlane16_swap_b32 v224, v225
    v_add_f32 v224, v224, v225
    v_mfma_f32_16x16x32_bf16 v[72:75], a[100:103], a[100:103], v[72:75]
    ds_read_b64_tr_b16 v[88:89], v138 offset:5120
    ds_read_b64_tr_b16 v[90:91], v138 offset:7680
    s_waitcnt lgkmcnt(8)
    v_mfma_f32_16x16x32_bf16 v[48:51], v[96:99], a[96:99], v[48:51]
    v_mov_b32 v225, v224
    s_nop 1
    v_permlane32_swap_b32 v224, v225
    v_mfma_f32_16x16x32_bf16 v[52:55], v[96:99], a[100:103], v[52:55]
    ds_read_b64_tr_b16 v[92:93], v137 offset:5200
    ds_read_b64_tr_b16 v[94:95], v137 offset:7760
    v_mfma_f32_16x16x32_bf16 v[8:11], v[100:103], v[76:79], v[8:11]
    ds_read_b64_tr_b16 v[96:97], v137 offset:5240
    ds_read_b64_tr_b16 v[98:99], v137 offset:7800
    s_waitcnt lgkmcnt(6)
    v_mfma_f32_16x16x32_bf16 v[0:3], v[80:83], a[104:107], v[0:3]
    v_add_f32 v224, v224, v225
    v_mul_f32 v224, 0x3ae38e39, v224
    v_mfma_f32_16x16x32_bf16 v[4:7], v[80:83], a[108:111], v[4:7]
    ds_read_b64_tr_b16 v[100:101], v251 offset:5120
    ds_read_b64_tr_b16 v[102:103], v251 offset:7680
    v_mfma_f32_16x16x32_bf16 v[12:15], v[84:87], a[104:107], v[12:15]
    s_lshl_b32 s97, s48, 2
    s_add_u32 s97, s97, s78
    s_mov_b64 exec, 1
    buffer_store_dword v224, off, s[36:39], s97 offset:3648 sc1
    s_mov_b64 exec, -1
    v_mfma_f32_16x16x32_bf16 v[16:19], v[84:87], a[108:111], v[16:19]
    v_mfma_f32_16x16x32_bf16 v[60:63], v[76:79], a[104:107], v[60:63]
    v_mfma_f32_16x16x32_bf16 v[68:71], a[104:107], a[104:107], v[68:71]
    ds_read_b128 a[112:115], v130 offset:4096
    ds_read_b128 a[116:119], v130 offset:6144
    s_waitcnt lgkmcnt(6)
    v_mfma_f32_16x16x32_bf16 v[24:27], v[88:91], a[104:107], v[24:27]
    ds_read_b64_tr_b16 v[80:81], v137 offset:10240
    ds_read_b64_tr_b16 v[82:83], v137 offset:12800
    v_mfma_f32_16x16x32_bf16 v[28:31], v[88:91], a[108:111], v[28:31]
    v_mfma_f32_16x16x32_bf16 v[32:35], v[88:91], v[76:79], v[32:35]
    ds_read_b64_tr_b16 v[84:85], v137 offset:10280
    ds_read_b64_tr_b16 v[86:87], v137 offset:12840
    v_mfma_f32_16x16x32_bf16 v[36:39], v[92:95], a[104:107], v[36:39]
    v_mfma_f32_16x16x32_bf16 v[40:43], v[92:95], a[108:111], v[40:43]
    v_mfma_f32_16x16x32_bf16 v[64:67], v[76:79], a[108:111], v[64:67]
    v_mfma_f32_16x16x32_bf16 v[72:75], a[108:111], a[108:111], v[72:75]
    ds_read_b64_tr_b16 v[88:89], v138 offset:10240
    ds_read_b64_tr_b16 v[90:91], v138 offset:12800
    s_waitcnt lgkmcnt(8)
    v_mfma_f32_16x16x32_bf16 v[48:51], v[96:99], a[104:107], v[48:51]
    v_mfma_f32_16x16x32_bf16 v[52:55], v[96:99], a[108:111], v[52:55]
    ds_read_b64_tr_b16 v[92:93], v137 offset:10320
    ds_read_b64_tr_b16 v[94:95], v137 offset:12880
    v_mfma_f32_16x16x32_bf16 v[8:11], v[100:103], v[76:79], v[8:11]
    ds_read_b64_tr_b16 v[96:97], v137 offset:10360
    ds_read_b64_tr_b16 v[98:99], v137 offset:12920
    s_waitcnt lgkmcnt(6)
    v_mfma_f32_16x16x32_bf16 v[0:3], v[80:83], a[112:115], v[0:3]
    v_mfma_f32_16x16x32_bf16 v[4:7], v[80:83], a[116:119], v[4:7]
    ds_read_b64_tr_b16 v[100:101], v251 offset:10240
    ds_read_b64_tr_b16 v[102:103], v251 offset:12800
    v_mfma_f32_16x16x32_bf16 v[12:15], v[84:87], a[112:115], v[12:15]
    v_mfma_f32_16x16x32_bf16 v[16:19], v[84:87], a[116:119], v[16:19]
    v_mfma_f32_16x16x32_bf16 v[60:63], v[76:79], a[112:115], v[60:63]
    v_mfma_f32_16x16x32_bf16 v[68:71], a[112:115], a[112:115], v[68:71]
    ds_read_b128 a[120:123], v131 offset:4096
    ds_read_b128 a[124:127], v131 offset:6144
    s_waitcnt lgkmcnt(6)
    v_mfma_f32_16x16x32_bf16 v[24:27], v[88:91], a[112:115], v[24:27]
    ds_read_b64_tr_b16 v[80:81], v137 offset:15360
    ds_read_b64_tr_b16 v[82:83], v137 offset:17920
    v_mfma_f32_16x16x32_bf16 v[28:31], v[88:91], a[116:119], v[28:31]
    v_mfma_f32_16x16x32_bf16 v[32:35], v[88:91], v[76:79], v[32:35]
    ds_read_b64_tr_b16 v[84:85], v137 offset:15400
    ds_read_b64_tr_b16 v[86:87], v137 offset:17960
    v_mfma_f32_16x16x32_bf16 v[36:39], v[92:95], a[112:115], v[36:39]
    v_mfma_f32_16x16x32_bf16 v[40:43], v[92:95], a[116:119], v[40:43]
    v_mfma_f32_16x16x32_bf16 v[64:67], v[76:79], a[116:119], v[64:67]
    v_mfma_f32_16x16x32_bf16 v[72:75], a[116:119], a[116:119], v[72:75]
    ds_read_b64_tr_b16 v[88:89], v138 offset:15360
    ds_read_b64_tr_b16 v[90:91], v138 offset:17920
    s_waitcnt lgkmcnt(8)
    v_mfma_f32_16x16x32_bf16 v[48:51], v[96:99], a[112:115], v[48:51]
    v_mfma_f32_16x16x32_bf16 v[52:55], v[96:99], a[116:119], v[52:55]
    ds_read_b64_tr_b16 v[92:93], v137 offset:15440
    ds_read_b64_tr_b16 v[94:95], v137 offset:18000
    v_mfma_f32_16x16x32_bf16 v[8:11], v[100:103], v[76:79], v[8:11]
    ds_read_b64_tr_b16 v[96:97], v137 offset:15480
    ds_read_b64_tr_b16 v[98:99], v137 offset:18040
    s_waitcnt lgkmcnt(6)
    v_mfma_f32_16x16x32_bf16 v[0:3], v[80:83], a[120:123], v[0:3]
    v_mfma_f32_16x16x32_bf16 v[4:7], v[80:83], a[124:127], v[4:7]
    ds_read_b64_tr_b16 v[100:101], v251 offset:15360
    ds_read_b64_tr_b16 v[102:103], v251 offset:17920
    v_mfma_f32_16x16x32_bf16 v[12:15], v[84:87], a[120:123], v[12:15]
    v_mfma_f32_16x16x32_bf16 v[16:19], v[84:87], a[124:127], v[16:19]
    v_mfma_f32_16x16x32_bf16 v[60:63], v[76:79], a[120:123], v[60:63]
    v_mfma_f32_16x16x32_bf16 v[68:71], a[120:123], a[120:123], v[68:71]
    s_waitcnt vmcnt(2)
    s_waitcnt lgkmcnt(0)
    s_barrier
    v_mfma_f32_16x16x32_bf16 v[24:27], v[88:91], a[120:123], v[24:27]
    v_add_u32 v130, 53248, v130
    v_add_u32 v131, 53248, v131
    v_mfma_f32_16x16x32_bf16 v[28:31], v[88:91], a[124:127], v[28:31]
    ds_read_b128 a[128:131], v130 offset:0
    ds_read_b128 a[132:135], v130 offset:2048
    v_mfma_f32_16x16x32_bf16 v[32:35], v[88:91], v[76:79], v[32:35]
    v_add_u32 v137, 53248, v137
    v_add_u32 v138, 53248, v138
    v_mfma_f32_16x16x32_bf16 v[36:39], v[92:95], a[120:123], v[36:39]
    v_add_u32 v251, 53248, v251
    ds_read_b64_tr_b16 v[80:81], v137 offset:0
    v_mfma_f32_16x16x32_bf16 v[40:43], v[92:95], a[124:127], v[40:43]
    ds_read_b64_tr_b16 v[82:83], v137 offset:2560
    ds_read_b64_tr_b16 v[84:85], v137 offset:40
    v_mfma_f32_16x16x32_bf16 v[64:67], v[76:79], a[124:127], v[64:67]
    ds_read_b64_tr_b16 v[86:87], v137 offset:2600
    v_and_b32 v232, 15, v139
    v_lshlrev_b32 v232, 2, v232
    buffer_load_dword v233, v232, s[40:43], 0 offen sc1
    v_mfma_f32_16x16x32_bf16 v[72:75], a[124:127], a[124:127], v[72:75]
    ds_read_b64_tr_b16 v[88:89], v138 offset:0
    ds_read_b64_tr_b16 v[90:91], v138 offset:2560
    v_mfma_f32_16x16x32_bf16 v[48:51], v[96:99], a[120:123], v[48:51]
    ds_read_b64_tr_b16 v[216:217], v249 offset:0
    ds_read_b64_tr_b16 v[218:219], v249 offset:2048
    v_mfma_f32_16x16x32_bf16 v[52:55], v[96:99], a[124:127], v[52:55]
    ds_read_b64_tr_b16 v[92:93], v137 offset:80
    ds_read_b64_tr_b16 v[94:95], v137 offset:2640
    v_mfma_f32_16x16x32_bf16 v[8:11], v[100:103], v[76:79], v[8:11]
    ds_read_b64_tr_b16 v[96:97], v137 offset:120
    ds_read_b64_tr_b16 v[98:99], v137 offset:2680
    s_waitcnt lgkmcnt(8)
    v_mfma_f32_16x16x32_bf16 v[0:3], v[80:83], a[128:131], v[0:3]
    ds_read_b64_tr_b16 v[220:221], v249 offset:8192
    ds_read_b64_tr_b16 v[222:223], v249 offset:10240
    v_mfma_f32_16x16x32_bf16 v[4:7], v[80:83], a[132:135], v[4:7]
    ds_read_b64_tr_b16 v[100:101], v251 offset:0
    ds_read_b64_tr_b16 v[102:103], v251 offset:2560
    v_mfma_f32_16x16x32_bf16 v[12:15], v[84:87], a[128:131], v[12:15]
    s_waitcnt lgkmcnt(8)
    buffer_store_dwordx4 v[216:219], v234, s[36:39], s79 offen sc1
    s_waitcnt lgkmcnt(2)
    buffer_store_dwordx4 v[220:223], v234, s[36:39], s3 offen sc1
    v_mfma_f32_16x16x32_bf16 v[16:19], v[84:87], a[132:135], v[16:19]
    v_mfma_f32_16x16x32_bf16 v[60:63], v[76:79], a[128:131], v[60:63]
    v_mfma_f32_16x16x32_bf16 v[68:71], a[128:131], a[128:131], v[68:71]
    ds_read_b128 a[136:139], v131 offset:0
    ds_read_b128 a[140:143], v131 offset:2048
    v_mfma_f32_16x16x32_bf16 v[24:27], v[88:91], a[128:131], v[24:27]
    ds_read_b64_tr_b16 v[80:81], v137 offset:5120
    ds_read_b64_tr_b16 v[82:83], v137 offset:7680
    v_mfma_f32_16x16x32_bf16 v[28:31], v[88:91], a[132:135], v[28:31]
    v_mfma_f32_16x16x32_bf16 v[32:35], v[88:91], v[76:79], v[32:35]
    ds_read_b64_tr_b16 v[84:85], v137 offset:5160
    ds_read_b64_tr_b16 v[86:87], v137 offset:7720
    v_mfma_f32_16x16x32_bf16 v[36:39], v[92:95], a[128:131], v[36:39]
    v_mfma_f32_16x16x32_bf16 v[40:43], v[92:95], a[132:135], v[40:43]
    v_mfma_f32_16x16x32_bf16 v[64:67], v[76:79], a[132:135], v[64:67]
    v_mfma_f32_16x16x32_bf16 v[72:75], a[132:135], a[132:135], v[72:75]
    ds_read_b64_tr_b16 v[88:89], v138 offset:5120
    ds_read_b64_tr_b16 v[90:91], v138 offset:7680
    s_waitcnt lgkmcnt(8)
    v_mfma_f32_16x16x32_bf16 v[48:51], v[96:99], a[128:131], v[48:51]
    v_mfma_f32_16x16x32_bf16 v[52:55], v[96:99], a[132:135], v[52:55]
    ds_read_b64_tr_b16 v[92:93], v137 offset:5200
    ds_read_b64_tr_b16 v[94:95], v137 offset:7760
    v_mfma_f32_16x16x32_bf16 v[8:11], v[100:103], v[76:79], v[8:11]
    ds_read_b64_tr_b16 v[96:97], v137 offset:5240
    ds_read_b64_tr_b16 v[98:99], v137 offset:7800
    s_waitcnt lgkmcnt(6)
    v_mfma_f32_16x16x32_bf16 v[0:3], v[80:83], a[136:139], v[0:3]
    v_mfma_f32_16x16x32_bf16 v[4:7], v[80:83], a[140:143], v[4:7]
    ds_read_b64_tr_b16 v[100:101], v251 offset:5120
    ds_read_b64_tr_b16 v[102:103], v251 offset:7680
    v_mfma_f32_16x16x32_bf16 v[12:15], v[84:87], a[136:139], v[12:15]
    v_mfma_f32_16x16x32_bf16 v[16:19], v[84:87], a[140:143], v[16:19]
    v_mfma_f32_16x16x32_bf16 v[60:63], v[76:79], a[136:139], v[60:63]
    v_mfma_f32_16x16x32_bf16 v[68:71], a[136:139], a[136:139], v[68:71]
    s_waitcnt lgkmcnt(4)
    v_mfma_f32_16x16x32_bf16 v[24:27], v[88:91], a[136:139], v[24:27]
    v_mfma_f32_16x16x32_bf16 v[28:31], v[88:91], a[140:143], v[28:31]
    v_mfma_f32_16x16x32_bf16 v[32:35], v[88:91], v[76:79], v[32:35]
    v_mfma_f32_16x16x32_bf16 v[36:39], v[92:95], a[136:139], v[36:39]
    v_mfma_f32_16x16x32_bf16 v[40:43], v[92:95], a[140:143], v[40:43]
    v_mfma_f32_16x16x32_bf16 v[64:67], v[76:79], a[140:143], v[64:67]
sequential_preLN__linear_kernel_hedgehog__glu_gated_reglu__prompt_kernel_hop0_1:
    s_cbranch_execz sequential_preLN__linear_kernel_hedgehog__glu_gated_reglu__prompt_kernel_hop0_2
    v_mfma_f32_16x16x32_bf16 v[72:75], a[140:143], a[140:143], v[72:75]
    s_waitcnt lgkmcnt(0)
    v_mfma_f32_16x16x32_bf16 v[48:51], v[96:99], a[136:139], v[48:51]
    v_mfma_f32_16x16x32_bf16 v[52:55], v[96:99], a[140:143], v[52:55]
    v_mfma_f32_16x16x32_bf16 v[8:11], v[100:103], v[76:79], v[8:11]
    s_nop 7
    ds_write_b128 v252, v[8:11]
    s_cmp_lg_u32 s48, 0
    s_cbranch_scc1 sequential_preLN__linear_kernel_hedgehog__glu_gated_reglu__prompt_kernel_nq_14
    s_add_u32 s96, s87, 1769472
    s_mov_b32 m0, 151552
    s_nop 0
    buffer_load_dwordx4 v239, s[8:11], s96 offen lds
sequential_preLN__linear_kernel_hedgehog__glu_gated_reglu__prompt_kernel_nq_14:
    v_cndmask_b32 v208, v68, v69, s[82:83]
    v_cndmask_b32 v209, v70, v71, s[82:83]
    v_cndmask_b32 v208, v208, v209, s[84:85]
    v_cndmask_b32 v208, 0, v208, s[80:81]
    v_cndmask_b32 v210, v72, v73, s[82:83]
    v_cndmask_b32 v211, v74, v75, s[82:83]
    v_cndmask_b32 v210, v210, v211, s[84:85]
    v_cndmask_b32 v210, 0, v210, s[80:81]
    v_mov_b32 v209, v208
    v_mov_b32 v211, v210
    s_nop 0
    v_permlane16_swap_b32 v208, v209
    v_permlane16_swap_b32 v210, v211
    v_add_f32 v208, v208, v209
    v_add_f32 v210, v210, v211
    v_mov_b32 v209, v208
    v_mov_b32 v211, v210
    s_nop 0
    v_permlane32_swap_b32 v208, v209
    v_permlane32_swap_b32 v210, v211
    v_add_f32 v208, v208, v209
    v_add_f32 v210, v210, v211
    v_mul_f32 v209, 0x3ae38e39, v60
    v_mul_f32 v208, 0x3ae38e39, v208
    ds_write_b32 v254, v209 offset:0
    v_fma_f32 v208, -v209, v209, v208
    v_max_f32 v208, 0, v208
    v_add_f32 v208, 0x3727c5ac, v208
    v_rsq_f32 v140, v208
    v_mul_f32 v211, 0x3ae38e39, v64
    s_mul_i32 s96, s48, 221184
    s_sub_u32 s96, s87, s96
    s_add_u32 s96, s96, 1769472
    s_add_u32 m0, s49, 147456
    s_nop 0
    buffer_load_dwordx4 v248, s[8:11], s96 offen lds
    v_mul_f32 v210, 0x3ae38e39, v210
    ds_write_b32 v254, v211 offset:64
    v_fma_f32 v210, -v211, v211, v210
    v_max_f32 v210, 0, v210
    v_add_f32 v210, 0x3727c5ac, v210
    v_rsq_f32 v141, v210
    v_mul_f32 v142, -v209, v140
    v_mul_f32 v143, -v211, v141
    s_waitcnt lgkmcnt(0)
    s_barrier
    ds_read_b128 v[8:11], v250 offset:0
    ds_read_b128 v[20:23], v250 offset:64
    ds_read_b128 v[44:47], v250 offset:128
    ds_read_b128 v[56:59], v250 offset:192
    s_mov_b32 s98, 1069066811
    s_waitcnt lgkmcnt(3)
    v_pk_mul_f32 v[208:209], v[8:9], v[142:143] op_sel_hi:[1,0]
    v_pk_mul_f32 v[210:211], v[10:11], v[142:143] op_sel_hi:[1,0]
    v_pk_fma_f32 v[0:1], v[0:1], v[140:141], v[208:209] op_sel_hi:[1,0,1]
    v_pk_fma_f32 v[2:3], v[2:3], v[140:141], v[210:211] op_sel_hi:[1,0,1]
    v_cvt_pk_bf16_f32 v144, v0, v1
    v_cvt_pk_bf16_f32 v145, v2, v3
    s_waitcnt lgkmcnt(2)
    v_pk_mul_f32 v[208:209], v[20:21], v[142:143] op_sel_hi:[1,0]
    v_pk_mul_f32 v[210:211], v[22:23], v[142:143] op_sel_hi:[1,0]
    v_pk_fma_f32 v[12:13], v[12:13], v[140:141], v[208:209] op_sel_hi:[1,0,1]
    v_pk_fma_f32 v[14:15], v[14:15], v[140:141], v[210:211] op_sel_hi:[1,0,1]
    v_cvt_pk_bf16_f32 v146, v12, v13
    v_cvt_pk_bf16_f32 v147, v14, v15
    v_pk_mul_f32 v[208:209], v[32:33], v[142:143] op_sel_hi:[1,0]
    s_add_u32 s96, s87, 0
    s_add_u32 m0, s77, 106496
    s_nop 0
    buffer_load_dwordx4 v235, s[8:11], s96 offen offset:0 lds
    v_pk_mul_f32 v[210:211], v[34:35], v[142:143] op_sel_hi:[1,0]
    v_pk_fma_f32 v[24:25], v[24:25], v[140:141], v[208:209] op_sel_hi:[1,0,1]
    v_pk_fma_f32 v[26:27], v[26:27], v[140:141], v[210:211] op_sel_hi:[1,0,1]
    v_cvt_pk_bf16_f32 v148, v24, v25
    v_cvt_pk_bf16_f32 v149, v26, v27
    v_mfma_f32_16x16x32_bf16 v[160:163], v[104:107], v[144:147], 0
    s_nop 0
    v_mfma_f32_16x16x32_bf16 v[160:163], v[108:111], v[148:151], v[160:163]
    v_mfma_f32_16x16x32_bf16 v[164:167], v[112:115], v[144:147], 0
    v_mfma_f32_16x16x32_bf16 v[164:167], v[116:119], v[148:151], v[164:167]
    v_mfma_f32_16x16x32_bf16 v[168:171], v[120:123], v[144:147], 0
    v_mfma_f32_16x16x32_bf16 v[168:171], v[124:127], v[148:151], v[168:171]
    v_pk_mul_f32 v[208:209], v[8:9], v[142:143] op_sel:[0,1] op_sel_hi:[1,1]
    v_pk_mul_f32 v[210:211], v[10:11], v[142:143] op_sel:[0,1] op_sel_hi:[1,1]
    v_pk_fma_f32 v[4:5], v[4:5], v[140:141], v[208:209] op_sel:[0,1,0] op_sel_hi:[1,1,1]
    v_pk_fma_f32 v[6:7], v[6:7], v[140:141], v[210:211] op_sel:[0,1,0] op_sel_hi:[1,1,1]
    v_cvt_pk_bf16_f32 v152, v4, v5
    v_cvt_pk_bf16_f32 v153, v6, v7
    v_pk_mul_f32 v[208:209], v[20:21], v[142:143] op_sel:[0,1] op_sel_hi:[1,1]
    v_pk_mul_f32 v[210:211], v[22:23], v[142:143] op_sel:[0,1] op_sel_hi:[1,1]
    v_pk_fma_f32 v[16:17], v[16:17], v[140:141], v[208:209] op_sel:[0,1,0] op_sel_hi:[1,1,1]
    v_pk_fma_f32 v[18:19], v[18:19], v[140:141], v[210:211] op_sel:[0,1,0] op_sel_hi:[1,1,1]
    v_cvt_pk_bf16_f32 v154, v16, v17
    v_cvt_pk_bf16_f32 v155, v18, v19
    v_pk_mul_f32 v[208:209], v[32:33], v[142:143] op_sel:[0,1] op_sel_hi:[1,1]
    v_pk_mul_f32 v[210:211], v[34:35], v[142:143] op_sel:[0,1] op_sel_hi:[1,1]
    v_pk_fma_f32 v[28:29], v[28:29], v[140:141], v[208:209] op_sel:[0,1,0] op_sel_hi:[1,1,1]
    v_pk_fma_f32 v[30:31], v[30:31], v[140:141], v[210:211] op_sel:[0,1,0] op_sel_hi:[1,1,1]
    v_cvt_pk_bf16_f32 v156, v28, v29
    buffer_load_dwordx4 v236, s[8:11], s96 offen offset:1024 lds
    v_cvt_pk_bf16_f32 v157, v30, v31
    v_mfma_f32_16x16x32_bf16 v[172:175], v[104:107], v[152:155], 0
    s_nop 0
    v_mfma_f32_16x16x32_bf16 v[172:175], v[108:111], v[156:159], v[172:175]
    v_mfma_f32_16x16x32_bf16 v[176:179], v[112:115], v[152:155], 0
    v_mfma_f32_16x16x32_bf16 v[176:179], v[116:119], v[156:159], v[176:179]
    v_mfma_f32_16x16x32_bf16 v[180:183], v[120:123], v[152:155], 0
    v_mfma_f32_16x16x32_bf16 v[180:183], v[124:127], v[156:159], v[180:183]
    s_waitcnt lgkmcnt(1)
    v_pk_mul_f32 v[208:209], v[44:45], v[142:143] op_sel_hi:[1,0]
    v_pk_mul_f32 v[210:211], v[46:47], v[142:143] op_sel_hi:[1,0]
    v_pk_fma_f32 v[36:37], v[36:37], v[140:141], v[208:209] op_sel_hi:[1,0,1]
    v_pk_fma_f32 v[38:39], v[38:39], v[140:141], v[210:211] op_sel_hi:[1,0,1]
    v_cvt_pk_bf16_f32 v212, v36, v37
    v_cvt_pk_bf16_f32 v213, v38, v39
    s_waitcnt lgkmcnt(0)
    v_pk_mul_f32 v[208:209], v[56:57], v[142:143] op_sel_hi:[1,0]
    v_pk_mul_f32 v[210:211], v[58:59], v[142:143] op_sel_hi:[1,0]
    v_pk_fma_f32 v[48:49], v[48:49], v[140:141], v[208:209] op_sel_hi:[1,0,1]
    v_pk_fma_f32 v[50:51], v[50:51], v[140:141], v[210:211] op_sel_hi:[1,0,1]
    v_cvt_pk_bf16_f32 v214, v48, v49
    v_cvt_pk_bf16_f32 v215, v50, v51
    v_cndmask_b32 v216, v148, v76, s[94:95]
    v_cndmask_b32 v217, v149, v76, s[94:95]
    ds_write_b64 v241, v[212:213] offset:192
    ds_write_b64 v241, v[214:215] offset:224
    ds_write_b64 v241, v[216:217] offset:256
    v_pk_mul_f32 v[208:209], v[44:45], v[142:143] op_sel:[0,1] op_sel_hi:[1,1]
    v_pk_mul_f32 v[210:211], v[46:47], v[142:143] op_sel:[0,1] op_sel_hi:[1,1]
    v_pk_fma_f32 v[40:41], v[40:41], v[140:141], v[208:209] op_sel:[0,1,0] op_sel_hi:[1,1,1]
    v_pk_fma_f32 v[42:43], v[42:43], v[140:141], v[210:211] op_sel:[0,1,0] op_sel_hi:[1,1,1]
    buffer_load_dwordx4 v237, s[8:11], s96 offen offset:2048 lds
    v_cvt_pk_bf16_f32 v212, v40, v41
    v_cvt_pk_bf16_f32 v213, v42, v43
    v_pk_mul_f32 v[208:209], v[56:57], v[142:143] op_sel:[0,1] op_sel_hi:[1,1]
    v_pk_mul_f32 v[210:211], v[58:59], v[142:143] op_sel:[0,1] op_sel_hi:[1,1]
    v_pk_fma_f32 v[52:53], v[52:53], v[140:141], v[208:209] op_sel:[0,1,0] op_sel_hi:[1,1,1]
    v_pk_fma_f32 v[54:55], v[54:55], v[140:141], v[210:211] op_sel:[0,1,0] op_sel_hi:[1,1,1]
    v_cvt_pk_bf16_f32 v214, v52, v53
    v_cvt_pk_bf16_f32 v215, v54, v55
    v_cndmask_b32 v216, v156, v76, s[94:95]
    v_cndmask_b32 v217, v157, v76, s[94:95]
    ds_write_b64 v241, v[212:213] offset:4800
    ds_write_b64 v241, v[214:215] offset:4832
    ds_write_b64 v241, v[216:217] offset:4864
    v_max3_f32 v208, v160, v161, v162
    v_min3_f32 v209, v160, v161, v162
    v_max3_f32 v208, v208, v163, v164
    v_min3_f32 v209, v209, v163, v164
    v_max3_f32 v208, v208, v165, v166
    v_min3_f32 v209, v209, v165, v166
    v_max3_f32 v208, v208, v167, v168
    v_min3_f32 v209, v209, v167, v168
    v_mov_b32 v210, v208
    v_mov_b32 v211, v209
    s_nop 0
    v_permlane16_swap_b32 v208, v210
    v_permlane16_swap_b32 v209, v211
    v_max_f32 v208, v208, v210
    v_min_f32 v209, v209, v211
    v_pk_mul_f32 v[208:209], v[208:209], s[98:99] op_sel_hi:[1,0]
    buffer_load_dwordx4 v238, s[8:11], s96 offen offset:3072 lds
    v_pk_fma_f32 v[212:213], v[160:161], s[98:99], v[208:209] op_sel_hi:[1,0,0] neg_lo:[0,0,1] neg_hi:[0,0,1]
    v_pk_fma_f32 v[222:223], v[160:161], s[98:99], v[208:209] op_sel:[0,0,1] op_sel_hi:[1,0,1] neg_lo:[1,0,0] neg_hi:[1,0,0]
    v_pk_fma_f32 v[214:215], v[162:163], s[98:99], v[208:209] op_sel_hi:[1,0,0] neg_lo:[0,0,1] neg_hi:[0,0,1]
    v_pk_fma_f32 v[224:225], v[162:163], s[98:99], v[208:209] op_sel:[0,0,1] op_sel_hi:[1,0,1] neg_lo:[1,0,0] neg_hi:[1,0,0]
    v_pk_fma_f32 v[216:217], v[164:165], s[98:99], v[208:209] op_sel_hi:[1,0,0] neg_lo:[0,0,1] neg_hi:[0,0,1]
    v_pk_fma_f32 v[226:227], v[164:165], s[98:99], v[208:209] op_sel:[0,0,1] op_sel_hi:[1,0,1] neg_lo:[1,0,0] neg_hi:[1,0,0]
    v_pk_fma_f32 v[218:219], v[166:167], s[98:99], v[208:209] op_sel_hi:[1,0,0] neg_lo:[0,0,1] neg_hi:[0,0,1]
    v_pk_fma_f32 v[228:229], v[166:167], s[98:99], v[208:209] op_sel:[0,0,1] op_sel_hi:[1,0,1] neg_lo:[1,0,0] neg_hi:[1,0,0]
    v_fma_f32 v220, v168, s98, -v208
    v_fma_f32 v230, -v168, s98, v209
    v_exp_f32 v212, v212
    v_exp_f32 v222, v222
    v_exp_f32 v213, v213
    v_exp_f32 v223, v223
    v_exp_f32 v214, v214
    v_exp_f32 v224, v224
    v_exp_f32 v215, v215
    v_exp_f32 v225, v225
    v_exp_f32 v216, v216
    v_exp_f32 v226, v226
    v_exp_f32 v217, v217
    v_exp_f32 v227, v227
    v_exp_f32 v218, v218
    v_exp_f32 v228, v228
    v_exp_f32 v219, v219
    v_exp_f32 v229, v229
    v_exp_f32 v220, v220
    v_exp_f32 v230, v230
    s_add_u32 m0, s77, 110592
    s_nop 0
    buffer_load_dwordx4 v239, s[8:11], s96 offen offset:0 lds
    v_pk_add_f32 v[208:209], v[212:213], v[214:215]
    v_pk_add_f32 v[210:211], v[222:223], v[224:225]
    v_pk_add_f32 v[208:209], v[208:209], v[216:217]
    v_pk_add_f32 v[210:211], v[210:211], v[226:227]
    v_pk_add_f32 v[208:209], v[208:209], v[218:219]
    v_pk_add_f32 v[210:211], v[210:211], v[228:229]
    v_add_f32 v208, v208, v209
    v_add_f32 v209, v210, v211
    v_add_f32 v208, v208, v220
    v_add_f32 v209, v209, v230
    v_mov_b32 v210, v208
    v_mov_b32 v211, v209
    s_nop 0
    v_permlane16_swap_b32 v208, v210
    v_permlane16_swap_b32 v209, v211
    v_pk_add_f32 v[208:209], v[208:209], v[210:211]
    v_rcp_f32 v208, v208
    v_rcp_f32 v209, v209
    v_mul_f32 v220, v220, v208
    v_mul_f32 v230, v230, v209
    v_pk_mul_f32 v[212:213], v[212:213], v[208:209] op_sel_hi:[1,0]
    v_pk_mul_f32 v[222:223], v[222:223], v[208:209] op_sel:[0,1] op_sel_hi:[1,1]
    v_pk_mul_f32 v[214:215], v[214:215], v[208:209] op_sel_hi:[1,0]
    v_pk_mul_f32 v[224:225], v[224:225], v[208:209] op_sel:[0,1] op_sel_hi:[1,1]
    v_pk_mul_f32 v[216:217], v[216:217], v[208:209] op_sel_hi:[1,0]
    v_pk_mul_f32 v[226:227], v[226:227], v[208:209] op_sel:[0,1] op_sel_hi:[1,1]
    v_pk_mul_f32 v[218:219], v[218:219], v[208:209] op_sel_hi:[1,0]
    v_pk_mul_f32 v[228:229], v[228:229], v[208:209] op_sel:[0,1] op_sel_hi:[1,1]
    v_cvt_pk_bf16_f32 v184, v212, v213
    s_add_u32 s96, s87, 884736
    s_add_u32 m0, s77, 126976
    s_nop 0
    buffer_load_dwordx4 v235, s[8:11], s96 offen offset:0 lds
    v_cvt_pk_bf16_f32 v185, v214, v215
    v_cvt_pk_bf16_f32 v186, v216, v217
    v_cvt_pk_bf16_f32 v188, v218, v219
    v_cvt_pk_bf16_f32 v189, v220, v222
    v_cvt_pk_bf16_f32 v190, v223, v224
    v_cvt_pk_bf16_f32 v192, v225, v226
    v_cvt_pk_bf16_f32 v193, v227, v228
    v_cvt_pk_bf16_f32 v194, v229, v230
    ds_write_b128 v240, v[184:187] offset:0
    ds_write_b128 v240, v[188:191] offset:16
    ds_write_b128 v240, v[192:195] offset:32
    v_max3_f32 v208, v172, v173, v174
    v_min3_f32 v209, v172, v173, v174
    v_max3_f32 v208, v208, v175, v176
    v_min3_f32 v209, v209, v175, v176
    v_max3_f32 v208, v208, v177, v178
    v_min3_f32 v209, v209, v177, v178
    v_max3_f32 v208, v208, v179, v180
    v_min3_f32 v209, v209, v179, v180
    v_mov_b32 v210, v208
    v_mov_b32 v211, v209
    s_nop 0
    v_permlane16_swap_b32 v208, v210
    v_permlane16_swap_b32 v209, v211
    v_max_f32 v208, v208, v210
    v_min_f32 v209, v209, v211
    v_pk_mul_f32 v[208:209], v[208:209], s[98:99] op_sel_hi:[1,0]
    v_pk_fma_f32 v[212:213], v[172:173], s[98:99], v[208:209] op_sel_hi:[1,0,0] neg_lo:[0,0,1] neg_hi:[0,0,1]
    v_pk_fma_f32 v[222:223], v[172:173], s[98:99], v[208:209] op_sel:[0,0,1] op_sel_hi:[1,0,1] neg_lo:[1,0,0] neg_hi:[1,0,0]
    buffer_load_dwordx4 v236, s[8:11], s96 offen offset:1024 lds
    v_pk_fma_f32 v[214:215], v[174:175], s[98:99], v[208:209] op_sel_hi:[1,0,0] neg_lo:[0,0,1] neg_hi:[0,0,1]
    v_pk_fma_f32 v[224:225], v[174:175], s[98:99], v[208:209] op_sel:[0,0,1] op_sel_hi:[1,0,1] neg_lo:[1,0,0] neg_hi:[1,0,0]
    v_pk_fma_f32 v[216:217], v[176:177], s[98:99], v[208:209] op_sel_hi:[1,0,0] neg_lo:[0,0,1] neg_hi:[0,0,1]
    v_pk_fma_f32 v[226:227], v[176:177], s[98:99], v[208:209] op_sel:[0,0,1] op_sel_hi:[1,0,1] neg_lo:[1,0,0] neg_hi:[1,0,0]
    v_pk_fma_f32 v[218:219], v[178:179], s[98:99], v[208:209] op_sel_hi:[1,0,0] neg_lo:[0,0,1] neg_hi:[0,0,1]
    v_pk_fma_f32 v[228:229], v[178:179], s[98:99], v[208:209] op_sel:[0,0,1] op_sel_hi:[1,0,1] neg_lo:[1,0,0] neg_hi:[1,0,0]
    v_fma_f32 v220, v180, s98, -v208
    v_fma_f32 v230, -v180, s98, v209
    v_exp_f32 v212, v212
    v_exp_f32 v222, v222
    v_exp_f32 v213, v213
    v_exp_f32 v223, v223
    v_exp_f32 v214, v214
    v_exp_f32 v224, v224
    v_exp_f32 v215, v215
    v_exp_f32 v225, v225
    v_exp_f32 v216, v216
    v_exp_f32 v226, v226
    v_exp_f32 v217, v217
    v_exp_f32 v227, v227
    v_exp_f32 v218, v218
    v_exp_f32 v228, v228
    v_exp_f32 v219, v219
    v_exp_f32 v229, v229
    v_exp_f32 v220, v220
    v_exp_f32 v230, v230
    v_pk_add_f32 v[208:209], v[212:213], v[214:215]
    v_pk_add_f32 v[210:211], v[222:223], v[224:225]
    buffer_load_dwordx4 v237, s[8:11], s96 offen offset:2048 lds
    v_pk_add_f32 v[208:209], v[208:209], v[216:217]
    v_pk_add_f32 v[210:211], v[210:211], v[226:227]
    v_pk_add_f32 v[208:209], v[208:209], v[218:219]
    v_pk_add_f32 v[210:211], v[210:211], v[228:229]
    v_add_f32 v208, v208, v209
    v_add_f32 v209, v210, v211
    v_add_f32 v208, v208, v220
    v_add_f32 v209, v209, v230
    v_mov_b32 v210, v208
    v_mov_b32 v211, v209
    s_nop 0
    v_permlane16_swap_b32 v208, v210
    v_permlane16_swap_b32 v209, v211
    v_pk_add_f32 v[208:209], v[208:209], v[210:211]
    v_rcp_f32 v208, v208
    v_rcp_f32 v209, v209
    v_mul_f32 v220, v220, v208
    v_mul_f32 v230, v230, v209
    v_pk_mul_f32 v[212:213], v[212:213], v[208:209] op_sel_hi:[1,0]
    v_pk_mul_f32 v[222:223], v[222:223], v[208:209] op_sel:[0,1] op_sel_hi:[1,1]
    v_pk_mul_f32 v[214:215], v[214:215], v[208:209] op_sel_hi:[1,0]
    v_pk_mul_f32 v[224:225], v[224:225], v[208:209] op_sel:[0,1] op_sel_hi:[1,1]
    v_pk_mul_f32 v[216:217], v[216:217], v[208:209] op_sel_hi:[1,0]
    v_pk_mul_f32 v[226:227], v[226:227], v[208:209] op_sel:[0,1] op_sel_hi:[1,1]
    v_pk_mul_f32 v[218:219], v[218:219], v[208:209] op_sel_hi:[1,0]
    v_pk_mul_f32 v[228:229], v[228:229], v[208:209] op_sel:[0,1] op_sel_hi:[1,1]
    v_cvt_pk_bf16_f32 v196, v212, v213
    v_cvt_pk_bf16_f32 v197, v214, v215
    v_cvt_pk_bf16_f32 v198, v216, v217
    buffer_load_dwordx4 v238, s[8:11], s96 offen offset:3072 lds
    v_cvt_pk_bf16_f32 v200, v218, v219
    v_cvt_pk_bf16_f32 v201, v220, v222
    v_cvt_pk_bf16_f32 v202, v223, v224
    v_cvt_pk_bf16_f32 v204, v225, v226
    v_cvt_pk_bf16_f32 v205, v227, v228
    v_cvt_pk_bf16_f32 v206, v229, v230
    ds_write_b128 v240, v[196:199] offset:4608
    ds_write_b128 v240, v[200:203] offset:4624
    ds_write_b128 v240, v[204:207] offset:4640
    s_waitcnt lgkmcnt(0)
    s_barrier
    ds_read_b64_tr_b16 v[12:13], v243 offset:192
    ds_read_b64_tr_b16 v[14:15], v243 offset:4800
    ds_read_b64_tr_b16 v[0:1], v242 offset:0
    ds_read_b64_tr_b16 v[2:3], v242 offset:4608
    ds_read_b64_tr_b16 v[4:5], v242 offset:32
    ds_read_b64_tr_b16 v[6:7], v242 offset:4640
    ds_read_b64_tr_b16 v[8:9], v242 offset:64
    ds_read_b64_tr_b16 v[10:11], v242 offset:4672
    ds_read_b64_tr_b16 v[28:29], v243 offset:9408
    ds_read_b64_tr_b16 v[30:31], v243 offset:14016
    ds_read_b64_tr_b16 v[16:17], v242 offset:9216
    ds_read_b64_tr_b16 v[18:19], v242 offset:13824
    ds_read_b64_tr_b16 v[20:21], v242 offset:9248
    ds_read_b64_tr_b16 v[22:23], v242 offset:13856
    ds_read_b64_tr_b16 v[24:25], v242 offset:9280
    ds_read_b64_tr_b16 v[26:27], v242 offset:13888
    s_waitcnt lgkmcnt(12)
    v_mfma_f32_16x16x32_bf16 v[160:163], v[0:3], v[12:15], 0
    s_waitcnt lgkmcnt(10)
    v_mfma_f32_16x16x32_bf16 v[164:167], v[4:7], v[12:15], 0
    s_waitcnt lgkmcnt(8)
    v_mfma_f32_16x16x32_bf16 v[168:171], v[8:11], v[12:15], 0
    ds_read_b64_tr_b16 v[44:45], v243 offset:18624
    s_add_u32 m0, s77, 131072
    s_nop 0
    buffer_load_dwordx4 v239, s[8:11], s96 offen offset:0 lds
    ds_read_b64_tr_b16 v[46:47], v243 offset:23232
    ds_read_b64_tr_b16 v[32:33], v242 offset:18432
    ds_read_b64_tr_b16 v[34:35], v242 offset:23040
    ds_read_b64_tr_b16 v[36:37], v242 offset:18464
    ds_read_b64_tr_b16 v[38:39], v242 offset:23072
    ds_read_b64_tr_b16 v[40:41], v242 offset:18496
    ds_read_b64_tr_b16 v[42:43], v242 offset:23104
    s_waitcnt lgkmcnt(12)
    v_mfma_f32_16x16x32_bf16 v[160:163], v[16:19], v[28:31], v[160:163]
    s_waitcnt lgkmcnt(10)
    v_mfma_f32_16x16x32_bf16 v[164:167], v[20:23], v[28:31], v[164:167]
    s_waitcnt lgkmcnt(8)
    v_mfma_f32_16x16x32_bf16 v[168:171], v[24:27], v[28:31], v[168:171]
    ds_read_b64_tr_b16 v[60:61], v243 offset:27840
    ds_read_b64_tr_b16 v[62:63], v243 offset:32448
    ds_read_b64_tr_b16 v[48:49], v242 offset:27648
    ds_read_b64_tr_b16 v[50:51], v242 offset:32256
    ds_read_b64_tr_b16 v[52:53], v242 offset:27680
    ds_read_b64_tr_b16 v[54:55], v242 offset:32288
    ds_read_b64_tr_b16 v[56:57], v242 offset:27712
    ds_read_b64_tr_b16 v[58:59], v242 offset:32320
    s_waitcnt lgkmcnt(12)
    v_mfma_f32_16x16x32_bf16 v[160:163], v[32:35], v[44:47], v[160:163]
    s_waitcnt lgkmcnt(10)
    v_mfma_f32_16x16x32_bf16 v[164:167], v[36:39], v[44:47], v[164:167]
    s_waitcnt lgkmcnt(8)
    v_mfma_f32_16x16x32_bf16 v[168:171], v[40:43], v[44:47], v[168:171]
    s_waitcnt lgkmcnt(4)
    v_mfma_f32_16x16x32_bf16 v[160:163], v[48:51], v[60:63], v[160:163]
    s_waitcnt lgkmcnt(2)
    v_mfma_f32_16x16x32_bf16 v[164:167], v[52:55], v[60:63], v[164:167]
    s_waitcnt lgkmcnt(0)
    v_mfma_f32_16x16x32_bf16 v[168:171], v[56:59], v[60:63], v[168:171]
    s_waitcnt vmcnt(13)
    v_cmp_eq_u32 vcc, 0, v233
    s_nop 0
    s_cbranch_vccnz sequential_preLN__linear_kernel_hedgehog__glu_gated_reglu__prompt_kernel_rdy_15
sequential_preLN__linear_kernel_hedgehog__glu_gated_reglu__prompt_kernel_rdy_15_b:
    v_readfirstlane_b32 s3, v233
    v_cvt_pk_bf16_f32 v208, v160, v161
    v_cvt_pk_bf16_f32 v209, v162, v163
    v_cvt_pk_bf16_f32 v210, v164, v165
    v_cvt_pk_bf16_f32 v211, v166, v167
    v_cvt_pk_bf16_f32 v212, v168, v169
    v_cvt_pk_bf16_f32 v213, v170, v171
    buffer_store_dwordx2 v[208:209], v253, s[36:39], s78 offen offset:0 sc1
    buffer_store_dwordx2 v[210:211], v253, s[36:39], s78 offen offset:32 sc1
    buffer_store_dwordx2 v[212:213], v253, s[36:39], s78 offen offset:64 sc1
    s_waitcnt vmcnt(3)
    s_barrier
    v_lshrrev_b32 v245, 2, v139
    v_mul_u32_u24 v245, 80, v245
    s_and_b32 s96, s59, 1
    s_lshl_b32 s96, s96, 3
    s_add_u32 s96, s96, 106496
    v_add_u32 v245, s96, v245
    v_and_b32 v244, 3, v139
    v_lshl_add_u32 v244, v244, 3, v245
    v_add_u32 v245, 32, v245
    ds_read_b64_tr_b16 v[80:81], v244 offset:0
    ds_read_b64_tr_b16 v[82:83], v244 offset:1280
    ds_read_b64_tr_b16 v[84:85], v244 offset:40
    ds_read_b64_tr_b16 v[86:87], v244 offset:1320
    ds_read_b64_tr_b16 v[88:89], v245 offset:0
    ds_read_b64_tr_b16 v[90:91], v245 offset:1280
    ds_read_b64_tr_b16 v[92:93], v244 offset:2560
    ds_read_b64_tr_b16 v[94:95], v244 offset:3840
    s_waitcnt lgkmcnt(4)
    v_mfma_f32_16x16x32_bf16 v[0:3], v[80:83], a[0:3], 0
    ds_read_b64_tr_b16 v[96:97], v244 offset:2600
    ds_read_b64_tr_b16 v[98:99], v244 offset:3880
    v_mfma_f32_16x16x32_bf16 v[4:7], v[80:83], a[4:7], 0
    s_lshl_b32 s98, s48, 3
    v_lshrrev_b32 v216, 3, v139
    v_mfma_f32_16x16x32_bf16 v[8:11], v[80:83], v[76:79], 0
    ds_read_b64_tr_b16 v[100:101], v245 offset:2560
    ds_read_b64_tr_b16 v[102:103], v245 offset:3840
    v_mfma_f32_16x16x32_bf16 v[12:15], v[84:87], a[0:3], 0
    v_add_u32 v216, s98, v216
    v_and_b32 v217, 6, v216
    v_mfma_f32_16x16x32_bf16 v[16:19], v[84:87], a[4:7], 0
    v_and_b32 v218, 7, v139
    v_xor_b32 v217, v217, v218
    v_mfma_f32_16x16x32_bf16 v[20:23], v[84:87], v[76:79], 0
    ds_read_b64_tr_b16 v[80:81], v244 offset:5120
    ds_read_b64_tr_b16 v[82:83], v244 offset:6400
    s_waitcnt lgkmcnt(6)
    v_mfma_f32_16x16x32_bf16 v[24:27], v[88:91], a[0:3], 0
    v_lshlrev_b32 v217, 4, v217
    v_lshrrev_b32 v218, 4, v216
    v_mfma_f32_16x16x32_bf16 v[28:31], v[88:91], a[4:7], 0
    v_and_b32 v219, 3, v216
    v_lshl_add_u32 v218, v218, 2, v219
    v_mfma_f32_16x16x32_bf16 v[32:35], v[88:91], v[76:79], 0
    ds_read_b64_tr_b16 v[84:85], v244 offset:5160
    ds_read_b64_tr_b16 v[86:87], v244 offset:6440
    v_mfma_f32_16x16x32_bf16 v[0:3], v[92:95], a[8:11], v[0:3]
    v_bfe_u32 v219, v216, 2, 2
    v_lshl_add_u32 v128, v219, 3, v218
    v_mfma_f32_16x16x32_bf16 v[4:7], v[92:95], a[12:15], v[4:7]
    v_lshrrev_b32 v129, 1, v219
    v_lshl_add_u32 v128, v129, 1, v128
    v_mfma_f32_16x16x32_bf16 v[8:11], v[92:95], v[76:79], v[8:11]
    ds_read_b64_tr_b16 v[88:89], v245 offset:5120
    ds_read_b64_tr_b16 v[90:91], v245 offset:6400
    s_waitcnt lgkmcnt(6)
    v_mfma_f32_16x16x32_bf16 v[12:15], v[96:99], a[8:11], v[12:15]
    v_lshrrev_b32 v129, 1, v218
    v_lshl_add_u32 v129, v219, 2, v129
    v_mfma_f32_16x16x32_bf16 v[16:19], v[96:99], a[12:15], v[16:19]
    v_mul_u32_u24 v129, 18, v129
    v_and_b32 v218, 1, v218
    v_mfma_f32_16x16x32_bf16 v[20:23], v[96:99], v[76:79], v[20:23]
    ds_read_b64_tr_b16 v[92:93], v244 offset:7680
    ds_read_b64_tr_b16 v[94:95], v244 offset:8960
    v_mfma_f32_16x16x32_bf16 v[24:27], v[100:103], a[8:11], v[24:27]
    v_add3_u32 v129, v129, v218, 16
    s_movk_i32 s98, 1152
    v_mfma_f32_16x16x32_bf16 v[28:31], v[100:103], a[12:15], v[28:31]
    v_mad_u32_u24 v128, v128, s98, v217
    v_mad_u32_u24 v129, v129, s98, v217
    v_mfma_f32_16x16x32_bf16 v[32:35], v[100:103], v[76:79], v[32:35]
    ds_read_b64_tr_b16 v[96:97], v244 offset:7720
    ds_read_b64_tr_b16 v[98:99], v244 offset:9000
    s_waitcnt lgkmcnt(6)
    v_mfma_f32_16x16x32_bf16 v[0:3], v[80:83], a[16:19], v[0:3]
    s_and_b32 s87, s59, 7
    s_lshl_b32 s87, s87, 7
    v_mfma_f32_16x16x32_bf16 v[4:7], v[80:83], a[20:23], v[4:7]
    s_lshr_b32 s96, s59, 3
    s_lshl_b32 s96, s96, 2
    v_mfma_f32_16x16x32_bf16 v[8:11], v[80:83], v[76:79], v[8:11]
    ds_read_b64_tr_b16 v[100:101], v245 offset:7680
    ds_read_b64_tr_b16 v[102:103], v245 offset:8960
    v_mfma_f32_16x16x32_bf16 v[12:15], v[84:87], a[16:19], v[12:15]
    s_lshl_b32 s97, s58, 3
    s_add_u32 s96, s96, s97
    v_mfma_f32_16x16x32_bf16 v[16:19], v[84:87], a[20:23], v[16:19]
    s_add_u32 s88, s96, s48
    v_mfma_f32_16x16x32_bf16 v[20:23], v[84:87], v[76:79], v[20:23]
    ds_read_b64_tr_b16 v[80:81], v244 offset:10240
    ds_read_b64_tr_b16 v[82:83], v244 offset:11520
    s_waitcnt lgkmcnt(6)
    v_mfma_f32_16x16x32_bf16 v[24:27], v[88:91], a[16:19], v[24:27]
    v_mfma_f32_16x16x32_bf16 v[28:31], v[88:91], a[20:23], v[28:31]
    v_mfma_f32_16x16x32_bf16 v[32:35], v[88:91], v[76:79], v[32:35]
    ds_read_b64_tr_b16 v[84:85], v244 offset:10280
    ds_read_b64_tr_b16 v[86:87], v244 offset:11560
    v_mfma_f32_16x16x32_bf16 v[0:3], v[92:95], a[24:27], v[0:3]
    v_mfma_f32_16x16x32_bf16 v[4:7], v[92:95], a[28:31], v[4:7]
    v_mfma_f32_16x16x32_bf16 v[8:11], v[92:95], v[76:79], v[8:11]
    ds_read_b64_tr_b16 v[88:89], v245 offset:10240
    ds_read_b64_tr_b16 v[90:91], v245 offset:11520
    s_waitcnt lgkmcnt(6)
    v_mfma_f32_16x16x32_bf16 v[12:15], v[96:99], a[24:27], v[12:15]
    v_mfma_f32_16x16x32_bf16 v[16:19], v[96:99], a[28:31], v[16:19]
    v_mfma_f32_16x16x32_bf16 v[20:23], v[96:99], v[76:79], v[20:23]
    ds_read_b64_tr_b16 v[92:93], v244 offset:12800
    ds_read_b64_tr_b16 v[94:95], v244 offset:14080
    s_waitcnt vmcnt(0)
    v_mov_b32 v215, 1
    s_mov_b64 exec, 1
    buffer_store_dword v215, off, s[36:39], s52 sc1
    s_mov_b64 exec, -1
    v_mfma_f32_16x16x32_bf16 v[24:27], v[100:103], a[24:27], v[24:27]
    s_add_u32 s96, s87, 0
    s_add_u32 m0, s49, 0
    s_nop 0
    buffer_load_dwordx4 v128, s[16:19], s96 offen lds
    v_mfma_f32_16x16x32_bf16 v[28:31], v[100:103], a[28:31], v[28:31]
    v_lshrrev_b32 v212, 2, v139
    v_and_b32 v232, 3, v212
    v_mfma_f32_16x16x32_bf16 v[32:35], v[100:103], v[76:79], v[32:35]
    ds_read_b64_tr_b16 v[96:97], v244 offset:12840
    ds_read_b64_tr_b16 v[98:99], v244 offset:14120
    s_waitcnt lgkmcnt(6)
    v_mfma_f32_16x16x32_bf16 v[0:3], v[80:83], a[32:35], v[0:3]
    v_lshlrev_b32 v232, 13, v232
    v_lshrrev_b32 v213, 2, v212
    v_mfma_f32_16x16x32_bf16 v[4:7], v[80:83], a[36:39], v[4:7]
    v_lshl_add_u32 v232, v213, 8, v232
    s_and_b32 s97, s59, 7
    v_mfma_f32_16x16x32_bf16 v[8:11], v[80:83], v[76:79], v[8:11]
    ds_read_b64_tr_b16 v[100:101], v245 offset:12800
    ds_read_b64_tr_b16 v[102:103], v245 offset:14080
    v_mfma_f32_16x16x32_bf16 v[12:15], v[84:87], a[32:35], v[12:15]
    s_add_u32 s96, s87, 41472
    s_add_u32 m0, s49, 4096
    s_nop 0
    buffer_load_dwordx4 v128, s[16:19], s96 offen lds
    v_mfma_f32_16x16x32_bf16 v[16:19], v[84:87], a[36:39], v[16:19]
    s_lshl_b32 s97, s97, 10
    s_lshr_b32 s98, s59, 3
    v_mfma_f32_16x16x32_bf16 v[20:23], v[84:87], v[76:79], v[20:23]
    ds_read_b64_tr_b16 v[80:81], v244 offset:15360
    ds_read_b64_tr_b16 v[82:83], v244 offset:16640
    s_waitcnt lgkmcnt(6)
    v_mfma_f32_16x16x32_bf16 v[24:27], v[88:91], a[32:35], v[24:27]
    s_lshl_b32 s98, s98, 7
    s_add_u32 s97, s97, s98
    v_mfma_f32_16x16x32_bf16 v[28:31], v[88:91], a[36:39], v[28:31]
    v_and_b32 v212, 3, v139
    v_lshl_add_u32 v232, v212, 2, v232
    v_mfma_f32_16x16x32_bf16 v[32:35], v[88:91], v[76:79], v[32:35]
    ds_read_b64_tr_b16 v[84:85], v244 offset:15400
    ds_read_b64_tr_b16 v[86:87], v244 offset:16680
    v_mfma_f32_16x16x32_bf16 v[0:3], v[92:95], a[40:43], v[0:3]
    v_add_u32 v232, s97, v232
    v_and_b32 v212, 12, v232
    v_mfma_f32_16x16x32_bf16 v[4:7], v[92:95], a[44:47], v[4:7]
    s_add_u32 s96, s87, 82944
    s_add_u32 m0, s49, 8192
    s_nop 0
    buffer_load_dwordx4 v128, s[16:19], s96 offen lds
    v_mfma_f32_16x16x32_bf16 v[8:11], v[92:95], v[76:79], v[8:11]
    ds_read_b64_tr_b16 v[88:89], v245 offset:15360
    ds_read_b64_tr_b16 v[90:91], v245 offset:16640
    s_waitcnt lgkmcnt(6)
    v_mfma_f32_16x16x32_bf16 v[12:15], v[96:99], a[40:43], v[12:15]
    v_and_b32 v232, 0xffffff80, v232
    v_lshlrev_b32 v232, 2, v232
    v_mfma_f32_16x16x32_bf16 v[16:19], v[96:99], a[44:47], v[16:19]
    v_lshl_add_u32 v232, v212, 5, v232
    v_bfe_u32 v208, v139, 3, 1
    v_mfma_f32_16x16x32_bf16 v[20:23], v[96:99], v[76:79], v[20:23]
    ds_read_b64_tr_b16 v[92:93], v244 offset:17920
    ds_read_b64_tr_b16 v[94:95], v244 offset:19200
    v_mfma_f32_16x16x32_bf16 v[24:27], v[100:103], a[40:43], v[24:27]
    v_lshrrev_b32 v209, 5, v139
    v_cmp_eq_u32 s[90:91], v208, v209
    v_mfma_f32_16x16x32_bf16 v[28:31], v[100:103], a[44:47], v[28:31]
    v_mul_u32_u24 v208, 1824, v208
    v_bfe_u32 v209, v139, 4, 1
    v_mfma_f32_16x16x32_bf16 v[32:35], v[100:103], v[76:79], v[32:35]
    ds_read_b64_tr_b16 v[96:97], v244 offset:17960
    ds_read_b64_tr_b16 v[98:99], v244 offset:19240
    s_waitcnt lgkmcnt(6)
    v_mfma_f32_16x16x32_bf16 v[0:3], v[80:83], a[48:51], v[0:3]
    s_add_u32 s96, s87, 124416
    s_add_u32 m0, s49, 12288
    s_nop 0
    buffer_load_dwordx4 v128, s[16:19], s96 offen lds
    v_mfma_f32_16x16x32_bf16 v[4:7], v[80:83], a[52:55], v[4:7]
    v_mad_u32_u24 v208, v209, 48, v208
    v_add_u32 v208, 92160, v208
    v_mfma_f32_16x16x32_bf16 v[8:11], v[80:83], v[76:79], v[8:11]
sequential_preLN__linear_kernel_hedgehog__glu_gated_reglu__prompt_kernel_hop0_2:
    s_cbranch_execz sequential_preLN__linear_kernel_hedgehog__glu_gated_reglu__prompt_kernel_hop0_3
    ds_read_b64_tr_b16 v[100:101], v245 offset:17920
    ds_read_b64_tr_b16 v[102:103], v245 offset:19200
    v_mfma_f32_16x16x32_bf16 v[12:15], v[84:87], a[48:51], v[12:15]
    v_bfe_u32 v209, v139, 2, 1
    v_and_b32 v210, 3, v139
    v_mfma_f32_16x16x32_bf16 v[16:19], v[84:87], a[52:55], v[16:19]
    v_lshl_add_u32 v209, v209, 3, v210
    v_mul_u32_u24 v209, 96, v209
    v_mfma_f32_16x16x32_bf16 v[20:23], v[84:87], v[76:79], v[20:23]
    ds_read_b64_tr_b16 v[80:81], v244 offset:20480
    ds_read_b64_tr_b16 v[82:83], v244 offset:21760
    s_waitcnt lgkmcnt(6)
    v_mfma_f32_16x16x32_bf16 v[24:27], v[88:91], a[48:51], v[24:27]
    s_add_u32 s96, s87, 165888
    s_add_u32 m0, s49, 16384
    s_nop 0
    buffer_load_dwordx4 v128, s[16:19], s96 offen lds
    v_mfma_f32_16x16x32_bf16 v[28:31], v[88:91], a[52:55], v[28:31]
    v_add_u32 v209, v209, v208
    v_mov_b32 v211, 96256
    v_mfma_f32_16x16x32_bf16 v[32:35], v[88:91], v[76:79], v[32:35]
    ds_read_b64_tr_b16 v[84:85], v244 offset:20520
    ds_read_b64_tr_b16 v[86:87], v244 offset:21800
    v_mfma_f32_16x16x32_bf16 v[0:3], v[92:95], a[56:59], v[0:3]
    v_cndmask_b32 v240, v211, v209, s[90:91]
    v_add_u32 v209, 15, v210
    v_mfma_f32_16x16x32_bf16 v[4:7], v[92:95], a[60:63], v[4:7]
    v_cmp_ne_u32 vcc, 0, v210
    s_nop 1
    v_cndmask_b32 v209, 18, v209, vcc
    v_mfma_f32_16x16x32_bf16 v[8:11], v[92:95], v[76:79], v[8:11]
    ds_read_b64_tr_b16 v[88:89], v245 offset:20480
    ds_read_b64_tr_b16 v[90:91], v245 offset:21760
    s_waitcnt lgkmcnt(6)
    v_mfma_f32_16x16x32_bf16 v[12:15], v[96:99], a[56:59], v[12:15]
    s_add_u32 s96, s87, 207360
    s_add_u32 m0, s49, 20480
    s_nop 0
    buffer_load_dwordx4 v128, s[16:19], s96 offen lds
    v_mfma_f32_16x16x32_bf16 v[16:19], v[96:99], a[60:63], v[16:19]
    v_mul_u32_u24 v209, 96, v209
    v_add_u32 v209, v209, v208
    v_mfma_f32_16x16x32_bf16 v[20:23], v[96:99], v[76:79], v[20:23]
    ds_read_b64_tr_b16 v[92:93], v244 offset:23040
    ds_read_b64_tr_b16 v[94:95], v244 offset:24320
    v_mfma_f32_16x16x32_bf16 v[24:27], v[100:103], a[56:59], v[24:27]
    v_cmp_ne_u32 vcc, 3, v210
    s_nop 0
    s_and_b64 vcc, vcc, s[90:91]
    v_mfma_f32_16x16x32_bf16 v[28:31], v[100:103], a[60:63], v[28:31]
    v_cndmask_b32 v241, v211, v209, vcc
    v_lshrrev_b32 v208, 5, v139
    v_mfma_f32_16x16x32_bf16 v[32:35], v[100:103], v[76:79], v[32:35]
    ds_read_b64_tr_b16 v[96:97], v244 offset:23080
    ds_read_b64_tr_b16 v[98:99], v244 offset:24360
    s_waitcnt lgkmcnt(6)
    v_mfma_f32_16x16x32_bf16 v[0:3], v[80:83], a[64:67], v[0:3]
    v_mul_u32_u24 v208, 80, v208
    v_add_u32 v208, 161792, v208
    v_mfma_f32_16x16x32_bf16 v[4:7], v[80:83], a[68:71], v[4:7]
    s_add_u32 s96, s87, 248832
    s_add_u32 m0, s49, 24576
    s_nop 0
    buffer_load_dwordx4 v128, s[16:19], s96 offen lds
    v_mfma_f32_16x16x32_bf16 v[8:11], v[80:83], v[76:79], v[8:11]
    ds_read_b64_tr_b16 v[100:101], v245 offset:23040
    ds_read_b64_tr_b16 v[102:103], v245 offset:24320
    v_mfma_f32_16x16x32_bf16 v[12:15], v[84:87], a[64:67], v[12:15]
    v_bfe_u32 v209, v139, 4, 1
    v_cmp_eq_u32 s[92:93], 1, v209
    v_mfma_f32_16x16x32_bf16 v[16:19], v[84:87], a[68:71], v[16:19]
    v_lshl_add_u32 v242, v209, 5, v208
    v_add_u32 v208, 64, v208
    v_mfma_f32_16x16x32_bf16 v[20:23], v[84:87], v[76:79], v[20:23]
    ds_read_b64_tr_b16 v[80:81], v244 offset:25600
    ds_read_b64_tr_b16 v[82:83], v244 offset:26880
    s_waitcnt lgkmcnt(6)
    v_mfma_f32_16x16x32_bf16 v[24:27], v[88:91], a[64:67], v[24:27]
    v_cndmask_b32 v243, v208, v211, s[92:93]
    v_and_b32 v208, 15, v139
    v_mfma_f32_16x16x32_bf16 v[28:31], v[88:91], a[68:71], v[28:31]
    v_lshlrev_b32 v208, 4, v208
    v_lshrrev_b32 v210, 5, v139
    v_mfma_f32_16x16x32_bf16 v[32:35], v[88:91], v[76:79], v[32:35]
    ds_read_b64_tr_b16 v[84:85], v244 offset:25640
    ds_read_b64_tr_b16 v[86:87], v244 offset:26920
    v_mfma_f32_16x16x32_bf16 v[0:3], v[92:95], a[72:75], v[0:3]
    s_add_u32 s96, s87, 290304
    s_add_u32 m0, s49, 28672
    s_nop 0
    buffer_load_dwordx4 v128, s[16:19], s96 offen lds
    v_mfma_f32_16x16x32_bf16 v[4:7], v[92:95], a[76:79], v[4:7]
    v_lshl_add_u32 v208, v210, 2, v208
    v_lshl_add_u32 v246, v209, 3, v208
    v_mfma_f32_16x16x32_bf16 v[8:11], v[92:95], v[76:79], v[8:11]
    ds_read_b64_tr_b16 v[88:89], v245 offset:25600
    ds_read_b64_tr_b16 v[90:91], v245 offset:26880
    s_waitcnt lgkmcnt(6)
    v_mfma_f32_16x16x32_bf16 v[12:15], v[96:99], a[72:75], v[12:15]
    v_add_u32 v247, s49, v234
    v_add_u32 v247, 92160, v247
    v_mfma_f32_16x16x32_bf16 v[16:19], v[96:99], a[76:79], v[16:19]
    v_mov_b32 v216, 0
    v_mov_b32 v217, 0
    v_mfma_f32_16x16x32_bf16 v[20:23], v[96:99], v[76:79], v[20:23]
    ds_read_b64_tr_b16 v[92:93], v244 offset:28160
    ds_read_b64_tr_b16 v[94:95], v244 offset:29440
    v_mfma_f32_16x16x32_bf16 v[24:27], v[100:103], a[72:75], v[24:27]
    s_add_u32 s96, s87, 331776
    s_add_u32 m0, s49, 32768
    s_nop 0
    buffer_load_dwordx4 v128, s[16:19], s96 offen lds
    v_mfma_f32_16x16x32_bf16 v[28:31], v[100:103], a[76:79], v[28:31]
    v_mov_b32 v218, 0
    v_mov_b32 v219, 0
    v_mfma_f32_16x16x32_bf16 v[32:35], v[100:103], v[76:79], v[32:35]
    ds_read_b64_tr_b16 v[96:97], v244 offset:28200
    ds_read_b64_tr_b16 v[98:99], v244 offset:29480
    s_waitcnt lgkmcnt(6)
    v_mfma_f32_16x16x32_bf16 v[0:3], v[80:83], a[80:83], v[0:3]
    v_and_b32 v210, 0x1f0, v234
    v_add_u32 v210, 96256, v210
    v_mfma_f32_16x16x32_bf16 v[4:7], v[80:83], a[84:87], v[4:7]
    ds_write_b128 v210, v[216:219]
    v_min_u32 v251, 17, v139
    v_mfma_f32_16x16x32_bf16 v[8:11], v[80:83], v[76:79], v[8:11]
    ds_read_b64_tr_b16 v[100:101], v245 offset:28160
    ds_read_b64_tr_b16 v[102:103], v245 offset:29440
    v_mfma_f32_16x16x32_bf16 v[12:15], v[84:87], a[80:83], v[12:15]
    v_add_u32 v251, 176, v251
    v_lshlrev_b32 v251, 9, v251
    v_mfma_f32_16x16x32_bf16 v[16:19], v[84:87], a[84:87], v[16:19]
    s_add_u32 s96, s87, 373248
    s_add_u32 m0, s49, 36864
    s_nop 0
    buffer_load_dwordx4 v128, s[16:19], s96 offen lds
    v_mfma_f32_16x16x32_bf16 v[20:23], v[84:87], v[76:79], v[20:23]
    ds_read_b64_tr_b16 v[80:81], v244 offset:30720
    ds_read_b64_tr_b16 v[82:83], v244 offset:32000
    s_waitcnt lgkmcnt(7)
    v_mfma_f32_16x16x32_bf16 v[24:27], v[88:91], a[80:83], v[24:27]
    s_lshr_b32 s97, s87, 8
    s_lshl_b32 s97, s97, 7
    v_mfma_f32_16x16x32_bf16 v[28:31], v[88:91], a[84:87], v[28:31]
    v_add_u32 v251, s97, v251
    s_lshr_b32 s97, s87, 3
    v_mfma_f32_16x16x32_bf16 v[32:35], v[88:91], v[76:79], v[32:35]
    ds_read_b64_tr_b16 v[84:85], v244 offset:30760
    ds_read_b64_tr_b16 v[86:87], v244 offset:32040
    v_mfma_f32_16x16x32_bf16 v[0:3], v[92:95], a[88:91], v[0:3]
    s_sub_u32 s97, s97, s87
    s_add_u32 s97, s97, 896
    v_mfma_f32_16x16x32_bf16 v[4:7], v[92:95], a[92:95], v[4:7]
    s_add_u32 s96, s87, 414720
    s_add_u32 m0, s49, 40960
    s_nop 0
    buffer_load_dwordx4 v128, s[16:19], s96 offen lds
    v_mfma_f32_16x16x32_bf16 v[8:11], v[92:95], v[76:79], v[8:11]
    ds_read_b64_tr_b16 v[88:89], v245 offset:30720
    ds_read_b64_tr_b16 v[90:91], v245 offset:32000
    s_waitcnt lgkmcnt(6)
    v_mfma_f32_16x16x32_bf16 v[12:15], v[96:99], a[88:91], v[12:15]
    v_add_u32 v208, 0, v139
    v_mul_u32_u24 v209, 7282, v208
    v_mfma_f32_16x16x32_bf16 v[16:19], v[96:99], a[92:95], v[16:19]
    v_lshrrev_b32 v209, 16, v209
    v_mov_b32 v210, v209
    v_mfma_f32_16x16x32_bf16 v[20:23], v[96:99], v[76:79], v[20:23]
    ds_read_b64_tr_b16 v[92:93], v244 offset:33280
    ds_read_b64_tr_b16 v[94:95], v244 offset:34560
    v_mfma_f32_16x16x32_bf16 v[24:27], v[100:103], a[88:91], v[24:27]
    v_mul_u32_u24 v209, 1008, v209
    v_lshl_add_u32 v248, v208, 4, v209
    v_mfma_f32_16x16x32_bf16 v[28:31], v[100:103], a[92:95], v[28:31]
    v_mul_u32_u24 v210, 9, v210
    v_sub_u32 v208, v208, v210
    v_mfma_f32_16x16x32_bf16 v[32:35], v[100:103], v[76:79], v[32:35]
    ds_read_b64_tr_b16 v[96:97], v244 offset:33320
    ds_read_b64_tr_b16 v[98:99], v244 offset:34600
    s_waitcnt lgkmcnt(6)
    v_mfma_f32_16x16x32_bf16 v[0:3], v[80:83], a[96:99], v[0:3]
    s_add_u32 s96, s87, 456192
    s_add_u32 m0, s49, 45056
    s_nop 0
    buffer_load_dwordx4 v128, s[16:19], s96 offen lds
    v_mfma_f32_16x16x32_bf16 v[4:7], v[80:83], a[100:103], v[4:7]
    v_cmp_eq_u32 vcc, 8, v208
    v_add_u32 v208, s97, v248
    v_mfma_f32_16x16x32_bf16 v[8:11], v[80:83], v[76:79], v[8:11]
    ds_read_b64_tr_b16 v[100:101], v245 offset:33280
    ds_read_b64_tr_b16 v[102:103], v245 offset:34560
    v_mfma_f32_16x16x32_bf16 v[12:15], v[84:87], a[96:99], v[12:15]
    v_cndmask_b32 v248, v248, v208, vcc
    v_add_u32 v208, 64, v139
    v_mfma_f32_16x16x32_bf16 v[16:19], v[84:87], a[100:103], v[16:19]
    v_mul_u32_u24 v209, 7282, v208
    v_lshrrev_b32 v209, 16, v209
    v_mfma_f32_16x16x32_bf16 v[20:23], v[84:87], v[76:79], v[20:23]
    ds_read_b64_tr_b16 v[80:81], v244 offset:35840
    ds_read_b64_tr_b16 v[82:83], v244 offset:37120
    s_waitcnt lgkmcnt(6)
    v_mfma_f32_16x16x32_bf16 v[24:27], v[88:91], a[96:99], v[24:27]
    s_add_u32 s96, s87, 497664
    s_add_u32 m0, s49, 49152
    s_nop 0
    buffer_load_dwordx4 v128, s[16:19], s96 offen lds
    v_mfma_f32_16x16x32_bf16 v[28:31], v[88:91], a[100:103], v[28:31]
    v_mov_b32 v210, v209
    v_mul_u32_u24 v209, 1008, v209
    v_mfma_f32_16x16x32_bf16 v[32:35], v[88:91], v[76:79], v[32:35]
    ds_read_b64_tr_b16 v[84:85], v244 offset:35880
    ds_read_b64_tr_b16 v[86:87], v244 offset:37160
    v_mfma_f32_16x16x32_bf16 v[0:3], v[92:95], a[104:107], v[0:3]
    v_lshl_add_u32 v249, v208, 4, v209
    v_mul_u32_u24 v210, 9, v210
    v_mfma_f32_16x16x32_bf16 v[4:7], v[92:95], a[108:111], v[4:7]
    v_sub_u32 v208, v208, v210
    v_cmp_eq_u32 vcc, 8, v208
    v_mfma_f32_16x16x32_bf16 v[8:11], v[92:95], v[76:79], v[8:11]
    ds_read_b64_tr_b16 v[88:89], v245 offset:35840
    ds_read_b64_tr_b16 v[90:91], v245 offset:37120
    s_waitcnt lgkmcnt(6)
    v_mfma_f32_16x16x32_bf16 v[12:15], v[96:99], a[104:107], v[12:15]
    v_add_u32 v208, s97, v249
    v_cndmask_b32 v249, v249, v208, vcc
    v_mfma_f32_16x16x32_bf16 v[16:19], v[96:99], a[108:111], v[16:19]
    s_add_u32 s96, s87, 539136
    s_add_u32 m0, s49, 53248
    s_nop 0
    buffer_load_dwordx4 v128, s[16:19], s96 offen lds
    v_mfma_f32_16x16x32_bf16 v[20:23], v[96:99], v[76:79], v[20:23]
    ds_read_b64_tr_b16 v[92:93], v244 offset:38400
    ds_read_b64_tr_b16 v[94:95], v244 offset:39680
    v_mfma_f32_16x16x32_bf16 v[24:27], v[100:103], a[104:107], v[24:27]
    v_subrev_u32 v249, 1024, v249
    v_add_u32 v208, 128, v139
    v_mfma_f32_16x16x32_bf16 v[28:31], v[100:103], a[108:111], v[28:31]
    v_mul_u32_u24 v209, 7282, v208
    v_lshrrev_b32 v209, 16, v209
    v_mfma_f32_16x16x32_bf16 v[32:35], v[100:103], v[76:79], v[32:35]
    ds_read_b64_tr_b16 v[96:97], v244 offset:38440
    ds_read_b64_tr_b16 v[98:99], v244 offset:39720
    s_waitcnt lgkmcnt(6)
    v_mfma_f32_16x16x32_bf16 v[0:3], v[80:83], a[112:115], v[0:3]
    v_mov_b32 v210, v209
    v_mul_u32_u24 v209, 1008, v209
    v_mfma_f32_16x16x32_bf16 v[4:7], v[80:83], a[116:119], v[4:7]
    s_add_u32 s96, s87, 580608
    s_add_u32 m0, s49, 57344
    s_nop 0
    buffer_load_dwordx4 v128, s[16:19], s96 offen lds
    v_mfma_f32_16x16x32_bf16 v[8:11], v[80:83], v[76:79], v[8:11]
    ds_read_b64_tr_b16 v[100:101], v245 offset:38400
    ds_read_b64_tr_b16 v[102:103], v245 offset:39680
    v_mfma_f32_16x16x32_bf16 v[12:15], v[84:87], a[112:115], v[12:15]
    v_lshl_add_u32 v250, v208, 4, v209
    v_mul_u32_u24 v210, 9, v210
    v_mfma_f32_16x16x32_bf16 v[16:19], v[84:87], a[116:119], v[16:19]
    v_sub_u32 v208, v208, v210
    v_cmp_eq_u32 vcc, 8, v208
    v_mfma_f32_16x16x32_bf16 v[20:23], v[84:87], v[76:79], v[20:23]
    ds_read_b64_tr_b16 v[80:81], v244 offset:40960
    ds_read_b64_tr_b16 v[82:83], v244 offset:42240
    s_waitcnt lgkmcnt(6)
    v_mfma_f32_16x16x32_bf16 v[24:27], v[88:91], a[112:115], v[24:27]
    v_add_u32 v208, s97, v250
    v_cndmask_b32 v250, v250, v208, vcc
    v_mfma_f32_16x16x32_bf16 v[28:31], v[88:91], a[116:119], v[28:31]
    v_subrev_u32 v250, 2048, v250
    v_cmp_gt_u32 vcc, 16, v139
    v_mfma_f32_16x16x32_bf16 v[32:35], v[88:91], v[76:79], v[32:35]
    ds_read_b64_tr_b16 v[84:85], v244 offset:41000
    ds_read_b64_tr_b16 v[86:87], v244 offset:42280
    v_mfma_f32_16x16x32_bf16 v[0:3], v[92:95], a[120:123], v[0:3]
    s_add_u32 s96, s87, 622080
    s_add_u32 m0, s49, 61440
    s_nop 0
    buffer_load_dwordx4 v128, s[16:19], s96 offen lds
    v_mfma_f32_16x16x32_bf16 v[4:7], v[92:95], a[124:127], v[4:7]
    v_mov_b32 v208, 0x1000000
    v_cndmask_b32 v250, v208, v250, vcc
    v_mfma_f32_16x16x32_bf16 v[8:11], v[92:95], v[76:79], v[8:11]
    ds_read_b64_tr_b16 v[88:89], v245 offset:40960
    ds_read_b64_tr_b16 v[90:91], v245 offset:42240
    s_waitcnt lgkmcnt(6)
    v_mfma_f32_16x16x32_bf16 v[12:15], v[96:99], a[120:123], v[12:15]
    v_mfma_f32_16x16x32_bf16 v[16:19], v[96:99], a[124:127], v[16:19]
    v_mfma_f32_16x16x32_bf16 v[20:23], v[96:99], v[76:79], v[20:23]
    ds_read_b64_tr_b16 v[92:93], v244 offset:43520
    ds_read_b64_tr_b16 v[94:95], v244 offset:44800
    v_mfma_f32_16x16x32_bf16 v[24:27], v[100:103], a[120:123], v[24:27]
    s_add_u32 s96, s87, 0
    s_add_u32 m0, s49, 65536
    s_nop 0
    buffer_load_dwordx4 v129, s[16:19], s96 offen lds
    v_mfma_f32_16x16x32_bf16 v[28:31], v[100:103], a[124:127], v[28:31]
    v_mfma_f32_16x16x32_bf16 v[32:35], v[100:103], v[76:79], v[32:35]
    ds_read_b64_tr_b16 v[96:97], v244 offset:43560
    ds_read_b64_tr_b16 v[98:99], v244 offset:44840
    s_waitcnt lgkmcnt(6)
    v_mfma_f32_16x16x32_bf16 v[0:3], v[80:83], a[128:131], v[0:3]
    v_mfma_f32_16x16x32_bf16 v[4:7], v[80:83], a[132:135], v[4:7]
    v_mfma_f32_16x16x32_bf16 v[8:11], v[80:83], v[76:79], v[8:11]
    ds_read_b64_tr_b16 v[100:101], v245 offset:43520
    ds_read_b64_tr_b16 v[102:103], v245 offset:44800
    v_mfma_f32_16x16x32_bf16 v[12:15], v[84:87], a[128:131], v[12:15]
    v_mfma_f32_16x16x32_bf16 v[16:19], v[84:87], a[132:135], v[16:19]
    s_add_u32 s96, s87, 331776
    s_add_u32 m0, s49, 69632
    s_nop 0
    buffer_load_dwordx4 v129, s[16:19], s96 offen lds
    v_mfma_f32_16x16x32_bf16 v[20:23], v[84:87], v[76:79], v[20:23]
    s_waitcnt lgkmcnt(4)
    v_mfma_f32_16x16x32_bf16 v[24:27], v[88:91], a[128:131], v[24:27]
    v_mfma_f32_16x16x32_bf16 v[28:31], v[88:91], a[132:135], v[28:31]
    v_mfma_f32_16x16x32_bf16 v[32:35], v[88:91], v[76:79], v[32:35]
    v_mfma_f32_16x16x32_bf16 v[0:3], v[92:95], a[136:139], v[0:3]
    v_mfma_f32_16x16x32_bf16 v[4:7], v[92:95], a[140:143], v[4:7]
    v_mfma_f32_16x16x32_bf16 v[8:11], v[92:95], v[76:79], v[8:11]
    s_waitcnt lgkmcnt(0)
    v_mfma_f32_16x16x32_bf16 v[12:15], v[96:99], a[136:139], v[12:15]
    v_mfma_f32_16x16x32_bf16 v[16:19], v[96:99], a[140:143], v[16:19]
    v_mfma_f32_16x16x32_bf16 v[20:23], v[96:99], v[76:79], v[20:23]
    v_mfma_f32_16x16x32_bf16 v[24:27], v[100:103], a[136:139], v[24:27]
    v_mfma_f32_16x16x32_bf16 v[28:31], v[100:103], a[140:143], v[28:31]
    v_mfma_f32_16x16x32_bf16 v[32:35], v[100:103], v[76:79], v[32:35]
    buffer_load_dword v233, v232, s[36:39], 0 offen sc1
    buffer_load_dword v252, v251, s[36:39], 0 offen sc1
    s_mov_b32 s98, 1069066811
    v_pk_mul_f32 v[208:209], v[8:9], v[142:143] op_sel_hi:[1,0]
    v_pk_mul_f32 v[210:211], v[10:11], v[142:143] op_sel_hi:[1,0]
    v_pk_fma_f32 v[0:1], v[0:1], v[140:141], v[208:209] op_sel_hi:[1,0,1]
    v_pk_fma_f32 v[2:3], v[2:3], v[140:141], v[210:211] op_sel_hi:[1,0,1]
    v_cvt_pk_bf16_f32 v144, v0, v1
    v_cvt_pk_bf16_f32 v145, v2, v3
    v_pk_mul_f32 v[208:209], v[20:21], v[142:143] op_sel_hi:[1,0]
    v_pk_mul_f32 v[210:211], v[22:23], v[142:143] op_sel_hi:[1,0]
    v_pk_fma_f32 v[12:13], v[12:13], v[140:141], v[208:209] op_sel_hi:[1,0,1]
    v_pk_fma_f32 v[14:15], v[14:15], v[140:141], v[210:211] op_sel_hi:[1,0,1]
    v_cvt_pk_bf16_f32 v146, v12, v13
    v_cvt_pk_bf16_f32 v147, v14, v15
    v_pk_mul_f32 v[208:209], v[32:33], v[142:143] op_sel_hi:[1,0]
    v_pk_mul_f32 v[210:211], v[34:35], v[142:143] op_sel_hi:[1,0]
    v_pk_fma_f32 v[24:25], v[24:25], v[140:141], v[208:209] op_sel_hi:[1,0,1]
    v_pk_fma_f32 v[26:27], v[26:27], v[140:141], v[210:211] op_sel_hi:[1,0,1]
    v_cvt_pk_bf16_f32 v148, v24, v25
    v_cvt_pk_bf16_f32 v149, v26, v27
    v_mfma_f32_16x16x32_bf16 v[160:163], v[104:107], v[144:147], 0
    s_nop 0
    v_mfma_f32_16x16x32_bf16 v[160:163], v[108:111], v[148:151], v[160:163]
    v_mfma_f32_16x16x32_bf16 v[164:167], v[112:115], v[144:147], 0
    v_mfma_f32_16x16x32_bf16 v[164:167], v[116:119], v[148:151], v[164:167]
    v_mfma_f32_16x16x32_bf16 v[168:171], v[120:123], v[144:147], 0
    v_mfma_f32_16x16x32_bf16 v[168:171], v[124:127], v[148:151], v[168:171]
    v_pk_mul_f32 v[208:209], v[8:9], v[142:143] op_sel:[0,1] op_sel_hi:[1,1]
    v_pk_mul_f32 v[210:211], v[10:11], v[142:143] op_sel:[0,1] op_sel_hi:[1,1]
    v_pk_fma_f32 v[4:5], v[4:5], v[140:141], v[208:209] op_sel:[0,1,0] op_sel_hi:[1,1,1]
    v_pk_fma_f32 v[6:7], v[6:7], v[140:141], v[210:211] op_sel:[0,1,0] op_sel_hi:[1,1,1]
    v_cvt_pk_bf16_f32 v152, v4, v5
    v_cvt_pk_bf16_f32 v153, v6, v7
    v_pk_mul_f32 v[208:209], v[20:21], v[142:143] op_sel:[0,1] op_sel_hi:[1,1]
    v_pk_mul_f32 v[210:211], v[22:23], v[142:143] op_sel:[0,1] op_sel_hi:[1,1]
    v_pk_fma_f32 v[16:17], v[16:17], v[140:141], v[208:209] op_sel:[0,1,0] op_sel_hi:[1,1,1]
    v_pk_fma_f32 v[18:19], v[18:19], v[140:141], v[210:211] op_sel:[0,1,0] op_sel_hi:[1,1,1]
    v_cvt_pk_bf16_f32 v154, v16, v17
    v_cvt_pk_bf16_f32 v155, v18, v19
    v_pk_mul_f32 v[208:209], v[32:33], v[142:143] op_sel:[0,1] op_sel_hi:[1,1]
    v_pk_mul_f32 v[210:211], v[34:35], v[142:143] op_sel:[0,1] op_sel_hi:[1,1]
    v_pk_fma_f32 v[28:29], v[28:29], v[140:141], v[208:209] op_sel:[0,1,0] op_sel_hi:[1,1,1]
    v_pk_fma_f32 v[30:31], v[30:31], v[140:141], v[210:211] op_sel:[0,1,0] op_sel_hi:[1,1,1]
    v_cvt_pk_bf16_f32 v156, v28, v29
    v_cvt_pk_bf16_f32 v157, v30, v31
    v_mfma_f32_16x16x32_bf16 v[172:175], v[104:107], v[152:155], 0
    s_nop 0
    v_mfma_f32_16x16x32_bf16 v[172:175], v[108:111], v[156:159], v[172:175]
    v_mfma_f32_16x16x32_bf16 v[176:179], v[112:115], v[152:155], 0
    v_mfma_f32_16x16x32_bf16 v[176:179], v[116:119], v[156:159], v[176:179]
    v_mfma_f32_16x16x32_bf16 v[180:183], v[120:123], v[152:155], 0
    v_mfma_f32_16x16x32_bf16 v[180:183], v[124:127], v[156:159], v[180:183]
    v_max3_f32 v208, v160, v161, v162
    v_min3_f32 v209, v160, v161, v162
    v_max3_f32 v208, v208, v163, v164
    v_min3_f32 v209, v209, v163, v164
    v_max3_f32 v208, v208, v165, v166
    v_min3_f32 v209, v209, v165, v166
    v_max3_f32 v208, v208, v167, v168
    v_min3_f32 v209, v209, v167, v168
    v_mov_b32 v210, v208
    v_mov_b32 v211, v209
    s_nop 0
    v_permlane16_swap_b32 v208, v210
    v_permlane16_swap_b32 v209, v211
    v_max_f32 v208, v208, v210
    v_min_f32 v209, v209, v211
    v_pk_mul_f32 v[208:209], v[208:209], s[98:99] op_sel_hi:[1,0]
    v_pk_fma_f32 v[212:213], v[160:161], s[98:99], v[208:209] op_sel_hi:[1,0,0] neg_lo:[0,0,1] neg_hi:[0,0,1]
    v_pk_fma_f32 v[222:223], v[160:161], s[98:99], v[208:209] op_sel:[0,0,1] op_sel_hi:[1,0,1] neg_lo:[1,0,0] neg_hi:[1,0,0]
    v_pk_fma_f32 v[214:215], v[162:163], s[98:99], v[208:209] op_sel_hi:[1,0,0] neg_lo:[0,0,1] neg_hi:[0,0,1]
    v_pk_fma_f32 v[224:225], v[162:163], s[98:99], v[208:209] op_sel:[0,0,1] op_sel_hi:[1,0,1] neg_lo:[1,0,0] neg_hi:[1,0,0]
    v_pk_fma_f32 v[216:217], v[164:165], s[98:99], v[208:209] op_sel_hi:[1,0,0] neg_lo:[0,0,1] neg_hi:[0,0,1]
    v_pk_fma_f32 v[226:227], v[164:165], s[98:99], v[208:209] op_sel:[0,0,1] op_sel_hi:[1,0,1] neg_lo:[1,0,0] neg_hi:[1,0,0]
    v_pk_fma_f32 v[218:219], v[166:167], s[98:99], v[208:209] op_sel_hi:[1,0,0] neg_lo:[0,0,1] neg_hi:[0,0,1]
    v_pk_fma_f32 v[228:229], v[166:167], s[98:99], v[208:209] op_sel:[0,0,1] op_sel_hi:[1,0,1] neg_lo:[1,0,0] neg_hi:[1,0,0]
    v_fma_f32 v220, v168, s98, -v208
    v_fma_f32 v230, -v168, s98, v209
    v_exp_f32 v212, v212
    v_exp_f32 v222, v222
    v_exp_f32 v213, v213
    v_exp_f32 v223, v223
    v_exp_f32 v214, v214
    v_exp_f32 v224, v224
    v_exp_f32 v215, v215
    v_exp_f32 v225, v225
    v_exp_f32 v216, v216
    v_exp_f32 v226, v226
    v_exp_f32 v217, v217
    v_exp_f32 v227, v227
    v_exp_f32 v218, v218
    v_exp_f32 v228, v228
    v_exp_f32 v219, v219
    v_exp_f32 v229, v229
    v_exp_f32 v220, v220
    v_exp_f32 v230, v230
    v_pk_add_f32 v[208:209], v[212:213], v[214:215]
    v_pk_add_f32 v[210:211], v[222:223], v[224:225]
    v_pk_add_f32 v[208:209], v[208:209], v[216:217]
    v_pk_add_f32 v[210:211], v[210:211], v[226:227]
    v_pk_add_f32 v[208:209], v[208:209], v[218:219]
    v_pk_add_f32 v[210:211], v[210:211], v[228:229]
    v_add_f32 v208, v208, v209
    v_add_f32 v209, v210, v211
    v_add_f32 v208, v208, v220
    v_add_f32 v209, v209, v230
    v_mov_b32 v210, v208
    v_mov_b32 v211, v209
    s_nop 0
    v_permlane16_swap_b32 v208, v210
    v_permlane16_swap_b32 v209, v211
    v_pk_add_f32 v[208:209], v[208:209], v[210:211]
    v_rcp_f32 v208, v208
    v_rcp_f32 v209, v209
    v_mul_f32 v220, v220, v208
    v_mul_f32 v230, v230, v209
    v_pk_mul_f32 v[212:213], v[212:213], v[208:209] op_sel_hi:[1,0]
    v_pk_mul_f32 v[222:223], v[222:223], v[208:209] op_sel:[0,1] op_sel_hi:[1,1]
    v_pk_mul_f32 v[214:215], v[214:215], v[208:209] op_sel_hi:[1,0]
    v_pk_mul_f32 v[224:225], v[224:225], v[208:209] op_sel:[0,1] op_sel_hi:[1,1]
    v_pk_mul_f32 v[216:217], v[216:217], v[208:209] op_sel_hi:[1,0]
    v_pk_mul_f32 v[226:227], v[226:227], v[208:209] op_sel:[0,1] op_sel_hi:[1,1]
    v_pk_mul_f32 v[218:219], v[218:219], v[208:209] op_sel_hi:[1,0]
    v_pk_mul_f32 v[228:229], v[228:229], v[208:209] op_sel:[0,1] op_sel_hi:[1,1]
    v_cvt_pk_bf16_f32 v184, v212, v213
    v_cvt_pk_bf16_f32 v185, v214, v215
    v_cvt_pk_bf16_f32 v186, v216, v217
    v_cvt_pk_bf16_f32 v188, v218, v219
    v_cvt_pk_bf16_f32 v189, v220, v222
    v_cvt_pk_bf16_f32 v190, v223, v224
    v_cvt_pk_bf16_f32 v192, v225, v226
    v_cvt_pk_bf16_f32 v193, v227, v228
    v_cvt_pk_bf16_f32 v194, v229, v230
    s_waitcnt vmcnt(1)
    v_cmp_gt_u32 vcc, 1, v233
    s_mov_b32 s53, 0
    s_cbranch_vccz sequential_preLN__linear_kernel_hedgehog__glu_gated_reglu__prompt_kernel_spin_16_b
sequential_preLN__linear_kernel_hedgehog__glu_gated_reglu__prompt_kernel_spin_16:
    buffer_load_dword v233, v232, s[36:39], 0 offen sc1
    s_add_u32 s53, s53, 1
    s_waitcnt vmcnt(0)
    v_cmp_gt_u32 vcc, 1, v233
    s_cmp_gt_u32 s53, 50000
    s_cbranch_scc1 sequential_preLN__linear_kernel_hedgehog__glu_gated_reglu__prompt_kernel_spin_16_b
    s_cbranch_vccnz sequential_preLN__linear_kernel_hedgehog__glu_gated_reglu__prompt_kernel_spin_16
sequential_preLN__linear_kernel_hedgehog__glu_gated_reglu__prompt_kernel_spin_16_b:
    s_lshl_b32 s97, s59, 16
    s_add_u32 s97, s97, 131072
    s_add_u32 s96, s97, s49
    buffer_load_dwordx4 v[0:3], v234, s[36:39], s96 offen sc1
    s_add_u32 s96, s96, 4096
    buffer_load_dwordx4 v[4:7], v234, s[36:39], s96 offen sc1
    s_add_u32 s96, s96, 4096
    buffer_load_dwordx4 v[8:11], v234, s[36:39], s96 offen sc1
    s_add_u32 s96, s96, 4096
    buffer_load_dwordx4 v[12:15], v234, s[36:39], s96 offen sc1
    s_add_u32 s96, s96, 4096
    buffer_load_dwordx4 v[16:19], v234, s[36:39], s96 offen sc1
    s_add_u32 s96, s96, 4096
    buffer_load_dwordx4 v[20:23], v234, s[36:39], s96 offen sc1
    s_add_u32 s96, s96, 4096
    buffer_load_dwordx4 v[24:27], v234, s[36:39], s96 offen sc1
    s_add_u32 s96, s96, 4096
    buffer_load_dwordx4 v[28:31], v234, s[36:39], s96 offen sc1
    s_add_u32 s96, s96, 4096
    buffer_load_dwordx4 v[32:35], v234, s[36:39], s96 offen sc1
    s_add_u32 s96, s96, 4096
    buffer_load_dwordx4 v[36:39], v234, s[36:39], s96 offen sc1
    s_add_u32 s96, s96, 4096
    buffer_load_dwordx4 v[40:43], v234, s[36:39], s96 offen sc1
    s_add_u32 s96, s96, 4096
    buffer_load_dwordx4 v[44:47], v234, s[36:39], s96 offen sc1
    s_add_u32 s96, s96, 4096
    buffer_load_dwordx4 v[48:51], v234, s[36:39], s96 offen sc1
    s_add_u32 s96, s96, 4096
    buffer_load_dwordx4 v[52:55], v234, s[36:39], s96 offen sc1
    s_add_u32 s96, s96, 4096
    buffer_load_dwordx4 v[56:59], v234, s[36:39], s96 offen sc1
    s_add_u32 s96, s96, 4096
    buffer_load_dwordx4 v[60:63], v234, s[36:39], s96 offen sc1
    v_and_b32 v145, 15, v139
    v_lshlrev_b32 v144, 12, v145
    buffer_load_dwordx3 v[148:150], v144, s[36:39], s97 offen offset:3648 sc1
    s_waitcnt vmcnt(17)
    v_cmp_gt_u32 vcc, 1, v252
    s_nop 0
    s_cbranch_vccnz sequential_preLN__linear_kernel_hedgehog__glu_gated_reglu__prompt_kernel_spin_17
sequential_preLN__linear_kernel_hedgehog__glu_gated_reglu__prompt_kernel_spin_17_b:
    s_lshr_b32 s96, s87, 8
    s_mul_i32 s96, s96, 18432
    s_add_u32 s96, s96, s49
    s_add_u32 s96, s96, 40697856
    s_cmp_gt_u32 s48, 1
    s_cbranch_scc1 sequential_preLN__linear_kernel_hedgehog__glu_gated_reglu__prompt_kernel_nl_18
    s_add_u32 m0, s49, 90112
    s_add_u32 s97, s96, 16384
    buffer_load_dwordx4 v234, s[36:39], s97 offen sc1 lds
sequential_preLN__linear_kernel_hedgehog__glu_gated_reglu__prompt_kernel_nl_18:
    v_max3_f32 v208, v172, v173, v174
    s_add_u32 m0, s49, 73728
    s_add_u32 s97, s96, 0
    buffer_load_dwordx4 v234, s[36:39], s97 offen sc1 lds
    v_min3_f32 v209, v172, v173, v174
    v_max3_f32 v208, v208, v175, v176
    v_min3_f32 v209, v209, v175, v176
    v_max3_f32 v208, v208, v177, v178
    v_min3_f32 v209, v209, v177, v178
    v_max3_f32 v208, v208, v179, v180
    v_min3_f32 v209, v209, v179, v180
    v_mov_b32 v210, v208
    v_mov_b32 v211, v209
    s_nop 0
    v_permlane16_swap_b32 v208, v210
    v_permlane16_swap_b32 v209, v211
    v_max_f32 v208, v208, v210
    v_min_f32 v209, v209, v211
    v_pk_mul_f32 v[208:209], v[208:209], s[98:99] op_sel_hi:[1,0]
    v_pk_fma_f32 v[212:213], v[172:173], s[98:99], v[208:209] op_sel_hi:[1,0,0] neg_lo:[0,0,1] neg_hi:[0,0,1]
    v_pk_fma_f32 v[222:223], v[172:173], s[98:99], v[208:209] op_sel:[0,0,1] op_sel_hi:[1,0,1] neg_lo:[1,0,0] neg_hi:[1,0,0]
    v_pk_fma_f32 v[214:215], v[174:175], s[98:99], v[208:209] op_sel_hi:[1,0,0] neg_lo:[0,0,1] neg_hi:[0,0,1]
    v_pk_fma_f32 v[224:225], v[174:175], s[98:99], v[208:209] op_sel:[0,0,1] op_sel_hi:[1,0,1] neg_lo:[1,0,0] neg_hi:[1,0,0]
    v_pk_fma_f32 v[216:217], v[176:177], s[98:99], v[208:209] op_sel_hi:[1,0,0] neg_lo:[0,0,1] neg_hi:[0,0,1]
    v_pk_fma_f32 v[226:227], v[176:177], s[98:99], v[208:209] op_sel:[0,0,1] op_sel_hi:[1,0,1] neg_lo:[1,0,0] neg_hi:[1,0,0]
    v_pk_fma_f32 v[218:219], v[178:179], s[98:99], v[208:209] op_sel_hi:[1,0,0] neg_lo:[0,0,1] neg_hi:[0,0,1]
    v_pk_fma_f32 v[228:229], v[178:179], s[98:99], v[208:209] op_sel:[0,0,1] op_sel_hi:[1,0,1] neg_lo:[1,0,0] neg_hi:[1,0,0]
    v_fma_f32 v220, v180, s98, -v208
    v_fma_f32 v230, -v180, s98, v209
    s_add_u32 m0, s49, 77824
    s_add_u32 s97, s96, 4096
    buffer_load_dwordx4 v234, s[36:39], s97 offen sc1 lds
    v_exp_f32 v212, v212
    v_exp_f32 v222, v222
    v_exp_f32 v213, v213
    v_exp_f32 v223, v223
    v_exp_f32 v214, v214
    v_exp_f32 v224, v224
    v_exp_f32 v215, v215
    v_exp_f32 v225, v225
    v_exp_f32 v216, v216
    v_exp_f32 v226, v226
    v_exp_f32 v217, v217
    v_exp_f32 v227, v227
    v_exp_f32 v218, v218
    v_exp_f32 v228, v228
    v_exp_f32 v219, v219
    v_exp_f32 v229, v229
    v_exp_f32 v220, v220
    v_exp_f32 v230, v230
    v_pk_add_f32 v[208:209], v[212:213], v[214:215]
    v_pk_add_f32 v[210:211], v[222:223], v[224:225]
    v_pk_add_f32 v[208:209], v[208:209], v[216:217]
    v_pk_add_f32 v[210:211], v[210:211], v[226:227]
    v_pk_add_f32 v[208:209], v[208:209], v[218:219]
    v_pk_add_f32 v[210:211], v[210:211], v[228:229]
    s_add_u32 m0, s49, 81920
    s_add_u32 s97, s96, 8192
    buffer_load_dwordx4 v234, s[36:39], s97 offen sc1 lds
    v_add_f32 v208, v208, v209
    v_add_f32 v209, v210, v211
    v_add_f32 v208, v208, v220
    v_add_f32 v209, v209, v230
    v_mov_b32 v210, v208
    v_mov_b32 v211, v209
    s_nop 0
    v_permlane16_swap_b32 v208, v210
    v_permlane16_swap_b32 v209, v211
    v_pk_add_f32 v[208:209], v[208:209], v[210:211]
    v_rcp_f32 v208, v208
    v_rcp_f32 v209, v209
    v_mul_f32 v220, v220, v208
    v_mul_f32 v230, v230, v209
    v_pk_mul_f32 v[212:213], v[212:213], v[208:209] op_sel_hi:[1,0]
    v_pk_mul_f32 v[222:223], v[222:223], v[208:209] op_sel:[0,1] op_sel_hi:[1,1]
    v_pk_mul_f32 v[214:215], v[214:215], v[208:209] op_sel_hi:[1,0]
    v_pk_mul_f32 v[224:225], v[224:225], v[208:209] op_sel:[0,1] op_sel_hi:[1,1]
    v_pk_mul_f32 v[216:217], v[216:217], v[208:209] op_sel_hi:[1,0]
    v_pk_mul_f32 v[226:227], v[226:227], v[208:209] op_sel:[0,1] op_sel_hi:[1,1]
    v_pk_mul_f32 v[218:219], v[218:219], v[208:209] op_sel_hi:[1,0]
    v_pk_mul_f32 v[228:229], v[228:229], v[208:209] op_sel:[0,1] op_sel_hi:[1,1]
    v_cvt_pk_bf16_f32 v196, v212, v213
    v_cvt_pk_bf16_f32 v197, v214, v215
sequential_preLN__linear_kernel_hedgehog__glu_gated_reglu__prompt_kernel_hop0_3:
    s_cbranch_execz sequential_preLN__linear_kernel_hedgehog__glu_gated_reglu__prompt_kernel_hop0_4
    v_cvt_pk_bf16_f32 v198, v216, v217
    s_add_u32 m0, s49, 86016
    s_add_u32 s97, s96, 12288
    buffer_load_dwordx4 v234, s[36:39], s97 offen sc1 lds
    v_cvt_pk_bf16_f32 v200, v218, v219
    v_cvt_pk_bf16_f32 v201, v220, v222
    v_cvt_pk_bf16_f32 v202, v223, v224
    v_cvt_pk_bf16_f32 v204, v225, v226
    v_cvt_pk_bf16_f32 v205, v227, v228
    v_cvt_pk_bf16_f32 v206, v229, v230
    v_mov_b32 v216, 0x3f80
    v_mov_b32 v217, 1.0
    v_mov_b32 v215, 0
    v_mov_b32 v80, 0
    v_mov_b32 v81, 0
    v_mov_b32 v82, 0
    v_mov_b32 v83, 0
    v_mov_b32 v84, 0
    v_mov_b32 v85, 0
    v_cmp_lt_u32 vcc, 8, v145
    s_nop 1
    v_addc_co_u32 v146, vcc, 0, v145, vcc
    v_lshlrev_b32 v146, 3, v146
    v_add_u32 v146, 161792, v146
    v_lshlrev_b32 v147, 2, v145
    v_add_u32 v147, 161928, v147
    s_waitcnt vmcnt(20)
    v_dot2c_f32_bf16 v80, v0, v216
    v_dot2c_f32_bf16 v81, v0, v217
    v_dot2c_f32_bf16 v82, v1, v216
    v_dot2c_f32_bf16 v83, v1, v217
    v_dot2c_f32_bf16 v84, v2, v216
    v_dot2c_f32_bf16 v85, v2, v217
    s_waitcnt vmcnt(19)
    v_dot2c_f32_bf16 v80, v4, v216
    v_dot2c_f32_bf16 v81, v4, v217
    v_dot2c_f32_bf16 v82, v5, v216
    v_dot2c_f32_bf16 v83, v5, v217
    v_dot2c_f32_bf16 v84, v6, v216
    v_dot2c_f32_bf16 v85, v6, v217
    s_waitcnt vmcnt(18)
    v_dot2c_f32_bf16 v80, v8, v216
    v_dot2c_f32_bf16 v81, v8, v217
    v_dot2c_f32_bf16 v82, v9, v216
    v_dot2c_f32_bf16 v83, v9, v217
    v_dot2c_f32_bf16 v84, v10, v216
    v_dot2c_f32_bf16 v85, v10, v217
    s_waitcnt vmcnt(17)
    v_dot2c_f32_bf16 v80, v12, v216
    v_dot2c_f32_bf16 v81, v12, v217
    v_dot2c_f32_bf16 v82, v13, v216
    v_dot2c_f32_bf16 v83, v13, v217
    v_dot2c_f32_bf16 v84, v14, v216
    v_dot2c_f32_bf16 v85, v14, v217
    s_waitcnt vmcnt(16)
    v_dot2c_f32_bf16 v80, v16, v216
    v_dot2c_f32_bf16 v81, v16, v217
    v_dot2c_f32_bf16 v82, v17, v216
    v_dot2c_f32_bf16 v83, v17, v217
    v_dot2c_f32_bf16 v84, v18, v216
    v_dot2c_f32_bf16 v85, v18, v217
    s_waitcnt vmcnt(15)
    v_dot2c_f32_bf16 v80, v20, v216
    v_dot2c_f32_bf16 v81, v20, v217
    v_dot2c_f32_bf16 v82, v21, v216
    v_dot2c_f32_bf16 v83, v21, v217
    v_dot2c_f32_bf16 v84, v22, v216
    v_dot2c_f32_bf16 v85, v22, v217
    s_waitcnt vmcnt(14)
    v_dot2c_f32_bf16 v80, v24, v216
    v_dot2c_f32_bf16 v81, v24, v217
    v_dot2c_f32_bf16 v82, v25, v216
    v_dot2c_f32_bf16 v83, v25, v217
    v_dot2c_f32_bf16 v84, v26, v216
    v_dot2c_f32_bf16 v85, v26, v217
    s_waitcnt vmcnt(13)
    v_dot2c_f32_bf16 v80, v28, v216
    v_dot2c_f32_bf16 v81, v28, v217
    v_dot2c_f32_bf16 v82, v29, v216
    v_dot2c_f32_bf16 v83, v29, v217
    v_dot2c_f32_bf16 v84, v30, v216
    v_dot2c_f32_bf16 v85, v30, v217
    s_waitcnt vmcnt(12)
    v_dot2c_f32_bf16 v80, v32, v216
    v_dot2c_f32_bf16 v81, v32, v217
    v_dot2c_f32_bf16 v82, v33, v216
    v_dot2c_f32_bf16 v83, v33, v217
    v_dot2c_f32_bf16 v84, v34, v216
    v_dot2c_f32_bf16 v85, v34, v217
    s_waitcnt vmcnt(11)
    v_dot2c_f32_bf16 v80, v36, v216
    v_dot2c_f32_bf16 v81, v36, v217
    v_dot2c_f32_bf16 v82, v37, v216
    v_dot2c_f32_bf16 v83, v37, v217
    v_dot2c_f32_bf16 v84, v38, v216
    v_dot2c_f32_bf16 v85, v38, v217
    s_waitcnt vmcnt(10)
    v_dot2c_f32_bf16 v80, v40, v216
    v_dot2c_f32_bf16 v81, v40, v217
    v_dot2c_f32_bf16 v82, v41, v216
    v_dot2c_f32_bf16 v83, v41, v217
    v_dot2c_f32_bf16 v84, v42, v216
    v_dot2c_f32_bf16 v85, v42, v217
    s_waitcnt vmcnt(9)
    v_dot2c_f32_bf16 v80, v44, v216
    v_dot2c_f32_bf16 v81, v44, v217
    v_dot2c_f32_bf16 v82, v45, v216
    v_dot2c_f32_bf16 v83, v45, v217
    v_dot2c_f32_bf16 v84, v46, v216
    v_dot2c_f32_bf16 v85, v46, v217
    s_waitcnt vmcnt(8)
    v_dot2c_f32_bf16 v80, v48, v216
    v_dot2c_f32_bf16 v81, v48, v217
    v_dot2c_f32_bf16 v82, v49, v216
    v_dot2c_f32_bf16 v83, v49, v217
    v_dot2c_f32_bf16 v84, v50, v216
    v_dot2c_f32_bf16 v85, v50, v217
    s_waitcnt vmcnt(7)
    v_dot2c_f32_bf16 v80, v52, v216
    v_dot2c_f32_bf16 v81, v52, v217
    v_dot2c_f32_bf16 v82, v53, v216
    v_dot2c_f32_bf16 v83, v53, v217
    v_dot2c_f32_bf16 v84, v54, v216
    v_dot2c_f32_bf16 v85, v54, v217
    s_waitcnt vmcnt(6)
    v_dot2c_f32_bf16 v80, v56, v216
    v_dot2c_f32_bf16 v81, v56, v217
    v_dot2c_f32_bf16 v82, v57, v216
    v_dot2c_f32_bf16 v83, v57, v217
    v_dot2c_f32_bf16 v84, v58, v216
    v_dot2c_f32_bf16 v85, v58, v217
    s_waitcnt vmcnt(5)
    v_dot2c_f32_bf16 v80, v60, v216
    v_dot2c_f32_bf16 v81, v60, v217
    v_dot2c_f32_bf16 v82, v61, v216
    v_dot2c_f32_bf16 v83, v61, v217
    v_dot2c_f32_bf16 v84, v62, v216
    v_dot2c_f32_bf16 v85, v62, v217
    v_cvt_pk_bf16_f32 v212, v80, v81
    v_cvt_pk_bf16_f32 v213, v82, v83
    s_nop 0
    v_cvt_pk_bf16_f32 v214, v84, v85
    ds_write_b128 v247, v[212:215]
    s_waitcnt vmcnt(4)
    ds_write_b64 v146, v[148:149]
    ds_write_b32 v147, v150
    s_waitcnt lgkmcnt(0)
    s_barrier
    ds_read_b128 v[0:3], v240 offset:0
    ds_read_b128 v[4:7], v240 offset:16
    ds_read_b128 v[8:11], v240 offset:32
    ds_read_b128 v[12:15], v240 offset:384
    ds_read_b128 v[16:19], v240 offset:400
    ds_read_b128 v[20:23], v240 offset:416
    ds_read_b128 v[24:27], v241 offset:0
    ds_read_b128 v[28:31], v241 offset:16
    ds_read_b128 v[32:35], v241 offset:32
    ds_read_b128 v[36:39], v242
    ds_read_b128 v[40:43], v242 offset:16
    ds_read_b64 v[44:45], v243
    s_mul_i32 s96, s48, 3072
    s_add_u32 m0, s96, 122880
    s_mul_i32 s96, s88, 18432
    s_add_u32 s96, s96, s87
    buffer_load_dwordx4 v248, s[4:7], s96 offen offset:0 lds
    buffer_load_dwordx4 v249, s[4:7], s96 offen offset:1024 lds
    buffer_load_dwordx4 v250, s[4:7], s96 offen offset:2048 lds
    s_lshl_b32 s96, s58, 3
    s_lshl_b32 s97, s48, 1
    s_add_u32 s96, s96, s97
    s_lshl_b32 s96, s96, 4
    s_add_u32 s96, s96, s59
    s_lshl_b32 s97, s96, 8
    s_add_u32 s97, s97, 3276800
    s_lshl_b32 s96, s96, 10
    s_add_u32 s96, s96, 1179648
    s_waitcnt lgkmcnt(5)
    v_mfma_f32_16x16x32_bf16 v[168:171], v[24:27], v[184:187], 0
    s_waitcnt lgkmcnt(4)
    v_mfma_f32_16x16x32_bf16 v[168:171], v[28:31], v[188:191], v[168:171]
    s_waitcnt lgkmcnt(3)
    v_mfma_f32_16x16x32_bf16 v[168:171], v[32:35], v[192:195], v[168:171]
    v_mfma_f32_16x16x32_bf16 v[160:163], v[0:3], v[184:187], 0
    v_mfma_f32_16x16x32_bf16 v[160:163], v[4:7], v[188:191], v[160:163]
    v_mfma_f32_16x16x32_bf16 v[160:163], v[8:11], v[192:195], v[160:163]
    v_mfma_f32_16x16x32_bf16 v[164:167], v[12:15], v[184:187], 0
    v_mfma_f32_16x16x32_bf16 v[164:167], v[16:19], v[188:191], v[164:167]
    v_mfma_f32_16x16x32_bf16 v[164:167], v[20:23], v[192:195], v[164:167]
    v_mfma_f32_16x16x32_bf16 v[180:183], v[24:27], v[196:199], 0
    v_mfma_f32_16x16x32_bf16 v[180:183], v[28:31], v[200:203], v[180:183]
    v_mfma_f32_16x16x32_bf16 v[180:183], v[32:35], v[204:207], v[180:183]
    v_mfma_f32_16x16x32_bf16 v[172:175], v[0:3], v[196:199], 0
    v_mfma_f32_16x16x32_bf16 v[172:175], v[4:7], v[200:203], v[172:175]
    v_mfma_f32_16x16x32_bf16 v[172:175], v[8:11], v[204:207], v[172:175]
    v_mfma_f32_16x16x32_bf16 v[176:179], v[12:15], v[196:199], 0
    v_mfma_f32_16x16x32_bf16 v[176:179], v[16:19], v[200:203], v[176:179]
    v_mfma_f32_16x16x32_bf16 v[176:179], v[20:23], v[204:207], v[176:179]
    v_add_f32 v144, 0x358637bd, v168
    v_rcp_f32 v144, v144
    s_nop 0
    v_mul_f32 v169, v169, v144
    v_mul_f32 v170, v170, v144
    v_pk_mul_f32 v[160:161], v[160:161], v[144:145] op_sel_hi:[1,0]
    v_pk_mul_f32 v[162:163], v[162:163], v[144:145] op_sel_hi:[1,0]
    v_pk_mul_f32 v[164:165], v[164:165], v[144:145] op_sel_hi:[1,0]
    v_pk_mul_f32 v[166:167], v[166:167], v[144:145] op_sel_hi:[1,0]
    v_cvt_pk_bf16_f32 v148, v160, v161
    v_cvt_pk_bf16_f32 v149, v162, v163
    v_cvt_pk_bf16_f32 v150, v164, v165
    v_cvt_pk_bf16_f32 v151, v166, v167
    buffer_store_dwordx4 v[148:151], v234, s[36:39], s96 offen sc1
    s_waitcnt lgkmcnt(2)
    v_pk_mul_f32 v[146:147], v[160:161], v[36:37]
    v_pk_fma_f32 v[146:147], v[162:163], v[38:39], v[146:147]
    s_waitcnt lgkmcnt(1)
    v_pk_fma_f32 v[146:147], v[164:165], v[40:41], v[146:147]
    v_pk_fma_f32 v[146:147], v[166:167], v[42:43], v[146:147]
    s_waitcnt lgkmcnt(0)
    v_fmac_f32 v146, v169, v44
    v_fmac_f32 v147, v170, v45
    v_add_f32 v145, v146, v147
    v_mov_b32 v146, v145
    s_nop 1
    v_permlane16_swap_b32 v145, v146
    v_add_f32 v145, v145, v146
    v_mov_b32 v146, v145
    s_nop 1
    v_permlane32_swap_b32 v145, v146
    v_add_f32 v145, v145, v146
    v_cvt_pk_bf16_f32 v146, v169, v170
    v_cndmask_b32 v156, v146, v145, s[92:93]
    buffer_store_dword v156, v246, s[36:39], s97 offen sc1
    s_add_u32 s96, s96, 16384
    s_add_u32 s97, s97, 4096
    v_add_f32 v144, 0x358637bd, v180
    v_rcp_f32 v144, v144
    s_nop 0
    v_mul_f32 v181, v181, v144
    v_mul_f32 v182, v182, v144
    v_pk_mul_f32 v[172:173], v[172:173], v[144:145] op_sel_hi:[1,0]
    v_pk_mul_f32 v[174:175], v[174:175], v[144:145] op_sel_hi:[1,0]
    v_pk_mul_f32 v[176:177], v[176:177], v[144:145] op_sel_hi:[1,0]
    v_pk_mul_f32 v[178:179], v[178:179], v[144:145] op_sel_hi:[1,0]
    v_cvt_pk_bf16_f32 v152, v172, v173
    v_cvt_pk_bf16_f32 v153, v174, v175
    v_cvt_pk_bf16_f32 v154, v176, v177
    v_cvt_pk_bf16_f32 v155, v178, v179
    buffer_store_dwordx4 v[152:155], v234, s[36:39], s96 offen sc1
    v_pk_mul_f32 v[146:147], v[172:173], v[36:37]
    v_pk_fma_f32 v[146:147], v[174:175], v[38:39], v[146:147]
    v_pk_fma_f32 v[146:147], v[176:177], v[40:41], v[146:147]
    v_pk_fma_f32 v[146:147], v[178:179], v[42:43], v[146:147]
    v_fmac_f32 v146, v181, v44
    v_fmac_f32 v147, v182, v45
    v_add_f32 v145, v146, v147
    v_mov_b32 v146, v145
    s_nop 1
    v_permlane16_swap_b32 v145, v146
    v_add_f32 v145, v145, v146
    v_mov_b32 v146, v145
    s_nop 1
    v_permlane32_swap_b32 v145, v146
    v_add_f32 v145, v145, v146
    v_cvt_pk_bf16_f32 v146, v181, v182
    v_cndmask_b32 v157, v146, v145, s[92:93]
    buffer_store_dword v157, v246, s[36:39], s97 offen sc1
    v_and_b32 v144, 15, v139
    v_and_b32 v232, 7, v144
    v_lshlrev_b32 v232, 10, v232
    v_lshrrev_b32 v145, 3, v144
    v_lshl_add_u32 v232, v145, 7, v232
    s_and_b32 s96, s58, 3
    s_lshl_b32 s96, s96, 13
    s_lshr_b32 s97, s58, 2
    s_lshl_b32 s97, s97, 8
    s_add_u32 s96, s96, s97
    s_and_b32 s97, s88, 7
    s_lshr_b32 s97, s97, 1
    s_lshl_b32 s97, s97, 2
    s_add_u32 s96, s96, s97
    v_add_u32 v232, s96, v232
    v_and_b32 v144, 12, v232
    v_and_b32 v232, 0xffffff80, v232
    v_lshlrev_b32 v232, 2, v232
    v_lshl_add_u32 v232, v144, 5, v232
    v_mov_b32 v225, v139
    s_lshl_b32 s96, s55, 6
    s_lshl_b32 s97, s56, 4
    s_add_u32 s96, s96, s97
    s_lshl_b32 s97, s48, 2
    s_add_u32 s97, s97, s96
    s_mul_i32 s76, s97, 18432
    s_add_u32 s76, s76, 3801088
    s_mul_i32 s97, s97, 147456
    s_mul_i32 s98, s54, 36864
    s_add_u32 s97, s97, s98
    s_add_u32 s97, s97, 19267584
    s_lshl_b32 s99, s57, 12
    s_add_u32 s82, s97, s99
    s_lshl_b32 s99, s57, 9
    s_add_u32 s83, s97, s99
    s_add_u32 s83, s83, 32768
    s_lshr_b32 s97, s57, 2
    s_lshl_b32 s97, s97, 3
    s_add_u32 s96, s96, s97
    s_lshl_b32 s97, s48, 1
    s_add_u32 s85, s96, s97
    s_mul_i32 s84, s85, 147456
    s_add_u32 s84, s84, s98
    s_add_u32 s84, s84, 19267584
    s_mul_i32 s96, s54, 2304
    s_lshl_b32 s97, s57, 8
    s_add_u32 s77, s96, s97
    s_lshl_b32 s97, s54, 3
    s_add_u32 s97, s97, s57
    s_mul_i32 s97, s97, 36864
    s_add_u32 s97, s97, s49
    s_add_u32 s78, s97, 38797312
    s_lshr_b32 s97, s48, 1
    s_mul_i32 s96, s54, 1327104
    s_and_b32 s98, s57, 3
    s_mul_i32 s79, s98, 147456
    s_lshl_b32 s98, s98, 8
    s_add_u32 s96, s96, s98
    s_mul_i32 s98, s54, 36864
    s_add_u32 s79, s79, s98
    s_add_u32 s79, s79, 40108032
    s_and_b32 s98, s48, 1
    s_lshl_b32 s97, s97, 2
    s_add_u32 s89, s98, s97
    s_mul_i32 s98, s89, 36864
    s_add_u32 s80, s96, s98
    s_lshl_b32 s89, s89, 10
    s_add_u32 s89, s89, s79
    s_add_u32 s98, s48, 32
    s_mul_i32 s98, s98, 36864
    s_add_u32 s81, s96, s98
    s_movk_i32 s99, 9216
    s_lshl_b32 s98, s48, 3
    v_lshrrev_b32 v240, 3, v225
    v_add_u32 v240, s98, v240
    v_and_b32 v241, 6, v240
    v_and_b32 v242, 7, v225
    v_xor_b32 v241, v241, v242
    v_lshlrev_b32 v241, 4, v241
    v_mad_u32_u24 v221, v240, s99, v241
    v_bfe_u32 v242, v240, 2, 2
    v_lshlrev_b32 v242, 3, v242
    v_lshrrev_b32 v243, 4, v240
    v_lshl_add_u32 v242, v243, 2, v242
    v_and_b32 v243, 3, v240
    v_add_u32 v242, v242, v243
    v_mad_u32_u24 v222, v242, s99, v241
    v_lshrrev_b32 v240, 2, v225
    v_and_b32 v241, 3, v225
    v_bfe_u32 v242, v240, 1, 2
    v_lshlrev_b32 v243, 7, v240
    v_lshl_add_u32 v243, v241, 3, v243
    v_xor_b32 v212, 0, v242
    v_lshl_add_u32 v212, v212, 5, v243
    v_xor_b32 v213, 1, v242
    v_lshl_add_u32 v213, v213, 5, v243
    v_xor_b32 v214, 2, v242
    v_lshl_add_u32 v214, v214, 5, v243
    v_xor_b32 v215, 3, v242
    v_lshl_add_u32 v215, v215, 5, v243
    v_add_u32 v226, 73728, v234
    v_and_b32 v240, 15, v225
    v_lshrrev_b32 v241, 4, v225
    v_mul_u32_u24 v242, 144, v240
    v_lshl_add_u32 v242, v241, 3, v242
    s_mul_i32 s97, s48, 3072
    s_add_u32 s97, s97, 122880
    v_add_u32 v242, s97, v242
    v_lshrrev_b32 v244, 1, v241
    v_lshlrev_b32 v244, 4, v244
    v_sub_u32 v244, v242, v244
    v_lshlrev_b32 v243, 4, v240
    v_lshl_add_u32 v227, v241, 9, v243
    v_lshlrev_b32 v229, 3, v225
    v_lshlrev_b32 v240, 2, v240
    s_and_b32 s97, s88, 7
    s_lshl_b32 s97, s97, 6
    s_add_u32 s97, s97, 162048
    v_add_u32 v240, s97, v240
    ds_read_b32 v230, v240
    s_waitcnt vmcnt(0)
    v_mov_b32 v243, 2
    s_mov_b64 exec, 1
    buffer_store_dword v243, off, s[36:39], s52 sc1
    s_mov_b64 exec, -1
    ds_read_b64 v[96:97], v242 offset:0
    ds_read_b64 v[98:99], v242 offset:32
    ds_read_b64 v[100:101], v242 offset:64
    ds_read_b64 v[102:103], v242 offset:96
    ds_read_b64 v[104:105], v244 offset:128
    s_cmp_lg_u32 s48, 3
    s_cbranch_scc1 sequential_preLN__linear_kernel_hedgehog__glu_gated_reglu__prompt_kernel_ct_19
    s_getpc_b64 s[100:101]
sequential_preLN__linear_kernel_hedgehog__glu_gated_reglu__prompt_kernel_ct_19_pc:
    s_sub_u32 s100, s100, sequential_preLN__linear_kernel_hedgehog__glu_gated_reglu__prompt_kernel_ct_19_pc-sequential_preLN__linear_kernel_hedgehog__glu_gated_reglu__prompt_kernel_body
    s_subb_u32 s101, s101, 0
    s_mul_i32 s97, s51, 2176
    v_min_u32 v240, 16, v225
    v_lshl_add_u32 v240, v240, 7, s97
    v_min_u32 v240, 65664, v240
    global_load_dword v255, v240, s[100:101]
sequential_preLN__linear_kernel_hedgehog__glu_gated_reglu__prompt_kernel_ct_19:
    ds_read_b64_tr_b16 a[0:1], v212 offset:0
    ds_read_b64_tr_b16 a[2:3], v212 offset:2048
    s_add_u32 m0, s49, 98304
    s_add_u32 s96, s77, 4718592
    buffer_load_dwordx4 v222, s[20:23], s96 offen lds
    ds_read_b64_tr_b16 a[4:5], v213 offset:0
    ds_read_b64_tr_b16 a[6:7], v213 offset:2048
    ds_read_b64_tr_b16 a[8:9], v214 offset:0
    ds_read_b64_tr_b16 a[10:11], v214 offset:2048
    ds_read_b64_tr_b16 a[12:13], v215 offset:0
    ds_read_b64_tr_b16 a[14:15], v215 offset:2048
    ds_read_b64_tr_b16 a[20:21], v212 offset:4096
    ds_read_b64_tr_b16 a[22:23], v212 offset:6144
    ds_read_b64_tr_b16 a[24:25], v213 offset:4096
    ds_read_b64_tr_b16 a[26:27], v213 offset:6144
    ds_read_b64_tr_b16 a[28:29], v214 offset:4096
    ds_read_b64_tr_b16 a[30:31], v214 offset:6144
    ds_read_b64_tr_b16 a[32:33], v215 offset:4096
    ds_read_b64_tr_b16 a[34:35], v215 offset:6144
    ds_read_b64_tr_b16 a[40:41], v212 offset:8192
    ds_read_b64_tr_b16 a[42:43], v212 offset:10240
    ds_read_b64_tr_b16 a[44:45], v213 offset:8192
    ds_read_b64_tr_b16 a[46:47], v213 offset:10240
    ds_read_b64_tr_b16 a[48:49], v214 offset:8192
    ds_read_b64_tr_b16 a[50:51], v214 offset:10240
    ds_read_b64_tr_b16 a[52:53], v215 offset:8192
    ds_read_b64_tr_b16 a[54:55], v215 offset:10240
    ds_read_b64_tr_b16 a[60:61], v212 offset:12288
    ds_read_b64_tr_b16 a[62:63], v212 offset:14336
    ds_read_b64_tr_b16 a[64:65], v213 offset:12288
    ds_read_b64_tr_b16 a[66:67], v213 offset:14336
    ds_read_b64_tr_b16 a[68:69], v214 offset:12288
    ds_read_b64_tr_b16 a[70:71], v214 offset:14336
    s_add_u32 m0, s49, 102400
    s_add_u32 s96, s77, 5013504
    buffer_load_dwordx4 v222, s[20:23], s96 offen lds
    ds_read_b64_tr_b16 a[72:73], v215 offset:12288
    ds_read_b64_tr_b16 a[74:75], v215 offset:14336
    ds_read_b64_tr_b16 a[80:81], v212 offset:16384
    ds_read_b64_tr_b16 a[82:83], v212 offset:18432
    ds_read_b64_tr_b16 a[84:85], v213 offset:16384
    ds_read_b64_tr_b16 a[86:87], v213 offset:18432
    ds_read_b64_tr_b16 a[88:89], v214 offset:16384
    ds_read_b64_tr_b16 a[90:91], v214 offset:18432
    ds_read_b64_tr_b16 a[92:93], v215 offset:16384
    ds_read_b64_tr_b16 a[94:95], v215 offset:18432
    ds_read_b64_tr_b16 a[100:101], v212 offset:20480
    ds_read_b64_tr_b16 a[102:103], v212 offset:22528
    ds_read_b64_tr_b16 a[104:105], v213 offset:20480
    ds_read_b64_tr_b16 a[106:107], v213 offset:22528
    ds_read_b64_tr_b16 a[108:109], v214 offset:20480
    ds_read_b64_tr_b16 a[110:111], v214 offset:22528
    ds_read_b64_tr_b16 a[112:113], v215 offset:20480
    ds_read_b64_tr_b16 a[114:115], v215 offset:22528
    ds_read_b64_tr_b16 a[120:121], v212 offset:24576
    ds_read_b64_tr_b16 a[122:123], v212 offset:26624
    ds_read_b64_tr_b16 a[124:125], v213 offset:24576
    ds_read_b64_tr_b16 a[126:127], v213 offset:26624
    ds_read_b64_tr_b16 a[128:129], v214 offset:24576
    ds_read_b64_tr_b16 a[130:131], v214 offset:26624
    ds_read_b64_tr_b16 a[132:133], v215 offset:24576
    ds_read_b64_tr_b16 a[134:135], v215 offset:26624
    ds_read_b64_tr_b16 a[140:141], v212 offset:28672
    ds_read_b64_tr_b16 a[142:143], v212 offset:30720
    s_add_u32 m0, s49, 106496
    s_add_u32 s96, s77, 4128768
    buffer_load_dwordx4 v221, s[20:23], s96 offen lds
    ds_read_b64_tr_b16 a[144:145], v213 offset:28672
    ds_read_b64_tr_b16 a[146:147], v213 offset:30720
    ds_read_b64_tr_b16 a[148:149], v214 offset:28672
    ds_read_b64_tr_b16 a[150:151], v214 offset:30720
    ds_read_b64_tr_b16 a[152:153], v215 offset:28672
    ds_read_b64_tr_b16 a[154:155], v215 offset:30720
    ds_read_b64_tr_b16 a[160:161], v212 offset:32768
    ds_read_b64_tr_b16 a[162:163], v212 offset:34816
    ds_read_b64_tr_b16 a[164:165], v213 offset:32768
    ds_read_b64_tr_b16 a[166:167], v213 offset:34816
    ds_read_b64_tr_b16 a[168:169], v214 offset:32768
    ds_read_b64_tr_b16 a[170:171], v214 offset:34816
    ds_read_b64_tr_b16 a[172:173], v215 offset:32768
    ds_read_b64_tr_b16 a[174:175], v215 offset:34816
    ds_read_b64_tr_b16 a[180:181], v212 offset:36864
    ds_read_b64_tr_b16 a[182:183], v212 offset:38912
    ds_read_b64_tr_b16 a[184:185], v213 offset:36864
    ds_read_b64_tr_b16 a[186:187], v213 offset:38912
    ds_read_b64_tr_b16 a[188:189], v214 offset:36864
    ds_read_b64_tr_b16 a[190:191], v214 offset:38912
    ds_read_b64_tr_b16 a[192:193], v215 offset:36864
    ds_read_b64_tr_b16 a[194:195], v215 offset:38912
    ds_read_b64_tr_b16 a[200:201], v212 offset:40960
    ds_read_b64_tr_b16 a[202:203], v212 offset:43008
    ds_read_b64_tr_b16 a[204:205], v213 offset:40960
    ds_read_b64_tr_b16 a[206:207], v213 offset:43008
    ds_read_b64_tr_b16 a[208:209], v214 offset:40960
    ds_read_b64_tr_b16 a[210:211], v214 offset:43008
    s_add_u32 m0, s49, 110592
    s_add_u32 s96, s77, 4423680
    buffer_load_dwordx4 v221, s[20:23], s96 offen lds
    ds_read_b64_tr_b16 a[212:213], v215 offset:40960
    ds_read_b64_tr_b16 a[214:215], v215 offset:43008
    ds_read_b64_tr_b16 a[220:221], v212 offset:45056
    ds_read_b64_tr_b16 a[222:223], v212 offset:47104
    ds_read_b64_tr_b16 a[224:225], v213 offset:45056
    ds_read_b64_tr_b16 a[226:227], v213 offset:47104
    ds_read_b64_tr_b16 a[228:229], v214 offset:45056
    ds_read_b64_tr_b16 a[230:231], v214 offset:47104
    ds_read_b64_tr_b16 a[232:233], v215 offset:45056
    ds_read_b64_tr_b16 a[234:235], v215 offset:47104
    ds_read_b64_tr_b16 a[240:241], v212 offset:49152
    ds_read_b64_tr_b16 a[242:243], v212 offset:51200
    ds_read_b64_tr_b16 a[244:245], v213 offset:49152
    ds_read_b64_tr_b16 a[246:247], v213 offset:51200
    ds_read_b64_tr_b16 a[248:249], v214 offset:49152
    ds_read_b64_tr_b16 a[250:251], v214 offset:51200
    ds_read_b64_tr_b16 a[252:253], v215 offset:49152
    ds_read_b64_tr_b16 a[254:255], v215 offset:51200
    ds_read_b64_tr_b16 v[112:113], v212 offset:53248
    ds_read_b64_tr_b16 v[114:115], v212 offset:55296
    ds_read_b64_tr_b16 v[116:117], v213 offset:53248
    ds_read_b64_tr_b16 v[118:119], v213 offset:55296
    ds_read_b64_tr_b16 v[120:121], v214 offset:53248
    ds_read_b64_tr_b16 v[122:123], v214 offset:55296
    ds_read_b64_tr_b16 v[124:125], v215 offset:53248
    ds_read_b64_tr_b16 v[126:127], v215 offset:55296
    ds_read_b64_tr_b16 v[132:133], v212 offset:57344
    ds_read_b64_tr_b16 v[134:135], v212 offset:59392
    s_add_u32 m0, s49, 114688
    s_add_u32 s96, s77, 0
    buffer_load_dwordx4 v221, s[20:23], s96 offen lds
    ds_read_b64_tr_b16 v[136:137], v213 offset:57344
    ds_read_b64_tr_b16 v[138:139], v213 offset:59392
    ds_read_b64_tr_b16 v[140:141], v214 offset:57344
    ds_read_b64_tr_b16 v[142:143], v214 offset:59392
    ds_read_b64_tr_b16 v[144:145], v215 offset:57344
    ds_read_b64_tr_b16 v[146:147], v215 offset:59392
    ds_read_b64_tr_b16 v[152:153], v212 offset:61440
    ds_read_b64_tr_b16 v[154:155], v212 offset:63488
    ds_read_b64_tr_b16 v[156:157], v213 offset:61440
    ds_read_b64_tr_b16 v[158:159], v213 offset:63488
    ds_read_b64_tr_b16 v[160:161], v214 offset:61440
    ds_read_b64_tr_b16 v[162:163], v214 offset:63488
    ds_read_b64_tr_b16 v[164:165], v215 offset:61440
    ds_read_b64_tr_b16 v[166:167], v215 offset:63488
    v_add_u32 v212, 65536, v212
    v_add_u32 v213, 65536, v213
    v_add_u32 v214, 65536, v214
    v_add_u32 v215, 65536, v215
    ds_read_b64_tr_b16 v[172:173], v212 offset:0
    ds_read_b64_tr_b16 v[174:175], v212 offset:2048
    ds_read_b64_tr_b16 v[176:177], v213 offset:0
    ds_read_b64_tr_b16 v[178:179], v213 offset:2048
    ds_read_b64_tr_b16 v[180:181], v214 offset:0
    ds_read_b64_tr_b16 v[182:183], v214 offset:2048
    ds_read_b64_tr_b16 v[184:185], v215 offset:0
    ds_read_b64_tr_b16 v[186:187], v215 offset:2048
    ds_read_b64_tr_b16 v[192:193], v212 offset:4096
    ds_read_b64_tr_b16 v[194:195], v212 offset:6144
    ds_read_b64_tr_b16 v[196:197], v213 offset:4096
    ds_read_b64_tr_b16 v[198:199], v213 offset:6144
    ds_read_b64_tr_b16 v[200:201], v214 offset:4096
    ds_read_b64_tr_b16 v[202:203], v214 offset:6144
    s_add_u32 m0, s49, 118784
    s_add_u32 s96, s77, 294912
    buffer_load_dwordx4 v221, s[20:23], s96 offen lds
    ds_read_b64_tr_b16 v[204:205], v215 offset:4096
    ds_read_b64_tr_b16 v[206:207], v215 offset:6144
    s_barrier
    ds_read_b128 a[16:19], v226 offset:0
    ds_read_b128 a[36:39], v226 offset:1024
    ds_read_b128 a[56:59], v226 offset:2048
    ds_read_b128 a[76:79], v226 offset:3072
    ds_read_b128 a[96:99], v226 offset:4096
    ds_read_b128 a[116:119], v226 offset:5120
    ds_read_b128 a[136:139], v226 offset:6144
    ds_read_b128 a[156:159], v226 offset:7168
    ds_read_b128 a[176:179], v226 offset:8192
    ds_read_b128 a[196:199], v226 offset:9216
    ds_read_b128 a[216:219], v226 offset:10240
    ds_read_b128 a[236:239], v226 offset:11264
    ds_read_b128 v[108:111], v226 offset:12288
    ds_read_b128 v[128:131], v226 offset:13312
    ds_read_b128 v[148:151], v226 offset:14336
    ds_read_b128 v[168:171], v226 offset:15360
    ds_read_b128 v[188:191], v226 offset:16384
    ds_read_b128 v[208:211], v226 offset:17408
    buffer_load_dword v233, v232, s[36:39], 0 offen sc1
    s_lshl_b32 s98, s88, 14
    s_add_u32 s98, s98, 1179648
    s_lshl_b32 s97, s88, 12
    s_add_u32 s97, s97, 3276800
    s_waitcnt lgkmcnt(0)
    s_barrier
    s_waitcnt vmcnt(0)
    v_cmp_gt_u32 vcc, 2, v233
    s_mov_b32 s53, 0
    s_cbranch_vccz sequential_preLN__linear_kernel_hedgehog__glu_gated_reglu__prompt_kernel_spin_20_b
sequential_preLN__linear_kernel_hedgehog__glu_gated_reglu__prompt_kernel_spin_20:
    buffer_load_dword v233, v232, s[36:39], 0 offen sc1
    s_add_u32 s53, s53, 1
    s_waitcnt vmcnt(0)
    v_cmp_gt_u32 vcc, 2, v233
    s_cmp_gt_u32 s53, 50000
    s_cbranch_scc1 sequential_preLN__linear_kernel_hedgehog__glu_gated_reglu__prompt_kernel_spin_20_b
    s_cbranch_vccnz sequential_preLN__linear_kernel_hedgehog__glu_gated_reglu__prompt_kernel_spin_20
sequential_preLN__linear_kernel_hedgehog__glu_gated_reglu__prompt_kernel_spin_20_b:
    buffer_load_dwordx4 v[0:3], v234, s[36:39], s98 offen offset:0 sc1
    buffer_load_dwordx4 v[4:7], v234, s[36:39], s98 offen offset:1024 sc1
    buffer_load_dwordx4 v[8:11], v234, s[36:39], s98 offen offset:2048 sc1
    buffer_load_dwordx4 v[12:15], v234, s[36:39], s98 offen offset:3072 sc1
    s_add_u32 s98, s98, 4096
    buffer_load_dwordx4 v[16:19], v234, s[36:39], s98 offen offset:0 sc1
    buffer_load_dwordx4 v[20:23], v234, s[36:39], s98 offen offset:1024 sc1
    buffer_load_dwordx4 v[24:27], v234, s[36:39], s98 offen offset:2048 sc1
    buffer_load_dwordx4 v[28:31], v234, s[36:39], s98 offen offset:3072 sc1
    buffer_load_dwordx3 v[64:66], v227, s[36:39], s97 offen offset:0 sc1
    buffer_load_dwordx3 v[244:246], v227, s[36:39], s97 offen offset:256 sc1
    buffer_load_dwordx3 v[68:70], v227, s[36:39], s97 offen offset:2048 sc1
    buffer_load_dwordx3 v[248:250], v227, s[36:39], s97 offen offset:2304 sc1
    s_add_u32 s98, s98, 4096
    buffer_load_dwordx4 v[32:35], v234, s[36:39], s98 offen offset:0 sc1
    buffer_load_dwordx4 v[36:39], v234, s[36:39], s98 offen offset:1024 sc1
    buffer_load_dwordx4 v[40:43], v234, s[36:39], s98 offen offset:2048 sc1
    buffer_load_dwordx4 v[44:47], v234, s[36:39], s98 offen offset:3072 sc1
    s_add_u32 s98, s98, 4096
    buffer_load_dwordx4 v[48:51], v234, s[36:39], s98 offen offset:0 sc1
    buffer_load_dwordx4 v[52:55], v234, s[36:39], s98 offen offset:1024 sc1
    buffer_load_dwordx4 v[56:59], v234, s[36:39], s98 offen offset:2048 sc1
    buffer_load_dwordx4 v[60:63], v234, s[36:39], s98 offen offset:3072 sc1
    s_waitcnt vmcnt(19)
    v_mfma_f32_16x16x32_bf16 v[72:75], a[0:3], v[0:3], 0
    v_mfma_f32_16x16x32_bf16 v[76:79], a[4:7], v[0:3], 0
    v_mfma_f32_16x16x32_bf16 v[80:83], a[8:11], v[0:3], 0
    s_and_b32 s99, s59, 7
    s_mul_i32 s86, s88, 18432
    v_mfma_f32_16x16x32_bf16 v[84:87], a[12:15], v[0:3], 0
    s_lshl_b32 s97, s99, 11
    s_add_u32 s97, s97, s86
    v_mfma_f32_16x16x32_bf16 v[88:91], a[16:19], v[0:3], 0
    s_add_u32 s97, s97, 6422528
    s_lshl_b32 s98, s99, 11
    s_waitcnt vmcnt(18)
    v_mfma_f32_16x16x32_bf16 v[72:75], a[20:23], v[4:7], v[72:75]
    s_add_u32 s98, s98, s86
    s_add_u32 s98, s98, 3801088
    v_mfma_f32_16x16x32_bf16 v[76:79], a[24:27], v[4:7], v[76:79]
    s_and_b32 s87, s99, 1
    v_lshrrev_b32 v240, 5, v225
    v_mfma_f32_16x16x32_bf16 v[80:83], a[28:31], v[4:7], v[80:83]
    v_cmp_eq_u32 s[90:91], s87, v240
    v_mov_b32 v240, 0x8000000
    v_mfma_f32_16x16x32_bf16 v[84:87], a[32:35], v[4:7], v[84:87]
sequential_preLN__linear_kernel_hedgehog__glu_gated_reglu__prompt_kernel_hop0_4:
    s_cbranch_execz sequential_preLN__linear_kernel_hedgehog__glu_gated_reglu__prompt_kernel_hopback0
    v_cndmask_b32 v231, v240, v229, s[90:91]
    v_and_b32 v241, 15, v225
    v_mfma_f32_16x16x32_bf16 v[88:91], a[36:39], v[4:7], v[88:91]
    v_lshlrev_b32 v241, 4, v241
    v_bfe_u32 v242, v225, 4, 1
    s_waitcnt vmcnt(17)
    v_mfma_f32_16x16x32_bf16 v[72:75], a[40:43], v[8:11], v[72:75]
    v_lshl_add_u32 v241, v242, 3, v241
    v_cndmask_b32 v228, v240, v241, s[90:91]
    v_mfma_f32_16x16x32_bf16 v[76:79], a[44:47], v[8:11], v[76:79]
    v_mfma_f32_16x16x32_bf16 v[80:83], a[48:51], v[8:11], v[80:83]
    v_mfma_f32_16x16x32_bf16 v[84:87], a[52:55], v[8:11], v[84:87]
    v_mfma_f32_16x16x32_bf16 v[88:91], a[56:59], v[8:11], v[88:91]
    s_waitcnt vmcnt(16)
    v_mfma_f32_16x16x32_bf16 v[72:75], a[60:63], v[12:15], v[72:75]
    v_mfma_f32_16x16x32_bf16 v[76:79], a[64:67], v[12:15], v[76:79]
    v_mfma_f32_16x16x32_bf16 v[80:83], a[68:71], v[12:15], v[80:83]
    v_mfma_f32_16x16x32_bf16 v[84:87], a[72:75], v[12:15], v[84:87]
    v_mfma_f32_16x16x32_bf16 v[88:91], a[76:79], v[12:15], v[88:91]
    s_waitcnt vmcnt(15)
    v_mfma_f32_16x16x32_bf16 v[72:75], a[80:83], v[16:19], v[72:75]
    v_mfma_f32_16x16x32_bf16 v[76:79], a[84:87], v[16:19], v[76:79]
    v_mfma_f32_16x16x32_bf16 v[80:83], a[88:91], v[16:19], v[80:83]
    v_mfma_f32_16x16x32_bf16 v[84:87], a[92:95], v[16:19], v[84:87]
    v_mfma_f32_16x16x32_bf16 v[88:91], a[96:99], v[16:19], v[88:91]
    s_waitcnt vmcnt(14)
    v_mfma_f32_16x16x32_bf16 v[72:75], a[100:103], v[20:23], v[72:75]
    v_mfma_f32_16x16x32_bf16 v[76:79], a[104:107], v[20:23], v[76:79]
    v_mfma_f32_16x16x32_bf16 v[80:83], a[108:111], v[20:23], v[80:83]
    v_mfma_f32_16x16x32_bf16 v[84:87], a[112:115], v[20:23], v[84:87]
    v_mfma_f32_16x16x32_bf16 v[88:91], a[116:119], v[20:23], v[88:91]
    s_waitcnt vmcnt(13)
    v_mfma_f32_16x16x32_bf16 v[72:75], a[120:123], v[24:27], v[72:75]
    v_mfma_f32_16x16x32_bf16 v[76:79], a[124:127], v[24:27], v[76:79]
    v_mfma_f32_16x16x32_bf16 v[80:83], a[128:131], v[24:27], v[80:83]
    v_mfma_f32_16x16x32_bf16 v[84:87], a[132:135], v[24:27], v[84:87]
    v_mfma_f32_16x16x32_bf16 v[88:91], a[136:139], v[24:27], v[88:91]
    s_waitcnt vmcnt(12)
    v_mfma_f32_16x16x32_bf16 v[72:75], a[140:143], v[28:31], v[72:75]
    v_mfma_f32_16x16x32_bf16 v[76:79], a[144:147], v[28:31], v[76:79]
    v_mfma_f32_16x16x32_bf16 v[80:83], a[148:151], v[28:31], v[80:83]
    v_mfma_f32_16x16x32_bf16 v[84:87], a[152:155], v[28:31], v[84:87]
    v_mfma_f32_16x16x32_bf16 v[88:91], a[156:159], v[28:31], v[88:91]
    s_waitcnt vmcnt(7)
    v_mfma_f32_16x16x32_bf16 v[72:75], a[160:163], v[32:35], v[72:75]
    s_add_u32 m0, s49, 155648
    s_add_u32 s96, s78, 32768
    v_mfma_f32_16x16x32_bf16 v[76:79], a[164:167], v[32:35], v[76:79]
    buffer_load_dwordx4 v234, s[36:39], s96 offen sc1 lds
    v_mfma_f32_16x16x32_bf16 v[80:83], a[168:171], v[32:35], v[80:83]
    s_add_u32 m0, s49, 151552
    s_add_u32 s96, s78, 28672
    v_mfma_f32_16x16x32_bf16 v[84:87], a[172:175], v[32:35], v[84:87]
    buffer_load_dwordx4 v234, s[36:39], s96 offen sc1 lds
    v_mfma_f32_16x16x32_bf16 v[88:91], a[176:179], v[32:35], v[88:91]
    s_waitcnt vmcnt(8)
    v_mfma_f32_16x16x32_bf16 v[72:75], a[180:183], v[36:39], v[72:75]
    s_add_u32 m0, s49, 122880
    s_add_u32 s96, s78, 0
    v_mfma_f32_16x16x32_bf16 v[76:79], a[184:187], v[36:39], v[76:79]
    buffer_load_dwordx4 v234, s[36:39], s96 offen sc1 lds
    v_add_f32 v92, v66, v246
    v_mfma_f32_16x16x32_bf16 v[80:83], a[188:191], v[36:39], v[80:83]
    v_mov_b32 v66, v244
    v_mov_b32 v67, v245
    v_mfma_f32_16x16x32_bf16 v[84:87], a[192:195], v[36:39], v[84:87]
    s_add_u32 m0, s49, 126976
    s_add_u32 s96, s78, 4096
    v_mfma_f32_16x16x32_bf16 v[88:91], a[196:199], v[36:39], v[88:91]
    buffer_load_dwordx4 v234, s[36:39], s96 offen sc1 lds
    v_add_f32 v93, v70, v250
    s_waitcnt vmcnt(9)
    v_mfma_f32_16x16x32_bf16 v[72:75], a[200:203], v[40:43], v[72:75]
    v_mov_b32 v70, v248
    v_mov_b32 v71, v249
    v_mfma_f32_16x16x32_bf16 v[76:79], a[204:207], v[40:43], v[76:79]
    s_add_u32 m0, s49, 131072
    s_add_u32 s96, s78, 8192
    v_mfma_f32_16x16x32_bf16 v[80:83], a[208:211], v[40:43], v[80:83]
    buffer_load_dwordx4 v234, s[36:39], s96 offen sc1 lds
    v_add_f32 v92, v92, v93
    v_mfma_f32_16x16x32_bf16 v[84:87], a[212:215], v[40:43], v[84:87]
    v_mov_b32 v93, v92
    s_nop 1
    v_permlane16_swap_b32 v92, v93
    v_mfma_f32_16x16x32_bf16 v[88:91], a[216:219], v[40:43], v[88:91]
    s_add_u32 m0, s49, 135168
    s_add_u32 s96, s78, 12288
    s_waitcnt vmcnt(9)
    v_mfma_f32_16x16x32_bf16 v[72:75], a[220:223], v[44:47], v[72:75]
    buffer_load_dwordx4 v234, s[36:39], s96 offen sc1 lds
    v_add_f32 v92, v92, v93
    v_mfma_f32_16x16x32_bf16 v[76:79], a[224:227], v[44:47], v[76:79]
    v_mov_b32 v93, v92
    s_nop 1
    v_permlane32_swap_b32 v92, v93
    v_mfma_f32_16x16x32_bf16 v[80:83], a[228:231], v[44:47], v[80:83]
    s_add_u32 m0, s49, 139264
    s_add_u32 s96, s78, 16384
    v_mfma_f32_16x16x32_bf16 v[84:87], a[232:235], v[44:47], v[84:87]
    buffer_load_dwordx4 v234, s[36:39], s96 offen sc1 lds
    v_add_f32 v92, v92, v93
    v_mfma_f32_16x16x32_bf16 v[88:91], a[236:239], v[44:47], v[88:91]
    v_add_f32 v92, v92, v230
    s_waitcnt vmcnt(10)
    v_mfma_f32_16x16x32_bf16 v[72:75], a[240:243], v[48:51], v[72:75]
    s_add_u32 m0, s49, 143360
    s_add_u32 s96, s78, 20480
    v_mfma_f32_16x16x32_bf16 v[76:79], a[244:247], v[48:51], v[76:79]
    buffer_load_dwordx4 v234, s[36:39], s96 offen sc1 lds
    v_mfma_f32_16x16x32_bf16 v[80:83], a[248:251], v[48:51], v[80:83]
    v_mfma_f32_16x16x32_bf16 v[84:87], a[252:255], v[48:51], v[84:87]
    s_add_u32 m0, s49, 147456
    s_add_u32 s96, s78, 24576
    v_mfma_f32_16x16x32_bf16 v[88:91], v[108:111], v[48:51], v[88:91]
    buffer_load_dwordx4 v234, s[36:39], s96 offen sc1 lds
    s_waitcnt vmcnt(11)
    v_mfma_f32_16x16x32_bf16 v[72:75], v[112:115], v[52:55], v[72:75]
    v_mfma_f32_16x16x32_bf16 v[76:79], v[116:119], v[52:55], v[76:79]
    s_add_u32 m0, s49, 73728
    s_add_u32 s96, s77, 589824
    v_mfma_f32_16x16x32_bf16 v[80:83], v[120:123], v[52:55], v[80:83]
    buffer_load_dwordx4 v221, s[20:23], s96 offen lds
    v_mfma_f32_16x16x32_bf16 v[84:87], v[124:127], v[52:55], v[84:87]
    v_mfma_f32_16x16x32_bf16 v[88:91], v[128:131], v[52:55], v[88:91]
    s_add_u32 m0, s49, 77824
    s_add_u32 s96, s77, 884736
    s_waitcnt vmcnt(11)
    v_mfma_f32_16x16x32_bf16 v[72:75], v[132:135], v[56:59], v[72:75]
    buffer_load_dwordx4 v221, s[20:23], s96 offen lds
    v_mfma_f32_16x16x32_bf16 v[76:79], v[136:139], v[56:59], v[76:79]
    v_mfma_f32_16x16x32_bf16 v[80:83], v[140:143], v[56:59], v[80:83]
    s_add_u32 m0, s49, 81920
    s_add_u32 s96, s77, 1179648
    v_mfma_f32_16x16x32_bf16 v[84:87], v[144:147], v[56:59], v[84:87]
    buffer_load_dwordx4 v221, s[20:23], s96 offen lds
    v_mfma_f32_16x16x32_bf16 v[88:91], v[148:151], v[56:59], v[88:91]
    s_waitcnt vmcnt(12)
    v_mfma_f32_16x16x32_bf16 v[72:75], v[152:155], v[60:63], v[72:75]
    s_add_u32 m0, s49, 86016
    s_add_u32 s96, s77, 1474560
    v_mfma_f32_16x16x32_bf16 v[76:79], v[156:159], v[60:63], v[76:79]
    buffer_load_dwordx4 v221, s[20:23], s96 offen lds
    v_mfma_f32_16x16x32_bf16 v[80:83], v[160:163], v[60:63], v[80:83]
    v_mfma_f32_16x16x32_bf16 v[84:87], v[164:167], v[60:63], v[84:87]
    s_add_u32 m0, s49, 90112
    s_add_u32 s96, s77, 1769472
    v_mfma_f32_16x16x32_bf16 v[88:91], v[168:171], v[60:63], v[88:91]
    buffer_load_dwordx4 v221, s[20:23], s96 offen lds
    v_mfma_f32_16x16x32_bf16 v[72:75], v[172:175], v[64:67], v[72:75]
    v_mfma_f32_16x16x32_bf16 v[76:79], v[176:179], v[64:67], v[76:79]
    s_add_u32 m0, s49, 94208
    s_add_u32 s96, s77, 2064384
    v_mfma_f32_16x16x32_bf16 v[80:83], v[180:183], v[64:67], v[80:83]
    buffer_load_dwordx4 v221, s[20:23], s96 offen lds
    v_mfma_f32_16x16x32_bf16 v[84:87], v[184:187], v[64:67], v[84:87]
    v_mfma_f32_16x16x32_bf16 v[88:91], v[188:191], v[64:67], v[88:91]
    v_mfma_f32_16x16x32_bf16 v[72:75], v[192:195], v[68:71], v[72:75]
    v_mfma_f32_16x16x32_bf16 v[76:79], v[196:199], v[68:71], v[76:79]
    v_mfma_f32_16x16x32_bf16 v[80:83], v[200:203], v[68:71], v[80:83]
    v_mfma_f32_16x16x32_bf16 v[84:87], v[204:207], v[68:71], v[84:87]
    v_mfma_f32_16x16x32_bf16 v[88:91], v[208:211], v[68:71], v[88:91]
    v_mov_b32 v94, 0
    v_mov_b32 v95, 0
    v_lshlrev_b32 v240, 16, v96
    v_and_b32 v241, 0xffff0000, v96
    v_pk_add_f32 v[240:241], v[240:241], v[72:73]
    v_cvt_pk_bf16_f32 v0, v240, v241
    v_lshlrev_b32 v240, 16, v0
    v_and_b32 v241, 0xffff0000, v0
    v_pk_add_f32 v[240:241], v[240:241], v[92:93] op_sel_hi:[1,0] neg_lo:[0,1] neg_hi:[0,1]
    v_cvt_pk_bf16_f32 v12, v240, v241
    v_pk_fma_f32 v[94:95], v[240:241], v[240:241], v[94:95]
    v_lshlrev_b32 v240, 16, v97
    v_and_b32 v241, 0xffff0000, v97
    v_pk_add_f32 v[240:241], v[240:241], v[74:75]
    v_cvt_pk_bf16_f32 v1, v240, v241
    v_lshlrev_b32 v240, 16, v1
    v_and_b32 v241, 0xffff0000, v1
    v_pk_add_f32 v[240:241], v[240:241], v[92:93] op_sel_hi:[1,0] neg_lo:[0,1] neg_hi:[0,1]
    v_cvt_pk_bf16_f32 v13, v240, v241
    v_pk_fma_f32 v[94:95], v[240:241], v[240:241], v[94:95]
    v_lshlrev_b32 v240, 16, v98
    v_and_b32 v241, 0xffff0000, v98
    v_pk_add_f32 v[240:241], v[240:241], v[76:77]
    v_cvt_pk_bf16_f32 v2, v240, v241
    v_lshlrev_b32 v240, 16, v2
    v_and_b32 v241, 0xffff0000, v2
    v_pk_add_f32 v[240:241], v[240:241], v[92:93] op_sel_hi:[1,0] neg_lo:[0,1] neg_hi:[0,1]
    v_cvt_pk_bf16_f32 v14, v240, v241
    v_pk_fma_f32 v[94:95], v[240:241], v[240:241], v[94:95]
    v_lshlrev_b32 v240, 16, v99
    v_and_b32 v241, 0xffff0000, v99
    v_pk_add_f32 v[240:241], v[240:241], v[78:79]
    v_cvt_pk_bf16_f32 v3, v240, v241
    v_lshlrev_b32 v240, 16, v3
    v_and_b32 v241, 0xffff0000, v3
    v_pk_add_f32 v[240:241], v[240:241], v[92:93] op_sel_hi:[1,0] neg_lo:[0,1] neg_hi:[0,1]
    v_cvt_pk_bf16_f32 v15, v240, v241
    v_pk_fma_f32 v[94:95], v[240:241], v[240:241], v[94:95]
    buffer_store_dwordx4 v[12:15], v234, s[36:39], s98 offen offset:0 sc1
    v_lshlrev_b32 v240, 16, v100
    v_and_b32 v241, 0xffff0000, v100
    v_pk_add_f32 v[240:241], v[240:241], v[80:81]
    v_cvt_pk_bf16_f32 v4, v240, v241
    v_lshlrev_b32 v240, 16, v4
    v_and_b32 v241, 0xffff0000, v4
    v_pk_add_f32 v[240:241], v[240:241], v[92:93] op_sel_hi:[1,0] neg_lo:[0,1] neg_hi:[0,1]
    v_cvt_pk_bf16_f32 v16, v240, v241
    v_pk_fma_f32 v[94:95], v[240:241], v[240:241], v[94:95]
    v_lshlrev_b32 v240, 16, v101
    v_and_b32 v241, 0xffff0000, v101
    v_pk_add_f32 v[240:241], v[240:241], v[82:83]
    v_cvt_pk_bf16_f32 v5, v240, v241
    v_lshlrev_b32 v240, 16, v5
    v_and_b32 v241, 0xffff0000, v5
    v_pk_add_f32 v[240:241], v[240:241], v[92:93] op_sel_hi:[1,0] neg_lo:[0,1] neg_hi:[0,1]
    v_cvt_pk_bf16_f32 v17, v240, v241
    v_pk_fma_f32 v[94:95], v[240:241], v[240:241], v[94:95]
    v_lshlrev_b32 v240, 16, v102
    v_and_b32 v241, 0xffff0000, v102
    v_pk_add_f32 v[240:241], v[240:241], v[84:85]
    v_cvt_pk_bf16_f32 v6, v240, v241
    v_lshlrev_b32 v240, 16, v6
    v_and_b32 v241, 0xffff0000, v6
    v_pk_add_f32 v[240:241], v[240:241], v[92:93] op_sel_hi:[1,0] neg_lo:[0,1] neg_hi:[0,1]
    v_cvt_pk_bf16_f32 v18, v240, v241
    v_pk_fma_f32 v[94:95], v[240:241], v[240:241], v[94:95]
    v_lshlrev_b32 v240, 16, v103
    v_and_b32 v241, 0xffff0000, v103
    v_pk_add_f32 v[240:241], v[240:241], v[86:87]
    v_cvt_pk_bf16_f32 v7, v240, v241
    v_lshlrev_b32 v240, 16, v7
    v_and_b32 v241, 0xffff0000, v7
    v_pk_add_f32 v[240:241], v[240:241], v[92:93] op_sel_hi:[1,0] neg_lo:[0,1] neg_hi:[0,1]
    v_cvt_pk_bf16_f32 v19, v240, v241
    v_pk_fma_f32 v[94:95], v[240:241], v[240:241], v[94:95]
    buffer_store_dwordx4 v[16:19], v234, s[36:39], s98 offen offset:1024 sc1
    v_lshlrev_b32 v240, 16, v104
    v_and_b32 v241, 0xffff0000, v104
    v_pk_add_f32 v[240:241], v[240:241], v[88:89]
    v_cvt_pk_bf16_f32 v8, v240, v241
    v_lshlrev_b32 v240, 16, v8
    v_and_b32 v241, 0xffff0000, v8
    v_pk_add_f32 v[240:241], v[240:241], v[92:93] op_sel_hi:[1,0] neg_lo:[0,1] neg_hi:[0,1]
    v_cvt_pk_bf16_f32 v20, v240, v241
    v_cndmask_b32 v241, 0, v241, s[90:91]
    v_cndmask_b32 v240, 0, v240, s[90:91]
    v_pk_fma_f32 v[94:95], v[240:241], v[240:241], v[94:95]
    v_lshlrev_b32 v240, 16, v105
    v_and_b32 v241, 0xffff0000, v105
    v_pk_add_f32 v[240:241], v[240:241], v[90:91]
    v_cvt_pk_bf16_f32 v9, v240, v241
    v_lshlrev_b32 v240, 16, v9
    v_and_b32 v241, 0xffff0000, v9
    v_pk_add_f32 v[240:241], v[240:241], v[92:93] op_sel_hi:[1,0] neg_lo:[0,1] neg_hi:[0,1]
    v_cvt_pk_bf16_f32 v21, v240, v241
    v_cndmask_b32 v241, 0, v241, s[90:91]
    v_cndmask_b32 v240, 0, v240, s[90:91]
    v_pk_fma_f32 v[94:95], v[240:241], v[240:241], v[94:95]
    s_lshl_b32 s98, s99, 8
    s_add_u32 s98, s98, s86
    s_add_u32 s98, s98, 3817472
    buffer_store_dwordx2 v[20:21], v228, s[36:39], s98 offen sc1
    v_add_f32 v94, v94, v95
    v_mov_b32 v95, v94
    s_nop 1
    v_permlane16_swap_b32 v94, v95
    v_add_f32 v94, v94, v95
    v_mov_b32 v95, v94
    s_nop 1
    v_permlane32_swap_b32 v94, v95
    v_add_f32 v94, v94, v95
    s_lshl_b32 s96, s88, 3
    s_add_u32 s96, s96, s99
    s_lshl_b32 s96, s96, 8
    s_add_u32 s96, s96, 6160384
    v_lshlrev_b32 v240, 2, v225
    buffer_store_dword v94, v240, s[36:39], s96 offen sc1
    buffer_store_dwordx2 v[0:1], v229, s[36:39], s97 offen offset:0 sc1
    buffer_store_dwordx2 v[2:3], v229, s[36:39], s97 offen offset:512 sc1
    buffer_store_dwordx2 v[4:5], v229, s[36:39], s97 offen offset:1024 sc1
    buffer_store_dwordx2 v[6:7], v229, s[36:39], s97 offen offset:1536 sc1
    s_lshr_b32 s97, s99, 1
    s_lshl_b32 s97, s97, 9
    s_add_u32 s97, s97, s86
    s_add_u32 s97, s97, 6438912
    buffer_store_dwordx2 v[8:9], v231, s[36:39], s97 offen sc1
    s_lshl_b32 s96, s55, 3
    s_lshl_b32 s97, s56, 1
    s_add_u32 s96, s96, s97
    s_lshr_b32 s97, s48, 1
    s_add_u32 s96, s96, s97
    s_and_b32 s98, s96, 3
    s_lshl_b32 s98, s98, 13
    s_lshr_b32 s97, s96, 2
    s_lshl_b32 s97, s97, 8
    s_add_u32 s98, s98, s97
    s_and_b32 s96, s48, 1
    s_lshl_b32 s96, s96, 3
    v_bfe_u32 v100, v225, 2, 3
    v_add_u32 v100, s96, v100
    v_and_b32 v238, 7, v100
    v_lshlrev_b32 v238, 10, v238
    v_lshrrev_b32 v101, 3, v100
    v_lshl_add_u32 v238, v101, 7, v238
    v_and_b32 v100, 3, v225
    v_lshl_add_u32 v238, v100, 2, v238
    v_add_u32 v238, s98, v238
    v_and_b32 v100, 12, v238
    v_and_b32 v238, 0xffffff80, v238
    v_lshlrev_b32 v238, 2, v238
    v_lshl_add_u32 v238, v100, 5, v238
    v_mov_b32 v102, v225
    v_lshlrev_b32 v232, 4, v102
    v_lshlrev_b32 v233, 3, v102
    v_lshrrev_b32 v240, 2, v102
    v_and_b32 v241, 3, v102
    v_add_u32 v220, 122880, v232
    v_bfe_u32 v242, v240, 1, 2
    v_lshlrev_b32 v243, 7, v240
    v_lshl_add_u32 v243, v241, 3, v243
    v_xor_b32 v216, 0, v242
    v_lshl_add_u32 v216, v216, 5, v243
    v_xor_b32 v217, 1, v242
    v_lshl_add_u32 v217, v217, 5, v243
    v_xor_b32 v218, 2, v242
    v_lshl_add_u32 v218, v218, 5, v243
    v_xor_b32 v219, 3, v242
    v_lshl_add_u32 v219, v219, 5, v243
    v_bfe_u32 v240, v102, 2, 2
    v_mul_u32_u24 v240, 1152, v240
    v_lshrrev_b32 v242, 4, v102
    v_lshl_add_u32 v240, v242, 6, v240
    v_lshl_add_u32 v242, v241, 4, v240
    v_xor_b32 v243, 32, v242
    v_add_u32 v223, 0, v242
    v_add_u32 v224, 3584, v243
    v_add_u32 v225, 7168, v242
    v_add_u32 v226, 10752, v243
    v_add_u32 v227, 18432, v242
    v_add_u32 v228, 22016, v243
    v_add_u32 v229, 25600, v242
    v_add_u32 v230, 29184, v243
    s_waitcnt vmcnt(0)
    v_mov_b32 v100, 3
    s_mov_b64 exec, 1
    buffer_store_dword v100, off, s[36:39], s52 sc1
    s_mov_b64 exec, -1
    s_add_u32 m0, s49, 0
    s_add_u32 s96, s77, 2359296
    buffer_load_dwordx4 v221, s[20:23], s96 offen lds
    s_add_u32 m0, s49, 4096
    s_add_u32 s96, s77, 2654208
    buffer_load_dwordx4 v221, s[20:23], s96 offen lds
    s_add_u32 m0, s49, 8192
    s_add_u32 s96, s77, 2949120
    buffer_load_dwordx4 v221, s[20:23], s96 offen lds
    s_add_u32 m0, s49, 12288
    s_add_u32 s96, s77, 3244032
    buffer_load_dwordx4 v221, s[20:23], s96 offen lds
    s_add_u32 m0, s49, 16384
    s_add_u32 s96, s77, 3538944
    buffer_load_dwordx4 v221, s[20:23], s96 offen lds
    s_add_u32 m0, s49, 20480
    s_add_u32 s96, s77, 3833856
    buffer_load_dwordx4 v221, s[20:23], s96 offen lds
    s_add_u32 m0, s49, 49152
    s_add_u32 s96, s77, 4718592
    buffer_load_dwordx4 v222, s[24:27], s96 offen lds
    s_add_u32 m0, s49, 53248
    s_add_u32 s96, s77, 5013504
    buffer_load_dwordx4 v222, s[24:27], s96 offen lds
    s_add_u32 m0, s49, 57344
    s_add_u32 s96, s77, 4128768
    buffer_load_dwordx4 v221, s[24:27], s96 offen lds
    s_add_u32 m0, s49, 61440
    s_add_u32 s96, s77, 4423680
    buffer_load_dwordx4 v221, s[24:27], s96 offen lds
    s_add_u32 m0, s49, 65536
    s_add_u32 s96, s77, 0
    buffer_load_dwordx4 v221, s[24:27], s96 offen lds
    s_add_u32 m0, s49, 69632
    s_add_u32 s96, s77, 294912
    buffer_load_dwordx4 v221, s[24:27], s96 offen lds
    s_add_u32 m0, s49, 24576
    s_add_u32 s96, s77, 589824
    buffer_load_dwordx4 v221, s[24:27], s96 offen lds
    s_add_u32 m0, s49, 28672
    s_add_u32 s96, s77, 884736
    buffer_load_dwordx4 v221, s[24:27], s96 offen lds
    s_add_u32 m0, s49, 32768
    s_add_u32 s96, s77, 1179648
    buffer_load_dwordx4 v221, s[24:27], s96 offen lds
    s_add_u32 m0, s49, 36864
    s_add_u32 s96, s77, 1474560
    buffer_load_dwordx4 v221, s[24:27], s96 offen lds
    s_add_u32 m0, s49, 40960
    s_add_u32 s96, s77, 1769472
    buffer_load_dwordx4 v221, s[24:27], s96 offen lds
    s_add_u32 m0, s49, 45056
    s_add_u32 s96, s77, 2064384
    buffer_load_dwordx4 v221, s[24:27], s96 offen lds
    s_mov_b64 exec, 0
    s_branch sequential_preLN__linear_kernel_hedgehog__glu_gated_reglu__prompt_kernel_hop1_0
sequential_preLN__linear_kernel_hedgehog__glu_gated_reglu__prompt_kernel_hopback1:
    s_mov_b64 exec, -1
    buffer_load_dword v239, v238, s[36:39], 0 offen sc1
    s_waitcnt vmcnt(0)
    v_cmp_gt_u32 vcc, 3, v239
    s_mov_b32 s53, 0
    s_cbranch_vccz sequential_preLN__linear_kernel_hedgehog__glu_gated_reglu__prompt_kernel_spin_21_b
sequential_preLN__linear_kernel_hedgehog__glu_gated_reglu__prompt_kernel_spin_21:
    buffer_load_dword v239, v238, s[36:39], 0 offen sc1
    s_add_u32 s53, s53, 1
    s_waitcnt vmcnt(0)
    v_cmp_gt_u32 vcc, 3, v239
    s_cmp_gt_u32 s53, 50000
    s_cbranch_scc1 sequential_preLN__linear_kernel_hedgehog__glu_gated_reglu__prompt_kernel_spin_21_b
    s_cbranch_vccnz sequential_preLN__linear_kernel_hedgehog__glu_gated_reglu__prompt_kernel_spin_21
sequential_preLN__linear_kernel_hedgehog__glu_gated_reglu__prompt_kernel_spin_21_b:
    s_add_u32 s97, s76, 16384
    buffer_load_dwordx4 v[0:3], v232, s[36:39], s97 offen sc1
    buffer_load_dwordx4 v[16:19], v232, s[36:39], s97 offen offset:1024 sc1
    s_add_u32 s97, s76, 34816
    buffer_load_dwordx4 v[4:7], v232, s[36:39], s97 offen sc1
    buffer_load_dwordx4 v[20:23], v232, s[36:39], s97 offen offset:1024 sc1
    s_add_u32 s97, s76, 53248
    buffer_load_dwordx4 v[8:11], v232, s[36:39], s97 offen sc1
    buffer_load_dwordx4 v[24:27], v232, s[36:39], s97 offen offset:1024 sc1
    s_add_u32 s97, s76, 71680
    buffer_load_dwordx4 v[12:15], v232, s[36:39], s97 offen sc1
    buffer_load_dwordx4 v[28:31], v232, s[36:39], s97 offen offset:1024 sc1
    s_add_u32 s97, s76, 14336
    buffer_load_dwordx4 a[224:227], v232, s[36:39], s97 offen sc1
    buffer_load_dwordx4 a[240:243], v232, s[36:39], s97 offen offset:1024 sc1
    s_add_u32 s97, s76, 32768
    buffer_load_dwordx4 a[228:231], v232, s[36:39], s97 offen sc1
    buffer_load_dwordx4 a[244:247], v232, s[36:39], s97 offen offset:1024 sc1
    s_add_u32 s97, s76, 51200
    buffer_load_dwordx4 a[232:235], v232, s[36:39], s97 offen sc1
    buffer_load_dwordx4 a[248:251], v232, s[36:39], s97 offen offset:1024 sc1
    s_add_u32 s97, s76, 69632
    buffer_load_dwordx4 a[236:239], v232, s[36:39], s97 offen sc1
    buffer_load_dwordx4 a[252:255], v232, s[36:39], s97 offen offset:1024 sc1
    v_lshrrev_b32 v238, 4, v232
    v_and_b32 v238, 7, v238
    v_lshlrev_b32 v238, 10, v238
    s_lshl_b32 s97, s56, 13
    s_lshl_b32 s92, s50, 7
    s_add_u32 s97, s97, s92
    s_lshr_b32 s92, s57, 2
    s_lshl_b32 s92, s92, 3
    s_add_u32 s97, s97, s92
    s_lshr_b32 s92, s48, 1
    s_lshl_b32 s92, s92, 2
    s_add_u32 s97, s97, s92
    v_add_u32 v238, s97, v238
    v_and_b32 v239, 12, v238
    v_and_b32 v238, 0xffffff80, v238
    v_lshlrev_b32 v238, 2, v238
    v_lshl_add_u32 v238, v239, 5, v238
    s_barrier
    s_mul_i32 s93, s48, 9216
    v_add_u32 v216, 98304, v216
    v_add_u32 v217, 98304, v217
    v_add_u32 v218, 98304, v218
    v_add_u32 v219, 98304, v219
    ds_read_b64_tr_b16 v[192:193], v216 offset:0
    ds_read_b64_tr_b16 v[194:195], v216 offset:2048
    ds_read_b64_tr_b16 v[196:197], v216 offset:4096
    ds_read_b64_tr_b16 v[198:199], v216 offset:6144
    ds_read_b64_tr_b16 v[200:201], v217 offset:0
    ds_read_b64_tr_b16 v[202:203], v217 offset:2048
    ds_read_b64_tr_b16 v[204:205], v217 offset:4096
    ds_read_b64_tr_b16 v[206:207], v217 offset:6144
    s_waitcnt lgkmcnt(4)
    s_waitcnt vmcnt(15)
    v_mfma_f32_16x16x32_bf16 v[32:35], v[192:195], v[0:3], 0
    ds_read_b64_tr_b16 v[208:209], v218 offset:0
    ds_read_b64_tr_b16 v[210:211], v218 offset:2048
    s_waitcnt vmcnt(14)
    v_mfma_f32_16x16x32_bf16 v[32:35], v[196:199], v[16:19], v[32:35]
    ds_read_b64_tr_b16 v[212:213], v218 offset:4096
    ds_read_b64_tr_b16 v[214:215], v218 offset:6144
    s_waitcnt vmcnt(12)
    v_mfma_f32_16x16x32_bf16 v[36:39], v[196:199], v[20:23], 0
    s_add_u32 s97, s76, 0
    buffer_load_dwordx4 a[0:3], v232, s[36:39], s97 offen sc1
    v_mfma_f32_16x16x32_bf16 v[36:39], v[192:195], v[4:7], v[36:39]
    s_waitcnt vmcnt(12)
    v_mfma_f32_16x16x32_bf16 v[40:43], v[192:195], v[8:11], 0
    s_waitcnt vmcnt(11)
    v_mfma_f32_16x16x32_bf16 v[40:43], v[196:199], v[24:27], v[40:43]
    buffer_load_dwordx4 a[16:19], v232, s[36:39], s97 offen offset:1024 sc1
    s_waitcnt vmcnt(10)
    v_mfma_f32_16x16x32_bf16 v[44:47], v[196:199], v[28:31], 0
    v_mfma_f32_16x16x32_bf16 v[44:47], v[192:195], v[12:15], v[44:47]
    ds_read_b64_tr_b16 v[192:193], v219 offset:0
    s_waitcnt lgkmcnt(5)
    v_mfma_f32_16x16x32_bf16 v[48:51], v[200:203], v[0:3], 0
    ds_read_b64_tr_b16 v[194:195], v219 offset:2048
    v_mfma_f32_16x16x32_bf16 v[48:51], v[204:207], v[16:19], v[48:51]
    ds_read_b64_tr_b16 v[196:197], v219 offset:4096
    s_add_u32 s97, s76, 18432
    v_mfma_f32_16x16x32_bf16 v[52:55], v[204:207], v[20:23], 0
    ds_read_b64_tr_b16 v[198:199], v219 offset:6144
    buffer_load_dwordx4 a[4:7], v232, s[36:39], s97 offen sc1
    v_mfma_f32_16x16x32_bf16 v[52:55], v[200:203], v[4:7], v[52:55]
    v_mfma_f32_16x16x32_bf16 v[56:59], v[200:203], v[8:11], 0
    v_mfma_f32_16x16x32_bf16 v[56:59], v[204:207], v[24:27], v[56:59]
    v_mfma_f32_16x16x32_bf16 v[60:63], v[204:207], v[28:31], 0
    v_mfma_f32_16x16x32_bf16 v[60:63], v[200:203], v[12:15], v[60:63]
    ds_read_b128 v[200:203], v220 offset:32768
    s_waitcnt lgkmcnt(5)
    v_mfma_f32_16x16x32_bf16 v[64:67], v[208:211], v[0:3], 0
    ds_read_b128 v[204:207], v220 offset:34816
    buffer_load_dwordx4 a[20:23], v232, s[36:39], s97 offen offset:1024 sc1
    v_mfma_f32_16x16x32_bf16 v[64:67], v[212:215], v[16:19], v[64:67]
    v_mfma_f32_16x16x32_bf16 v[68:71], v[212:215], v[20:23], 0
    v_mfma_f32_16x16x32_bf16 v[68:71], v[208:211], v[4:7], v[68:71]
    s_add_u32 s97, s76, 36864
    v_mfma_f32_16x16x32_bf16 v[72:75], v[208:211], v[8:11], 0
    buffer_load_dwordx4 a[8:11], v232, s[36:39], s97 offen sc1
    v_mfma_f32_16x16x32_bf16 v[72:75], v[212:215], v[24:27], v[72:75]
    v_mfma_f32_16x16x32_bf16 v[76:79], v[212:215], v[28:31], 0
    v_mfma_f32_16x16x32_bf16 v[76:79], v[208:211], v[12:15], v[76:79]
    ds_read_b128 v[208:211], v220 offset:33792
    s_waitcnt lgkmcnt(3)
    v_mfma_f32_16x16x32_bf16 v[80:83], v[192:195], v[0:3], 0
    ds_read_b128 v[212:215], v220 offset:35840
    v_mfma_f32_16x16x32_bf16 v[80:83], v[196:199], v[16:19], v[80:83]
    buffer_load_dwordx4 a[24:27], v232, s[36:39], s97 offen offset:1024 sc1
    v_mfma_f32_16x16x32_bf16 v[84:87], v[196:199], v[20:23], 0
    v_mfma_f32_16x16x32_bf16 v[84:87], v[192:195], v[4:7], v[84:87]
    v_mfma_f32_16x16x32_bf16 v[88:91], v[192:195], v[8:11], 0
    v_mfma_f32_16x16x32_bf16 v[88:91], v[196:199], v[24:27], v[88:91]
    s_add_u32 s97, s76, 55296
    v_mfma_f32_16x16x32_bf16 v[92:95], v[196:199], v[28:31], 0
    buffer_load_dwordx4 a[12:15], v232, s[36:39], s97 offen sc1
    v_mfma_f32_16x16x32_bf16 v[92:95], v[192:195], v[12:15], v[92:95]
    ds_read_b64_tr_b16 v[192:193], v216 offset:8192
    s_waitcnt lgkmcnt(3)
    v_mfma_f32_16x16x32_bf16 v[160:163], v[200:203], v[0:3], 0
    ds_read_b64_tr_b16 v[194:195], v216 offset:10240
    v_mfma_f32_16x16x32_bf16 v[160:163], v[204:207], v[16:19], v[160:163]
    ds_read_b64_tr_b16 v[196:197], v216 offset:12288
    v_mfma_f32_16x16x32_bf16 v[164:167], v[204:207], v[20:23], 0
    ds_read_b64_tr_b16 v[198:199], v216 offset:14336
    v_mfma_f32_16x16x32_bf16 v[164:167], v[200:203], v[4:7], v[164:167]
    buffer_load_dwordx4 a[28:31], v232, s[36:39], s97 offen offset:1024 sc1
    v_mfma_f32_16x16x32_bf16 v[168:171], v[200:203], v[8:11], 0
    v_mfma_f32_16x16x32_bf16 v[168:171], v[204:207], v[24:27], v[168:171]
    v_mfma_f32_16x16x32_bf16 v[172:175], v[204:207], v[28:31], 0
    v_mfma_f32_16x16x32_bf16 v[172:175], v[200:203], v[12:15], v[172:175]
    ds_read_b64_tr_b16 v[200:201], v217 offset:8192
    s_waitcnt lgkmcnt(5)
    v_mfma_f32_16x16x32_bf16 v[176:179], v[208:211], v[0:3], 0
    ds_read_b64_tr_b16 v[202:203], v217 offset:10240
    s_add_u32 s97, s76, 2048
    v_mfma_f32_16x16x32_bf16 v[176:179], v[212:215], v[16:19], v[176:179]
    ds_read_b64_tr_b16 v[204:205], v217 offset:12288
    buffer_load_dwordx4 a[32:35], v232, s[36:39], s97 offen sc1
    v_mfma_f32_16x16x32_bf16 v[180:183], v[212:215], v[20:23], 0
    ds_read_b64_tr_b16 v[206:207], v217 offset:14336
    v_mfma_f32_16x16x32_bf16 v[180:183], v[208:211], v[4:7], v[180:183]
    v_mfma_f32_16x16x32_bf16 v[184:187], v[208:211], v[8:11], 0
    v_mfma_f32_16x16x32_bf16 v[184:187], v[212:215], v[24:27], v[184:187]
    buffer_load_dwordx4 a[48:51], v232, s[36:39], s97 offen offset:1024 sc1
    v_mfma_f32_16x16x32_bf16 v[188:191], v[212:215], v[28:31], 0
    v_mfma_f32_16x16x32_bf16 v[188:191], v[208:211], v[12:15], v[188:191]
    ds_read_b64_tr_b16 v[208:209], v218 offset:8192
    s_waitcnt vmcnt(10) lgkmcnt(5)
    v_mfma_f32_16x16x32_bf16 v[32:35], v[192:195], a[224:227], v[32:35]
    ds_read_b64_tr_b16 v[210:211], v218 offset:10240
    v_mfma_f32_16x16x32_bf16 v[32:35], v[196:199], a[240:243], v[32:35]
    ds_read_b64_tr_b16 v[212:213], v218 offset:12288
    s_add_u32 s97, s76, 20480
    v_mfma_f32_16x16x32_bf16 v[36:39], v[196:199], a[244:247], v[36:39]
    ds_read_b64_tr_b16 v[214:215], v218 offset:14336
    buffer_load_dwordx4 a[36:39], v232, s[36:39], s97 offen sc1
    v_mfma_f32_16x16x32_bf16 v[36:39], v[192:195], a[228:231], v[36:39]
    v_mfma_f32_16x16x32_bf16 v[40:43], v[192:195], a[232:235], v[40:43]
    v_mfma_f32_16x16x32_bf16 v[40:43], v[196:199], a[248:251], v[40:43]
    v_mfma_f32_16x16x32_bf16 v[44:47], v[196:199], a[252:255], v[44:47]
    v_mfma_f32_16x16x32_bf16 v[44:47], v[192:195], a[236:239], v[44:47]
    ds_read_b64_tr_b16 v[192:193], v219 offset:8192
    s_waitcnt lgkmcnt(5)
    v_mfma_f32_16x16x32_bf16 v[48:51], v[200:203], a[224:227], v[48:51]
    ds_read_b64_tr_b16 v[194:195], v219 offset:10240
    buffer_load_dwordx4 a[52:55], v232, s[36:39], s97 offen offset:1024 sc1
    v_mfma_f32_16x16x32_bf16 v[48:51], v[204:207], a[240:243], v[48:51]
sequential_preLN__linear_kernel_hedgehog__glu_gated_reglu__prompt_kernel_hop1_0:
    s_cbranch_execz sequential_preLN__linear_kernel_hedgehog__glu_gated_reglu__prompt_kernel_hop1_1
    ds_read_b64_tr_b16 v[196:197], v219 offset:12288
    v_mfma_f32_16x16x32_bf16 v[52:55], v[204:207], a[244:247], v[52:55]
    ds_read_b64_tr_b16 v[198:199], v219 offset:14336
    v_mfma_f32_16x16x32_bf16 v[52:55], v[200:203], a[228:231], v[52:55]
    s_add_u32 s97, s76, 38912
    v_mfma_f32_16x16x32_bf16 v[56:59], v[200:203], a[232:235], v[56:59]
    buffer_load_dwordx4 a[40:43], v232, s[36:39], s97 offen sc1
    v_mfma_f32_16x16x32_bf16 v[56:59], v[204:207], a[248:251], v[56:59]
    v_mfma_f32_16x16x32_bf16 v[60:63], v[204:207], a[252:255], v[60:63]
    v_mfma_f32_16x16x32_bf16 v[60:63], v[200:203], a[236:239], v[60:63]
    ds_read_b128 v[200:203], v220 offset:28672
    s_waitcnt lgkmcnt(5)
    v_mfma_f32_16x16x32_bf16 v[64:67], v[208:211], a[224:227], v[64:67]
    ds_read_b128 v[204:207], v220 offset:30720
    v_mfma_f32_16x16x32_bf16 v[64:67], v[212:215], a[240:243], v[64:67]
    buffer_load_dwordx4 a[56:59], v232, s[36:39], s97 offen offset:1024 sc1
    v_mfma_f32_16x16x32_bf16 v[68:71], v[212:215], a[244:247], v[68:71]
    v_mfma_f32_16x16x32_bf16 v[68:71], v[208:211], a[228:231], v[68:71]
    v_mfma_f32_16x16x32_bf16 v[72:75], v[208:211], a[232:235], v[72:75]
    v_mfma_f32_16x16x32_bf16 v[72:75], v[212:215], a[248:251], v[72:75]
    s_add_u32 s97, s76, 57344
    v_mfma_f32_16x16x32_bf16 v[76:79], v[212:215], a[252:255], v[76:79]
    buffer_load_dwordx4 a[44:47], v232, s[36:39], s97 offen sc1
    v_mfma_f32_16x16x32_bf16 v[76:79], v[208:211], a[236:239], v[76:79]
    ds_read_b128 v[208:211], v220 offset:29696
    s_waitcnt lgkmcnt(3)
    v_mfma_f32_16x16x32_bf16 v[80:83], v[192:195], a[224:227], v[80:83]
    ds_read_b128 v[212:215], v220 offset:31744
    v_mfma_f32_16x16x32_bf16 v[80:83], v[196:199], a[240:243], v[80:83]
    v_mfma_f32_16x16x32_bf16 v[84:87], v[196:199], a[244:247], v[84:87]
    v_mfma_f32_16x16x32_bf16 v[84:87], v[192:195], a[228:231], v[84:87]
    buffer_load_dwordx4 a[60:63], v232, s[36:39], s97 offen offset:1024 sc1
    v_mfma_f32_16x16x32_bf16 v[88:91], v[192:195], a[232:235], v[88:91]
    v_mfma_f32_16x16x32_bf16 v[88:91], v[196:199], a[248:251], v[88:91]
    v_mfma_f32_16x16x32_bf16 v[92:95], v[196:199], a[252:255], v[92:95]
    v_mfma_f32_16x16x32_bf16 v[92:95], v[192:195], a[236:239], v[92:95]
    ds_read_b64_tr_b16 v[192:193], v216 offset:16384
    s_waitcnt lgkmcnt(3)
    v_mfma_f32_16x16x32_bf16 v[160:163], v[200:203], a[224:227], v[160:163]
    ds_read_b64_tr_b16 v[194:195], v216 offset:18432
    s_add_u32 s97, s76, 4096
    v_mfma_f32_16x16x32_bf16 v[160:163], v[204:207], a[240:243], v[160:163]
    ds_read_b64_tr_b16 v[196:197], v216 offset:20480
    buffer_load_dwordx4 a[64:67], v232, s[36:39], s97 offen sc1
    v_mfma_f32_16x16x32_bf16 v[164:167], v[204:207], a[244:247], v[164:167]
    ds_read_b64_tr_b16 v[198:199], v216 offset:22528
    v_mfma_f32_16x16x32_bf16 v[164:167], v[200:203], a[228:231], v[164:167]
    v_mfma_f32_16x16x32_bf16 v[168:171], v[200:203], a[232:235], v[168:171]
    v_mfma_f32_16x16x32_bf16 v[168:171], v[204:207], a[248:251], v[168:171]
    buffer_load_dwordx4 a[80:83], v232, s[36:39], s97 offen offset:1024 sc1
    v_mfma_f32_16x16x32_bf16 v[172:175], v[204:207], a[252:255], v[172:175]
    v_mfma_f32_16x16x32_bf16 v[172:175], v[200:203], a[236:239], v[172:175]
    ds_read_b64_tr_b16 v[200:201], v217 offset:16384
    s_waitcnt lgkmcnt(5)
    v_mfma_f32_16x16x32_bf16 v[176:179], v[208:211], a[224:227], v[176:179]
    ds_read_b64_tr_b16 v[202:203], v217 offset:18432
    v_mfma_f32_16x16x32_bf16 v[176:179], v[212:215], a[240:243], v[176:179]
    ds_read_b64_tr_b16 v[204:205], v217 offset:20480
    s_add_u32 s97, s76, 22528
    v_mfma_f32_16x16x32_bf16 v[180:183], v[212:215], a[244:247], v[180:183]
    ds_read_b64_tr_b16 v[206:207], v217 offset:22528
    buffer_load_dwordx4 a[68:71], v232, s[36:39], s97 offen sc1
    v_mfma_f32_16x16x32_bf16 v[180:183], v[208:211], a[228:231], v[180:183]
    v_mfma_f32_16x16x32_bf16 v[184:187], v[208:211], a[232:235], v[184:187]
    v_mfma_f32_16x16x32_bf16 v[184:187], v[212:215], a[248:251], v[184:187]
    v_mfma_f32_16x16x32_bf16 v[188:191], v[212:215], a[252:255], v[188:191]
    v_mfma_f32_16x16x32_bf16 v[188:191], v[208:211], a[236:239], v[188:191]
    ds_read_b64_tr_b16 v[208:209], v218 offset:16384
    s_waitcnt vmcnt(11) lgkmcnt(5)
    v_mfma_f32_16x16x32_bf16 v[32:35], v[192:195], a[0:3], v[32:35]
    ds_read_b64_tr_b16 v[210:211], v218 offset:18432
    buffer_load_dwordx4 a[84:87], v232, s[36:39], s97 offen offset:1024 sc1
    v_mfma_f32_16x16x32_bf16 v[32:35], v[196:199], a[16:19], v[32:35]
    ds_read_b64_tr_b16 v[212:213], v218 offset:20480
    v_mfma_f32_16x16x32_bf16 v[36:39], v[196:199], a[20:23], v[36:39]
    ds_read_b64_tr_b16 v[214:215], v218 offset:22528
    v_mfma_f32_16x16x32_bf16 v[36:39], v[192:195], a[4:7], v[36:39]
    s_add_u32 s97, s76, 40960
    v_mfma_f32_16x16x32_bf16 v[40:43], v[192:195], a[8:11], v[40:43]
    buffer_load_dwordx4 a[72:75], v232, s[36:39], s97 offen sc1
    v_mfma_f32_16x16x32_bf16 v[40:43], v[196:199], a[24:27], v[40:43]
    v_mfma_f32_16x16x32_bf16 v[44:47], v[196:199], a[28:31], v[44:47]
    v_mfma_f32_16x16x32_bf16 v[44:47], v[192:195], a[12:15], v[44:47]
    ds_read_b64_tr_b16 v[192:193], v219 offset:16384
    s_waitcnt lgkmcnt(5)
    v_mfma_f32_16x16x32_bf16 v[48:51], v[200:203], a[0:3], v[48:51]
    ds_read_b64_tr_b16 v[194:195], v219 offset:18432
    v_mfma_f32_16x16x32_bf16 v[48:51], v[204:207], a[16:19], v[48:51]
    ds_read_b64_tr_b16 v[196:197], v219 offset:20480
    buffer_load_dwordx4 a[88:91], v232, s[36:39], s97 offen offset:1024 sc1
    v_mfma_f32_16x16x32_bf16 v[52:55], v[204:207], a[20:23], v[52:55]
    ds_read_b64_tr_b16 v[198:199], v219 offset:22528
    v_mfma_f32_16x16x32_bf16 v[52:55], v[200:203], a[4:7], v[52:55]
    v_mfma_f32_16x16x32_bf16 v[56:59], v[200:203], a[8:11], v[56:59]
    v_mfma_f32_16x16x32_bf16 v[56:59], v[204:207], a[24:27], v[56:59]
    s_add_u32 s97, s76, 59392
    v_mfma_f32_16x16x32_bf16 v[60:63], v[204:207], a[28:31], v[60:63]
    buffer_load_dwordx4 a[76:79], v232, s[36:39], s97 offen sc1
    v_mfma_f32_16x16x32_bf16 v[60:63], v[200:203], a[12:15], v[60:63]
    ds_read_b128 v[200:203], v220 offset:0
    s_waitcnt lgkmcnt(5)
    v_mfma_f32_16x16x32_bf16 v[64:67], v[208:211], a[0:3], v[64:67]
    ds_read_b128 v[204:207], v220 offset:2048
    v_mfma_f32_16x16x32_bf16 v[64:67], v[212:215], a[16:19], v[64:67]
    v_mfma_f32_16x16x32_bf16 v[68:71], v[212:215], a[20:23], v[68:71]
    v_mfma_f32_16x16x32_bf16 v[68:71], v[208:211], a[4:7], v[68:71]
    buffer_load_dwordx4 a[92:95], v232, s[36:39], s97 offen offset:1024 sc1
    v_mfma_f32_16x16x32_bf16 v[72:75], v[208:211], a[8:11], v[72:75]
    v_mfma_f32_16x16x32_bf16 v[72:75], v[212:215], a[24:27], v[72:75]
    v_mfma_f32_16x16x32_bf16 v[76:79], v[212:215], a[28:31], v[76:79]
    v_mfma_f32_16x16x32_bf16 v[76:79], v[208:211], a[12:15], v[76:79]
    ds_read_b128 v[208:211], v220 offset:1024
    s_waitcnt lgkmcnt(3)
    v_mfma_f32_16x16x32_bf16 v[80:83], v[192:195], a[0:3], v[80:83]
    ds_read_b128 v[212:215], v220 offset:3072
    s_add_u32 s97, s76, 6144
    v_mfma_f32_16x16x32_bf16 v[80:83], v[196:199], a[16:19], v[80:83]
    buffer_load_dwordx4 a[96:99], v232, s[36:39], s97 offen sc1
    v_mfma_f32_16x16x32_bf16 v[84:87], v[196:199], a[20:23], v[84:87]
    v_mfma_f32_16x16x32_bf16 v[84:87], v[192:195], a[4:7], v[84:87]
    v_mfma_f32_16x16x32_bf16 v[88:91], v[192:195], a[8:11], v[88:91]
    v_mfma_f32_16x16x32_bf16 v[88:91], v[196:199], a[24:27], v[88:91]
    buffer_load_dwordx4 a[112:115], v232, s[36:39], s97 offen offset:1024 sc1
    v_mfma_f32_16x16x32_bf16 v[92:95], v[196:199], a[28:31], v[92:95]
    v_mfma_f32_16x16x32_bf16 v[92:95], v[192:195], a[12:15], v[92:95]
    v_subrev_u32 v216, 24576, v216
    s_waitcnt lgkmcnt(2)
    v_mfma_f32_16x16x32_bf16 v[160:163], v[200:203], a[0:3], v[160:163]
    v_subrev_u32 v217, 24576, v217
    v_subrev_u32 v218, 24576, v218
    v_mfma_f32_16x16x32_bf16 v[160:163], v[204:207], a[16:19], v[160:163]
    v_subrev_u32 v219, 24576, v219
    ds_read_b64_tr_b16 v[192:193], v216 offset:0
    v_mfma_f32_16x16x32_bf16 v[164:167], v[204:207], a[20:23], v[164:167]
    ds_read_b64_tr_b16 v[194:195], v216 offset:2048
    ds_read_b64_tr_b16 v[196:197], v216 offset:4096
    v_mfma_f32_16x16x32_bf16 v[164:167], v[200:203], a[4:7], v[164:167]
    ds_read_b64_tr_b16 v[198:199], v216 offset:6144
    s_add_u32 s97, s76, 24576
    v_mfma_f32_16x16x32_bf16 v[168:171], v[200:203], a[8:11], v[168:171]
    buffer_load_dwordx4 a[100:103], v232, s[36:39], s97 offen sc1
    v_mfma_f32_16x16x32_bf16 v[168:171], v[204:207], a[24:27], v[168:171]
    v_mfma_f32_16x16x32_bf16 v[172:175], v[204:207], a[28:31], v[172:175]
    v_mfma_f32_16x16x32_bf16 v[172:175], v[200:203], a[12:15], v[172:175]
    ds_read_b64_tr_b16 v[200:201], v217 offset:0
    s_waitcnt lgkmcnt(5)
    v_mfma_f32_16x16x32_bf16 v[176:179], v[208:211], a[0:3], v[176:179]
    ds_read_b64_tr_b16 v[202:203], v217 offset:2048
    buffer_load_dwordx4 a[116:119], v232, s[36:39], s97 offen offset:1024 sc1
    v_mfma_f32_16x16x32_bf16 v[176:179], v[212:215], a[16:19], v[176:179]
    ds_read_b64_tr_b16 v[204:205], v217 offset:4096
    v_mfma_f32_16x16x32_bf16 v[180:183], v[212:215], a[20:23], v[180:183]
    ds_read_b64_tr_b16 v[206:207], v217 offset:6144
    v_mfma_f32_16x16x32_bf16 v[180:183], v[208:211], a[4:7], v[180:183]
    s_add_u32 s97, s76, 43008
    v_mfma_f32_16x16x32_bf16 v[184:187], v[208:211], a[8:11], v[184:187]
    buffer_load_dwordx4 a[104:107], v232, s[36:39], s97 offen sc1
    v_mfma_f32_16x16x32_bf16 v[184:187], v[212:215], a[24:27], v[184:187]
    v_mfma_f32_16x16x32_bf16 v[188:191], v[212:215], a[28:31], v[188:191]
    v_mfma_f32_16x16x32_bf16 v[188:191], v[208:211], a[12:15], v[188:191]
    ds_read_b64_tr_b16 v[208:209], v218 offset:0
    s_waitcnt vmcnt(13) lgkmcnt(5)
    v_mfma_f32_16x16x32_bf16 v[32:35], v[192:195], a[32:35], v[32:35]
    ds_read_b64_tr_b16 v[210:211], v218 offset:2048
    v_mfma_f32_16x16x32_bf16 v[32:35], v[196:199], a[48:51], v[32:35]
    ds_read_b64_tr_b16 v[212:213], v218 offset:4096
    buffer_load_dwordx4 a[120:123], v232, s[36:39], s97 offen offset:1024 sc1
    v_mfma_f32_16x16x32_bf16 v[36:39], v[196:199], a[52:55], v[36:39]
    ds_read_b64_tr_b16 v[214:215], v218 offset:6144
    v_mfma_f32_16x16x32_bf16 v[36:39], v[192:195], a[36:39], v[36:39]
    v_mfma_f32_16x16x32_bf16 v[40:43], v[192:195], a[40:43], v[40:43]
    v_mfma_f32_16x16x32_bf16 v[40:43], v[196:199], a[56:59], v[40:43]
    s_add_u32 s97, s76, 61440
    v_mfma_f32_16x16x32_bf16 v[44:47], v[196:199], a[60:63], v[44:47]
    buffer_load_dwordx4 a[108:111], v232, s[36:39], s97 offen sc1
    v_mfma_f32_16x16x32_bf16 v[44:47], v[192:195], a[44:47], v[44:47]
    ds_read_b64_tr_b16 v[192:193], v219 offset:0
    s_waitcnt lgkmcnt(5)
    v_mfma_f32_16x16x32_bf16 v[48:51], v[200:203], a[32:35], v[48:51]
    ds_read_b64_tr_b16 v[194:195], v219 offset:2048
    v_mfma_f32_16x16x32_bf16 v[48:51], v[204:207], a[48:51], v[48:51]
    ds_read_b64_tr_b16 v[196:197], v219 offset:4096
    v_mfma_f32_16x16x32_bf16 v[52:55], v[204:207], a[52:55], v[52:55]
    ds_read_b64_tr_b16 v[198:199], v219 offset:6144
    v_mfma_f32_16x16x32_bf16 v[52:55], v[200:203], a[36:39], v[52:55]
    buffer_load_dwordx4 a[124:127], v232, s[36:39], s97 offen offset:1024 sc1
    v_mfma_f32_16x16x32_bf16 v[56:59], v[200:203], a[40:43], v[56:59]
    v_mfma_f32_16x16x32_bf16 v[56:59], v[204:207], a[56:59], v[56:59]
    v_mfma_f32_16x16x32_bf16 v[60:63], v[204:207], a[60:63], v[60:63]
    v_mfma_f32_16x16x32_bf16 v[60:63], v[200:203], a[44:47], v[60:63]
    ds_read_b128 v[200:203], v220 offset:4096
    s_waitcnt lgkmcnt(5)
    v_mfma_f32_16x16x32_bf16 v[64:67], v[208:211], a[32:35], v[64:67]
    ds_read_b128 v[204:207], v220 offset:6144
    s_add_u32 s97, s76, 8192
    v_mfma_f32_16x16x32_bf16 v[64:67], v[212:215], a[48:51], v[64:67]
    buffer_load_dwordx4 a[128:131], v232, s[36:39], s97 offen sc1
    v_mfma_f32_16x16x32_bf16 v[68:71], v[212:215], a[52:55], v[68:71]
    v_mfma_f32_16x16x32_bf16 v[68:71], v[208:211], a[36:39], v[68:71]
    v_mfma_f32_16x16x32_bf16 v[72:75], v[208:211], a[40:43], v[72:75]
    v_mfma_f32_16x16x32_bf16 v[72:75], v[212:215], a[56:59], v[72:75]
    buffer_load_dwordx4 a[144:147], v232, s[36:39], s97 offen offset:1024 sc1
    v_mfma_f32_16x16x32_bf16 v[76:79], v[212:215], a[60:63], v[76:79]
    v_mfma_f32_16x16x32_bf16 v[76:79], v[208:211], a[44:47], v[76:79]
    ds_read_b128 v[208:211], v220 offset:5120
    s_waitcnt lgkmcnt(3)
    v_mfma_f32_16x16x32_bf16 v[80:83], v[192:195], a[32:35], v[80:83]
    ds_read_b128 v[212:215], v220 offset:7168
    v_mfma_f32_16x16x32_bf16 v[80:83], v[196:199], a[48:51], v[80:83]
    s_add_u32 s97, s76, 26624
    v_mfma_f32_16x16x32_bf16 v[84:87], v[196:199], a[52:55], v[84:87]
    buffer_load_dwordx4 a[132:135], v232, s[36:39], s97 offen sc1
    v_mfma_f32_16x16x32_bf16 v[84:87], v[192:195], a[36:39], v[84:87]
    v_mfma_f32_16x16x32_bf16 v[88:91], v[192:195], a[40:43], v[88:91]
    v_mfma_f32_16x16x32_bf16 v[88:91], v[196:199], a[56:59], v[88:91]
    v_mfma_f32_16x16x32_bf16 v[92:95], v[196:199], a[60:63], v[92:95]
    v_mfma_f32_16x16x32_bf16 v[92:95], v[192:195], a[44:47], v[92:95]
    ds_read_b64_tr_b16 v[192:193], v216 offset:8192
    s_waitcnt lgkmcnt(3)
    v_mfma_f32_16x16x32_bf16 v[160:163], v[200:203], a[32:35], v[160:163]
    ds_read_b64_tr_b16 v[194:195], v216 offset:10240
    buffer_load_dwordx4 a[148:151], v232, s[36:39], s97 offen offset:1024 sc1
    v_mfma_f32_16x16x32_bf16 v[160:163], v[204:207], a[48:51], v[160:163]
    ds_read_b64_tr_b16 v[196:197], v216 offset:12288
    v_mfma_f32_16x16x32_bf16 v[164:167], v[204:207], a[52:55], v[164:167]
    ds_read_b64_tr_b16 v[198:199], v216 offset:14336
    v_mfma_f32_16x16x32_bf16 v[164:167], v[200:203], a[36:39], v[164:167]
    s_add_u32 s97, s76, 45056
    v_mfma_f32_16x16x32_bf16 v[168:171], v[200:203], a[40:43], v[168:171]
    buffer_load_dwordx4 a[136:139], v232, s[36:39], s97 offen sc1
    v_mfma_f32_16x16x32_bf16 v[168:171], v[204:207], a[56:59], v[168:171]
    v_mfma_f32_16x16x32_bf16 v[172:175], v[204:207], a[60:63], v[172:175]
    v_mfma_f32_16x16x32_bf16 v[172:175], v[200:203], a[44:47], v[172:175]
    ds_read_b64_tr_b16 v[200:201], v217 offset:8192
    s_waitcnt lgkmcnt(5)
    v_mfma_f32_16x16x32_bf16 v[176:179], v[208:211], a[32:35], v[176:179]
    ds_read_b64_tr_b16 v[202:203], v217 offset:10240
    v_mfma_f32_16x16x32_bf16 v[176:179], v[212:215], a[48:51], v[176:179]
    ds_read_b64_tr_b16 v[204:205], v217 offset:12288
    buffer_load_dwordx4 a[152:155], v232, s[36:39], s97 offen offset:1024 sc1
    v_mfma_f32_16x16x32_bf16 v[180:183], v[212:215], a[52:55], v[180:183]
    ds_read_b64_tr_b16 v[206:207], v217 offset:14336
    v_mfma_f32_16x16x32_bf16 v[180:183], v[208:211], a[36:39], v[180:183]
    v_mfma_f32_16x16x32_bf16 v[184:187], v[208:211], a[40:43], v[184:187]
    v_mfma_f32_16x16x32_bf16 v[184:187], v[212:215], a[56:59], v[184:187]
    s_add_u32 s97, s76, 63488
    v_mfma_f32_16x16x32_bf16 v[188:191], v[212:215], a[60:63], v[188:191]
    buffer_load_dwordx4 a[140:143], v232, s[36:39], s97 offen sc1
    v_mfma_f32_16x16x32_bf16 v[188:191], v[208:211], a[44:47], v[188:191]
    ds_read_b64_tr_b16 v[208:209], v218 offset:8192
    s_waitcnt vmcnt(15) lgkmcnt(5)
    v_mfma_f32_16x16x32_bf16 v[32:35], v[192:195], a[64:67], v[32:35]
    ds_read_b64_tr_b16 v[210:211], v218 offset:10240
    v_mfma_f32_16x16x32_bf16 v[32:35], v[196:199], a[80:83], v[32:35]
    ds_read_b64_tr_b16 v[212:213], v218 offset:12288
    v_mfma_f32_16x16x32_bf16 v[36:39], v[196:199], a[84:87], v[36:39]
    ds_read_b64_tr_b16 v[214:215], v218 offset:14336
    v_mfma_f32_16x16x32_bf16 v[36:39], v[192:195], a[68:71], v[36:39]
    buffer_load_dwordx4 a[156:159], v232, s[36:39], s97 offen offset:1024 sc1
    v_mfma_f32_16x16x32_bf16 v[40:43], v[192:195], a[72:75], v[40:43]
    v_mfma_f32_16x16x32_bf16 v[40:43], v[196:199], a[88:91], v[40:43]
    v_mfma_f32_16x16x32_bf16 v[44:47], v[196:199], a[92:95], v[44:47]
    v_mfma_f32_16x16x32_bf16 v[44:47], v[192:195], a[76:79], v[44:47]
    ds_read_b64_tr_b16 v[192:193], v219 offset:8192
    s_waitcnt lgkmcnt(5)
    v_mfma_f32_16x16x32_bf16 v[48:51], v[200:203], a[64:67], v[48:51]
    ds_read_b64_tr_b16 v[194:195], v219 offset:10240
    s_add_u32 s97, s76, 10240
    v_mfma_f32_16x16x32_bf16 v[48:51], v[204:207], a[80:83], v[48:51]
    ds_read_b64_tr_b16 v[196:197], v219 offset:12288
    buffer_load_dwordx4 a[160:163], v232, s[36:39], s97 offen sc1
    v_mfma_f32_16x16x32_bf16 v[52:55], v[204:207], a[84:87], v[52:55]
    ds_read_b64_tr_b16 v[198:199], v219 offset:14336
    v_mfma_f32_16x16x32_bf16 v[52:55], v[200:203], a[68:71], v[52:55]
    v_mfma_f32_16x16x32_bf16 v[56:59], v[200:203], a[72:75], v[56:59]
    v_mfma_f32_16x16x32_bf16 v[56:59], v[204:207], a[88:91], v[56:59]
    buffer_load_dwordx4 a[176:179], v232, s[36:39], s97 offen offset:1024 sc1
    v_mfma_f32_16x16x32_bf16 v[60:63], v[204:207], a[92:95], v[60:63]
    v_mfma_f32_16x16x32_bf16 v[60:63], v[200:203], a[76:79], v[60:63]
    ds_read_b128 v[200:203], v220 offset:8192
    s_waitcnt lgkmcnt(5)
    v_mfma_f32_16x16x32_bf16 v[64:67], v[208:211], a[64:67], v[64:67]
    ds_read_b128 v[204:207], v220 offset:10240
    v_mfma_f32_16x16x32_bf16 v[64:67], v[212:215], a[80:83], v[64:67]
    s_add_u32 s97, s76, 28672
    v_mfma_f32_16x16x32_bf16 v[68:71], v[212:215], a[84:87], v[68:71]
    buffer_load_dwordx4 a[164:167], v232, s[36:39], s97 offen sc1
    v_mfma_f32_16x16x32_bf16 v[68:71], v[208:211], a[68:71], v[68:71]
    v_mfma_f32_16x16x32_bf16 v[72:75], v[208:211], a[72:75], v[72:75]
    v_mfma_f32_16x16x32_bf16 v[72:75], v[212:215], a[88:91], v[72:75]
    v_mfma_f32_16x16x32_bf16 v[76:79], v[212:215], a[92:95], v[76:79]
    v_mfma_f32_16x16x32_bf16 v[76:79], v[208:211], a[76:79], v[76:79]
    ds_read_b128 v[208:211], v220 offset:9216
    s_waitcnt lgkmcnt(3)
    v_mfma_f32_16x16x32_bf16 v[80:83], v[192:195], a[64:67], v[80:83]
    ds_read_b128 v[212:215], v220 offset:11264
    buffer_load_dwordx4 a[180:183], v232, s[36:39], s97 offen offset:1024 sc1
    v_mfma_f32_16x16x32_bf16 v[80:83], v[196:199], a[80:83], v[80:83]
    v_mfma_f32_16x16x32_bf16 v[84:87], v[196:199], a[84:87], v[84:87]
    v_mfma_f32_16x16x32_bf16 v[84:87], v[192:195], a[68:71], v[84:87]
    s_add_u32 s97, s76, 47104
    v_mfma_f32_16x16x32_bf16 v[88:91], v[192:195], a[72:75], v[88:91]
    buffer_load_dwordx4 a[168:171], v232, s[36:39], s97 offen sc1
    v_mfma_f32_16x16x32_bf16 v[88:91], v[196:199], a[88:91], v[88:91]
    v_mfma_f32_16x16x32_bf16 v[92:95], v[196:199], a[92:95], v[92:95]
    v_mfma_f32_16x16x32_bf16 v[92:95], v[192:195], a[76:79], v[92:95]
    ds_read_b64_tr_b16 v[192:193], v216 offset:16384
    s_waitcnt lgkmcnt(3)
    v_mfma_f32_16x16x32_bf16 v[160:163], v[200:203], a[64:67], v[160:163]
    ds_read_b64_tr_b16 v[194:195], v216 offset:18432
    v_mfma_f32_16x16x32_bf16 v[160:163], v[204:207], a[80:83], v[160:163]
    ds_read_b64_tr_b16 v[196:197], v216 offset:20480
    buffer_load_dwordx4 a[184:187], v232, s[36:39], s97 offen offset:1024 sc1
    v_mfma_f32_16x16x32_bf16 v[164:167], v[204:207], a[84:87], v[164:167]
    ds_read_b64_tr_b16 v[198:199], v216 offset:22528
    v_mfma_f32_16x16x32_bf16 v[164:167], v[200:203], a[68:71], v[164:167]
    v_mfma_f32_16x16x32_bf16 v[168:171], v[200:203], a[72:75], v[168:171]
    v_mfma_f32_16x16x32_bf16 v[168:171], v[204:207], a[88:91], v[168:171]
    s_add_u32 s97, s76, 65536
    v_mfma_f32_16x16x32_bf16 v[172:175], v[204:207], a[92:95], v[172:175]
    buffer_load_dwordx4 a[172:175], v232, s[36:39], s97 offen sc1
    v_mfma_f32_16x16x32_bf16 v[172:175], v[200:203], a[76:79], v[172:175]
    ds_read_b64_tr_b16 v[200:201], v217 offset:16384
    s_waitcnt lgkmcnt(5)
    v_mfma_f32_16x16x32_bf16 v[176:179], v[208:211], a[64:67], v[176:179]
    ds_read_b64_tr_b16 v[202:203], v217 offset:18432
    v_mfma_f32_16x16x32_bf16 v[176:179], v[212:215], a[80:83], v[176:179]
    ds_read_b64_tr_b16 v[204:205], v217 offset:20480
    v_mfma_f32_16x16x32_bf16 v[180:183], v[212:215], a[84:87], v[180:183]
    ds_read_b64_tr_b16 v[206:207], v217 offset:22528
    v_mfma_f32_16x16x32_bf16 v[180:183], v[208:211], a[68:71], v[180:183]
    buffer_load_dwordx4 a[188:191], v232, s[36:39], s97 offen offset:1024 sc1
    v_mfma_f32_16x16x32_bf16 v[184:187], v[208:211], a[72:75], v[184:187]
    v_mfma_f32_16x16x32_bf16 v[184:187], v[212:215], a[88:91], v[184:187]
    v_mfma_f32_16x16x32_bf16 v[188:191], v[212:215], a[92:95], v[188:191]
    v_mfma_f32_16x16x32_bf16 v[188:191], v[208:211], a[76:79], v[188:191]
    ds_read_b64_tr_b16 v[208:209], v218 offset:16384
    s_waitcnt vmcnt(16) lgkmcnt(5)
    v_mfma_f32_16x16x32_bf16 v[32:35], v[192:195], a[96:99], v[32:35]
    ds_read_b64_tr_b16 v[210:211], v218 offset:18432
    s_add_u32 s97, s76, 12288
    v_mfma_f32_16x16x32_bf16 v[32:35], v[196:199], a[112:115], v[32:35]
    ds_read_b64_tr_b16 v[212:213], v218 offset:20480
    buffer_load_dwordx4 a[192:195], v232, s[36:39], s97 offen sc1
    v_mfma_f32_16x16x32_bf16 v[36:39], v[196:199], a[116:119], v[36:39]
    ds_read_b64_tr_b16 v[214:215], v218 offset:22528
    v_mfma_f32_16x16x32_bf16 v[36:39], v[192:195], a[100:103], v[36:39]
    v_mfma_f32_16x16x32_bf16 v[40:43], v[192:195], a[104:107], v[40:43]
    v_mfma_f32_16x16x32_bf16 v[40:43], v[196:199], a[120:123], v[40:43]
    buffer_load_dwordx4 a[208:211], v232, s[36:39], s97 offen offset:1024 sc1
    v_mfma_f32_16x16x32_bf16 v[44:47], v[196:199], a[124:127], v[44:47]
    v_mfma_f32_16x16x32_bf16 v[44:47], v[192:195], a[108:111], v[44:47]
    ds_read_b64_tr_b16 v[192:193], v219 offset:16384
    s_waitcnt lgkmcnt(5)
    v_mfma_f32_16x16x32_bf16 v[48:51], v[200:203], a[96:99], v[48:51]
    ds_read_b64_tr_b16 v[194:195], v219 offset:18432
    v_mfma_f32_16x16x32_bf16 v[48:51], v[204:207], a[112:115], v[48:51]
    ds_read_b64_tr_b16 v[196:197], v219 offset:20480
    s_add_u32 s97, s76, 30720
    v_mfma_f32_16x16x32_bf16 v[52:55], v[204:207], a[116:119], v[52:55]
    ds_read_b64_tr_b16 v[198:199], v219 offset:22528
    buffer_load_dwordx4 a[196:199], v232, s[36:39], s97 offen sc1
    v_mfma_f32_16x16x32_bf16 v[52:55], v[200:203], a[100:103], v[52:55]
    v_mfma_f32_16x16x32_bf16 v[56:59], v[200:203], a[104:107], v[56:59]
    v_mfma_f32_16x16x32_bf16 v[56:59], v[204:207], a[120:123], v[56:59]
    v_mfma_f32_16x16x32_bf16 v[60:63], v[204:207], a[124:127], v[60:63]
    v_mfma_f32_16x16x32_bf16 v[60:63], v[200:203], a[108:111], v[60:63]
    ds_read_b128 v[200:203], v220 offset:12288
    s_waitcnt lgkmcnt(5)
    v_mfma_f32_16x16x32_bf16 v[64:67], v[208:211], a[96:99], v[64:67]
    ds_read_b128 v[204:207], v220 offset:14336
    buffer_load_dwordx4 a[212:215], v232, s[36:39], s97 offen offset:1024 sc1
    v_mfma_f32_16x16x32_bf16 v[64:67], v[212:215], a[112:115], v[64:67]
    v_mfma_f32_16x16x32_bf16 v[68:71], v[212:215], a[116:119], v[68:71]
    v_mfma_f32_16x16x32_bf16 v[68:71], v[208:211], a[100:103], v[68:71]
    s_add_u32 s97, s76, 49152
    v_mfma_f32_16x16x32_bf16 v[72:75], v[208:211], a[104:107], v[72:75]
    buffer_load_dwordx4 a[200:203], v232, s[36:39], s97 offen sc1
    v_mfma_f32_16x16x32_bf16 v[72:75], v[212:215], a[120:123], v[72:75]
    v_mfma_f32_16x16x32_bf16 v[76:79], v[212:215], a[124:127], v[76:79]
    v_mfma_f32_16x16x32_bf16 v[76:79], v[208:211], a[108:111], v[76:79]
    ds_read_b128 v[208:211], v220 offset:13312
    s_waitcnt lgkmcnt(3)
    v_mfma_f32_16x16x32_bf16 v[80:83], v[192:195], a[96:99], v[80:83]
    ds_read_b128 v[212:215], v220 offset:15360
    v_mfma_f32_16x16x32_bf16 v[80:83], v[196:199], a[112:115], v[80:83]
    buffer_load_dwordx4 a[216:219], v232, s[36:39], s97 offen offset:1024 sc1
    v_mfma_f32_16x16x32_bf16 v[84:87], v[196:199], a[116:119], v[84:87]
    v_mfma_f32_16x16x32_bf16 v[84:87], v[192:195], a[100:103], v[84:87]
    v_mfma_f32_16x16x32_bf16 v[88:91], v[192:195], a[104:107], v[88:91]
    v_mfma_f32_16x16x32_bf16 v[88:91], v[196:199], a[120:123], v[88:91]
    s_add_u32 s97, s76, 67584
    v_mfma_f32_16x16x32_bf16 v[92:95], v[196:199], a[124:127], v[92:95]
    buffer_load_dwordx4 a[204:207], v232, s[36:39], s97 offen sc1
    v_mfma_f32_16x16x32_bf16 v[92:95], v[192:195], a[108:111], v[92:95]
    v_subrev_u32 v216, 73728, v216
    s_waitcnt lgkmcnt(2)
    v_mfma_f32_16x16x32_bf16 v[160:163], v[200:203], a[96:99], v[160:163]
    v_subrev_u32 v217, 73728, v217
    v_subrev_u32 v218, 73728, v218
    v_mfma_f32_16x16x32_bf16 v[160:163], v[204:207], a[112:115], v[160:163]
    v_subrev_u32 v219, 73728, v219
    ds_read_b64_tr_b16 v[192:193], v216 offset:0
    v_mfma_f32_16x16x32_bf16 v[164:167], v[204:207], a[116:119], v[164:167]
    ds_read_b64_tr_b16 v[194:195], v216 offset:2048
    ds_read_b64_tr_b16 v[196:197], v216 offset:4096
    v_mfma_f32_16x16x32_bf16 v[164:167], v[200:203], a[100:103], v[164:167]
    ds_read_b64_tr_b16 v[198:199], v216 offset:6144
    buffer_load_dwordx4 a[220:223], v232, s[36:39], s97 offen offset:1024 sc1
    v_mfma_f32_16x16x32_bf16 v[168:171], v[200:203], a[104:107], v[168:171]
    v_mfma_f32_16x16x32_bf16 v[168:171], v[204:207], a[120:123], v[168:171]
    v_mfma_f32_16x16x32_bf16 v[172:175], v[204:207], a[124:127], v[172:175]
    v_mfma_f32_16x16x32_bf16 v[172:175], v[200:203], a[108:111], v[172:175]
    ds_read_b64_tr_b16 v[200:201], v217 offset:0
    s_waitcnt lgkmcnt(5)
    v_mfma_f32_16x16x32_bf16 v[176:179], v[208:211], a[96:99], v[176:179]
    ds_read_b64_tr_b16 v[202:203], v217 offset:2048
    v_lshrrev_b32 v248, 2, v232
    v_mfma_f32_16x16x32_bf16 v[176:179], v[212:215], a[112:115], v[176:179]
    ds_read_b64_tr_b16 v[204:205], v217 offset:4096
    v_and_b32 v248, 0x3c, v248
    v_mfma_f32_16x16x32_bf16 v[180:183], v[212:215], a[116:119], v[180:183]
    ds_read_b64_tr_b16 v[206:207], v217 offset:6144
    v_lshrrev_b32 v249, 8, v232
    v_mfma_f32_16x16x32_bf16 v[180:183], v[208:211], a[100:103], v[180:183]
    v_lshl_add_u32 v248, v249, 9, v248
    s_sub_u32 s97, s76, 3801088
    v_mfma_f32_16x16x32_bf16 v[184:187], v[208:211], a[104:107], v[184:187]
    s_mul_hi_u32 s97, s97, 477218589
    s_add_u32 s97, s97, 6160384
    v_mfma_f32_16x16x32_bf16 v[184:187], v[212:215], a[120:123], v[184:187]
    buffer_load_dword v240, v248, s[36:39], s97 offen offset:0 sc1
    buffer_load_dword v241, v248, s[36:39], s97 offen offset:256 sc1
    v_mfma_f32_16x16x32_bf16 v[188:191], v[212:215], a[124:127], v[188:191]
    buffer_load_dword v242, v248, s[36:39], s97 offen offset:2048 sc1
    v_mfma_f32_16x16x32_bf16 v[188:191], v[208:211], a[108:111], v[188:191]
    ds_read_b64_tr_b16 v[208:209], v218 offset:0
    s_waitcnt vmcnt(19) lgkmcnt(5)
    v_mfma_f32_16x16x32_bf16 v[32:35], v[192:195], a[128:131], v[32:35]
    ds_read_b64_tr_b16 v[210:211], v218 offset:2048
    v_mfma_f32_16x16x32_bf16 v[32:35], v[196:199], a[144:147], v[32:35]
    ds_read_b64_tr_b16 v[212:213], v218 offset:4096
    buffer_load_dword v243, v248, s[36:39], s97 offen offset:2304 sc1
    v_mfma_f32_16x16x32_bf16 v[36:39], v[196:199], a[148:151], v[36:39]
    ds_read_b64_tr_b16 v[214:215], v218 offset:6144
    v_mfma_f32_16x16x32_bf16 v[36:39], v[192:195], a[132:135], v[36:39]
    s_add_u32 s97, s97, 4096
    v_mfma_f32_16x16x32_bf16 v[40:43], v[192:195], a[136:139], v[40:43]
    buffer_load_dword v244, v248, s[36:39], s97 offen offset:0 sc1
    v_mfma_f32_16x16x32_bf16 v[40:43], v[196:199], a[152:155], v[40:43]
    v_mfma_f32_16x16x32_bf16 v[44:47], v[196:199], a[156:159], v[44:47]
    v_mfma_f32_16x16x32_bf16 v[44:47], v[192:195], a[140:143], v[44:47]
    ds_read_b64_tr_b16 v[192:193], v219 offset:0
    s_waitcnt lgkmcnt(5)
    v_mfma_f32_16x16x32_bf16 v[48:51], v[200:203], a[128:131], v[48:51]
    ds_read_b64_tr_b16 v[194:195], v219 offset:2048
    buffer_load_dword v245, v248, s[36:39], s97 offen offset:256 sc1
    v_mfma_f32_16x16x32_bf16 v[48:51], v[204:207], a[144:147], v[48:51]
    ds_read_b64_tr_b16 v[196:197], v219 offset:4096
    v_mfma_f32_16x16x32_bf16 v[52:55], v[204:207], a[148:151], v[52:55]
    ds_read_b64_tr_b16 v[198:199], v219 offset:6144
    buffer_load_dword v246, v248, s[36:39], s97 offen offset:2048 sc1
    v_mfma_f32_16x16x32_bf16 v[52:55], v[200:203], a[132:135], v[52:55]
    v_mfma_f32_16x16x32_bf16 v[56:59], v[200:203], a[136:139], v[56:59]
    v_mfma_f32_16x16x32_bf16 v[56:59], v[204:207], a[152:155], v[56:59]
    buffer_load_dword v247, v248, s[36:39], s97 offen offset:2304 sc1
    s_lshl_b32 s92, s48, 6
    s_lshl_b32 s97, s51, 1
    s_add_u32 s92, s92, s97
    s_add_u32 s92, s92, s55
    v_lshrrev_b32 v253, 4, v232
    v_lshrrev_b32 v250, 3, v253
    v_and_b32 v251, 7, v253
    v_lshl_add_u32 v251, v251, 1, 1
    v_mul_u32_u24 v250, 9216, v250
    v_lshl_add_u32 v250, v251, 7, v250
    s_cmp_ge_u32 s92, 72
    s_cselect_b32 s44, s24, s20
    s_cselect_b32 s45, s25, s21
    s_cselect_b32 s97, 72, 0
    s_sub_u32 s92, s92, s97
    s_mul_i32 s92, s92, 73728
    s_mul_i32 s97, s54, 2304
    s_add_u32 s97, s97, s92
    buffer_load_dword v239, v250, s[44:47], s97 offen
    v_mfma_f32_16x16x32_bf16 v[60:63], v[204:207], a[156:159], v[60:63]
    v_mfma_f32_16x16x32_bf16 v[60:63], v[200:203], a[140:143], v[60:63]
    ds_read_b128 v[200:203], v220 offset:16384
    s_waitcnt lgkmcnt(5)
    v_mfma_f32_16x16x32_bf16 v[64:67], v[208:211], a[128:131], v[64:67]
    ds_read_b128 v[204:207], v220 offset:18432
    v_mfma_f32_16x16x32_bf16 v[64:67], v[212:215], a[144:147], v[64:67]
    v_mfma_f32_16x16x32_bf16 v[68:71], v[212:215], a[148:151], v[68:71]
    v_mfma_f32_16x16x32_bf16 v[68:71], v[208:211], a[132:135], v[68:71]
    v_mfma_f32_16x16x32_bf16 v[72:75], v[208:211], a[136:139], v[72:75]
    v_mfma_f32_16x16x32_bf16 v[72:75], v[212:215], a[152:155], v[72:75]
    v_mfma_f32_16x16x32_bf16 v[76:79], v[212:215], a[156:159], v[76:79]
    v_mfma_f32_16x16x32_bf16 v[76:79], v[208:211], a[140:143], v[76:79]
    ds_read_b128 v[208:211], v220 offset:17408
    s_waitcnt lgkmcnt(3)
    v_mfma_f32_16x16x32_bf16 v[80:83], v[192:195], a[128:131], v[80:83]
    ds_read_b128 v[212:215], v220 offset:19456
    v_mfma_f32_16x16x32_bf16 v[80:83], v[196:199], a[144:147], v[80:83]
    v_mfma_f32_16x16x32_bf16 v[84:87], v[196:199], a[148:151], v[84:87]
    v_mfma_f32_16x16x32_bf16 v[84:87], v[192:195], a[132:135], v[84:87]
    v_mfma_f32_16x16x32_bf16 v[88:91], v[192:195], a[136:139], v[88:91]
    v_mfma_f32_16x16x32_bf16 v[88:91], v[196:199], a[152:155], v[88:91]
    v_mfma_f32_16x16x32_bf16 v[92:95], v[196:199], a[156:159], v[92:95]
    v_mfma_f32_16x16x32_bf16 v[92:95], v[192:195], a[140:143], v[92:95]
    ds_read_b64_tr_b16 v[192:193], v216 offset:8192
    s_waitcnt lgkmcnt(3)
    v_mfma_f32_16x16x32_bf16 v[160:163], v[200:203], a[128:131], v[160:163]
    ds_read_b64_tr_b16 v[194:195], v216 offset:10240
    v_mfma_f32_16x16x32_bf16 v[160:163], v[204:207], a[144:147], v[160:163]
    ds_read_b64_tr_b16 v[196:197], v216 offset:12288
    v_mfma_f32_16x16x32_bf16 v[164:167], v[204:207], a[148:151], v[164:167]
    ds_read_b64_tr_b16 v[198:199], v216 offset:14336
    v_mfma_f32_16x16x32_bf16 v[164:167], v[200:203], a[132:135], v[164:167]
    v_mfma_f32_16x16x32_bf16 v[168:171], v[200:203], a[136:139], v[168:171]
    v_mfma_f32_16x16x32_bf16 v[168:171], v[204:207], a[152:155], v[168:171]
    v_mfma_f32_16x16x32_bf16 v[172:175], v[204:207], a[156:159], v[172:175]
    v_mfma_f32_16x16x32_bf16 v[172:175], v[200:203], a[140:143], v[172:175]
    ds_read_b64_tr_b16 v[200:201], v217 offset:8192
    s_waitcnt lgkmcnt(5)
    v_mfma_f32_16x16x32_bf16 v[176:179], v[208:211], a[128:131], v[176:179]
    ds_read_b64_tr_b16 v[202:203], v217 offset:10240
    v_mfma_f32_16x16x32_bf16 v[176:179], v[212:215], a[144:147], v[176:179]
    ds_read_b64_tr_b16 v[204:205], v217 offset:12288
    v_mfma_f32_16x16x32_bf16 v[180:183], v[212:215], a[148:151], v[180:183]
    ds_read_b64_tr_b16 v[206:207], v217 offset:14336
    v_mfma_f32_16x16x32_bf16 v[180:183], v[208:211], a[132:135], v[180:183]
    v_mfma_f32_16x16x32_bf16 v[184:187], v[208:211], a[136:139], v[184:187]
    v_mfma_f32_16x16x32_bf16 v[184:187], v[212:215], a[152:155], v[184:187]
    v_mfma_f32_16x16x32_bf16 v[188:191], v[212:215], a[156:159], v[188:191]
    v_mfma_f32_16x16x32_bf16 v[188:191], v[208:211], a[140:143], v[188:191]
    ds_read_b64_tr_b16 v[208:209], v218 offset:8192
sequential_preLN__linear_kernel_hedgehog__glu_gated_reglu__prompt_kernel_hop1_1:
    s_cbranch_execz sequential_preLN__linear_kernel_hedgehog__glu_gated_reglu__prompt_kernel_hop1_2
    s_waitcnt vmcnt(17) lgkmcnt(5)
    v_mfma_f32_16x16x32_bf16 v[32:35], v[192:195], a[160:163], v[32:35]
    ds_read_b64_tr_b16 v[210:211], v218 offset:10240
    v_mfma_f32_16x16x32_bf16 v[32:35], v[196:199], a[176:179], v[32:35]
    ds_read_b64_tr_b16 v[212:213], v218 offset:12288
    v_mfma_f32_16x16x32_bf16 v[36:39], v[196:199], a[180:183], v[36:39]
    ds_read_b64_tr_b16 v[214:215], v218 offset:14336
    v_mfma_f32_16x16x32_bf16 v[36:39], v[192:195], a[164:167], v[36:39]
    v_mfma_f32_16x16x32_bf16 v[40:43], v[192:195], a[168:171], v[40:43]
    v_mfma_f32_16x16x32_bf16 v[40:43], v[196:199], a[184:187], v[40:43]
    v_mfma_f32_16x16x32_bf16 v[44:47], v[196:199], a[188:191], v[44:47]
    v_mfma_f32_16x16x32_bf16 v[44:47], v[192:195], a[172:175], v[44:47]
    ds_read_b64_tr_b16 v[192:193], v219 offset:8192
    s_waitcnt lgkmcnt(5)
    v_mfma_f32_16x16x32_bf16 v[48:51], v[200:203], a[160:163], v[48:51]
    ds_read_b64_tr_b16 v[194:195], v219 offset:10240
    v_mfma_f32_16x16x32_bf16 v[48:51], v[204:207], a[176:179], v[48:51]
    ds_read_b64_tr_b16 v[196:197], v219 offset:12288
    v_mfma_f32_16x16x32_bf16 v[52:55], v[204:207], a[180:183], v[52:55]
    ds_read_b64_tr_b16 v[198:199], v219 offset:14336
    v_mfma_f32_16x16x32_bf16 v[52:55], v[200:203], a[164:167], v[52:55]
    v_mfma_f32_16x16x32_bf16 v[56:59], v[200:203], a[168:171], v[56:59]
    v_mfma_f32_16x16x32_bf16 v[56:59], v[204:207], a[184:187], v[56:59]
    v_mfma_f32_16x16x32_bf16 v[60:63], v[204:207], a[188:191], v[60:63]
    v_mfma_f32_16x16x32_bf16 v[60:63], v[200:203], a[172:175], v[60:63]
    ds_read_b128 v[200:203], v220 offset:20480
    s_waitcnt lgkmcnt(5)
    v_mfma_f32_16x16x32_bf16 v[64:67], v[208:211], a[160:163], v[64:67]
    ds_read_b128 v[204:207], v220 offset:22528
    v_mfma_f32_16x16x32_bf16 v[64:67], v[212:215], a[176:179], v[64:67]
    v_mfma_f32_16x16x32_bf16 v[68:71], v[212:215], a[180:183], v[68:71]
    v_mfma_f32_16x16x32_bf16 v[68:71], v[208:211], a[164:167], v[68:71]
    v_mfma_f32_16x16x32_bf16 v[72:75], v[208:211], a[168:171], v[72:75]
    v_mfma_f32_16x16x32_bf16 v[72:75], v[212:215], a[184:187], v[72:75]
    v_mfma_f32_16x16x32_bf16 v[76:79], v[212:215], a[188:191], v[76:79]
    v_mfma_f32_16x16x32_bf16 v[76:79], v[208:211], a[172:175], v[76:79]
    ds_read_b128 v[208:211], v220 offset:21504
    s_waitcnt lgkmcnt(3)
    v_mfma_f32_16x16x32_bf16 v[80:83], v[192:195], a[160:163], v[80:83]
    ds_read_b128 v[212:215], v220 offset:23552
    v_mfma_f32_16x16x32_bf16 v[80:83], v[196:199], a[176:179], v[80:83]
    v_mfma_f32_16x16x32_bf16 v[84:87], v[196:199], a[180:183], v[84:87]
    v_mfma_f32_16x16x32_bf16 v[84:87], v[192:195], a[164:167], v[84:87]
    v_mfma_f32_16x16x32_bf16 v[88:91], v[192:195], a[168:171], v[88:91]
    v_mfma_f32_16x16x32_bf16 v[88:91], v[196:199], a[184:187], v[88:91]
    v_mfma_f32_16x16x32_bf16 v[92:95], v[196:199], a[188:191], v[92:95]
    v_mfma_f32_16x16x32_bf16 v[92:95], v[192:195], a[172:175], v[92:95]
    ds_read_b64_tr_b16 v[192:193], v216 offset:16384
    s_waitcnt lgkmcnt(3)
    v_mfma_f32_16x16x32_bf16 v[160:163], v[200:203], a[160:163], v[160:163]
    ds_read_b64_tr_b16 v[194:195], v216 offset:18432
    v_mfma_f32_16x16x32_bf16 v[160:163], v[204:207], a[176:179], v[160:163]
    ds_read_b64_tr_b16 v[196:197], v216 offset:20480
    v_mfma_f32_16x16x32_bf16 v[164:167], v[204:207], a[180:183], v[164:167]
    ds_read_b64_tr_b16 v[198:199], v216 offset:22528
    v_mfma_f32_16x16x32_bf16 v[164:167], v[200:203], a[164:167], v[164:167]
    v_mfma_f32_16x16x32_bf16 v[168:171], v[200:203], a[168:171], v[168:171]
    v_mfma_f32_16x16x32_bf16 v[168:171], v[204:207], a[184:187], v[168:171]
    v_mfma_f32_16x16x32_bf16 v[172:175], v[204:207], a[188:191], v[172:175]
    v_mfma_f32_16x16x32_bf16 v[172:175], v[200:203], a[172:175], v[172:175]
    ds_read_b64_tr_b16 v[200:201], v217 offset:16384
    s_waitcnt lgkmcnt(5)
    v_mfma_f32_16x16x32_bf16 v[176:179], v[208:211], a[160:163], v[176:179]
    ds_read_b64_tr_b16 v[202:203], v217 offset:18432
    v_mfma_f32_16x16x32_bf16 v[176:179], v[212:215], a[176:179], v[176:179]
    ds_read_b64_tr_b16 v[204:205], v217 offset:20480
    v_mfma_f32_16x16x32_bf16 v[180:183], v[212:215], a[180:183], v[180:183]
    ds_read_b64_tr_b16 v[206:207], v217 offset:22528
    v_mfma_f32_16x16x32_bf16 v[180:183], v[208:211], a[164:167], v[180:183]
    v_mfma_f32_16x16x32_bf16 v[184:187], v[208:211], a[168:171], v[184:187]
    v_mfma_f32_16x16x32_bf16 v[184:187], v[212:215], a[184:187], v[184:187]
    v_mfma_f32_16x16x32_bf16 v[188:191], v[212:215], a[188:191], v[188:191]
    v_mfma_f32_16x16x32_bf16 v[188:191], v[208:211], a[172:175], v[188:191]
    ds_read_b64_tr_b16 v[208:209], v218 offset:16384
    s_waitcnt vmcnt(9) lgkmcnt(5)
    v_mfma_f32_16x16x32_bf16 v[32:35], v[192:195], a[192:195], v[32:35]
    ds_read_b64_tr_b16 v[210:211], v218 offset:18432
    s_waitcnt vmcnt(7)
    v_add_f32 v234, v240, v241
    v_mfma_f32_16x16x32_bf16 v[32:35], v[196:199], a[208:211], v[32:35]
    ds_read_b64_tr_b16 v[212:213], v218 offset:20480
    v_mov_b32 v249, v234
    v_mfma_f32_16x16x32_bf16 v[36:39], v[196:199], a[212:215], v[36:39]
    ds_read_b64_tr_b16 v[214:215], v218 offset:22528
    v_permlane16_swap_b32 v234, v249
    v_mfma_f32_16x16x32_bf16 v[36:39], v[192:195], a[196:199], v[36:39]
    v_add_f32 v234, v234, v249
    v_mov_b32 v249, v234
    v_mfma_f32_16x16x32_bf16 v[40:43], v[192:195], a[200:203], v[40:43]
    s_nop 0
    v_permlane32_swap_b32 v234, v249
    v_mfma_f32_16x16x32_bf16 v[40:43], v[196:199], a[216:219], v[40:43]
    v_mfma_f32_16x16x32_bf16 v[44:47], v[196:199], a[220:223], v[44:47]
    v_add_f32 v234, v234, v249
    v_mfma_f32_16x16x32_bf16 v[44:47], v[192:195], a[204:207], v[44:47]
    ds_read_b64_tr_b16 v[192:193], v219 offset:16384
    s_waitcnt lgkmcnt(5)
    v_mfma_f32_16x16x32_bf16 v[48:51], v[200:203], a[192:195], v[48:51]
    ds_read_b64_tr_b16 v[194:195], v219 offset:18432
    v_mov_b32 v249, 0x3727c5ac
    v_mfma_f32_16x16x32_bf16 v[48:51], v[204:207], a[208:211], v[48:51]
    ds_read_b64_tr_b16 v[196:197], v219 offset:20480
    v_fmac_f32 v249, 0x3ae38e39, v234
    v_mfma_f32_16x16x32_bf16 v[52:55], v[204:207], a[212:215], v[52:55]
    ds_read_b64_tr_b16 v[198:199], v219 offset:22528
    v_rcp_f32 v234, v249
    v_mfma_f32_16x16x32_bf16 v[52:55], v[200:203], a[196:199], v[52:55]
    s_waitcnt vmcnt(5)
    v_add_f32 v235, v242, v243
    v_mov_b32 v249, v235
    v_mfma_f32_16x16x32_bf16 v[56:59], v[200:203], a[200:203], v[56:59]
    v_mfma_f32_16x16x32_bf16 v[56:59], v[204:207], a[216:219], v[56:59]
    v_permlane16_swap_b32 v235, v249
    v_mfma_f32_16x16x32_bf16 v[60:63], v[204:207], a[220:223], v[60:63]
    v_add_f32 v235, v235, v249
    v_mfma_f32_16x16x32_bf16 v[60:63], v[200:203], a[204:207], v[60:63]
    ds_read_b128 v[200:203], v220 offset:24576
    s_waitcnt lgkmcnt(5)
    v_mfma_f32_16x16x32_bf16 v[64:67], v[208:211], a[192:195], v[64:67]
    ds_read_b128 v[204:207], v220 offset:26624
    v_mov_b32 v249, v235
    v_mfma_f32_16x16x32_bf16 v[64:67], v[212:215], a[208:211], v[64:67]
    s_nop 0
    v_permlane32_swap_b32 v235, v249
    v_add_f32 v235, v235, v249
    v_mfma_f32_16x16x32_bf16 v[68:71], v[212:215], a[212:215], v[68:71]
    v_mov_b32 v249, 0x3727c5ac
    v_mfma_f32_16x16x32_bf16 v[68:71], v[208:211], a[196:199], v[68:71]
    v_mfma_f32_16x16x32_bf16 v[72:75], v[208:211], a[200:203], v[72:75]
    v_fmac_f32 v249, 0x3ae38e39, v235
    v_mfma_f32_16x16x32_bf16 v[72:75], v[212:215], a[216:219], v[72:75]
    v_rcp_f32 v235, v249
    v_mfma_f32_16x16x32_bf16 v[76:79], v[212:215], a[220:223], v[76:79]
    s_waitcnt vmcnt(3)
    v_add_f32 v236, v244, v245
    v_mfma_f32_16x16x32_bf16 v[76:79], v[208:211], a[204:207], v[76:79]
    ds_read_b128 v[208:211], v220 offset:25600
    s_waitcnt lgkmcnt(3)
    v_mfma_f32_16x16x32_bf16 v[80:83], v[192:195], a[192:195], v[80:83]
    ds_read_b128 v[212:215], v220 offset:27648
    v_mov_b32 v249, v236
    v_mfma_f32_16x16x32_bf16 v[80:83], v[196:199], a[208:211], v[80:83]
    s_nop 0
    v_permlane16_swap_b32 v236, v249
    v_mfma_f32_16x16x32_bf16 v[84:87], v[196:199], a[212:215], v[84:87]
    v_add_f32 v236, v236, v249
    v_mfma_f32_16x16x32_bf16 v[84:87], v[192:195], a[196:199], v[84:87]
    v_mov_b32 v249, v236
    v_mfma_f32_16x16x32_bf16 v[88:91], v[192:195], a[200:203], v[88:91]
    s_nop 0
    v_permlane32_swap_b32 v236, v249
    v_mfma_f32_16x16x32_bf16 v[88:91], v[196:199], a[216:219], v[88:91]
    v_add_f32 v236, v236, v249
    v_mfma_f32_16x16x32_bf16 v[92:95], v[196:199], a[220:223], v[92:95]
    v_mov_b32 v249, 0x3727c5ac
    v_mfma_f32_16x16x32_bf16 v[92:95], v[192:195], a[204:207], v[92:95]
    s_waitcnt lgkmcnt(0)
    s_barrier
    v_mfma_f32_16x16x32_bf16 v[160:163], v[200:203], a[192:195], v[160:163]
    v_add_u32 v216, 49152, v216
    v_add_u32 v217, 49152, v217
    v_mfma_f32_16x16x32_bf16 v[160:163], v[204:207], a[208:211], v[160:163]
    v_add_u32 v218, 49152, v218
    v_add_u32 v219, 49152, v219
    v_mfma_f32_16x16x32_bf16 v[164:167], v[204:207], a[212:215], v[164:167]
    ds_read_b64_tr_b16 v[192:193], v216 offset:0
    ds_read_b64_tr_b16 v[194:195], v216 offset:2048
    v_mfma_f32_16x16x32_bf16 v[164:167], v[200:203], a[196:199], v[164:167]
    ds_read_b64_tr_b16 v[196:197], v216 offset:4096
    ds_read_b64_tr_b16 v[198:199], v216 offset:6144
    v_mfma_f32_16x16x32_bf16 v[168:171], v[200:203], a[200:203], v[168:171]
    s_add_u32 m0, s49, 0
    s_add_u32 s96, s77, 2359296
    v_mfma_f32_16x16x32_bf16 v[168:171], v[204:207], a[216:219], v[168:171]
    buffer_load_dwordx4 v221, s[24:27], s96 offen lds
    v_fmac_f32 v249, 0x3ae38e39, v236
    v_mfma_f32_16x16x32_bf16 v[172:175], v[204:207], a[220:223], v[172:175]
    v_rcp_f32 v236, v249
    s_waitcnt vmcnt(2)
    v_add_f32 v237, v246, v247
    v_mfma_f32_16x16x32_bf16 v[172:175], v[200:203], a[204:207], v[172:175]
    ds_read_b64_tr_b16 v[200:201], v217 offset:0
    v_mfma_f32_16x16x32_bf16 v[176:179], v[208:211], a[192:195], v[176:179]
    ds_read_b64_tr_b16 v[202:203], v217 offset:2048
    v_mov_b32 v249, v237
    v_mfma_f32_16x16x32_bf16 v[176:179], v[212:215], a[208:211], v[176:179]
    ds_read_b64_tr_b16 v[204:205], v217 offset:4096
    v_permlane16_swap_b32 v237, v249
    v_mfma_f32_16x16x32_bf16 v[180:183], v[212:215], a[212:215], v[180:183]
    ds_read_b64_tr_b16 v[206:207], v217 offset:6144
    v_add_f32 v237, v237, v249
    v_mfma_f32_16x16x32_bf16 v[180:183], v[208:211], a[196:199], v[180:183]
    v_mov_b32 v249, v237
    s_nop 1
    v_permlane32_swap_b32 v237, v249
    v_mfma_f32_16x16x32_bf16 v[184:187], v[208:211], a[200:203], v[184:187]
    v_add_f32 v237, v237, v249
    v_mov_b32 v249, 0x3727c5ac
    v_mfma_f32_16x16x32_bf16 v[184:187], v[212:215], a[216:219], v[184:187]
    v_fmac_f32 v249, 0x3ae38e39, v237
    v_rcp_f32 v237, v249
    v_mfma_f32_16x16x32_bf16 v[188:191], v[212:215], a[220:223], v[188:191]
    v_mfma_f32_16x16x32_bf16 v[188:191], v[208:211], a[204:207], v[188:191]
    ds_read_b64_tr_b16 v[208:209], v218 offset:0
    s_waitcnt lgkmcnt(5)
    v_mfma_f32_16x16x32_bf16 v[96:99], v[192:195], v[0:3], 0
    ds_read_b64_tr_b16 v[210:211], v218 offset:2048
    v_mfma_f32_16x16x32_bf16 v[96:99], v[196:199], v[16:19], v[96:99]
    ds_read_b64_tr_b16 v[212:213], v218 offset:4096
    s_add_u32 m0, s49, 4096
    v_mfma_f32_16x16x32_bf16 v[100:103], v[196:199], v[20:23], 0
    ds_read_b64_tr_b16 v[214:215], v218 offset:6144
    s_add_u32 s96, s77, 2654208
    v_mfma_f32_16x16x32_bf16 v[100:103], v[192:195], v[4:7], v[100:103]
    buffer_load_dwordx4 v221, s[24:27], s96 offen lds
    v_max_f32 v160, 0, v160
    v_mfma_f32_16x16x32_bf16 v[104:107], v[192:195], v[8:11], 0
    v_mul_f32 v176, v234, v176
    v_mfma_f32_16x16x32_bf16 v[104:107], v[196:199], v[24:27], v[104:107]
    v_mul_f32 v160, v160, v176
    v_mfma_f32_16x16x32_bf16 v[108:111], v[196:199], v[28:31], 0
    v_mfma_f32_16x16x32_bf16 v[108:111], v[192:195], v[12:15], v[108:111]
    ds_read_b64_tr_b16 v[192:193], v219 offset:0
    s_waitcnt lgkmcnt(5)
    v_mfma_f32_16x16x32_bf16 v[112:115], v[200:203], v[0:3], 0
    ds_read_b64_tr_b16 v[194:195], v219 offset:2048
    v_max_f32 v161, 0, v161
    v_mfma_f32_16x16x32_bf16 v[112:115], v[204:207], v[16:19], v[112:115]
    ds_read_b64_tr_b16 v[196:197], v219 offset:4096
    v_mul_f32 v177, v234, v177
    v_mfma_f32_16x16x32_bf16 v[116:119], v[204:207], v[20:23], 0
    ds_read_b64_tr_b16 v[198:199], v219 offset:6144
    v_mul_f32 v161, v161, v177
    v_mfma_f32_16x16x32_bf16 v[116:119], v[200:203], v[4:7], v[116:119]
    v_max_f32 v162, 0, v162
    v_mfma_f32_16x16x32_bf16 v[120:123], v[200:203], v[8:11], 0
    v_mfma_f32_16x16x32_bf16 v[120:123], v[204:207], v[24:27], v[120:123]
    v_mul_f32 v178, v234, v178
    v_mfma_f32_16x16x32_bf16 v[124:127], v[204:207], v[28:31], 0
    v_mul_f32 v162, v162, v178
    v_mfma_f32_16x16x32_bf16 v[124:127], v[200:203], v[12:15], v[124:127]
    ds_read_b64_tr_b16 v[200:201], v216 offset:8192
    s_waitcnt lgkmcnt(5)
    v_mfma_f32_16x16x32_bf16 v[128:131], v[208:211], v[0:3], 0
    ds_read_b64_tr_b16 v[202:203], v216 offset:10240
    v_max_f32 v163, 0, v163
    v_mfma_f32_16x16x32_bf16 v[128:131], v[212:215], v[16:19], v[128:131]
    ds_read_b64_tr_b16 v[204:205], v216 offset:12288
    s_add_u32 m0, s49, 8192
    v_mfma_f32_16x16x32_bf16 v[132:135], v[212:215], v[20:23], 0
    ds_read_b64_tr_b16 v[206:207], v216 offset:14336
    s_add_u32 s96, s77, 2949120
    v_mfma_f32_16x16x32_bf16 v[132:135], v[208:211], v[4:7], v[132:135]
    buffer_load_dwordx4 v221, s[24:27], s96 offen lds
    v_mul_f32 v179, v234, v179
    v_mfma_f32_16x16x32_bf16 v[136:139], v[208:211], v[8:11], 0
    v_mul_f32 v163, v163, v179
    v_cvt_pk_bf16_f32 v248, v160, v161
    v_mfma_f32_16x16x32_bf16 v[136:139], v[212:215], v[24:27], v[136:139]
    v_cvt_pk_bf16_f32 v249, v162, v163
    v_mfma_f32_16x16x32_bf16 v[140:143], v[212:215], v[28:31], 0
    v_mfma_f32_16x16x32_bf16 v[140:143], v[208:211], v[12:15], v[140:143]
    ds_read_b64_tr_b16 v[208:209], v217 offset:8192
    s_waitcnt lgkmcnt(5)
    v_mfma_f32_16x16x32_bf16 v[144:147], v[192:195], v[0:3], 0
    ds_read_b64_tr_b16 v[210:211], v217 offset:10240
    s_add_u32 s94, s83, 0
    v_mfma_f32_16x16x32_bf16 v[144:147], v[196:199], v[16:19], v[144:147]
    ds_read_b64_tr_b16 v[212:213], v217 offset:12288
    buffer_store_dwordx2 v[248:249], v233, s[36:39], s94 offen sc1
    v_mfma_f32_16x16x32_bf16 v[148:151], v[196:199], v[20:23], 0
    ds_read_b64_tr_b16 v[214:215], v217 offset:14336
    v_max_f32 v164, 0, v164
    v_mfma_f32_16x16x32_bf16 v[148:151], v[192:195], v[4:7], v[148:151]
    v_mul_f32 v180, v235, v180
    v_mfma_f32_16x16x32_bf16 v[152:155], v[192:195], v[8:11], 0
    v_mul_f32 v164, v164, v180
    v_mfma_f32_16x16x32_bf16 v[152:155], v[196:199], v[24:27], v[152:155]
    v_mfma_f32_16x16x32_bf16 v[156:159], v[196:199], v[28:31], 0
    v_max_f32 v165, 0, v165
    v_mfma_f32_16x16x32_bf16 v[156:159], v[192:195], v[12:15], v[156:159]
    ds_read_b64_tr_b16 v[192:193], v218 offset:8192
    s_waitcnt lgkmcnt(5)
    v_mfma_f32_16x16x32_bf16 v[96:99], v[200:203], a[224:227], v[96:99]
    ds_read_b64_tr_b16 v[194:195], v218 offset:10240
    v_mul_f32 v181, v235, v181
    v_mfma_f32_16x16x32_bf16 v[96:99], v[204:207], a[240:243], v[96:99]
    ds_read_b64_tr_b16 v[196:197], v218 offset:12288
    s_add_u32 m0, s49, 12288
    v_mfma_f32_16x16x32_bf16 v[100:103], v[204:207], a[244:247], v[100:103]
    ds_read_b64_tr_b16 v[198:199], v218 offset:14336
    s_add_u32 s96, s77, 3244032
    v_mfma_f32_16x16x32_bf16 v[100:103], v[200:203], a[228:231], v[100:103]
    buffer_load_dwordx4 v221, s[24:27], s96 offen lds
    v_mul_f32 v165, v165, v181
    v_mfma_f32_16x16x32_bf16 v[104:107], v[200:203], a[232:235], v[104:107]
    v_max_f32 v166, 0, v166
    v_mul_f32 v182, v235, v182
    v_mfma_f32_16x16x32_bf16 v[104:107], v[204:207], a[248:251], v[104:107]
    v_mul_f32 v166, v166, v182
    v_mfma_f32_16x16x32_bf16 v[108:111], v[204:207], a[252:255], v[108:111]
    v_mfma_f32_16x16x32_bf16 v[108:111], v[200:203], a[236:239], v[108:111]
    ds_read_b64_tr_b16 v[200:201], v219 offset:8192
    s_waitcnt lgkmcnt(5)
    v_mfma_f32_16x16x32_bf16 v[112:115], v[208:211], a[224:227], v[112:115]
    ds_read_b64_tr_b16 v[202:203], v219 offset:10240
    v_max_f32 v167, 0, v167
    v_mfma_f32_16x16x32_bf16 v[112:115], v[212:215], a[240:243], v[112:115]
    ds_read_b64_tr_b16 v[204:205], v219 offset:12288
    v_mul_f32 v183, v235, v183
    v_mfma_f32_16x16x32_bf16 v[116:119], v[212:215], a[244:247], v[116:119]
    ds_read_b64_tr_b16 v[206:207], v219 offset:14336
    v_mul_f32 v167, v167, v183
    v_mfma_f32_16x16x32_bf16 v[116:119], v[208:211], a[228:231], v[116:119]
    v_cvt_pk_bf16_f32 v252, v164, v165
    v_mfma_f32_16x16x32_bf16 v[120:123], v[208:211], a[232:235], v[120:123]
    v_cvt_pk_bf16_f32 v253, v166, v167
    v_mfma_f32_16x16x32_bf16 v[120:123], v[212:215], a[248:251], v[120:123]
    v_mfma_f32_16x16x32_bf16 v[124:127], v[212:215], a[252:255], v[124:127]
    s_add_u32 s94, s83, 147456
    v_mfma_f32_16x16x32_bf16 v[124:127], v[208:211], a[236:239], v[124:127]
    ds_read_b64_tr_b16 v[208:209], v216 offset:16384
    s_waitcnt lgkmcnt(5)
    v_mfma_f32_16x16x32_bf16 v[128:131], v[192:195], a[224:227], v[128:131]
    ds_read_b64_tr_b16 v[210:211], v216 offset:18432
    s_lshl_b32 s92, s48, 6
    s_lshl_b32 s97, s51, 1
    s_add_u32 s92, s92, s97
    s_add_u32 s92, s92, s55
    v_lshrrev_b32 v247, 4, v232
    v_min_u32 v244, 20, v247
    v_add_u32 v244, 0, v244
    v_min_u32 v244, 40, v244
    v_lshlrev_b32 v244, 7, v244
    s_mul_i32 s92, s92, 5248
    s_mul_i32 s97, s54, 1327104
    s_add_u32 s97, s97, s92
    buffer_load_dword v239, v244, s[28:31], s97 offen
    v_mfma_f32_16x16x32_bf16 v[128:131], v[196:199], a[240:243], v[128:131]
    ds_read_b64_tr_b16 v[212:213], v216 offset:20480
    s_add_u32 m0, s49, 16384
    v_mfma_f32_16x16x32_bf16 v[132:135], v[196:199], a[244:247], v[132:135]
    ds_read_b64_tr_b16 v[214:215], v216 offset:22528
    s_add_u32 s96, s77, 3538944
    v_mfma_f32_16x16x32_bf16 v[132:135], v[192:195], a[228:231], v[132:135]
    buffer_load_dwordx4 v221, s[24:27], s96 offen lds
    buffer_store_dwordx2 v[252:253], v233, s[36:39], s94 offen sc1
    v_mfma_f32_16x16x32_bf16 v[136:139], v[192:195], a[232:235], v[136:139]
    v_max_f32 v168, 0, v168
    v_mul_f32 v184, v236, v184
    v_mfma_f32_16x16x32_bf16 v[136:139], v[196:199], a[248:251], v[136:139]
    v_mul_f32 v168, v168, v184
    v_max_f32 v169, 0, v169
    v_mfma_f32_16x16x32_bf16 v[140:143], v[196:199], a[252:255], v[140:143]
    v_mul_f32 v185, v236, v185
    v_mfma_f32_16x16x32_bf16 v[140:143], v[192:195], a[236:239], v[140:143]
    ds_read_b64_tr_b16 v[192:193], v217 offset:16384
    s_waitcnt lgkmcnt(5)
    v_mfma_f32_16x16x32_bf16 v[144:147], v[200:203], a[224:227], v[144:147]
    ds_read_b64_tr_b16 v[194:195], v217 offset:18432
    v_mul_f32 v169, v169, v185
    v_mfma_f32_16x16x32_bf16 v[144:147], v[204:207], a[240:243], v[144:147]
    ds_read_b64_tr_b16 v[196:197], v217 offset:20480
    v_max_f32 v170, 0, v170
    v_mfma_f32_16x16x32_bf16 v[148:151], v[204:207], a[244:247], v[148:151]
    ds_read_b64_tr_b16 v[198:199], v217 offset:22528
    v_mfma_f32_16x16x32_bf16 v[148:151], v[200:203], a[228:231], v[148:151]
    v_mul_f32 v186, v236, v186
    v_mfma_f32_16x16x32_bf16 v[152:155], v[200:203], a[232:235], v[152:155]
    v_mul_f32 v170, v170, v186
    v_mfma_f32_16x16x32_bf16 v[152:155], v[204:207], a[248:251], v[152:155]
    v_mfma_f32_16x16x32_bf16 v[156:159], v[204:207], a[252:255], v[156:159]
    v_max_f32 v171, 0, v171
    v_mfma_f32_16x16x32_bf16 v[156:159], v[200:203], a[236:239], v[156:159]
    ds_read_b64_tr_b16 v[200:201], v218 offset:16384
    s_waitcnt lgkmcnt(5)
    v_mfma_f32_16x16x32_bf16 v[96:99], v[208:211], a[0:3], v[96:99]
    ds_read_b64_tr_b16 v[202:203], v218 offset:18432
    v_mul_f32 v187, v236, v187
    v_mfma_f32_16x16x32_bf16 v[96:99], v[212:215], a[16:19], v[96:99]
    ds_read_b64_tr_b16 v[204:205], v218 offset:20480
    s_add_u32 m0, s49, 20480
    v_mfma_f32_16x16x32_bf16 v[100:103], v[212:215], a[20:23], v[100:103]
    ds_read_b64_tr_b16 v[206:207], v218 offset:22528
    s_add_u32 s96, s77, 3833856
    v_mfma_f32_16x16x32_bf16 v[100:103], v[208:211], a[4:7], v[100:103]
    buffer_load_dwordx4 v221, s[24:27], s96 offen lds
    v_mul_f32 v171, v171, v187
    v_mfma_f32_16x16x32_bf16 v[104:107], v[208:211], a[8:11], v[104:107]
    v_cvt_pk_bf16_f32 v248, v168, v169
    v_cvt_pk_bf16_f32 v249, v170, v171
    v_mfma_f32_16x16x32_bf16 v[104:107], v[212:215], a[24:27], v[104:107]
    s_add_u32 s94, s83, 294912
    v_mfma_f32_16x16x32_bf16 v[108:111], v[212:215], a[28:31], v[108:111]
    buffer_store_dwordx2 v[248:249], v233, s[36:39], s94 offen sc1
    v_mfma_f32_16x16x32_bf16 v[108:111], v[208:211], a[12:15], v[108:111]
    ds_read_b64_tr_b16 v[208:209], v219 offset:16384
    s_waitcnt lgkmcnt(5)
    v_mfma_f32_16x16x32_bf16 v[112:115], v[192:195], a[0:3], v[112:115]
    ds_read_b64_tr_b16 v[210:211], v219 offset:18432
    v_max_f32 v172, 0, v172
    v_mfma_f32_16x16x32_bf16 v[112:115], v[196:199], a[16:19], v[112:115]
    ds_read_b64_tr_b16 v[212:213], v219 offset:20480
    v_mul_f32 v188, v237, v188
    v_mfma_f32_16x16x32_bf16 v[116:119], v[196:199], a[20:23], v[116:119]
    ds_read_b64_tr_b16 v[214:215], v219 offset:22528
    v_mfma_f32_16x16x32_bf16 v[116:119], v[192:195], a[4:7], v[116:119]
    v_mul_f32 v172, v172, v188
    v_mfma_f32_16x16x32_bf16 v[120:123], v[192:195], a[8:11], v[120:123]
    v_max_f32 v173, 0, v173
    v_mfma_f32_16x16x32_bf16 v[120:123], v[196:199], a[24:27], v[120:123]
    v_mfma_f32_16x16x32_bf16 v[124:127], v[196:199], a[28:31], v[124:127]
    v_mul_f32 v189, v237, v189
    v_mfma_f32_16x16x32_bf16 v[124:127], v[192:195], a[12:15], v[124:127]
    s_waitcnt lgkmcnt(0)
    s_barrier
    v_mfma_f32_16x16x32_bf16 v[128:131], v[200:203], a[0:3], v[128:131]
    v_subrev_u32 v216, 24576, v216
    v_subrev_u32 v217, 24576, v217
    v_mfma_f32_16x16x32_bf16 v[128:131], v[204:207], a[16:19], v[128:131]
    v_subrev_u32 v218, 24576, v218
    v_subrev_u32 v219, 24576, v219
    v_mfma_f32_16x16x32_bf16 v[132:135], v[204:207], a[20:23], v[132:135]
    ds_read_b64_tr_b16 v[192:193], v216 offset:0
    ds_read_b64_tr_b16 v[194:195], v216 offset:2048
    v_mfma_f32_16x16x32_bf16 v[132:135], v[200:203], a[4:7], v[132:135]
    ds_read_b64_tr_b16 v[196:197], v216 offset:4096
    ds_read_b64_tr_b16 v[198:199], v216 offset:6144
    v_mfma_f32_16x16x32_bf16 v[136:139], v[200:203], a[8:11], v[136:139]
    s_add_u32 m0, s49, 49152
    s_add_u32 s96, s77, 4718720
    v_mfma_f32_16x16x32_bf16 v[136:139], v[204:207], a[24:27], v[136:139]
    buffer_load_dwordx4 v222, s[20:23], s96 offen lds
    v_mul_f32 v173, v173, v189
    v_mfma_f32_16x16x32_bf16 v[140:143], v[204:207], a[28:31], v[140:143]
    v_max_f32 v174, 0, v174
    v_mul_f32 v190, v237, v190
    v_mfma_f32_16x16x32_bf16 v[140:143], v[200:203], a[12:15], v[140:143]
    ds_read_b64_tr_b16 v[200:201], v217 offset:0
    v_mfma_f32_16x16x32_bf16 v[144:147], v[208:211], a[0:3], v[144:147]
    ds_read_b64_tr_b16 v[202:203], v217 offset:2048
    v_mul_f32 v174, v174, v190
    v_mfma_f32_16x16x32_bf16 v[144:147], v[212:215], a[16:19], v[144:147]
    ds_read_b64_tr_b16 v[204:205], v217 offset:4096
    v_max_f32 v175, 0, v175
    v_mfma_f32_16x16x32_bf16 v[148:151], v[212:215], a[20:23], v[148:151]
    ds_read_b64_tr_b16 v[206:207], v217 offset:6144
    v_mul_f32 v191, v237, v191
    v_mfma_f32_16x16x32_bf16 v[148:151], v[208:211], a[4:7], v[148:151]
    v_mul_f32 v175, v175, v191
    v_cvt_pk_bf16_f32 v252, v172, v173
    v_mfma_f32_16x16x32_bf16 v[152:155], v[208:211], a[8:11], v[152:155]
    v_cvt_pk_bf16_f32 v253, v174, v175
    s_add_u32 s94, s83, 442368
    v_mfma_f32_16x16x32_bf16 v[152:155], v[212:215], a[24:27], v[152:155]
    buffer_store_dwordx2 v[252:253], v233, s[36:39], s94 offen sc1
    v_mfma_f32_16x16x32_bf16 v[156:159], v[212:215], a[28:31], v[156:159]
    v_mfma_f32_16x16x32_bf16 v[156:159], v[208:211], a[12:15], v[156:159]
    ds_read_b64_tr_b16 v[208:209], v218 offset:0
    s_waitcnt lgkmcnt(5)
    v_mfma_f32_16x16x32_bf16 v[96:99], v[192:195], a[32:35], v[96:99]
    ds_read_b64_tr_b16 v[210:211], v218 offset:2048
    v_mul_f32 v32, v234, v32
    v_mfma_f32_16x16x32_bf16 v[96:99], v[196:199], a[48:51], v[96:99]
    ds_read_b64_tr_b16 v[212:213], v218 offset:4096
    s_add_u32 m0, s49, 53248
    v_mfma_f32_16x16x32_bf16 v[100:103], v[196:199], a[52:55], v[100:103]
    ds_read_b64_tr_b16 v[214:215], v218 offset:6144
    s_add_u32 s96, s77, 5013632
    v_mfma_f32_16x16x32_bf16 v[100:103], v[192:195], a[36:39], v[100:103]
    buffer_load_dwordx4 v222, s[20:23], s96 offen lds
    v_mul_f32 v33, v234, v33
    v_mfma_f32_16x16x32_bf16 v[104:107], v[192:195], a[40:43], v[104:107]
    v_mul_f32 v34, v234, v34
    v_mul_f32 v35, v234, v35
    v_mfma_f32_16x16x32_bf16 v[104:107], v[196:199], a[56:59], v[104:107]
    v_cvt_pk_bf16_f32 v160, v32, v33
    v_mfma_f32_16x16x32_bf16 v[108:111], v[196:199], a[60:63], v[108:111]
    v_cvt_pk_bf16_f32 v161, v34, v35
    v_mfma_f32_16x16x32_bf16 v[108:111], v[192:195], a[44:47], v[108:111]
    ds_read_b64_tr_b16 v[192:193], v219 offset:0
    s_waitcnt lgkmcnt(5)
    v_mfma_f32_16x16x32_bf16 v[112:115], v[200:203], a[32:35], v[112:115]
    ds_read_b64_tr_b16 v[194:195], v219 offset:2048
    v_pk_max_i16 v160, v160, 0
    v_mfma_f32_16x16x32_bf16 v[112:115], v[204:207], a[48:51], v[112:115]
    ds_read_b64_tr_b16 v[196:197], v219 offset:4096
    v_pk_max_i16 v161, v161, 0
    v_mfma_f32_16x16x32_bf16 v[116:119], v[204:207], a[52:55], v[116:119]
    ds_read_b64_tr_b16 v[198:199], v219 offset:6144
    v_mul_f32 v36, v235, v36
    v_mfma_f32_16x16x32_bf16 v[116:119], v[200:203], a[36:39], v[116:119]
    v_mfma_f32_16x16x32_bf16 v[120:123], v[200:203], a[40:43], v[120:123]
    v_mul_f32 v37, v235, v37
    v_mfma_f32_16x16x32_bf16 v[120:123], v[204:207], a[56:59], v[120:123]
    v_mul_f32 v38, v235, v38
    v_mfma_f32_16x16x32_bf16 v[124:127], v[204:207], a[60:63], v[124:127]
    v_mfma_f32_16x16x32_bf16 v[124:127], v[200:203], a[44:47], v[124:127]
    ds_read_b64_tr_b16 v[200:201], v216 offset:8192
    s_waitcnt lgkmcnt(5)
    v_mfma_f32_16x16x32_bf16 v[128:131], v[208:211], a[32:35], v[128:131]
    ds_read_b64_tr_b16 v[202:203], v216 offset:10240
    v_mul_f32 v39, v235, v39
    v_mfma_f32_16x16x32_bf16 v[128:131], v[212:215], a[48:51], v[128:131]
    ds_read_b64_tr_b16 v[204:205], v216 offset:12288
    s_add_u32 m0, s49, 57344
    v_mfma_f32_16x16x32_bf16 v[132:135], v[212:215], a[52:55], v[132:135]
    ds_read_b64_tr_b16 v[206:207], v216 offset:14336
    s_add_u32 s96, s77, 4128896
    v_mfma_f32_16x16x32_bf16 v[132:135], v[208:211], a[36:39], v[132:135]
    buffer_load_dwordx4 v221, s[20:23], s96 offen lds
    v_cvt_pk_bf16_f32 v162, v36, v37
    v_mfma_f32_16x16x32_bf16 v[136:139], v[208:211], a[40:43], v[136:139]
    v_cvt_pk_bf16_f32 v163, v38, v39
    v_pk_max_i16 v162, v162, 0
    v_mfma_f32_16x16x32_bf16 v[136:139], v[212:215], a[56:59], v[136:139]
    v_pk_max_i16 v163, v163, 0
    v_mfma_f32_16x16x32_bf16 v[140:143], v[212:215], a[60:63], v[140:143]
    v_mul_f32 v40, v236, v40
    v_mfma_f32_16x16x32_bf16 v[140:143], v[208:211], a[44:47], v[140:143]
    ds_read_b64_tr_b16 v[208:209], v217 offset:8192
    s_waitcnt lgkmcnt(5)
    v_mfma_f32_16x16x32_bf16 v[144:147], v[192:195], a[32:35], v[144:147]
    ds_read_b64_tr_b16 v[210:211], v217 offset:10240
    v_mul_f32 v41, v236, v41
    v_mfma_f32_16x16x32_bf16 v[144:147], v[196:199], a[48:51], v[144:147]
    ds_read_b64_tr_b16 v[212:213], v217 offset:12288
    v_mul_f32 v42, v236, v42
    v_mfma_f32_16x16x32_bf16 v[148:151], v[196:199], a[52:55], v[148:151]
    ds_read_b64_tr_b16 v[214:215], v217 offset:14336
    v_mul_f32 v43, v236, v43
    v_mfma_f32_16x16x32_bf16 v[148:151], v[192:195], a[36:39], v[148:151]
    v_mfma_f32_16x16x32_bf16 v[152:155], v[192:195], a[40:43], v[152:155]
    v_cvt_pk_bf16_f32 v164, v40, v41
    v_mfma_f32_16x16x32_bf16 v[152:155], v[196:199], a[56:59], v[152:155]
    v_cvt_pk_bf16_f32 v165, v42, v43
    v_mfma_f32_16x16x32_bf16 v[156:159], v[196:199], a[60:63], v[156:159]
    v_mfma_f32_16x16x32_bf16 v[156:159], v[192:195], a[44:47], v[156:159]
    ds_read_b64_tr_b16 v[192:193], v218 offset:8192
    s_waitcnt lgkmcnt(5)
    v_mfma_f32_16x16x32_bf16 v[96:99], v[200:203], a[64:67], v[96:99]
    ds_read_b64_tr_b16 v[194:195], v218 offset:10240
    v_pk_max_i16 v164, v164, 0
    v_mfma_f32_16x16x32_bf16 v[96:99], v[204:207], a[80:83], v[96:99]
    ds_read_b64_tr_b16 v[196:197], v218 offset:12288
    s_add_u32 m0, s49, 61440
    v_mfma_f32_16x16x32_bf16 v[100:103], v[204:207], a[84:87], v[100:103]
    ds_read_b64_tr_b16 v[198:199], v218 offset:14336
    s_add_u32 s96, s77, 4423808
    v_mfma_f32_16x16x32_bf16 v[100:103], v[200:203], a[68:71], v[100:103]
    buffer_load_dwordx4 v221, s[20:23], s96 offen lds
    v_pk_max_i16 v165, v165, 0
    v_mfma_f32_16x16x32_bf16 v[104:107], v[200:203], a[72:75], v[104:107]
    v_mul_f32 v44, v237, v44
    v_mul_f32 v45, v237, v45
    v_mfma_f32_16x16x32_bf16 v[104:107], v[204:207], a[88:91], v[104:107]
    v_mul_f32 v46, v237, v46
    v_mfma_f32_16x16x32_bf16 v[108:111], v[204:207], a[92:95], v[108:111]
    v_mul_f32 v47, v237, v47
    v_mfma_f32_16x16x32_bf16 v[108:111], v[200:203], a[76:79], v[108:111]
    ds_read_b64_tr_b16 v[200:201], v219 offset:8192
    s_waitcnt lgkmcnt(5)
    v_mfma_f32_16x16x32_bf16 v[112:115], v[208:211], a[64:67], v[112:115]
    ds_read_b64_tr_b16 v[202:203], v219 offset:10240
    v_cvt_pk_bf16_f32 v166, v44, v45
    v_mfma_f32_16x16x32_bf16 v[112:115], v[212:215], a[80:83], v[112:115]
    ds_read_b64_tr_b16 v[204:205], v219 offset:12288
    v_cvt_pk_bf16_f32 v167, v46, v47
    v_mfma_f32_16x16x32_bf16 v[116:119], v[212:215], a[84:87], v[116:119]
    ds_read_b64_tr_b16 v[206:207], v219 offset:14336
    v_pk_max_i16 v166, v166, 0
    v_mfma_f32_16x16x32_bf16 v[116:119], v[208:211], a[68:71], v[116:119]
    v_mfma_f32_16x16x32_bf16 v[120:123], v[208:211], a[72:75], v[120:123]
    v_pk_max_i16 v167, v167, 0
    v_mfma_f32_16x16x32_bf16 v[120:123], v[212:215], a[88:91], v[120:123]
    v_mul_f32 v48, v234, v48
    v_mfma_f32_16x16x32_bf16 v[124:127], v[212:215], a[92:95], v[124:127]
    v_mul_f32 v49, v234, v49
    v_mfma_f32_16x16x32_bf16 v[124:127], v[208:211], a[76:79], v[124:127]
    ds_read_b64_tr_b16 v[208:209], v216 offset:16384
    s_waitcnt lgkmcnt(5)
    v_mfma_f32_16x16x32_bf16 v[128:131], v[192:195], a[64:67], v[128:131]
    ds_read_b64_tr_b16 v[210:211], v216 offset:18432
    v_mul_f32 v50, v234, v50
    v_mfma_f32_16x16x32_bf16 v[128:131], v[196:199], a[80:83], v[128:131]
    ds_read_b64_tr_b16 v[212:213], v216 offset:20480
    s_add_u32 m0, s49, 65536
sequential_preLN__linear_kernel_hedgehog__glu_gated_reglu__prompt_kernel_hop1_2:
    s_cbranch_execz sequential_preLN__linear_kernel_hedgehog__glu_gated_reglu__prompt_kernel_hop1_3
    v_mfma_f32_16x16x32_bf16 v[132:135], v[196:199], a[84:87], v[132:135]
    ds_read_b64_tr_b16 v[214:215], v216 offset:22528
    s_add_u32 s96, s77, 128
    v_mfma_f32_16x16x32_bf16 v[132:135], v[192:195], a[68:71], v[132:135]
    buffer_load_dwordx4 v221, s[20:23], s96 offen lds
    v_mul_f32 v51, v234, v51
    v_mfma_f32_16x16x32_bf16 v[136:139], v[192:195], a[72:75], v[136:139]
    s_lshl_b32 s92, s48, 6
    s_lshl_b32 s97, s51, 1
    s_add_u32 s92, s92, s97
    s_add_u32 s92, s92, s55
    v_lshrrev_b32 v247, 4, v232
    v_min_u32 v244, 20, v247
    v_add_u32 v244, 21, v244
    v_min_u32 v244, 40, v244
    v_lshlrev_b32 v244, 7, v244
    s_mul_i32 s92, s92, 5248
    s_mul_i32 s97, s54, 1327104
    s_add_u32 s97, s97, s92
    buffer_load_dword v239, v244, s[28:31], s97 offen
    v_mfma_f32_16x16x32_bf16 v[136:139], v[196:199], a[88:91], v[136:139]
    v_cvt_pk_bf16_f32 v168, v48, v49
    v_cvt_pk_bf16_f32 v169, v50, v51
    v_mfma_f32_16x16x32_bf16 v[140:143], v[196:199], a[92:95], v[140:143]
    v_pk_max_i16 v168, v168, 0
    v_mfma_f32_16x16x32_bf16 v[140:143], v[192:195], a[76:79], v[140:143]
    ds_read_b64_tr_b16 v[192:193], v217 offset:16384
    s_waitcnt lgkmcnt(5)
    v_mfma_f32_16x16x32_bf16 v[144:147], v[200:203], a[64:67], v[144:147]
    ds_read_b64_tr_b16 v[194:195], v217 offset:18432
    v_pk_max_i16 v169, v169, 0
    v_mfma_f32_16x16x32_bf16 v[144:147], v[204:207], a[80:83], v[144:147]
    ds_read_b64_tr_b16 v[196:197], v217 offset:20480
    v_mul_f32 v52, v235, v52
    v_mfma_f32_16x16x32_bf16 v[148:151], v[204:207], a[84:87], v[148:151]
    ds_read_b64_tr_b16 v[198:199], v217 offset:22528
    v_mul_f32 v53, v235, v53
    v_mfma_f32_16x16x32_bf16 v[148:151], v[200:203], a[68:71], v[148:151]
    v_mul_f32 v54, v235, v54
    v_mfma_f32_16x16x32_bf16 v[152:155], v[200:203], a[72:75], v[152:155]
    v_mfma_f32_16x16x32_bf16 v[152:155], v[204:207], a[88:91], v[152:155]
    v_mul_f32 v55, v235, v55
    v_mfma_f32_16x16x32_bf16 v[156:159], v[204:207], a[92:95], v[156:159]
    v_cvt_pk_bf16_f32 v170, v52, v53
    v_mfma_f32_16x16x32_bf16 v[156:159], v[200:203], a[76:79], v[156:159]
    ds_read_b64_tr_b16 v[200:201], v218 offset:16384
    s_waitcnt lgkmcnt(5)
    v_mfma_f32_16x16x32_bf16 v[96:99], v[208:211], a[96:99], v[96:99]
    ds_read_b64_tr_b16 v[202:203], v218 offset:18432
    v_cvt_pk_bf16_f32 v171, v54, v55
    v_mfma_f32_16x16x32_bf16 v[96:99], v[212:215], a[112:115], v[96:99]
    ds_read_b64_tr_b16 v[204:205], v218 offset:20480
    s_add_u32 m0, s49, 69632
    v_mfma_f32_16x16x32_bf16 v[100:103], v[212:215], a[116:119], v[100:103]
    ds_read_b64_tr_b16 v[206:207], v218 offset:22528
    s_add_u32 s96, s77, 295040
    v_mfma_f32_16x16x32_bf16 v[100:103], v[208:211], a[100:103], v[100:103]
    buffer_load_dwordx4 v221, s[20:23], s96 offen lds
    v_pk_max_i16 v170, v170, 0
    v_mfma_f32_16x16x32_bf16 v[104:107], v[208:211], a[104:107], v[104:107]
    v_pk_max_i16 v171, v171, 0
    v_mul_f32 v56, v236, v56
    v_mfma_f32_16x16x32_bf16 v[104:107], v[212:215], a[120:123], v[104:107]
    v_mfma_f32_16x16x32_bf16 v[108:111], v[212:215], a[124:127], v[108:111]
    v_mul_f32 v57, v236, v57
    v_mfma_f32_16x16x32_bf16 v[108:111], v[208:211], a[108:111], v[108:111]
    ds_read_b64_tr_b16 v[208:209], v219 offset:16384
    s_waitcnt lgkmcnt(5)
    v_mfma_f32_16x16x32_bf16 v[112:115], v[192:195], a[96:99], v[112:115]
    ds_read_b64_tr_b16 v[210:211], v219 offset:18432
    v_mul_f32 v58, v236, v58
    v_mfma_f32_16x16x32_bf16 v[112:115], v[196:199], a[112:115], v[112:115]
    ds_read_b64_tr_b16 v[212:213], v219 offset:20480
    v_mul_f32 v59, v236, v59
    v_mfma_f32_16x16x32_bf16 v[116:119], v[196:199], a[116:119], v[116:119]
    ds_read_b64_tr_b16 v[214:215], v219 offset:22528
    v_cvt_pk_bf16_f32 v172, v56, v57
    v_mfma_f32_16x16x32_bf16 v[116:119], v[192:195], a[100:103], v[116:119]
    v_cvt_pk_bf16_f32 v173, v58, v59
    v_mfma_f32_16x16x32_bf16 v[120:123], v[192:195], a[104:107], v[120:123]
    v_mfma_f32_16x16x32_bf16 v[120:123], v[196:199], a[120:123], v[120:123]
    v_pk_max_i16 v172, v172, 0
    v_mfma_f32_16x16x32_bf16 v[124:127], v[196:199], a[124:127], v[124:127]
    v_pk_max_i16 v173, v173, 0
    v_mfma_f32_16x16x32_bf16 v[124:127], v[192:195], a[108:111], v[124:127]
    s_waitcnt vmcnt(9)
    s_waitcnt lgkmcnt(0)
    s_barrier
    v_mfma_f32_16x16x32_bf16 v[128:131], v[200:203], a[96:99], v[128:131]
    v_subrev_u32 v216, 24576, v216
    v_subrev_u32 v217, 24576, v217
    v_mfma_f32_16x16x32_bf16 v[128:131], v[204:207], a[112:115], v[128:131]
    v_subrev_u32 v218, 24576, v218
    v_subrev_u32 v219, 24576, v219
    v_mfma_f32_16x16x32_bf16 v[132:135], v[204:207], a[116:119], v[132:135]
    ds_read_b64_tr_b16 v[192:193], v216 offset:0
    ds_read_b64_tr_b16 v[194:195], v216 offset:2048
    v_mfma_f32_16x16x32_bf16 v[132:135], v[200:203], a[100:103], v[132:135]
    ds_read_b64_tr_b16 v[196:197], v216 offset:4096
    ds_read_b64_tr_b16 v[198:199], v216 offset:6144
    v_mfma_f32_16x16x32_bf16 v[136:139], v[200:203], a[104:107], v[136:139]
    s_add_u32 m0, s49, 24576
    s_add_u32 s96, s77, 589952
    v_mfma_f32_16x16x32_bf16 v[136:139], v[204:207], a[120:123], v[136:139]
    buffer_load_dwordx4 v221, s[20:23], s96 offen lds
    v_mul_f32 v60, v237, v60
    v_mfma_f32_16x16x32_bf16 v[140:143], v[204:207], a[124:127], v[140:143]
    v_mul_f32 v61, v237, v61
    v_mul_f32 v62, v237, v62
    v_mfma_f32_16x16x32_bf16 v[140:143], v[200:203], a[108:111], v[140:143]
    ds_read_b64_tr_b16 v[200:201], v217 offset:0
    v_mfma_f32_16x16x32_bf16 v[144:147], v[208:211], a[96:99], v[144:147]
    ds_read_b64_tr_b16 v[202:203], v217 offset:2048
    v_mul_f32 v63, v237, v63
    v_mfma_f32_16x16x32_bf16 v[144:147], v[212:215], a[112:115], v[144:147]
    ds_read_b64_tr_b16 v[204:205], v217 offset:4096
    v_cvt_pk_bf16_f32 v174, v60, v61
    v_mfma_f32_16x16x32_bf16 v[148:151], v[212:215], a[116:119], v[148:151]
    ds_read_b64_tr_b16 v[206:207], v217 offset:6144
    v_cvt_pk_bf16_f32 v175, v62, v63
    v_mfma_f32_16x16x32_bf16 v[148:151], v[208:211], a[100:103], v[148:151]
    v_pk_max_i16 v174, v174, 0
    v_pk_max_i16 v175, v175, 0
    v_mfma_f32_16x16x32_bf16 v[152:155], v[208:211], a[104:107], v[152:155]
    v_mul_f32 v64, v234, v64
    v_mfma_f32_16x16x32_bf16 v[152:155], v[212:215], a[120:123], v[152:155]
    v_mul_f32 v65, v234, v65
    v_mfma_f32_16x16x32_bf16 v[156:159], v[212:215], a[124:127], v[156:159]
    v_mul_f32 v66, v234, v66
    v_mfma_f32_16x16x32_bf16 v[156:159], v[208:211], a[108:111], v[156:159]
    ds_read_b64_tr_b16 v[208:209], v218 offset:0
    s_waitcnt lgkmcnt(5)
    v_mfma_f32_16x16x32_bf16 v[96:99], v[192:195], a[128:131], v[96:99]
    ds_read_b64_tr_b16 v[210:211], v218 offset:2048
    v_mul_f32 v67, v234, v67
    v_mfma_f32_16x16x32_bf16 v[96:99], v[196:199], a[144:147], v[96:99]
    ds_read_b64_tr_b16 v[212:213], v218 offset:4096
    s_add_u32 m0, s49, 28672
    v_mfma_f32_16x16x32_bf16 v[100:103], v[196:199], a[148:151], v[100:103]
    ds_read_b64_tr_b16 v[214:215], v218 offset:6144
    s_add_u32 s96, s77, 884864
    v_mfma_f32_16x16x32_bf16 v[100:103], v[192:195], a[132:135], v[100:103]
    buffer_load_dwordx4 v221, s[20:23], s96 offen lds
    v_cvt_pk_bf16_f32 v176, v64, v65
    v_mfma_f32_16x16x32_bf16 v[104:107], v[192:195], a[136:139], v[104:107]
    v_cvt_pk_bf16_f32 v177, v66, v67
    v_pk_max_i16 v176, v176, 0
    v_mfma_f32_16x16x32_bf16 v[104:107], v[196:199], a[152:155], v[104:107]
    v_pk_max_i16 v177, v177, 0
    v_mfma_f32_16x16x32_bf16 v[108:111], v[196:199], a[156:159], v[108:111]
    v_mfma_f32_16x16x32_bf16 v[108:111], v[192:195], a[140:143], v[108:111]
    ds_read_b64_tr_b16 v[192:193], v219 offset:0
    s_waitcnt lgkmcnt(5)
    v_mfma_f32_16x16x32_bf16 v[112:115], v[200:203], a[128:131], v[112:115]
    ds_read_b64_tr_b16 v[194:195], v219 offset:2048
    v_mul_f32 v68, v235, v68
    v_mfma_f32_16x16x32_bf16 v[112:115], v[204:207], a[144:147], v[112:115]
    ds_read_b64_tr_b16 v[196:197], v219 offset:4096
    v_mul_f32 v69, v235, v69
    v_mfma_f32_16x16x32_bf16 v[116:119], v[204:207], a[148:151], v[116:119]
    ds_read_b64_tr_b16 v[198:199], v219 offset:6144
    v_mul_f32 v70, v235, v70
    v_mfma_f32_16x16x32_bf16 v[116:119], v[200:203], a[132:135], v[116:119]
    v_mul_f32 v71, v235, v71
    v_mfma_f32_16x16x32_bf16 v[120:123], v[200:203], a[136:139], v[120:123]
    v_cvt_pk_bf16_f32 v178, v68, v69
    v_mfma_f32_16x16x32_bf16 v[120:123], v[204:207], a[152:155], v[120:123]
    v_mfma_f32_16x16x32_bf16 v[124:127], v[204:207], a[156:159], v[124:127]
    v_cvt_pk_bf16_f32 v179, v70, v71
    v_mfma_f32_16x16x32_bf16 v[124:127], v[200:203], a[140:143], v[124:127]
    ds_read_b64_tr_b16 v[200:201], v216 offset:8192
    s_waitcnt lgkmcnt(5)
    v_mfma_f32_16x16x32_bf16 v[128:131], v[208:211], a[128:131], v[128:131]
    ds_read_b64_tr_b16 v[202:203], v216 offset:10240
    v_pk_max_i16 v178, v178, 0
    v_mfma_f32_16x16x32_bf16 v[128:131], v[212:215], a[144:147], v[128:131]
    ds_read_b64_tr_b16 v[204:205], v216 offset:12288
    s_add_u32 m0, s49, 32768
    v_mfma_f32_16x16x32_bf16 v[132:135], v[212:215], a[148:151], v[132:135]
    ds_read_b64_tr_b16 v[206:207], v216 offset:14336
    s_add_u32 s96, s77, 1179776
    v_mfma_f32_16x16x32_bf16 v[132:135], v[208:211], a[132:135], v[132:135]
    buffer_load_dwordx4 v221, s[20:23], s96 offen lds
    v_pk_max_i16 v179, v179, 0
    v_mfma_f32_16x16x32_bf16 v[136:139], v[208:211], a[136:139], v[136:139]
    v_mul_f32 v72, v236, v72
    v_mul_f32 v73, v236, v73
    v_mfma_f32_16x16x32_bf16 v[136:139], v[212:215], a[152:155], v[136:139]
    v_mul_f32 v74, v236, v74
    v_mfma_f32_16x16x32_bf16 v[140:143], v[212:215], a[156:159], v[140:143]
    v_mfma_f32_16x16x32_bf16 v[140:143], v[208:211], a[140:143], v[140:143]
    ds_read_b64_tr_b16 v[208:209], v217 offset:8192
    s_waitcnt lgkmcnt(5)
    v_mfma_f32_16x16x32_bf16 v[144:147], v[192:195], a[128:131], v[144:147]
    ds_read_b64_tr_b16 v[210:211], v217 offset:10240
    v_mul_f32 v75, v236, v75
    v_mfma_f32_16x16x32_bf16 v[144:147], v[196:199], a[144:147], v[144:147]
    ds_read_b64_tr_b16 v[212:213], v217 offset:12288
    v_cvt_pk_bf16_f32 v180, v72, v73
    v_mfma_f32_16x16x32_bf16 v[148:151], v[196:199], a[148:151], v[148:151]
    ds_read_b64_tr_b16 v[214:215], v217 offset:14336
    v_cvt_pk_bf16_f32 v181, v74, v75
    v_mfma_f32_16x16x32_bf16 v[148:151], v[192:195], a[132:135], v[148:151]
    v_pk_max_i16 v180, v180, 0
    v_mfma_f32_16x16x32_bf16 v[152:155], v[192:195], a[136:139], v[152:155]
    v_pk_max_i16 v181, v181, 0
    v_mfma_f32_16x16x32_bf16 v[152:155], v[196:199], a[152:155], v[152:155]
    v_mfma_f32_16x16x32_bf16 v[156:159], v[196:199], a[156:159], v[156:159]
    v_mul_f32 v76, v237, v76
    v_mfma_f32_16x16x32_bf16 v[156:159], v[192:195], a[140:143], v[156:159]
    ds_read_b64_tr_b16 v[192:193], v218 offset:8192
    s_waitcnt lgkmcnt(5)
    v_mfma_f32_16x16x32_bf16 v[96:99], v[200:203], a[160:163], v[96:99]
    ds_read_b64_tr_b16 v[194:195], v218 offset:10240
    v_mul_f32 v77, v237, v77
    v_mfma_f32_16x16x32_bf16 v[96:99], v[204:207], a[176:179], v[96:99]
    ds_read_b64_tr_b16 v[196:197], v218 offset:12288
    s_add_u32 m0, s49, 36864
    v_mfma_f32_16x16x32_bf16 v[100:103], v[204:207], a[180:183], v[100:103]
    ds_read_b64_tr_b16 v[198:199], v218 offset:14336
    s_add_u32 s96, s77, 1474688
    v_mfma_f32_16x16x32_bf16 v[100:103], v[200:203], a[164:167], v[100:103]
    buffer_load_dwordx4 v221, s[20:23], s96 offen lds
    v_mul_f32 v78, v237, v78
    v_mfma_f32_16x16x32_bf16 v[104:107], v[200:203], a[168:171], v[104:107]
    v_mul_f32 v79, v237, v79
    v_cvt_pk_bf16_f32 v182, v76, v77
    v_mfma_f32_16x16x32_bf16 v[104:107], v[204:207], a[184:187], v[104:107]
    v_cvt_pk_bf16_f32 v183, v78, v79
    v_mfma_f32_16x16x32_bf16 v[108:111], v[204:207], a[188:191], v[108:111]
    v_pk_max_i16 v182, v182, 0
    v_mfma_f32_16x16x32_bf16 v[108:111], v[200:203], a[172:175], v[108:111]
    ds_read_b64_tr_b16 v[200:201], v219 offset:8192
    s_waitcnt lgkmcnt(5)
    v_mfma_f32_16x16x32_bf16 v[112:115], v[208:211], a[160:163], v[112:115]
    ds_read_b64_tr_b16 v[202:203], v219 offset:10240
    v_pk_max_i16 v183, v183, 0
    v_mfma_f32_16x16x32_bf16 v[112:115], v[212:215], a[176:179], v[112:115]
    ds_read_b64_tr_b16 v[204:205], v219 offset:12288
    v_mul_f32 v80, v234, v80
    v_mfma_f32_16x16x32_bf16 v[116:119], v[212:215], a[180:183], v[116:119]
    ds_read_b64_tr_b16 v[206:207], v219 offset:14336
    v_mfma_f32_16x16x32_bf16 v[116:119], v[208:211], a[164:167], v[116:119]
    v_mul_f32 v81, v234, v81
    v_mfma_f32_16x16x32_bf16 v[120:123], v[208:211], a[168:171], v[120:123]
    v_mul_f32 v82, v234, v82
    v_mfma_f32_16x16x32_bf16 v[120:123], v[212:215], a[184:187], v[120:123]
    v_mfma_f32_16x16x32_bf16 v[124:127], v[212:215], a[188:191], v[124:127]
    v_mul_f32 v83, v234, v83
    v_mfma_f32_16x16x32_bf16 v[124:127], v[208:211], a[172:175], v[124:127]
    ds_read_b64_tr_b16 v[208:209], v216 offset:16384
    s_waitcnt lgkmcnt(5)
    v_mfma_f32_16x16x32_bf16 v[128:131], v[192:195], a[160:163], v[128:131]
    ds_read_b64_tr_b16 v[210:211], v216 offset:18432
    v_cvt_pk_bf16_f32 v184, v80, v81
    v_mfma_f32_16x16x32_bf16 v[128:131], v[196:199], a[176:179], v[128:131]
    ds_read_b64_tr_b16 v[212:213], v216 offset:20480
    s_add_u32 m0, s49, 40960
    v_mfma_f32_16x16x32_bf16 v[132:135], v[196:199], a[180:183], v[132:135]
    ds_read_b64_tr_b16 v[214:215], v216 offset:22528
    s_add_u32 s96, s77, 1769600
    v_mfma_f32_16x16x32_bf16 v[132:135], v[192:195], a[164:167], v[132:135]
    buffer_load_dwordx4 v221, s[20:23], s96 offen lds
    v_cvt_pk_bf16_f32 v185, v82, v83
    v_mfma_f32_16x16x32_bf16 v[136:139], v[192:195], a[168:171], v[136:139]
    v_pk_max_i16 v184, v184, 0
    v_pk_max_i16 v185, v185, 0
    v_mfma_f32_16x16x32_bf16 v[136:139], v[196:199], a[184:187], v[136:139]
    v_mul_f32 v84, v235, v84
    v_mfma_f32_16x16x32_bf16 v[140:143], v[196:199], a[188:191], v[140:143]
    v_mul_f32 v85, v235, v85
    v_mfma_f32_16x16x32_bf16 v[140:143], v[192:195], a[172:175], v[140:143]
    ds_read_b64_tr_b16 v[192:193], v217 offset:16384
    s_waitcnt lgkmcnt(5)
    v_mfma_f32_16x16x32_bf16 v[144:147], v[200:203], a[160:163], v[144:147]
    ds_read_b64_tr_b16 v[194:195], v217 offset:18432
    v_mul_f32 v86, v235, v86
    v_mfma_f32_16x16x32_bf16 v[144:147], v[204:207], a[176:179], v[144:147]
    ds_read_b64_tr_b16 v[196:197], v217 offset:20480
    v_mul_f32 v87, v235, v87
    v_mfma_f32_16x16x32_bf16 v[148:151], v[204:207], a[180:183], v[148:151]
    ds_read_b64_tr_b16 v[198:199], v217 offset:22528
    v_mfma_f32_16x16x32_bf16 v[148:151], v[200:203], a[164:167], v[148:151]
    v_cvt_pk_bf16_f32 v186, v84, v85
    v_mfma_f32_16x16x32_bf16 v[152:155], v[200:203], a[168:171], v[152:155]
    v_cvt_pk_bf16_f32 v187, v86, v87
    v_mfma_f32_16x16x32_bf16 v[152:155], v[204:207], a[184:187], v[152:155]
    v_mfma_f32_16x16x32_bf16 v[156:159], v[204:207], a[188:191], v[156:159]
    v_pk_max_i16 v186, v186, 0
    v_mfma_f32_16x16x32_bf16 v[156:159], v[200:203], a[172:175], v[156:159]
    ds_read_b64_tr_b16 v[200:201], v218 offset:16384
    s_waitcnt lgkmcnt(5)
    v_mfma_f32_16x16x32_bf16 v[96:99], v[208:211], a[192:195], v[96:99]
    ds_read_b64_tr_b16 v[202:203], v218 offset:18432
    v_pk_max_i16 v187, v187, 0
    v_mfma_f32_16x16x32_bf16 v[96:99], v[212:215], a[208:211], v[96:99]
    ds_read_b64_tr_b16 v[204:205], v218 offset:20480
    s_add_u32 m0, s49, 45056
    v_mfma_f32_16x16x32_bf16 v[100:103], v[212:215], a[212:215], v[100:103]
    ds_read_b64_tr_b16 v[206:207], v218 offset:22528
    s_add_u32 s96, s77, 2064512
    v_mfma_f32_16x16x32_bf16 v[100:103], v[208:211], a[196:199], v[100:103]
    buffer_load_dwordx4 v221, s[20:23], s96 offen lds
    v_mul_f32 v88, v236, v88
    v_mfma_f32_16x16x32_bf16 v[104:107], v[208:211], a[200:203], v[104:107]
    v_mul_f32 v89, v236, v89
    v_mul_f32 v90, v236, v90
    v_mfma_f32_16x16x32_bf16 v[104:107], v[212:215], a[216:219], v[104:107]
    v_mul_f32 v91, v236, v91
    v_mfma_f32_16x16x32_bf16 v[108:111], v[212:215], a[220:223], v[108:111]
    v_cvt_pk_bf16_f32 v188, v88, v89
    v_mfma_f32_16x16x32_bf16 v[108:111], v[208:211], a[204:207], v[108:111]
    ds_read_b64_tr_b16 v[208:209], v219 offset:16384
    s_waitcnt lgkmcnt(5)
    v_mfma_f32_16x16x32_bf16 v[112:115], v[192:195], a[192:195], v[112:115]
    ds_read_b64_tr_b16 v[210:211], v219 offset:18432
    v_cvt_pk_bf16_f32 v189, v90, v91
    v_mfma_f32_16x16x32_bf16 v[112:115], v[196:199], a[208:211], v[112:115]
    ds_read_b64_tr_b16 v[212:213], v219 offset:20480
    v_pk_max_i16 v188, v188, 0
    v_mfma_f32_16x16x32_bf16 v[116:119], v[196:199], a[212:215], v[116:119]
    ds_read_b64_tr_b16 v[214:215], v219 offset:22528
    v_mfma_f32_16x16x32_bf16 v[116:119], v[192:195], a[196:199], v[116:119]
    v_pk_max_i16 v189, v189, 0
    v_mfma_f32_16x16x32_bf16 v[120:123], v[192:195], a[200:203], v[120:123]
    v_mul_f32 v92, v237, v92
    v_mfma_f32_16x16x32_bf16 v[120:123], v[196:199], a[216:219], v[120:123]
    v_mul_f32 v93, v237, v93
    v_mfma_f32_16x16x32_bf16 v[124:127], v[196:199], a[220:223], v[124:127]
    v_mfma_f32_16x16x32_bf16 v[124:127], v[192:195], a[204:207], v[124:127]
    s_waitcnt vmcnt(6)
    s_waitcnt lgkmcnt(0)
    s_barrier
    v_mfma_f32_16x16x32_bf16 v[128:131], v[200:203], a[192:195], v[128:131]
    v_add_u32 v216, 49152, v216
    v_add_u32 v217, 49152, v217
    v_mfma_f32_16x16x32_bf16 v[128:131], v[204:207], a[208:211], v[128:131]
    v_add_u32 v218, 49152, v218
    v_add_u32 v219, 49152, v219
    v_mfma_f32_16x16x32_bf16 v[132:135], v[204:207], a[212:215], v[132:135]
    ds_read_b64_tr_b16 v[192:193], v216 offset:0
    ds_read_b64_tr_b16 v[194:195], v216 offset:2048
    v_mfma_f32_16x16x32_bf16 v[132:135], v[200:203], a[196:199], v[132:135]
    ds_read_b64_tr_b16 v[196:197], v216 offset:4096
    ds_read_b64_tr_b16 v[198:199], v216 offset:6144
    v_mfma_f32_16x16x32_bf16 v[136:139], v[200:203], a[200:203], v[136:139]
    s_add_u32 m0, s49, 0
    s_add_u32 s96, s77, 2359424
    v_mfma_f32_16x16x32_bf16 v[136:139], v[204:207], a[216:219], v[136:139]
    buffer_load_dwordx4 v221, s[20:23], s96 offen lds
    v_mul_f32 v94, v237, v94
    v_mfma_f32_16x16x32_bf16 v[140:143], v[204:207], a[220:223], v[140:143]
    v_mul_f32 v95, v237, v95
    v_cvt_pk_bf16_f32 v190, v92, v93
    v_mfma_f32_16x16x32_bf16 v[140:143], v[200:203], a[204:207], v[140:143]
    ds_read_b64_tr_b16 v[200:201], v217 offset:0
    v_mfma_f32_16x16x32_bf16 v[144:147], v[208:211], a[192:195], v[144:147]
    ds_read_b64_tr_b16 v[202:203], v217 offset:2048
    v_cvt_pk_bf16_f32 v191, v94, v95
    v_mfma_f32_16x16x32_bf16 v[144:147], v[212:215], a[208:211], v[144:147]
    ds_read_b64_tr_b16 v[204:205], v217 offset:4096
    v_pk_max_i16 v190, v190, 0
    v_mfma_f32_16x16x32_bf16 v[148:151], v[212:215], a[212:215], v[148:151]
    ds_read_b64_tr_b16 v[206:207], v217 offset:6144
    v_pk_max_i16 v191, v191, 0
    v_mfma_f32_16x16x32_bf16 v[148:151], v[208:211], a[196:199], v[148:151]
    v_mfma_f32_16x16x32_bf16 v[152:155], v[208:211], a[200:203], v[152:155]
    v_mfma_f32_16x16x32_bf16 v[152:155], v[212:215], a[216:219], v[152:155]
    v_mfma_f32_16x16x32_bf16 v[156:159], v[212:215], a[220:223], v[156:159]
    v_mfma_f32_16x16x32_bf16 v[156:159], v[208:211], a[204:207], v[156:159]
    ds_read_b64_tr_b16 v[208:209], v218 offset:0
    s_waitcnt lgkmcnt(5)
    v_mfma_f32_16x16x32_bf16 v[32:35], v[192:195], v[0:3], 0
    ds_read_b64_tr_b16 v[210:211], v218 offset:2048
    v_mfma_f32_16x16x32_bf16 v[32:35], v[196:199], v[16:19], v[32:35]
    ds_read_b64_tr_b16 v[212:213], v218 offset:4096
    s_add_u32 m0, s49, 4096
    v_mfma_f32_16x16x32_bf16 v[36:39], v[196:199], v[20:23], 0
    ds_read_b64_tr_b16 v[214:215], v218 offset:6144
    s_add_u32 s96, s77, 2654336
    v_mfma_f32_16x16x32_bf16 v[36:39], v[192:195], v[4:7], v[36:39]
    buffer_load_dwordx4 v221, s[20:23], s96 offen lds
    v_lshlrev_b32 v245, 16, v160
    v_mfma_f32_16x16x32_bf16 v[40:43], v[192:195], v[8:11], 0
    v_and_b32 v246, 0xffff0000, v160
    v_mfma_f32_16x16x32_bf16 v[40:43], v[196:199], v[24:27], v[40:43]
    v_mul_f32 v245, v245, v96
    v_mfma_f32_16x16x32_bf16 v[44:47], v[196:199], v[28:31], 0
    v_mul_f32 v246, v246, v97
    v_mfma_f32_16x16x32_bf16 v[44:47], v[192:195], v[12:15], v[44:47]
    ds_read_b64_tr_b16 v[192:193], v219 offset:0
    s_waitcnt lgkmcnt(5)
    v_mfma_f32_16x16x32_bf16 v[48:51], v[200:203], v[0:3], 0
    ds_read_b64_tr_b16 v[194:195], v219 offset:2048
    v_cvt_pk_bf16_f32 v248, v245, v246
    v_mfma_f32_16x16x32_bf16 v[48:51], v[204:207], v[16:19], v[48:51]
    ds_read_b64_tr_b16 v[196:197], v219 offset:4096
    v_lshlrev_b32 v245, 16, v161
    v_mfma_f32_16x16x32_bf16 v[52:55], v[204:207], v[20:23], 0
    ds_read_b64_tr_b16 v[198:199], v219 offset:6144
    v_and_b32 v246, 0xffff0000, v161
    v_mfma_f32_16x16x32_bf16 v[52:55], v[200:203], v[4:7], v[52:55]
    v_mul_f32 v245, v245, v98
    v_mfma_f32_16x16x32_bf16 v[56:59], v[200:203], v[8:11], 0
    v_mul_f32 v246, v246, v99
    v_mfma_f32_16x16x32_bf16 v[56:59], v[204:207], v[24:27], v[56:59]
    v_cvt_pk_bf16_f32 v249, v245, v246
    v_mfma_f32_16x16x32_bf16 v[60:63], v[204:207], v[28:31], 0
    v_lshlrev_b32 v245, 16, v168
    v_mfma_f32_16x16x32_bf16 v[60:63], v[200:203], v[12:15], v[60:63]
    ds_read_b64_tr_b16 v[200:201], v216 offset:8192
    s_waitcnt lgkmcnt(5)
    v_mfma_f32_16x16x32_bf16 v[64:67], v[208:211], v[0:3], 0
    ds_read_b64_tr_b16 v[202:203], v216 offset:10240
    v_and_b32 v246, 0xffff0000, v168
    v_mfma_f32_16x16x32_bf16 v[64:67], v[212:215], v[16:19], v[64:67]
    ds_read_b64_tr_b16 v[204:205], v216 offset:12288
    s_add_u32 m0, s49, 8192
    v_mfma_f32_16x16x32_bf16 v[68:71], v[212:215], v[20:23], 0
    ds_read_b64_tr_b16 v[206:207], v216 offset:14336
    s_add_u32 s96, s77, 2949248
    v_mfma_f32_16x16x32_bf16 v[68:71], v[208:211], v[4:7], v[68:71]
    buffer_load_dwordx4 v221, s[20:23], s96 offen lds
    v_mul_f32 v245, v245, v112
    v_mfma_f32_16x16x32_bf16 v[72:75], v[208:211], v[8:11], 0
    v_mul_f32 v246, v246, v113
    v_cvt_pk_bf16_f32 v250, v245, v246
    v_mfma_f32_16x16x32_bf16 v[72:75], v[212:215], v[24:27], v[72:75]
    v_lshlrev_b32 v245, 16, v169
    v_and_b32 v246, 0xffff0000, v169
    v_mfma_f32_16x16x32_bf16 v[76:79], v[212:215], v[28:31], 0
    v_mul_f32 v245, v245, v114
    v_mfma_f32_16x16x32_bf16 v[76:79], v[208:211], v[12:15], v[76:79]
    ds_read_b64_tr_b16 v[208:209], v217 offset:8192
    s_waitcnt lgkmcnt(5)
    v_mfma_f32_16x16x32_bf16 v[80:83], v[192:195], v[0:3], 0
    ds_read_b64_tr_b16 v[210:211], v217 offset:10240
    v_mul_f32 v246, v246, v115
    v_mfma_f32_16x16x32_bf16 v[80:83], v[196:199], v[16:19], v[80:83]
    ds_read_b64_tr_b16 v[212:213], v217 offset:12288
    v_cvt_pk_bf16_f32 v251, v245, v246
    v_mfma_f32_16x16x32_bf16 v[84:87], v[196:199], v[20:23], 0
    ds_read_b64_tr_b16 v[214:215], v217 offset:14336
    s_add_u32 s95, s82, 0
    v_mfma_f32_16x16x32_bf16 v[84:87], v[192:195], v[4:7], v[84:87]
    buffer_store_dwordx4 v[248:251], v232, s[36:39], s95 offen offset:0 sc1
    v_mfma_f32_16x16x32_bf16 v[88:91], v[192:195], v[8:11], 0
    v_lshlrev_b32 v245, 16, v176
    v_mfma_f32_16x16x32_bf16 v[88:91], v[196:199], v[24:27], v[88:91]
    v_and_b32 v246, 0xffff0000, v176
    v_mfma_f32_16x16x32_bf16 v[92:95], v[196:199], v[28:31], 0
    v_mul_f32 v245, v245, v128
    v_mfma_f32_16x16x32_bf16 v[92:95], v[192:195], v[12:15], v[92:95]
    ds_read_b64_tr_b16 v[192:193], v218 offset:8192
    s_waitcnt lgkmcnt(5)
    v_mfma_f32_16x16x32_bf16 v[32:35], v[200:203], a[224:227], v[32:35]
    ds_read_b64_tr_b16 v[194:195], v218 offset:10240
    v_mul_f32 v246, v246, v129
    v_mfma_f32_16x16x32_bf16 v[32:35], v[204:207], a[240:243], v[32:35]
    ds_read_b64_tr_b16 v[196:197], v218 offset:12288
    s_add_u32 m0, s49, 12288
    v_mfma_f32_16x16x32_bf16 v[36:39], v[204:207], a[244:247], v[36:39]
    ds_read_b64_tr_b16 v[198:199], v218 offset:14336
    s_add_u32 s96, s77, 3244160
    v_mfma_f32_16x16x32_bf16 v[36:39], v[200:203], a[228:231], v[36:39]
    buffer_load_dwordx4 v221, s[20:23], s96 offen lds
    v_cvt_pk_bf16_f32 v252, v245, v246
    v_mfma_f32_16x16x32_bf16 v[40:43], v[200:203], a[232:235], v[40:43]
    v_lshlrev_b32 v245, 16, v177
    v_and_b32 v246, 0xffff0000, v177
    v_mfma_f32_16x16x32_bf16 v[40:43], v[204:207], a[248:251], v[40:43]
    v_mul_f32 v245, v245, v130
    v_mul_f32 v246, v246, v131
    v_mfma_f32_16x16x32_bf16 v[44:47], v[204:207], a[252:255], v[44:47]
    v_cvt_pk_bf16_f32 v253, v245, v246
    v_mfma_f32_16x16x32_bf16 v[44:47], v[200:203], a[236:239], v[44:47]
    ds_read_b64_tr_b16 v[200:201], v219 offset:8192
    s_waitcnt lgkmcnt(5)
    v_mfma_f32_16x16x32_bf16 v[48:51], v[208:211], a[224:227], v[48:51]
    ds_read_b64_tr_b16 v[202:203], v219 offset:10240
    v_lshlrev_b32 v245, 16, v184
    v_mfma_f32_16x16x32_bf16 v[48:51], v[212:215], a[240:243], v[48:51]
    ds_read_b64_tr_b16 v[204:205], v219 offset:12288
    v_and_b32 v246, 0xffff0000, v184
    v_mfma_f32_16x16x32_bf16 v[52:55], v[212:215], a[244:247], v[52:55]
    ds_read_b64_tr_b16 v[206:207], v219 offset:14336
    v_mul_f32 v245, v245, v144
    v_mfma_f32_16x16x32_bf16 v[52:55], v[208:211], a[228:231], v[52:55]
    v_mul_f32 v246, v246, v145
    v_mfma_f32_16x16x32_bf16 v[56:59], v[208:211], a[232:235], v[56:59]
    v_cvt_pk_bf16_f32 v254, v245, v246
    v_mfma_f32_16x16x32_bf16 v[56:59], v[212:215], a[248:251], v[56:59]
    v_lshlrev_b32 v245, 16, v185
    v_mfma_f32_16x16x32_bf16 v[60:63], v[212:215], a[252:255], v[60:63]
    v_and_b32 v246, 0xffff0000, v185
    v_mfma_f32_16x16x32_bf16 v[60:63], v[208:211], a[236:239], v[60:63]
    ds_read_b64_tr_b16 v[208:209], v216 offset:16384
    s_waitcnt lgkmcnt(5)
    v_mfma_f32_16x16x32_bf16 v[64:67], v[192:195], a[224:227], v[64:67]
    ds_read_b64_tr_b16 v[210:211], v216 offset:18432
    v_mul_f32 v245, v245, v146
    v_mfma_f32_16x16x32_bf16 v[64:67], v[196:199], a[240:243], v[64:67]
    ds_read_b64_tr_b16 v[212:213], v216 offset:20480
    s_add_u32 m0, s49, 16384
    v_mfma_f32_16x16x32_bf16 v[68:71], v[196:199], a[244:247], v[68:71]
    ds_read_b64_tr_b16 v[214:215], v216 offset:22528
    s_add_u32 s96, s77, 3539072
    v_mfma_f32_16x16x32_bf16 v[68:71], v[192:195], a[228:231], v[68:71]
    buffer_load_dwordx4 v221, s[20:23], s96 offen lds
    v_mul_f32 v246, v246, v147
    v_mfma_f32_16x16x32_bf16 v[72:75], v[192:195], a[232:235], v[72:75]
    v_cvt_pk_bf16_f32 v255, v245, v246
    buffer_store_dwordx4 v[252:255], v232, s[36:39], s95 offen offset:1024 sc1
    v_mfma_f32_16x16x32_bf16 v[72:75], v[196:199], a[248:251], v[72:75]
    v_lshlrev_b32 v245, 16, v162
    v_and_b32 v246, 0xffff0000, v162
    v_mfma_f32_16x16x32_bf16 v[76:79], v[196:199], a[252:255], v[76:79]
    v_mul_f32 v245, v245, v100
    v_mfma_f32_16x16x32_bf16 v[76:79], v[192:195], a[236:239], v[76:79]
    ds_read_b64_tr_b16 v[192:193], v217 offset:16384
    s_waitcnt lgkmcnt(5)
    v_mfma_f32_16x16x32_bf16 v[80:83], v[200:203], a[224:227], v[80:83]
    ds_read_b64_tr_b16 v[194:195], v217 offset:18432
    v_mul_f32 v246, v246, v101
    v_mfma_f32_16x16x32_bf16 v[80:83], v[204:207], a[240:243], v[80:83]
    ds_read_b64_tr_b16 v[196:197], v217 offset:20480
    v_cvt_pk_bf16_f32 v248, v245, v246
    v_mfma_f32_16x16x32_bf16 v[84:87], v[204:207], a[244:247], v[84:87]
    ds_read_b64_tr_b16 v[198:199], v217 offset:22528
    v_lshlrev_b32 v245, 16, v163
    v_mfma_f32_16x16x32_bf16 v[84:87], v[200:203], a[228:231], v[84:87]
    v_and_b32 v246, 0xffff0000, v163
    v_mfma_f32_16x16x32_bf16 v[88:91], v[200:203], a[232:235], v[88:91]
    v_mul_f32 v245, v245, v102
    v_mfma_f32_16x16x32_bf16 v[88:91], v[204:207], a[248:251], v[88:91]
    v_mul_f32 v246, v246, v103
    v_mfma_f32_16x16x32_bf16 v[92:95], v[204:207], a[252:255], v[92:95]
    v_cvt_pk_bf16_f32 v249, v245, v246
    v_mfma_f32_16x16x32_bf16 v[92:95], v[200:203], a[236:239], v[92:95]
    ds_read_b64_tr_b16 v[200:201], v218 offset:16384
    s_waitcnt lgkmcnt(5)
    v_mfma_f32_16x16x32_bf16 v[32:35], v[208:211], a[0:3], v[32:35]
    ds_read_b64_tr_b16 v[202:203], v218 offset:18432
    v_lshlrev_b32 v245, 16, v170
    v_mfma_f32_16x16x32_bf16 v[32:35], v[212:215], a[16:19], v[32:35]
    ds_read_b64_tr_b16 v[204:205], v218 offset:20480
    s_add_u32 m0, s49, 20480
    v_mfma_f32_16x16x32_bf16 v[36:39], v[212:215], a[20:23], v[36:39]
    ds_read_b64_tr_b16 v[206:207], v218 offset:22528
    s_add_u32 s96, s77, 3833984
    v_mfma_f32_16x16x32_bf16 v[36:39], v[208:211], a[4:7], v[36:39]
    buffer_load_dwordx4 v221, s[20:23], s96 offen lds
    v_and_b32 v246, 0xffff0000, v170
    v_mfma_f32_16x16x32_bf16 v[40:43], v[208:211], a[8:11], v[40:43]
    v_mul_f32 v245, v245, v116
    v_mul_f32 v246, v246, v117
    v_mfma_f32_16x16x32_bf16 v[40:43], v[212:215], a[24:27], v[40:43]
    v_cvt_pk_bf16_f32 v250, v245, v246
    v_lshlrev_b32 v245, 16, v171
    v_mfma_f32_16x16x32_bf16 v[44:47], v[212:215], a[28:31], v[44:47]
    v_and_b32 v246, 0xffff0000, v171
    v_mfma_f32_16x16x32_bf16 v[44:47], v[208:211], a[12:15], v[44:47]
    ds_read_b64_tr_b16 v[208:209], v219 offset:16384
    s_waitcnt lgkmcnt(5)
    v_mfma_f32_16x16x32_bf16 v[48:51], v[192:195], a[0:3], v[48:51]
    ds_read_b64_tr_b16 v[210:211], v219 offset:18432
    v_mul_f32 v245, v245, v118
    v_mfma_f32_16x16x32_bf16 v[48:51], v[196:199], a[16:19], v[48:51]
    ds_read_b64_tr_b16 v[212:213], v219 offset:20480
    v_mul_f32 v246, v246, v119
    v_mfma_f32_16x16x32_bf16 v[52:55], v[196:199], a[20:23], v[52:55]
    ds_read_b64_tr_b16 v[214:215], v219 offset:22528
sequential_preLN__linear_kernel_hedgehog__glu_gated_reglu__prompt_kernel_hop1_3:
    s_cbranch_execz sequential_preLN__linear_kernel_hedgehog__glu_gated_reglu__prompt_kernel_hop1_4
    v_cvt_pk_bf16_f32 v251, v245, v246
    v_mfma_f32_16x16x32_bf16 v[52:55], v[192:195], a[4:7], v[52:55]
    s_add_u32 s95, s82, 147456
    v_mfma_f32_16x16x32_bf16 v[56:59], v[192:195], a[8:11], v[56:59]
    buffer_store_dwordx4 v[248:251], v232, s[36:39], s95 offen offset:0 sc1
    v_mfma_f32_16x16x32_bf16 v[56:59], v[196:199], a[24:27], v[56:59]
    v_lshlrev_b32 v245, 16, v178
    v_mfma_f32_16x16x32_bf16 v[60:63], v[196:199], a[28:31], v[60:63]
    v_and_b32 v246, 0xffff0000, v178
    v_mfma_f32_16x16x32_bf16 v[60:63], v[192:195], a[12:15], v[60:63]
    s_waitcnt vmcnt(9)
    s_waitcnt lgkmcnt(0)
    s_barrier
    v_mfma_f32_16x16x32_bf16 v[64:67], v[200:203], a[0:3], v[64:67]
    v_subrev_u32 v216, 24576, v216
    v_subrev_u32 v217, 24576, v217
    v_mfma_f32_16x16x32_bf16 v[64:67], v[204:207], a[16:19], v[64:67]
    v_subrev_u32 v218, 24576, v218
    v_subrev_u32 v219, 24576, v219
    v_mfma_f32_16x16x32_bf16 v[68:71], v[204:207], a[20:23], v[68:71]
    ds_read_b64_tr_b16 v[192:193], v216 offset:0
    ds_read_b64_tr_b16 v[194:195], v216 offset:2048
    v_mfma_f32_16x16x32_bf16 v[68:71], v[200:203], a[4:7], v[68:71]
    ds_read_b64_tr_b16 v[196:197], v216 offset:4096
    ds_read_b64_tr_b16 v[198:199], v216 offset:6144
    v_mfma_f32_16x16x32_bf16 v[72:75], v[200:203], a[8:11], v[72:75]
    s_cmp_lg_u32 s48, 3
    s_cbranch_scc1 sequential_preLN__linear_kernel_hedgehog__glu_gated_reglu__prompt_kernel_c3_22
    s_getpc_b64 s[100:101]
sequential_preLN__linear_kernel_hedgehog__glu_gated_reglu__prompt_kernel_c3_22_pc:
    s_sub_u32 s100, s100, sequential_preLN__linear_kernel_hedgehog__glu_gated_reglu__prompt_kernel_c3_22_pc-sequential_preLN__linear_kernel_hedgehog__glu_gated_reglu__prompt_kernel_body
    s_subb_u32 s101, s101, 0
    s_mul_i32 s97, s51, 2176
    v_lshrrev_b32 v242, 4, v232
    v_min_u32 v242, 16, v242
    v_lshl_add_u32 v242, v242, 7, s97
    v_min_u32 v242, 65664, v242
    global_load_dword v239, v242, s[100:101]
sequential_preLN__linear_kernel_hedgehog__glu_gated_reglu__prompt_kernel_c3_22:
    v_mfma_f32_16x16x32_bf16 v[72:75], v[204:207], a[24:27], v[72:75]
    s_add_u32 m0, s49, 49152
    s_add_u32 s96, s77, 4718720
    v_mfma_f32_16x16x32_bf16 v[76:79], v[204:207], a[28:31], v[76:79]
    buffer_load_dwordx4 v222, s[24:27], s96 offen lds
    v_mul_f32 v245, v245, v132
    v_mfma_f32_16x16x32_bf16 v[76:79], v[200:203], a[12:15], v[76:79]
    ds_read_b64_tr_b16 v[200:201], v217 offset:0
    v_mfma_f32_16x16x32_bf16 v[80:83], v[208:211], a[0:3], v[80:83]
    ds_read_b64_tr_b16 v[202:203], v217 offset:2048
    v_mul_f32 v246, v246, v133
    v_mfma_f32_16x16x32_bf16 v[80:83], v[212:215], a[16:19], v[80:83]
    ds_read_b64_tr_b16 v[204:205], v217 offset:4096
    v_cvt_pk_bf16_f32 v252, v245, v246
    v_mfma_f32_16x16x32_bf16 v[84:87], v[212:215], a[20:23], v[84:87]
    ds_read_b64_tr_b16 v[206:207], v217 offset:6144
    v_lshlrev_b32 v245, 16, v179
    v_mfma_f32_16x16x32_bf16 v[84:87], v[208:211], a[4:7], v[84:87]
    v_and_b32 v246, 0xffff0000, v179
    v_mul_f32 v245, v245, v134
    v_mfma_f32_16x16x32_bf16 v[88:91], v[208:211], a[8:11], v[88:91]
    v_mul_f32 v246, v246, v135
    v_cvt_pk_bf16_f32 v253, v245, v246
    v_mfma_f32_16x16x32_bf16 v[88:91], v[212:215], a[24:27], v[88:91]
    v_lshlrev_b32 v245, 16, v186
    v_and_b32 v246, 0xffff0000, v186
    v_mfma_f32_16x16x32_bf16 v[92:95], v[212:215], a[28:31], v[92:95]
    v_mul_f32 v245, v245, v148
    v_mul_f32 v246, v246, v149
    v_mfma_f32_16x16x32_bf16 v[92:95], v[208:211], a[12:15], v[92:95]
    ds_read_b64_tr_b16 v[208:209], v218 offset:0
    s_waitcnt lgkmcnt(5)
    v_mfma_f32_16x16x32_bf16 v[32:35], v[192:195], a[32:35], v[32:35]
    ds_read_b64_tr_b16 v[210:211], v218 offset:2048
    v_cvt_pk_bf16_f32 v254, v245, v246
    v_mfma_f32_16x16x32_bf16 v[32:35], v[196:199], a[48:51], v[32:35]
    ds_read_b64_tr_b16 v[212:213], v218 offset:4096
    s_add_u32 m0, s49, 53248
    v_mfma_f32_16x16x32_bf16 v[36:39], v[196:199], a[52:55], v[36:39]
    ds_read_b64_tr_b16 v[214:215], v218 offset:6144
    s_add_u32 s96, s77, 5013632
    v_mfma_f32_16x16x32_bf16 v[36:39], v[192:195], a[36:39], v[36:39]
    buffer_load_dwordx4 v222, s[24:27], s96 offen lds
    v_lshlrev_b32 v245, 16, v187
    v_mfma_f32_16x16x32_bf16 v[40:43], v[192:195], a[40:43], v[40:43]
    v_and_b32 v246, 0xffff0000, v187
    v_mul_f32 v245, v245, v150
    v_mfma_f32_16x16x32_bf16 v[40:43], v[196:199], a[56:59], v[40:43]
    v_mul_f32 v246, v246, v151
    v_cvt_pk_bf16_f32 v255, v245, v246
    v_mfma_f32_16x16x32_bf16 v[44:47], v[196:199], a[60:63], v[44:47]
    buffer_store_dwordx4 v[252:255], v232, s[36:39], s95 offen offset:1024 sc1
    v_lshlrev_b32 v245, 16, v164
    v_mfma_f32_16x16x32_bf16 v[44:47], v[192:195], a[44:47], v[44:47]
    ds_read_b64_tr_b16 v[192:193], v219 offset:0
    s_waitcnt lgkmcnt(5)
    v_mfma_f32_16x16x32_bf16 v[48:51], v[200:203], a[32:35], v[48:51]
    ds_read_b64_tr_b16 v[194:195], v219 offset:2048
    v_and_b32 v246, 0xffff0000, v164
    v_mfma_f32_16x16x32_bf16 v[48:51], v[204:207], a[48:51], v[48:51]
    ds_read_b64_tr_b16 v[196:197], v219 offset:4096
    v_mul_f32 v245, v245, v104
    v_mfma_f32_16x16x32_bf16 v[52:55], v[204:207], a[52:55], v[52:55]
    ds_read_b64_tr_b16 v[198:199], v219 offset:6144
    v_mul_f32 v246, v246, v105
    v_mfma_f32_16x16x32_bf16 v[52:55], v[200:203], a[36:39], v[52:55]
    v_cvt_pk_bf16_f32 v248, v245, v246
    v_lshlrev_b32 v245, 16, v165
    v_mfma_f32_16x16x32_bf16 v[56:59], v[200:203], a[40:43], v[56:59]
    v_and_b32 v246, 0xffff0000, v165
    v_mfma_f32_16x16x32_bf16 v[56:59], v[204:207], a[56:59], v[56:59]
    v_mul_f32 v245, v245, v106
    v_mfma_f32_16x16x32_bf16 v[60:63], v[204:207], a[60:63], v[60:63]
    v_mul_f32 v246, v246, v107
    v_mfma_f32_16x16x32_bf16 v[60:63], v[200:203], a[44:47], v[60:63]
    ds_read_b64_tr_b16 v[200:201], v216 offset:8192
    s_waitcnt lgkmcnt(5)
    v_mfma_f32_16x16x32_bf16 v[64:67], v[208:211], a[32:35], v[64:67]
    ds_read_b64_tr_b16 v[202:203], v216 offset:10240
    v_cvt_pk_bf16_f32 v249, v245, v246
    v_mfma_f32_16x16x32_bf16 v[64:67], v[212:215], a[48:51], v[64:67]
    ds_read_b64_tr_b16 v[204:205], v216 offset:12288
    s_add_u32 m0, s49, 57344
    v_mfma_f32_16x16x32_bf16 v[68:71], v[212:215], a[52:55], v[68:71]
    ds_read_b64_tr_b16 v[206:207], v216 offset:14336
    s_add_u32 s96, s77, 4128896
    v_mfma_f32_16x16x32_bf16 v[68:71], v[208:211], a[36:39], v[68:71]
    buffer_load_dwordx4 v221, s[24:27], s96 offen lds
    v_lshlrev_b32 v245, 16, v172
    v_mfma_f32_16x16x32_bf16 v[72:75], v[208:211], a[40:43], v[72:75]
    v_and_b32 v246, 0xffff0000, v172
    v_mul_f32 v245, v245, v120
    v_mfma_f32_16x16x32_bf16 v[72:75], v[212:215], a[56:59], v[72:75]
    v_mul_f32 v246, v246, v121
    v_cvt_pk_bf16_f32 v250, v245, v246
    v_mfma_f32_16x16x32_bf16 v[76:79], v[212:215], a[60:63], v[76:79]
    v_lshlrev_b32 v245, 16, v173
    v_mfma_f32_16x16x32_bf16 v[76:79], v[208:211], a[44:47], v[76:79]
    ds_read_b64_tr_b16 v[208:209], v217 offset:8192
    s_waitcnt lgkmcnt(5)
    v_mfma_f32_16x16x32_bf16 v[80:83], v[192:195], a[32:35], v[80:83]
    ds_read_b64_tr_b16 v[210:211], v217 offset:10240
    v_and_b32 v246, 0xffff0000, v173
    v_mfma_f32_16x16x32_bf16 v[80:83], v[196:199], a[48:51], v[80:83]
    ds_read_b64_tr_b16 v[212:213], v217 offset:12288
    v_mul_f32 v245, v245, v122
    v_mfma_f32_16x16x32_bf16 v[84:87], v[196:199], a[52:55], v[84:87]
    ds_read_b64_tr_b16 v[214:215], v217 offset:14336
    v_mul_f32 v246, v246, v123
    v_mfma_f32_16x16x32_bf16 v[84:87], v[192:195], a[36:39], v[84:87]
    v_cvt_pk_bf16_f32 v251, v245, v246
    v_mfma_f32_16x16x32_bf16 v[88:91], v[192:195], a[40:43], v[88:91]
    s_add_u32 s95, s82, 294912
    v_mfma_f32_16x16x32_bf16 v[88:91], v[196:199], a[56:59], v[88:91]
    buffer_store_dwordx4 v[248:251], v232, s[36:39], s95 offen offset:0 sc1
    v_mfma_f32_16x16x32_bf16 v[92:95], v[196:199], a[60:63], v[92:95]
    v_lshlrev_b32 v245, 16, v180
    v_mfma_f32_16x16x32_bf16 v[92:95], v[192:195], a[44:47], v[92:95]
    ds_read_b64_tr_b16 v[192:193], v218 offset:8192
    s_waitcnt lgkmcnt(5)
    v_mfma_f32_16x16x32_bf16 v[32:35], v[200:203], a[64:67], v[32:35]
    ds_read_b64_tr_b16 v[194:195], v218 offset:10240
    v_and_b32 v246, 0xffff0000, v180
    v_mfma_f32_16x16x32_bf16 v[32:35], v[204:207], a[80:83], v[32:35]
    ds_read_b64_tr_b16 v[196:197], v218 offset:12288
    s_add_u32 m0, s49, 61440
    v_mfma_f32_16x16x32_bf16 v[36:39], v[204:207], a[84:87], v[36:39]
    ds_read_b64_tr_b16 v[198:199], v218 offset:14336
    s_add_u32 s96, s77, 4423808
    v_mfma_f32_16x16x32_bf16 v[36:39], v[200:203], a[68:71], v[36:39]
    buffer_load_dwordx4 v221, s[24:27], s96 offen lds
    v_mul_f32 v245, v245, v136
    v_mfma_f32_16x16x32_bf16 v[40:43], v[200:203], a[72:75], v[40:43]
    v_mul_f32 v246, v246, v137
    v_cvt_pk_bf16_f32 v252, v245, v246
    v_mfma_f32_16x16x32_bf16 v[40:43], v[204:207], a[88:91], v[40:43]
    v_lshlrev_b32 v245, 16, v181
    v_and_b32 v246, 0xffff0000, v181
    v_mfma_f32_16x16x32_bf16 v[44:47], v[204:207], a[92:95], v[44:47]
    v_mul_f32 v245, v245, v138
    v_mfma_f32_16x16x32_bf16 v[44:47], v[200:203], a[76:79], v[44:47]
    ds_read_b64_tr_b16 v[200:201], v219 offset:8192
    s_waitcnt lgkmcnt(5)
    v_mfma_f32_16x16x32_bf16 v[48:51], v[208:211], a[64:67], v[48:51]
    ds_read_b64_tr_b16 v[202:203], v219 offset:10240
    v_mul_f32 v246, v246, v139
    v_mfma_f32_16x16x32_bf16 v[48:51], v[212:215], a[80:83], v[48:51]
    ds_read_b64_tr_b16 v[204:205], v219 offset:12288
    v_cvt_pk_bf16_f32 v253, v245, v246
    v_mfma_f32_16x16x32_bf16 v[52:55], v[212:215], a[84:87], v[52:55]
    ds_read_b64_tr_b16 v[206:207], v219 offset:14336
    v_lshlrev_b32 v245, 16, v188
    v_mfma_f32_16x16x32_bf16 v[52:55], v[208:211], a[68:71], v[52:55]
    v_and_b32 v246, 0xffff0000, v188
    v_mfma_f32_16x16x32_bf16 v[56:59], v[208:211], a[72:75], v[56:59]
    v_mul_f32 v245, v245, v152
    v_mfma_f32_16x16x32_bf16 v[56:59], v[212:215], a[88:91], v[56:59]
    v_mul_f32 v246, v246, v153
    v_mfma_f32_16x16x32_bf16 v[60:63], v[212:215], a[92:95], v[60:63]
    v_cvt_pk_bf16_f32 v254, v245, v246
    v_mfma_f32_16x16x32_bf16 v[60:63], v[208:211], a[76:79], v[60:63]
    ds_read_b64_tr_b16 v[208:209], v216 offset:16384
    s_waitcnt lgkmcnt(5)
    v_mfma_f32_16x16x32_bf16 v[64:67], v[192:195], a[64:67], v[64:67]
    ds_read_b64_tr_b16 v[210:211], v216 offset:18432
    v_lshlrev_b32 v245, 16, v189
    v_mfma_f32_16x16x32_bf16 v[64:67], v[196:199], a[80:83], v[64:67]
    ds_read_b64_tr_b16 v[212:213], v216 offset:20480
    s_add_u32 m0, s49, 65536
    v_mfma_f32_16x16x32_bf16 v[68:71], v[196:199], a[84:87], v[68:71]
    ds_read_b64_tr_b16 v[214:215], v216 offset:22528
    s_add_u32 s96, s77, 128
    v_mfma_f32_16x16x32_bf16 v[68:71], v[192:195], a[68:71], v[68:71]
    buffer_load_dwordx4 v221, s[24:27], s96 offen lds
    v_and_b32 v246, 0xffff0000, v189
    v_mfma_f32_16x16x32_bf16 v[72:75], v[192:195], a[72:75], v[72:75]
    v_mul_f32 v245, v245, v154
    v_mul_f32 v246, v246, v155
    v_mfma_f32_16x16x32_bf16 v[72:75], v[196:199], a[88:91], v[72:75]
    v_cvt_pk_bf16_f32 v255, v245, v246
    buffer_store_dwordx4 v[252:255], v232, s[36:39], s95 offen offset:1024 sc1
    v_mfma_f32_16x16x32_bf16 v[76:79], v[196:199], a[92:95], v[76:79]
    v_lshlrev_b32 v245, 16, v166
    v_mfma_f32_16x16x32_bf16 v[76:79], v[192:195], a[76:79], v[76:79]
    ds_read_b64_tr_b16 v[192:193], v217 offset:16384
    s_waitcnt lgkmcnt(5)
    v_mfma_f32_16x16x32_bf16 v[80:83], v[200:203], a[64:67], v[80:83]
    ds_read_b64_tr_b16 v[194:195], v217 offset:18432
    v_and_b32 v246, 0xffff0000, v166
    v_mfma_f32_16x16x32_bf16 v[80:83], v[204:207], a[80:83], v[80:83]
    ds_read_b64_tr_b16 v[196:197], v217 offset:20480
    v_mul_f32 v245, v245, v108
    v_mfma_f32_16x16x32_bf16 v[84:87], v[204:207], a[84:87], v[84:87]
    ds_read_b64_tr_b16 v[198:199], v217 offset:22528
    v_mul_f32 v246, v246, v109
    v_mfma_f32_16x16x32_bf16 v[84:87], v[200:203], a[68:71], v[84:87]
    v_cvt_pk_bf16_f32 v248, v245, v246
    v_mfma_f32_16x16x32_bf16 v[88:91], v[200:203], a[72:75], v[88:91]
    v_lshlrev_b32 v245, 16, v167
    v_mfma_f32_16x16x32_bf16 v[88:91], v[204:207], a[88:91], v[88:91]
    v_and_b32 v246, 0xffff0000, v167
    v_mfma_f32_16x16x32_bf16 v[92:95], v[204:207], a[92:95], v[92:95]
    v_mul_f32 v245, v245, v110
    v_mfma_f32_16x16x32_bf16 v[92:95], v[200:203], a[76:79], v[92:95]
    ds_read_b64_tr_b16 v[200:201], v218 offset:16384
    s_waitcnt lgkmcnt(5)
    v_mfma_f32_16x16x32_bf16 v[32:35], v[208:211], a[96:99], v[32:35]
    ds_read_b64_tr_b16 v[202:203], v218 offset:18432
    v_mul_f32 v246, v246, v111
    v_mfma_f32_16x16x32_bf16 v[32:35], v[212:215], a[112:115], v[32:35]
    ds_read_b64_tr_b16 v[204:205], v218 offset:20480
    s_add_u32 m0, s49, 69632
    v_mfma_f32_16x16x32_bf16 v[36:39], v[212:215], a[116:119], v[36:39]
    ds_read_b64_tr_b16 v[206:207], v218 offset:22528
    s_add_u32 s96, s77, 295040
    v_mfma_f32_16x16x32_bf16 v[36:39], v[208:211], a[100:103], v[36:39]
    buffer_load_dwordx4 v221, s[24:27], s96 offen lds
    v_cvt_pk_bf16_f32 v249, v245, v246
    v_mfma_f32_16x16x32_bf16 v[40:43], v[208:211], a[104:107], v[40:43]
    v_lshlrev_b32 v245, 16, v174
    v_and_b32 v246, 0xffff0000, v174
    v_mfma_f32_16x16x32_bf16 v[40:43], v[212:215], a[120:123], v[40:43]
    v_mul_f32 v245, v245, v124
    v_mul_f32 v246, v246, v125
    v_mfma_f32_16x16x32_bf16 v[44:47], v[212:215], a[124:127], v[44:47]
    v_cvt_pk_bf16_f32 v250, v245, v246
    v_mfma_f32_16x16x32_bf16 v[44:47], v[208:211], a[108:111], v[44:47]
    ds_read_b64_tr_b16 v[208:209], v219 offset:16384
    s_waitcnt lgkmcnt(5)
    v_mfma_f32_16x16x32_bf16 v[48:51], v[192:195], a[96:99], v[48:51]
    ds_read_b64_tr_b16 v[210:211], v219 offset:18432
    v_lshlrev_b32 v245, 16, v175
    v_mfma_f32_16x16x32_bf16 v[48:51], v[196:199], a[112:115], v[48:51]
    ds_read_b64_tr_b16 v[212:213], v219 offset:20480
    v_and_b32 v246, 0xffff0000, v175
    v_mfma_f32_16x16x32_bf16 v[52:55], v[196:199], a[116:119], v[52:55]
    ds_read_b64_tr_b16 v[214:215], v219 offset:22528
    v_mul_f32 v245, v245, v126
    v_mfma_f32_16x16x32_bf16 v[52:55], v[192:195], a[100:103], v[52:55]
    v_mul_f32 v246, v246, v127
    v_mfma_f32_16x16x32_bf16 v[56:59], v[192:195], a[104:107], v[56:59]
    v_cvt_pk_bf16_f32 v251, v245, v246
    v_mfma_f32_16x16x32_bf16 v[56:59], v[196:199], a[120:123], v[56:59]
    s_add_u32 s95, s82, 442368
    v_mfma_f32_16x16x32_bf16 v[60:63], v[196:199], a[124:127], v[60:63]
    buffer_store_dwordx4 v[248:251], v232, s[36:39], s95 offen offset:0 sc1
    v_mfma_f32_16x16x32_bf16 v[60:63], v[192:195], a[108:111], v[60:63]
    s_waitcnt vmcnt(11)
    s_waitcnt lgkmcnt(0)
    s_barrier
    v_mfma_f32_16x16x32_bf16 v[64:67], v[200:203], a[96:99], v[64:67]
    v_subrev_u32 v216, 24576, v216
    v_subrev_u32 v217, 24576, v217
    v_mfma_f32_16x16x32_bf16 v[64:67], v[204:207], a[112:115], v[64:67]
    v_subrev_u32 v218, 24576, v218
    v_subrev_u32 v219, 24576, v219
    v_mfma_f32_16x16x32_bf16 v[68:71], v[204:207], a[116:119], v[68:71]
    ds_read_b64_tr_b16 v[192:193], v216 offset:0
    ds_read_b64_tr_b16 v[194:195], v216 offset:2048
    v_mfma_f32_16x16x32_bf16 v[68:71], v[200:203], a[100:103], v[68:71]
    ds_read_b64_tr_b16 v[196:197], v216 offset:4096
    ds_read_b64_tr_b16 v[198:199], v216 offset:6144
    v_mfma_f32_16x16x32_bf16 v[72:75], v[200:203], a[104:107], v[72:75]
    s_add_u32 s99, s79, s49
    s_add_u32 s99, s99, 32768
    v_mfma_f32_16x16x32_bf16 v[72:75], v[204:207], a[120:123], v[72:75]
    s_add_u32 m0, s93, 122880
    s_nop 0
    buffer_load_dwordx4 v223, s[28:31], s81 offen offset:0 lds
    v_mfma_f32_16x16x32_bf16 v[76:79], v[204:207], a[124:127], v[76:79]
    buffer_load_dwordx4 v224, s[28:31], s81 offen offset:1024 lds
    v_lshlrev_b32 v245, 16, v182
    v_mfma_f32_16x16x32_bf16 v[76:79], v[200:203], a[108:111], v[76:79]
    ds_read_b64_tr_b16 v[200:201], v217 offset:0
    v_mfma_f32_16x16x32_bf16 v[80:83], v[208:211], a[96:99], v[80:83]
    ds_read_b64_tr_b16 v[202:203], v217 offset:2048
    v_and_b32 v246, 0xffff0000, v182
    v_mfma_f32_16x16x32_bf16 v[80:83], v[212:215], a[112:115], v[80:83]
    ds_read_b64_tr_b16 v[204:205], v217 offset:4096
    v_mul_f32 v245, v245, v140
    v_mfma_f32_16x16x32_bf16 v[84:87], v[212:215], a[116:119], v[84:87]
    ds_read_b64_tr_b16 v[206:207], v217 offset:6144
    v_mul_f32 v246, v246, v141
    v_mfma_f32_16x16x32_bf16 v[84:87], v[208:211], a[100:103], v[84:87]
    buffer_load_dwordx4 v225, s[28:31], s81 offen offset:2048 lds
    v_cvt_pk_bf16_f32 v252, v245, v246
    v_mfma_f32_16x16x32_bf16 v[88:91], v[208:211], a[104:107], v[88:91]
    v_lshlrev_b32 v245, 16, v183
    v_and_b32 v246, 0xffff0000, v183
    v_mfma_f32_16x16x32_bf16 v[88:91], v[212:215], a[120:123], v[88:91]
    v_mul_f32 v245, v245, v142
    v_mul_f32 v246, v246, v143
    v_mfma_f32_16x16x32_bf16 v[92:95], v[212:215], a[124:127], v[92:95]
    v_cvt_pk_bf16_f32 v253, v245, v246
    v_lshlrev_b32 v245, 16, v190
    v_mfma_f32_16x16x32_bf16 v[92:95], v[208:211], a[108:111], v[92:95]
    ds_read_b64_tr_b16 v[208:209], v218 offset:0
    s_waitcnt lgkmcnt(5)
    v_mfma_f32_16x16x32_bf16 v[32:35], v[192:195], a[128:131], v[32:35]
    ds_read_b64_tr_b16 v[210:211], v218 offset:2048
    buffer_load_dwordx4 v226, s[28:31], s81 offen offset:3072 lds
    v_mfma_f32_16x16x32_bf16 v[32:35], v[196:199], a[144:147], v[32:35]
    ds_read_b64_tr_b16 v[212:213], v218 offset:4096
    v_and_b32 v246, 0xffff0000, v190
    v_mfma_f32_16x16x32_bf16 v[36:39], v[196:199], a[148:151], v[36:39]
    ds_read_b64_tr_b16 v[214:215], v218 offset:6144
    v_mul_f32 v245, v245, v156
    v_mfma_f32_16x16x32_bf16 v[36:39], v[192:195], a[132:135], v[36:39]
    v_mul_f32 v246, v246, v157
    v_cvt_pk_bf16_f32 v254, v245, v246
    v_mfma_f32_16x16x32_bf16 v[40:43], v[192:195], a[136:139], v[40:43]
    s_add_u32 m0, s93, 126976
    v_lshlrev_b32 v245, 16, v191
    v_mfma_f32_16x16x32_bf16 v[40:43], v[196:199], a[152:155], v[40:43]
    buffer_load_dwordx4 v227, s[28:31], s81 offen offset:0 lds
    v_and_b32 v246, 0xffff0000, v191
    v_mfma_f32_16x16x32_bf16 v[44:47], v[196:199], a[156:159], v[44:47]
    v_mul_f32 v245, v245, v158
    v_mul_f32 v246, v246, v159
    v_mfma_f32_16x16x32_bf16 v[44:47], v[192:195], a[140:143], v[44:47]
    ds_read_b64_tr_b16 v[192:193], v219 offset:0
    s_waitcnt lgkmcnt(5)
    v_mfma_f32_16x16x32_bf16 v[48:51], v[200:203], a[128:131], v[48:51]
    ds_read_b64_tr_b16 v[194:195], v219 offset:2048
    v_cvt_pk_bf16_f32 v255, v245, v246
    v_mfma_f32_16x16x32_bf16 v[48:51], v[204:207], a[144:147], v[48:51]
    ds_read_b64_tr_b16 v[196:197], v219 offset:4096
    buffer_store_dwordx4 v[252:255], v232, s[36:39], s95 offen offset:1024 sc1
    v_mfma_f32_16x16x32_bf16 v[52:55], v[204:207], a[148:151], v[52:55]
    ds_read_b64_tr_b16 v[198:199], v219 offset:6144
    buffer_load_dwordx4 v228, s[28:31], s81 offen offset:1024 lds
    v_mfma_f32_16x16x32_bf16 v[52:55], v[200:203], a[132:135], v[52:55]
    v_mfma_f32_16x16x32_bf16 v[56:59], v[200:203], a[136:139], v[56:59]
    v_mfma_f32_16x16x32_bf16 v[56:59], v[204:207], a[152:155], v[56:59]
    v_mfma_f32_16x16x32_bf16 v[60:63], v[204:207], a[156:159], v[60:63]
    v_mfma_f32_16x16x32_bf16 v[60:63], v[200:203], a[140:143], v[60:63]
    ds_read_b64_tr_b16 v[200:201], v216 offset:8192
    s_waitcnt lgkmcnt(5)
    v_mfma_f32_16x16x32_bf16 v[64:67], v[208:211], a[128:131], v[64:67]
    ds_read_b64_tr_b16 v[202:203], v216 offset:10240
    buffer_load_dwordx4 v229, s[28:31], s81 offen offset:2048 lds
    v_mfma_f32_16x16x32_bf16 v[64:67], v[212:215], a[144:147], v[64:67]
    ds_read_b64_tr_b16 v[204:205], v216 offset:12288
    v_mfma_f32_16x16x32_bf16 v[68:71], v[212:215], a[148:151], v[68:71]
    ds_read_b64_tr_b16 v[206:207], v216 offset:14336
    v_mfma_f32_16x16x32_bf16 v[68:71], v[208:211], a[132:135], v[68:71]
    v_mfma_f32_16x16x32_bf16 v[72:75], v[208:211], a[136:139], v[72:75]
    buffer_load_dwordx4 v230, s[28:31], s81 offen offset:3072 lds
    v_mfma_f32_16x16x32_bf16 v[72:75], v[212:215], a[152:155], v[72:75]
    v_mfma_f32_16x16x32_bf16 v[76:79], v[212:215], a[156:159], v[76:79]
    v_mfma_f32_16x16x32_bf16 v[76:79], v[208:211], a[140:143], v[76:79]
    ds_read_b64_tr_b16 v[208:209], v217 offset:8192
    s_waitcnt lgkmcnt(5)
    v_mfma_f32_16x16x32_bf16 v[80:83], v[192:195], a[128:131], v[80:83]
    ds_read_b64_tr_b16 v[210:211], v217 offset:10240
    s_add_u32 m0, s93, 131072
    v_mfma_f32_16x16x32_bf16 v[80:83], v[196:199], a[144:147], v[80:83]
    ds_read_b64_tr_b16 v[212:213], v217 offset:12288
    buffer_load_dwordx4 v232, s[36:39], s99 offen sc1 lds
    v_mfma_f32_16x16x32_bf16 v[84:87], v[196:199], a[148:151], v[84:87]
    ds_read_b64_tr_b16 v[214:215], v217 offset:14336
    s_add_u32 m0, s49, 24576
    v_mfma_f32_16x16x32_bf16 v[84:87], v[192:195], a[132:135], v[84:87]
    s_add_u32 s96, s77, 589952
    buffer_load_dwordx4 v221, s[24:27], s96 offen lds
    v_mfma_f32_16x16x32_bf16 v[88:91], v[192:195], a[136:139], v[88:91]
    s_add_u32 m0, s49, 28672
    s_add_u32 s96, s77, 884864
    v_mfma_f32_16x16x32_bf16 v[88:91], v[196:199], a[152:155], v[88:91]
    buffer_load_dwordx4 v221, s[24:27], s96 offen lds
    s_add_u32 m0, s49, 32768
    v_mfma_f32_16x16x32_bf16 v[92:95], v[196:199], a[156:159], v[92:95]
    s_add_u32 s96, s77, 1179776
    buffer_load_dwordx4 v221, s[24:27], s96 offen lds
    v_mfma_f32_16x16x32_bf16 v[92:95], v[192:195], a[140:143], v[92:95]
    ds_read_b64_tr_b16 v[192:193], v218 offset:8192
    s_waitcnt lgkmcnt(5)
    v_mfma_f32_16x16x32_bf16 v[32:35], v[200:203], a[160:163], v[32:35]
    ds_read_b64_tr_b16 v[194:195], v218 offset:10240
    v_mfma_f32_16x16x32_bf16 v[32:35], v[204:207], a[176:179], v[32:35]
    ds_read_b64_tr_b16 v[196:197], v218 offset:12288
    s_add_u32 m0, s49, 36864
    v_mfma_f32_16x16x32_bf16 v[36:39], v[204:207], a[180:183], v[36:39]
    ds_read_b64_tr_b16 v[198:199], v218 offset:14336
    s_add_u32 s96, s77, 1474688
    v_mfma_f32_16x16x32_bf16 v[36:39], v[200:203], a[164:167], v[36:39]
    buffer_load_dwordx4 v221, s[24:27], s96 offen lds
    v_mfma_f32_16x16x32_bf16 v[40:43], v[200:203], a[168:171], v[40:43]
    v_mfma_f32_16x16x32_bf16 v[40:43], v[204:207], a[184:187], v[40:43]
    v_mfma_f32_16x16x32_bf16 v[44:47], v[204:207], a[188:191], v[44:47]
    v_mfma_f32_16x16x32_bf16 v[44:47], v[200:203], a[172:175], v[44:47]
    ds_read_b64_tr_b16 v[200:201], v219 offset:8192
    s_waitcnt lgkmcnt(5)
    v_mfma_f32_16x16x32_bf16 v[48:51], v[208:211], a[160:163], v[48:51]
    ds_read_b64_tr_b16 v[202:203], v219 offset:10240
    v_mfma_f32_16x16x32_bf16 v[48:51], v[212:215], a[176:179], v[48:51]
    ds_read_b64_tr_b16 v[204:205], v219 offset:12288
    v_mfma_f32_16x16x32_bf16 v[52:55], v[212:215], a[180:183], v[52:55]
    ds_read_b64_tr_b16 v[206:207], v219 offset:14336
    v_mfma_f32_16x16x32_bf16 v[52:55], v[208:211], a[164:167], v[52:55]
    v_mfma_f32_16x16x32_bf16 v[56:59], v[208:211], a[168:171], v[56:59]
    v_mfma_f32_16x16x32_bf16 v[56:59], v[212:215], a[184:187], v[56:59]
    v_mfma_f32_16x16x32_bf16 v[60:63], v[212:215], a[188:191], v[60:63]
    v_mfma_f32_16x16x32_bf16 v[60:63], v[208:211], a[172:175], v[60:63]
    ds_read_b64_tr_b16 v[208:209], v216 offset:16384
    s_waitcnt lgkmcnt(5)
    v_mfma_f32_16x16x32_bf16 v[64:67], v[192:195], a[160:163], v[64:67]
    ds_read_b64_tr_b16 v[210:211], v216 offset:18432
    v_mfma_f32_16x16x32_bf16 v[64:67], v[196:199], a[176:179], v[64:67]
    ds_read_b64_tr_b16 v[212:213], v216 offset:20480
    s_add_u32 m0, s49, 40960
    v_mfma_f32_16x16x32_bf16 v[68:71], v[196:199], a[180:183], v[68:71]
    ds_read_b64_tr_b16 v[214:215], v216 offset:22528
    s_add_u32 s96, s77, 1769600
    v_mfma_f32_16x16x32_bf16 v[68:71], v[192:195], a[164:167], v[68:71]
    buffer_load_dwordx4 v221, s[24:27], s96 offen lds
    v_mfma_f32_16x16x32_bf16 v[72:75], v[192:195], a[168:171], v[72:75]
    v_mfma_f32_16x16x32_bf16 v[72:75], v[196:199], a[184:187], v[72:75]
    v_mfma_f32_16x16x32_bf16 v[76:79], v[196:199], a[188:191], v[76:79]
    v_mfma_f32_16x16x32_bf16 v[76:79], v[192:195], a[172:175], v[76:79]
    ds_read_b64_tr_b16 v[192:193], v217 offset:16384
    s_waitcnt lgkmcnt(5)
    v_mfma_f32_16x16x32_bf16 v[80:83], v[200:203], a[160:163], v[80:83]
    ds_read_b64_tr_b16 v[194:195], v217 offset:18432
    v_mfma_f32_16x16x32_bf16 v[80:83], v[204:207], a[176:179], v[80:83]
    ds_read_b64_tr_b16 v[196:197], v217 offset:20480
    v_mfma_f32_16x16x32_bf16 v[84:87], v[204:207], a[180:183], v[84:87]
    ds_read_b64_tr_b16 v[198:199], v217 offset:22528
    v_mfma_f32_16x16x32_bf16 v[84:87], v[200:203], a[164:167], v[84:87]
    v_mfma_f32_16x16x32_bf16 v[88:91], v[200:203], a[168:171], v[88:91]
    v_mfma_f32_16x16x32_bf16 v[88:91], v[204:207], a[184:187], v[88:91]
    v_mfma_f32_16x16x32_bf16 v[92:95], v[204:207], a[188:191], v[92:95]
    v_mfma_f32_16x16x32_bf16 v[92:95], v[200:203], a[172:175], v[92:95]
    ds_read_b64_tr_b16 v[200:201], v218 offset:16384
    s_waitcnt lgkmcnt(5)
    v_mfma_f32_16x16x32_bf16 v[32:35], v[208:211], a[192:195], v[32:35]
    ds_read_b64_tr_b16 v[202:203], v218 offset:18432
    v_mfma_f32_16x16x32_bf16 v[32:35], v[212:215], a[208:211], v[32:35]
    ds_read_b64_tr_b16 v[204:205], v218 offset:20480
    s_add_u32 m0, s49, 45056
    v_mfma_f32_16x16x32_bf16 v[36:39], v[212:215], a[212:215], v[36:39]
    ds_read_b64_tr_b16 v[206:207], v218 offset:22528
    s_add_u32 s96, s77, 2064512
    v_mfma_f32_16x16x32_bf16 v[36:39], v[208:211], a[196:199], v[36:39]
    buffer_load_dwordx4 v221, s[24:27], s96 offen lds
    v_mfma_f32_16x16x32_bf16 v[40:43], v[208:211], a[200:203], v[40:43]
    v_mfma_f32_16x16x32_bf16 v[40:43], v[212:215], a[216:219], v[40:43]
    v_mfma_f32_16x16x32_bf16 v[44:47], v[212:215], a[220:223], v[44:47]
    v_mfma_f32_16x16x32_bf16 v[44:47], v[208:211], a[204:207], v[44:47]
    ds_read_b64_tr_b16 v[208:209], v219 offset:16384
    s_waitcnt lgkmcnt(5)
    v_mfma_f32_16x16x32_bf16 v[48:51], v[192:195], a[192:195], v[48:51]
    ds_read_b64_tr_b16 v[210:211], v219 offset:18432
    s_waitcnt vmcnt(10)
    v_mov_b32 v245, 4
    s_mov_b64 exec, 1
    buffer_store_dword v245, off, s[36:39], s52 sc1
    s_mov_b64 exec, -1
    v_mfma_f32_16x16x32_bf16 v[48:51], v[196:199], a[208:211], v[48:51]
    ds_read_b64_tr_b16 v[212:213], v219 offset:20480
    v_mfma_f32_16x16x32_bf16 v[52:55], v[196:199], a[212:215], v[52:55]
    ds_read_b64_tr_b16 v[214:215], v219 offset:22528
    v_mfma_f32_16x16x32_bf16 v[52:55], v[192:195], a[196:199], v[52:55]
    v_mfma_f32_16x16x32_bf16 v[56:59], v[192:195], a[200:203], v[56:59]
    v_mfma_f32_16x16x32_bf16 v[56:59], v[196:199], a[216:219], v[56:59]
    v_mfma_f32_16x16x32_bf16 v[60:63], v[196:199], a[220:223], v[60:63]
    v_mfma_f32_16x16x32_bf16 v[60:63], v[192:195], a[204:207], v[60:63]
    s_waitcnt lgkmcnt(0)
    s_barrier
    v_mfma_f32_16x16x32_bf16 v[64:67], v[200:203], a[192:195], v[64:67]
    v_add_u32 v216, 49152, v216
    v_add_u32 v217, 49152, v217
    v_mfma_f32_16x16x32_bf16 v[64:67], v[204:207], a[208:211], v[64:67]
    v_add_u32 v218, 49152, v218
    v_add_u32 v219, 49152, v219
    v_mfma_f32_16x16x32_bf16 v[68:71], v[204:207], a[212:215], v[68:71]
    ds_read_b64_tr_b16 v[192:193], v216 offset:0
    ds_read_b64_tr_b16 v[194:195], v216 offset:2048
    v_mfma_f32_16x16x32_bf16 v[68:71], v[200:203], a[196:199], v[68:71]
    ds_read_b64_tr_b16 v[196:197], v216 offset:4096
    ds_read_b64_tr_b16 v[198:199], v216 offset:6144
    v_mfma_f32_16x16x32_bf16 v[72:75], v[200:203], a[200:203], v[72:75]
    s_add_u32 s98, s80, 0
    s_add_u32 s99, s89, 0
    v_mfma_f32_16x16x32_bf16 v[72:75], v[204:207], a[216:219], v[72:75]
    s_add_u32 m0, s93, 86016
    s_nop 0
    buffer_load_dwordx4 v223, s[28:31], s98 offen offset:0 lds
    v_mfma_f32_16x16x32_bf16 v[76:79], v[204:207], a[220:223], v[76:79]
    buffer_load_dwordx4 v224, s[28:31], s98 offen offset:1024 lds
    v_mfma_f32_16x16x32_bf16 v[76:79], v[200:203], a[204:207], v[76:79]
    ds_read_b64_tr_b16 v[200:201], v217 offset:0
    v_mfma_f32_16x16x32_bf16 v[80:83], v[208:211], a[192:195], v[80:83]
    ds_read_b64_tr_b16 v[202:203], v217 offset:2048
    v_mfma_f32_16x16x32_bf16 v[80:83], v[212:215], a[208:211], v[80:83]
    ds_read_b64_tr_b16 v[204:205], v217 offset:4096
    v_mfma_f32_16x16x32_bf16 v[84:87], v[212:215], a[212:215], v[84:87]
    ds_read_b64_tr_b16 v[206:207], v217 offset:6144
    v_mfma_f32_16x16x32_bf16 v[84:87], v[208:211], a[196:199], v[84:87]
    buffer_load_dwordx4 v225, s[28:31], s98 offen offset:2048 lds
    v_mfma_f32_16x16x32_bf16 v[88:91], v[208:211], a[200:203], v[88:91]
    v_mfma_f32_16x16x32_bf16 v[88:91], v[212:215], a[216:219], v[88:91]
    v_mfma_f32_16x16x32_bf16 v[92:95], v[212:215], a[220:223], v[92:95]
    v_mfma_f32_16x16x32_bf16 v[92:95], v[208:211], a[204:207], v[92:95]
    ds_read_b64_tr_b16 v[208:209], v218 offset:0
    s_waitcnt lgkmcnt(5)
    v_mfma_f32_16x16x32_bf16 v[96:99], v[192:195], v[0:3], 0
    ds_read_b64_tr_b16 v[210:211], v218 offset:2048
    buffer_load_dwordx4 v226, s[28:31], s98 offen offset:3072 lds
    v_mfma_f32_16x16x32_bf16 v[96:99], v[196:199], v[16:19], v[96:99]
    ds_read_b64_tr_b16 v[212:213], v218 offset:4096
    v_mfma_f32_16x16x32_bf16 v[100:103], v[196:199], v[20:23], 0
    ds_read_b64_tr_b16 v[214:215], v218 offset:6144
    v_mfma_f32_16x16x32_bf16 v[100:103], v[192:195], v[4:7], v[100:103]
    v_mfma_f32_16x16x32_bf16 v[104:107], v[192:195], v[8:11], 0
    s_add_u32 m0, s93, 90112
    v_mfma_f32_16x16x32_bf16 v[104:107], v[196:199], v[24:27], v[104:107]
    buffer_load_dwordx4 v227, s[28:31], s98 offen offset:0 lds
    v_mfma_f32_16x16x32_bf16 v[108:111], v[196:199], v[28:31], 0
    v_mfma_f32_16x16x32_bf16 v[108:111], v[192:195], v[12:15], v[108:111]
    ds_read_b64_tr_b16 v[192:193], v219 offset:0
    s_waitcnt lgkmcnt(5)
    v_mfma_f32_16x16x32_bf16 v[112:115], v[200:203], v[0:3], 0
    ds_read_b64_tr_b16 v[194:195], v219 offset:2048
    v_mfma_f32_16x16x32_bf16 v[112:115], v[204:207], v[16:19], v[112:115]
    ds_read_b64_tr_b16 v[196:197], v219 offset:4096
    v_mul_f32 v32, v234, v32
    v_mfma_f32_16x16x32_bf16 v[116:119], v[204:207], v[20:23], 0
sequential_preLN__linear_kernel_hedgehog__glu_gated_reglu__prompt_kernel_hop1_4:
    s_cbranch_execz sequential_preLN__linear_kernel_hedgehog__glu_gated_reglu__prompt_kernel_hop1_5
    ds_read_b64_tr_b16 v[198:199], v219 offset:6144
    buffer_load_dwordx4 v228, s[28:31], s98 offen offset:1024 lds
    v_mfma_f32_16x16x32_bf16 v[116:119], v[200:203], v[4:7], v[116:119]
    v_max_f32 v32, 0, v32
    v_mfma_f32_16x16x32_bf16 v[120:123], v[200:203], v[8:11], 0
    v_mfma_f32_16x16x32_bf16 v[120:123], v[204:207], v[24:27], v[120:123]
    v_mul_f32 v33, v234, v33
    v_mfma_f32_16x16x32_bf16 v[124:127], v[204:207], v[28:31], 0
    v_mfma_f32_16x16x32_bf16 v[124:127], v[200:203], v[12:15], v[124:127]
    ds_read_b64_tr_b16 v[200:201], v216 offset:8192
    s_waitcnt lgkmcnt(5)
    v_mfma_f32_16x16x32_bf16 v[128:131], v[208:211], v[0:3], 0
    ds_read_b64_tr_b16 v[202:203], v216 offset:10240
    buffer_load_dwordx4 v229, s[28:31], s98 offen offset:2048 lds
    v_mfma_f32_16x16x32_bf16 v[128:131], v[212:215], v[16:19], v[128:131]
    ds_read_b64_tr_b16 v[204:205], v216 offset:12288
    v_max_f32 v33, 0, v33
    v_mfma_f32_16x16x32_bf16 v[132:135], v[212:215], v[20:23], 0
    ds_read_b64_tr_b16 v[206:207], v216 offset:14336
    v_mul_f32 v34, v234, v34
    v_mfma_f32_16x16x32_bf16 v[132:135], v[208:211], v[4:7], v[132:135]
    v_max_f32 v34, 0, v34
    v_mfma_f32_16x16x32_bf16 v[136:139], v[208:211], v[8:11], 0
    buffer_load_dwordx4 v230, s[28:31], s98 offen offset:3072 lds
    v_mfma_f32_16x16x32_bf16 v[136:139], v[212:215], v[24:27], v[136:139]
    v_mul_f32 v35, v234, v35
    v_mfma_f32_16x16x32_bf16 v[140:143], v[212:215], v[28:31], 0
    v_mfma_f32_16x16x32_bf16 v[140:143], v[208:211], v[12:15], v[140:143]
    ds_read_b64_tr_b16 v[208:209], v217 offset:8192
    s_waitcnt lgkmcnt(5)
    v_mfma_f32_16x16x32_bf16 v[144:147], v[192:195], v[0:3], 0
    ds_read_b64_tr_b16 v[210:211], v217 offset:10240
    s_add_u32 m0, s93, 94208
    v_mfma_f32_16x16x32_bf16 v[144:147], v[196:199], v[16:19], v[144:147]
    ds_read_b64_tr_b16 v[212:213], v217 offset:12288
    buffer_load_dwordx4 v232, s[36:39], s99 offen sc1 lds
    v_mfma_f32_16x16x32_bf16 v[148:151], v[196:199], v[20:23], 0
    ds_read_b64_tr_b16 v[214:215], v217 offset:14336
    s_add_u32 m0, s49, 0
    v_mfma_f32_16x16x32_bf16 v[148:151], v[192:195], v[4:7], v[148:151]
    s_add_u32 s96, s77, 2359424
    buffer_load_dwordx4 v221, s[24:27], s96 offen lds
    v_mfma_f32_16x16x32_bf16 v[152:155], v[192:195], v[8:11], 0
    s_add_u32 m0, s49, 4096
    s_add_u32 s96, s77, 2654336
    v_mfma_f32_16x16x32_bf16 v[152:155], v[196:199], v[24:27], v[152:155]
    buffer_load_dwordx4 v221, s[24:27], s96 offen lds
    s_add_u32 m0, s49, 8192
    v_mfma_f32_16x16x32_bf16 v[156:159], v[196:199], v[28:31], 0
    s_add_u32 s96, s77, 2949248
    buffer_load_dwordx4 v221, s[24:27], s96 offen lds
    v_mfma_f32_16x16x32_bf16 v[156:159], v[192:195], v[12:15], v[156:159]
    ds_read_b64_tr_b16 v[192:193], v218 offset:8192
    s_waitcnt lgkmcnt(5)
    v_mfma_f32_16x16x32_bf16 v[96:99], v[200:203], a[224:227], v[96:99]
    ds_read_b64_tr_b16 v[194:195], v218 offset:10240
    v_max_f32 v35, 0, v35
    v_mfma_f32_16x16x32_bf16 v[96:99], v[204:207], a[240:243], v[96:99]
    ds_read_b64_tr_b16 v[196:197], v218 offset:12288
    s_add_u32 m0, s49, 12288
    v_mfma_f32_16x16x32_bf16 v[100:103], v[204:207], a[244:247], v[100:103]
    ds_read_b64_tr_b16 v[198:199], v218 offset:14336
    s_add_u32 s96, s77, 3244160
    v_mfma_f32_16x16x32_bf16 v[100:103], v[200:203], a[228:231], v[100:103]
    buffer_load_dwordx4 v221, s[24:27], s96 offen lds
    v_mul_f32 v36, v235, v36
    v_mfma_f32_16x16x32_bf16 v[104:107], v[200:203], a[232:235], v[104:107]
    v_max_f32 v36, 0, v36
    v_mul_f32 v37, v235, v37
    v_mfma_f32_16x16x32_bf16 v[104:107], v[204:207], a[248:251], v[104:107]
    v_max_f32 v37, 0, v37
    v_mul_f32 v38, v235, v38
    v_mfma_f32_16x16x32_bf16 v[108:111], v[204:207], a[252:255], v[108:111]
    v_max_f32 v38, 0, v38
    v_mul_f32 v39, v235, v39
    v_mfma_f32_16x16x32_bf16 v[108:111], v[200:203], a[236:239], v[108:111]
    ds_read_b64_tr_b16 v[200:201], v219 offset:8192
    s_waitcnt lgkmcnt(5)
    v_mfma_f32_16x16x32_bf16 v[112:115], v[208:211], a[224:227], v[112:115]
    ds_read_b64_tr_b16 v[202:203], v219 offset:10240
    buffer_load_dword v239, v238, s[36:39], 0 offen sc1
    v_mfma_f32_16x16x32_bf16 v[112:115], v[212:215], a[240:243], v[112:115]
    ds_read_b64_tr_b16 v[204:205], v219 offset:12288
    v_max_f32 v39, 0, v39
    v_mfma_f32_16x16x32_bf16 v[116:119], v[212:215], a[244:247], v[116:119]
    ds_read_b64_tr_b16 v[206:207], v219 offset:14336
    v_mul_f32 v40, v236, v40
    v_mfma_f32_16x16x32_bf16 v[116:119], v[208:211], a[228:231], v[116:119]
    v_mfma_f32_16x16x32_bf16 v[120:123], v[208:211], a[232:235], v[120:123]
    v_max_f32 v40, 0, v40
    v_mfma_f32_16x16x32_bf16 v[120:123], v[212:215], a[248:251], v[120:123]
    v_mfma_f32_16x16x32_bf16 v[124:127], v[212:215], a[252:255], v[124:127]
    v_mfma_f32_16x16x32_bf16 v[124:127], v[208:211], a[236:239], v[124:127]
    ds_read_b64_tr_b16 v[208:209], v216 offset:16384
    s_waitcnt lgkmcnt(5)
    v_mfma_f32_16x16x32_bf16 v[128:131], v[192:195], a[224:227], v[128:131]
    ds_read_b64_tr_b16 v[210:211], v216 offset:18432
    v_mul_f32 v41, v236, v41
    v_mfma_f32_16x16x32_bf16 v[128:131], v[196:199], a[240:243], v[128:131]
    ds_read_b64_tr_b16 v[212:213], v216 offset:20480
    s_add_u32 m0, s49, 16384
    v_mfma_f32_16x16x32_bf16 v[132:135], v[196:199], a[244:247], v[132:135]
    ds_read_b64_tr_b16 v[214:215], v216 offset:22528
    s_add_u32 s96, s77, 3539072
    v_mfma_f32_16x16x32_bf16 v[132:135], v[192:195], a[228:231], v[132:135]
    buffer_load_dwordx4 v221, s[24:27], s96 offen lds
    v_max_f32 v41, 0, v41
    v_mfma_f32_16x16x32_bf16 v[136:139], v[192:195], a[232:235], v[136:139]
    v_mul_f32 v42, v236, v42
    v_mfma_f32_16x16x32_bf16 v[136:139], v[196:199], a[248:251], v[136:139]
    v_max_f32 v42, 0, v42
    v_mfma_f32_16x16x32_bf16 v[140:143], v[196:199], a[252:255], v[140:143]
    v_mfma_f32_16x16x32_bf16 v[140:143], v[192:195], a[236:239], v[140:143]
    ds_read_b64_tr_b16 v[192:193], v217 offset:16384
    s_waitcnt lgkmcnt(5)
    v_mfma_f32_16x16x32_bf16 v[144:147], v[200:203], a[224:227], v[144:147]
    ds_read_b64_tr_b16 v[194:195], v217 offset:18432
    v_mul_f32 v43, v236, v43
    v_mfma_f32_16x16x32_bf16 v[144:147], v[204:207], a[240:243], v[144:147]
    ds_read_b64_tr_b16 v[196:197], v217 offset:20480
    v_max_f32 v43, 0, v43
    v_mfma_f32_16x16x32_bf16 v[148:151], v[204:207], a[244:247], v[148:151]
    ds_read_b64_tr_b16 v[198:199], v217 offset:22528
    v_mfma_f32_16x16x32_bf16 v[148:151], v[200:203], a[228:231], v[148:151]
    v_mul_f32 v44, v237, v44
    v_mfma_f32_16x16x32_bf16 v[152:155], v[200:203], a[232:235], v[152:155]
    v_mfma_f32_16x16x32_bf16 v[152:155], v[204:207], a[248:251], v[152:155]
    v_max_f32 v44, 0, v44
    v_mfma_f32_16x16x32_bf16 v[156:159], v[204:207], a[252:255], v[156:159]
    v_mfma_f32_16x16x32_bf16 v[156:159], v[200:203], a[236:239], v[156:159]
    ds_read_b64_tr_b16 v[200:201], v218 offset:16384
    s_waitcnt lgkmcnt(5)
    v_mfma_f32_16x16x32_bf16 v[96:99], v[208:211], a[0:3], v[96:99]
    ds_read_b64_tr_b16 v[202:203], v218 offset:18432
    v_mul_f32 v45, v237, v45
    v_mfma_f32_16x16x32_bf16 v[96:99], v[212:215], a[16:19], v[96:99]
    ds_read_b64_tr_b16 v[204:205], v218 offset:20480
    s_add_u32 m0, s49, 20480
    v_mfma_f32_16x16x32_bf16 v[100:103], v[212:215], a[20:23], v[100:103]
    ds_read_b64_tr_b16 v[206:207], v218 offset:22528
    s_add_u32 s96, s77, 3833984
    v_mfma_f32_16x16x32_bf16 v[100:103], v[208:211], a[4:7], v[100:103]
    buffer_load_dwordx4 v221, s[24:27], s96 offen lds
    v_max_f32 v45, 0, v45
    v_mfma_f32_16x16x32_bf16 v[104:107], v[208:211], a[8:11], v[104:107]
    v_mul_f32 v46, v237, v46
    v_mfma_f32_16x16x32_bf16 v[104:107], v[212:215], a[24:27], v[104:107]
    v_mfma_f32_16x16x32_bf16 v[108:111], v[212:215], a[28:31], v[108:111]
    v_max_f32 v46, 0, v46
    v_mfma_f32_16x16x32_bf16 v[108:111], v[208:211], a[12:15], v[108:111]
    ds_read_b64_tr_b16 v[208:209], v219 offset:16384
    s_waitcnt lgkmcnt(5)
    v_mfma_f32_16x16x32_bf16 v[112:115], v[192:195], a[0:3], v[112:115]
    ds_read_b64_tr_b16 v[210:211], v219 offset:18432
    v_mul_f32 v47, v237, v47
    v_mfma_f32_16x16x32_bf16 v[112:115], v[196:199], a[16:19], v[112:115]
    ds_read_b64_tr_b16 v[212:213], v219 offset:20480
    v_mfma_f32_16x16x32_bf16 v[116:119], v[196:199], a[20:23], v[116:119]
    ds_read_b64_tr_b16 v[214:215], v219 offset:22528
    v_max_f32 v47, 0, v47
    v_mfma_f32_16x16x32_bf16 v[116:119], v[192:195], a[4:7], v[116:119]
    v_mfma_f32_16x16x32_bf16 v[120:123], v[192:195], a[8:11], v[120:123]
    v_mul_f32 v48, v234, v48
    v_mfma_f32_16x16x32_bf16 v[120:123], v[196:199], a[24:27], v[120:123]
    v_mfma_f32_16x16x32_bf16 v[124:127], v[196:199], a[28:31], v[124:127]
    v_max_f32 v48, 0, v48
    v_mfma_f32_16x16x32_bf16 v[124:127], v[192:195], a[12:15], v[124:127]
    s_waitcnt vmcnt(17)
    s_waitcnt lgkmcnt(0)
    s_barrier
    v_mfma_f32_16x16x32_bf16 v[128:131], v[200:203], a[0:3], v[128:131]
    v_subrev_u32 v216, 24576, v216
    v_subrev_u32 v217, 24576, v217
    v_mfma_f32_16x16x32_bf16 v[128:131], v[204:207], a[16:19], v[128:131]
    v_subrev_u32 v218, 24576, v218
    v_subrev_u32 v219, 24576, v219
    v_mfma_f32_16x16x32_bf16 v[132:135], v[204:207], a[20:23], v[132:135]
    ds_read_b64_tr_b16 v[192:193], v216 offset:0
    ds_read_b64_tr_b16 v[194:195], v216 offset:2048
    v_mfma_f32_16x16x32_bf16 v[132:135], v[200:203], a[4:7], v[132:135]
    ds_read_b64_tr_b16 v[196:197], v216 offset:4096
    ds_read_b64_tr_b16 v[198:199], v216 offset:6144
    v_mfma_f32_16x16x32_bf16 v[136:139], v[200:203], a[8:11], v[136:139]
    s_add_u32 s98, s80, 294912
    s_add_u32 s99, s89, 8192
    v_mfma_f32_16x16x32_bf16 v[136:139], v[204:207], a[24:27], v[136:139]
    s_add_u32 m0, s93, 49152
    s_nop 0
    buffer_load_dwordx4 v223, s[28:31], s98 offen offset:0 lds
    v_mfma_f32_16x16x32_bf16 v[140:143], v[204:207], a[28:31], v[140:143]
    v_mul_f32 v49, v234, v49
    v_max_f32 v49, 0, v49
    v_mfma_f32_16x16x32_bf16 v[140:143], v[200:203], a[12:15], v[140:143]
    ds_read_b64_tr_b16 v[200:201], v217 offset:0
    v_mfma_f32_16x16x32_bf16 v[144:147], v[208:211], a[0:3], v[144:147]
    ds_read_b64_tr_b16 v[202:203], v217 offset:2048
    v_mul_f32 v50, v234, v50
    v_mfma_f32_16x16x32_bf16 v[144:147], v[212:215], a[16:19], v[144:147]
    ds_read_b64_tr_b16 v[204:205], v217 offset:4096
    v_max_f32 v50, 0, v50
    v_mfma_f32_16x16x32_bf16 v[148:151], v[212:215], a[20:23], v[148:151]
    ds_read_b64_tr_b16 v[206:207], v217 offset:6144
    v_mul_f32 v51, v234, v51
    v_mfma_f32_16x16x32_bf16 v[148:151], v[208:211], a[4:7], v[148:151]
    buffer_load_dwordx4 v224, s[28:31], s98 offen offset:1024 lds
    v_max_f32 v51, 0, v51
    v_mfma_f32_16x16x32_bf16 v[152:155], v[208:211], a[8:11], v[152:155]
    v_mfma_f32_16x16x32_bf16 v[152:155], v[212:215], a[24:27], v[152:155]
    v_mul_f32 v52, v235, v52
    v_mfma_f32_16x16x32_bf16 v[156:159], v[212:215], a[28:31], v[156:159]
    v_mfma_f32_16x16x32_bf16 v[156:159], v[208:211], a[12:15], v[156:159]
    ds_read_b64_tr_b16 v[208:209], v218 offset:0
    s_waitcnt lgkmcnt(5)
    v_mfma_f32_16x16x32_bf16 v[96:99], v[192:195], a[32:35], v[96:99]
    ds_read_b64_tr_b16 v[210:211], v218 offset:2048
    s_waitcnt vmcnt(4)
    v_cmp_gt_u32 vcc, 4, v239
    s_nop 0
    s_cbranch_vccnz sequential_preLN__linear_kernel_hedgehog__glu_gated_reglu__prompt_kernel_spin_23
sequential_preLN__linear_kernel_hedgehog__glu_gated_reglu__prompt_kernel_spin_23_b:
    v_mfma_f32_16x16x32_bf16 v[96:99], v[196:199], a[48:51], v[96:99]
    ds_read_b64_tr_b16 v[212:213], v218 offset:4096
    s_add_u32 s97, s84, 32768
    v_mfma_f32_16x16x32_bf16 v[100:103], v[196:199], a[52:55], v[100:103]
    ds_read_b64_tr_b16 v[214:215], v218 offset:6144
    buffer_load_dwordx2 a[0:1], v233, s[36:39], s97 offen offset:0 sc1
    v_mfma_f32_16x16x32_bf16 v[100:103], v[192:195], a[36:39], v[100:103]
    v_max_f32 v52, 0, v52
    v_mul_f32 v53, v235, v53
    v_mfma_f32_16x16x32_bf16 v[104:107], v[192:195], a[40:43], v[104:107]
    buffer_load_dwordx2 a[2:3], v233, s[36:39], s97 offen offset:512 sc1
    v_max_f32 v53, 0, v53
    v_mfma_f32_16x16x32_bf16 v[104:107], v[196:199], a[56:59], v[104:107]
    buffer_load_dwordx4 v225, s[28:31], s98 offen offset:2048 lds
    v_mfma_f32_16x16x32_bf16 v[108:111], v[196:199], a[60:63], v[108:111]
    v_mul_f32 v54, v235, v54
    v_mfma_f32_16x16x32_bf16 v[108:111], v[192:195], a[44:47], v[108:111]
    ds_read_b64_tr_b16 v[192:193], v219 offset:0
    s_waitcnt lgkmcnt(5)
    v_mfma_f32_16x16x32_bf16 v[112:115], v[200:203], a[32:35], v[112:115]
    ds_read_b64_tr_b16 v[194:195], v219 offset:2048
    s_add_u32 s97, s84, 180224
    v_mfma_f32_16x16x32_bf16 v[112:115], v[204:207], a[48:51], v[112:115]
    ds_read_b64_tr_b16 v[196:197], v219 offset:4096
    buffer_load_dwordx2 a[4:5], v233, s[36:39], s97 offen offset:0 sc1
    v_mfma_f32_16x16x32_bf16 v[116:119], v[204:207], a[52:55], v[116:119]
    ds_read_b64_tr_b16 v[198:199], v219 offset:6144
    v_max_f32 v54, 0, v54
    v_mfma_f32_16x16x32_bf16 v[116:119], v[200:203], a[36:39], v[116:119]
    v_mul_f32 v55, v235, v55
    v_mfma_f32_16x16x32_bf16 v[120:123], v[200:203], a[40:43], v[120:123]
    buffer_load_dwordx2 a[6:7], v233, s[36:39], s97 offen offset:512 sc1
    v_max_f32 v55, 0, v55
    v_mfma_f32_16x16x32_bf16 v[120:123], v[204:207], a[56:59], v[120:123]
    v_mfma_f32_16x16x32_bf16 v[124:127], v[204:207], a[60:63], v[124:127]
    v_mul_f32 v56, v236, v56
    v_mfma_f32_16x16x32_bf16 v[124:127], v[200:203], a[44:47], v[124:127]
    ds_read_b64_tr_b16 v[200:201], v216 offset:8192
    s_waitcnt lgkmcnt(5)
    v_mfma_f32_16x16x32_bf16 v[128:131], v[208:211], a[32:35], v[128:131]
    ds_read_b64_tr_b16 v[202:203], v216 offset:10240
    s_add_u32 s97, s84, 33792
    v_mfma_f32_16x16x32_bf16 v[128:131], v[212:215], a[48:51], v[128:131]
    ds_read_b64_tr_b16 v[204:205], v216 offset:12288
    buffer_load_dwordx2 a[8:9], v233, s[36:39], s97 offen offset:0 sc1
    v_mfma_f32_16x16x32_bf16 v[132:135], v[212:215], a[52:55], v[132:135]
    ds_read_b64_tr_b16 v[206:207], v216 offset:14336
    buffer_load_dwordx4 v226, s[28:31], s98 offen offset:3072 lds
    v_mfma_f32_16x16x32_bf16 v[132:135], v[208:211], a[36:39], v[132:135]
    v_max_f32 v56, 0, v56
    v_mul_f32 v57, v236, v57
    v_mfma_f32_16x16x32_bf16 v[136:139], v[208:211], a[40:43], v[136:139]
    buffer_load_dwordx2 a[10:11], v233, s[36:39], s97 offen offset:512 sc1
    v_max_f32 v57, 0, v57
    v_mfma_f32_16x16x32_bf16 v[136:139], v[212:215], a[56:59], v[136:139]
    v_mfma_f32_16x16x32_bf16 v[140:143], v[212:215], a[60:63], v[140:143]
    v_mfma_f32_16x16x32_bf16 v[140:143], v[208:211], a[44:47], v[140:143]
    ds_read_b64_tr_b16 v[208:209], v217 offset:8192
    s_waitcnt lgkmcnt(5)
    v_mfma_f32_16x16x32_bf16 v[144:147], v[192:195], a[32:35], v[144:147]
    ds_read_b64_tr_b16 v[210:211], v217 offset:10240
    s_add_u32 s97, s84, 181248
    v_mfma_f32_16x16x32_bf16 v[144:147], v[196:199], a[48:51], v[144:147]
    ds_read_b64_tr_b16 v[212:213], v217 offset:12288
    buffer_load_dwordx2 a[12:13], v233, s[36:39], s97 offen offset:0 sc1
    v_mfma_f32_16x16x32_bf16 v[148:151], v[196:199], a[52:55], v[148:151]
    ds_read_b64_tr_b16 v[214:215], v217 offset:14336
    s_add_u32 m0, s93, 53248
    v_mfma_f32_16x16x32_bf16 v[148:151], v[192:195], a[36:39], v[148:151]
    buffer_load_dwordx4 v227, s[28:31], s98 offen offset:0 lds
    v_mul_f32 v58, v236, v58
    v_mfma_f32_16x16x32_bf16 v[152:155], v[192:195], a[40:43], v[152:155]
    buffer_load_dwordx2 a[14:15], v233, s[36:39], s97 offen offset:512 sc1
    v_max_f32 v58, 0, v58
    v_mfma_f32_16x16x32_bf16 v[152:155], v[196:199], a[56:59], v[152:155]
    v_mul_f32 v59, v236, v59
    v_max_f32 v59, 0, v59
    v_mfma_f32_16x16x32_bf16 v[156:159], v[196:199], a[60:63], v[156:159]
    v_mfma_f32_16x16x32_bf16 v[156:159], v[192:195], a[44:47], v[156:159]
    ds_read_b64_tr_b16 v[192:193], v218 offset:8192
    s_waitcnt lgkmcnt(5)
    v_mfma_f32_16x16x32_bf16 v[96:99], v[200:203], a[64:67], v[96:99]
    ds_read_b64_tr_b16 v[194:195], v218 offset:10240
    s_add_u32 s97, s84, 34816
    v_mfma_f32_16x16x32_bf16 v[96:99], v[204:207], a[80:83], v[96:99]
    ds_read_b64_tr_b16 v[196:197], v218 offset:12288
    buffer_load_dwordx2 a[16:17], v233, s[36:39], s97 offen offset:0 sc1
    v_mfma_f32_16x16x32_bf16 v[100:103], v[204:207], a[84:87], v[100:103]
    ds_read_b64_tr_b16 v[198:199], v218 offset:14336
    v_mul_f32 v60, v237, v60
    v_mfma_f32_16x16x32_bf16 v[100:103], v[200:203], a[68:71], v[100:103]
    buffer_load_dwordx4 v228, s[28:31], s98 offen offset:1024 lds
    v_max_f32 v60, 0, v60
    v_mfma_f32_16x16x32_bf16 v[104:107], v[200:203], a[72:75], v[104:107]
    buffer_load_dwordx2 a[18:19], v233, s[36:39], s97 offen offset:512 sc1
    v_mul_f32 v61, v237, v61
    v_mfma_f32_16x16x32_bf16 v[104:107], v[204:207], a[88:91], v[104:107]
    v_max_f32 v61, 0, v61
    v_mfma_f32_16x16x32_bf16 v[108:111], v[204:207], a[92:95], v[108:111]
    v_mfma_f32_16x16x32_bf16 v[108:111], v[200:203], a[76:79], v[108:111]
    ds_read_b64_tr_b16 v[200:201], v219 offset:8192
    s_waitcnt lgkmcnt(5)
    v_mfma_f32_16x16x32_bf16 v[112:115], v[208:211], a[64:67], v[112:115]
    ds_read_b64_tr_b16 v[202:203], v219 offset:10240
    s_add_u32 s97, s84, 182272
    v_mfma_f32_16x16x32_bf16 v[112:115], v[212:215], a[80:83], v[112:115]
    ds_read_b64_tr_b16 v[204:205], v219 offset:12288
    buffer_load_dwordx2 a[20:21], v233, s[36:39], s97 offen offset:0 sc1
    v_mfma_f32_16x16x32_bf16 v[116:119], v[212:215], a[84:87], v[116:119]
    ds_read_b64_tr_b16 v[206:207], v219 offset:14336
    v_mul_f32 v62, v237, v62
    v_mfma_f32_16x16x32_bf16 v[116:119], v[208:211], a[68:71], v[116:119]
    v_max_f32 v62, 0, v62
    v_mfma_f32_16x16x32_bf16 v[120:123], v[208:211], a[72:75], v[120:123]
    buffer_load_dwordx2 a[22:23], v233, s[36:39], s97 offen offset:512 sc1
    v_mul_f32 v63, v237, v63
    v_mfma_f32_16x16x32_bf16 v[120:123], v[212:215], a[88:91], v[120:123]
    buffer_load_dwordx4 v229, s[28:31], s98 offen offset:2048 lds
    v_mfma_f32_16x16x32_bf16 v[124:127], v[212:215], a[92:95], v[124:127]
    v_max_f32 v63, 0, v63
    v_mfma_f32_16x16x32_bf16 v[124:127], v[208:211], a[76:79], v[124:127]
    ds_read_b64_tr_b16 v[208:209], v216 offset:16384
    s_waitcnt lgkmcnt(5)
    v_mfma_f32_16x16x32_bf16 v[128:131], v[192:195], a[64:67], v[128:131]
    ds_read_b64_tr_b16 v[210:211], v216 offset:18432
    s_add_u32 s97, s84, 35840
    v_mfma_f32_16x16x32_bf16 v[128:131], v[196:199], a[80:83], v[128:131]
    ds_read_b64_tr_b16 v[212:213], v216 offset:20480
    buffer_load_dwordx2 a[24:25], v233, s[36:39], s97 offen offset:0 sc1
    v_mfma_f32_16x16x32_bf16 v[132:135], v[196:199], a[84:87], v[132:135]
    ds_read_b64_tr_b16 v[214:215], v216 offset:22528
    v_mul_f32 v64, v234, v64
    v_mfma_f32_16x16x32_bf16 v[132:135], v[192:195], a[68:71], v[132:135]
    v_max_f32 v64, 0, v64
    v_mfma_f32_16x16x32_bf16 v[136:139], v[192:195], a[72:75], v[136:139]
    buffer_load_dwordx2 a[26:27], v233, s[36:39], s97 offen offset:512 sc1
    v_mul_f32 v65, v234, v65
    v_mfma_f32_16x16x32_bf16 v[136:139], v[196:199], a[88:91], v[136:139]
    v_mfma_f32_16x16x32_bf16 v[140:143], v[196:199], a[92:95], v[140:143]
    v_max_f32 v65, 0, v65
    v_mfma_f32_16x16x32_bf16 v[140:143], v[192:195], a[76:79], v[140:143]
    ds_read_b64_tr_b16 v[192:193], v217 offset:16384
    s_waitcnt lgkmcnt(5)
    v_mfma_f32_16x16x32_bf16 v[144:147], v[200:203], a[64:67], v[144:147]
    ds_read_b64_tr_b16 v[194:195], v217 offset:18432
    s_add_u32 s97, s84, 183296
    v_mfma_f32_16x16x32_bf16 v[144:147], v[204:207], a[80:83], v[144:147]
    ds_read_b64_tr_b16 v[196:197], v217 offset:20480
    buffer_load_dwordx2 a[28:29], v233, s[36:39], s97 offen offset:0 sc1
    v_mfma_f32_16x16x32_bf16 v[148:151], v[204:207], a[84:87], v[148:151]
    ds_read_b64_tr_b16 v[198:199], v217 offset:22528
    buffer_load_dwordx4 v230, s[28:31], s98 offen offset:3072 lds
    v_mfma_f32_16x16x32_bf16 v[148:151], v[200:203], a[68:71], v[148:151]
    v_mul_f32 v66, v234, v66
    v_max_f32 v66, 0, v66
    v_mfma_f32_16x16x32_bf16 v[152:155], v[200:203], a[72:75], v[152:155]
    buffer_load_dwordx2 a[30:31], v233, s[36:39], s97 offen offset:512 sc1
    v_mfma_f32_16x16x32_bf16 v[152:155], v[204:207], a[88:91], v[152:155]
    v_mul_f32 v67, v234, v67
    v_mfma_f32_16x16x32_bf16 v[156:159], v[204:207], a[92:95], v[156:159]
    v_mfma_f32_16x16x32_bf16 v[156:159], v[200:203], a[76:79], v[156:159]
    ds_read_b64_tr_b16 v[200:201], v218 offset:16384
    s_waitcnt lgkmcnt(5)
    v_mfma_f32_16x16x32_bf16 v[96:99], v[208:211], a[96:99], v[96:99]
    ds_read_b64_tr_b16 v[202:203], v218 offset:18432
    s_add_u32 s97, s84, 0
    v_mfma_f32_16x16x32_bf16 v[96:99], v[212:215], a[112:115], v[96:99]
    ds_read_b64_tr_b16 v[204:205], v218 offset:20480
    buffer_load_dwordx4 a[32:35], v232, s[36:39], s97 offen sc1
    v_mfma_f32_16x16x32_bf16 v[100:103], v[212:215], a[116:119], v[100:103]
    ds_read_b64_tr_b16 v[206:207], v218 offset:22528
    s_add_u32 m0, s93, 57344
    v_mfma_f32_16x16x32_bf16 v[100:103], v[208:211], a[100:103], v[100:103]
    buffer_load_dwordx4 v232, s[36:39], s99 offen sc1 lds
    v_max_f32 v67, 0, v67
    v_mfma_f32_16x16x32_bf16 v[104:107], v[208:211], a[104:107], v[104:107]
    buffer_load_dwordx4 a[40:43], v232, s[36:39], s97 offen offset:1024 sc1
    v_mul_f32 v68, v235, v68
    v_mfma_f32_16x16x32_bf16 v[104:107], v[212:215], a[120:123], v[104:107]
    v_max_f32 v68, 0, v68
    v_mul_f32 v69, v235, v69
    v_mfma_f32_16x16x32_bf16 v[108:111], v[212:215], a[124:127], v[108:111]
    v_mfma_f32_16x16x32_bf16 v[108:111], v[208:211], a[108:111], v[108:111]
    ds_read_b64_tr_b16 v[208:209], v219 offset:16384
    s_waitcnt lgkmcnt(5)
    v_mfma_f32_16x16x32_bf16 v[112:115], v[192:195], a[96:99], v[112:115]
    ds_read_b64_tr_b16 v[210:211], v219 offset:18432
    s_add_u32 s97, s84, 147456
    v_mfma_f32_16x16x32_bf16 v[112:115], v[196:199], a[112:115], v[112:115]
    ds_read_b64_tr_b16 v[212:213], v219 offset:20480
    buffer_load_dwordx4 a[36:39], v232, s[36:39], s97 offen sc1
    v_mfma_f32_16x16x32_bf16 v[116:119], v[196:199], a[116:119], v[116:119]
    ds_read_b64_tr_b16 v[214:215], v219 offset:22528
    v_max_f32 v69, 0, v69
    v_mfma_f32_16x16x32_bf16 v[116:119], v[192:195], a[100:103], v[116:119]
    v_mul_f32 v70, v235, v70
    v_mfma_f32_16x16x32_bf16 v[120:123], v[192:195], a[104:107], v[120:123]
    buffer_load_dwordx4 a[44:47], v232, s[36:39], s97 offen offset:1024 sc1
    v_max_f32 v70, 0, v70
    v_mfma_f32_16x16x32_bf16 v[120:123], v[196:199], a[120:123], v[120:123]
    v_mfma_f32_16x16x32_bf16 v[124:127], v[196:199], a[124:127], v[124:127]
    v_mul_f32 v71, v235, v71
    v_mfma_f32_16x16x32_bf16 v[124:127], v[192:195], a[108:111], v[124:127]
    s_waitcnt vmcnt(29)
    s_waitcnt lgkmcnt(0)
    s_barrier
    v_mfma_f32_16x16x32_bf16 v[128:131], v[200:203], a[96:99], v[128:131]
    v_subrev_u32 v216, 24576, v216
    v_subrev_u32 v217, 24576, v217
    v_mfma_f32_16x16x32_bf16 v[128:131], v[204:207], a[112:115], v[128:131]
    v_subrev_u32 v218, 24576, v218
    v_subrev_u32 v219, 24576, v219
    v_mfma_f32_16x16x32_bf16 v[132:135], v[204:207], a[116:119], v[132:135]
    ds_read_b64_tr_b16 v[192:193], v216 offset:0
    ds_read_b64_tr_b16 v[194:195], v216 offset:2048
    v_mfma_f32_16x16x32_bf16 v[132:135], v[200:203], a[100:103], v[132:135]
    ds_read_b64_tr_b16 v[196:197], v216 offset:4096
    ds_read_b64_tr_b16 v[198:199], v216 offset:6144
    v_mfma_f32_16x16x32_bf16 v[136:139], v[200:203], a[104:107], v[136:139]
    s_add_u32 s97, s84, 4096
    buffer_load_dwordx4 a[48:51], v232, s[36:39], s97 offen sc1
    v_mfma_f32_16x16x32_bf16 v[136:139], v[204:207], a[120:123], v[136:139]
    buffer_load_dwordx4 a[56:59], v232, s[36:39], s97 offen offset:1024 sc1
    v_max_f32 v71, 0, v71
    v_mfma_f32_16x16x32_bf16 v[140:143], v[204:207], a[124:127], v[140:143]
    v_mul_f32 v72, v236, v72
    v_max_f32 v72, 0, v72
    v_mfma_f32_16x16x32_bf16 v[140:143], v[200:203], a[108:111], v[140:143]
    ds_read_b64_tr_b16 v[200:201], v217 offset:0
    v_mfma_f32_16x16x32_bf16 v[144:147], v[208:211], a[96:99], v[144:147]
    ds_read_b64_tr_b16 v[202:203], v217 offset:2048
    s_add_u32 s97, s84, 151552
    v_mfma_f32_16x16x32_bf16 v[144:147], v[212:215], a[112:115], v[144:147]
    ds_read_b64_tr_b16 v[204:205], v217 offset:4096
    buffer_load_dwordx4 a[52:55], v232, s[36:39], s97 offen sc1
    v_mfma_f32_16x16x32_bf16 v[148:151], v[212:215], a[116:119], v[148:151]
    ds_read_b64_tr_b16 v[206:207], v217 offset:6144
    v_mul_f32 v73, v236, v73
    v_mfma_f32_16x16x32_bf16 v[148:151], v[208:211], a[100:103], v[148:151]
    v_max_f32 v73, 0, v73
    v_mul_f32 v74, v236, v74
    v_mfma_f32_16x16x32_bf16 v[152:155], v[208:211], a[104:107], v[152:155]
    buffer_load_dwordx4 a[60:63], v232, s[36:39], s97 offen offset:1024 sc1
    v_max_f32 v74, 0, v74
    v_mfma_f32_16x16x32_bf16 v[152:155], v[212:215], a[120:123], v[152:155]
    v_mfma_f32_16x16x32_bf16 v[156:159], v[212:215], a[124:127], v[156:159]
    v_mfma_f32_16x16x32_bf16 v[156:159], v[208:211], a[108:111], v[156:159]
    ds_read_b64_tr_b16 v[208:209], v218 offset:0
    s_waitcnt lgkmcnt(5)
    v_mfma_f32_16x16x32_bf16 v[96:99], v[192:195], a[128:131], v[96:99]
    ds_read_b64_tr_b16 v[210:211], v218 offset:2048
    s_add_u32 s97, s84, 8192
    v_mfma_f32_16x16x32_bf16 v[96:99], v[196:199], a[144:147], v[96:99]
    ds_read_b64_tr_b16 v[212:213], v218 offset:4096
    buffer_load_dwordx4 a[64:67], v232, s[36:39], s97 offen sc1
    v_mfma_f32_16x16x32_bf16 v[100:103], v[196:199], a[148:151], v[100:103]
    ds_read_b64_tr_b16 v[214:215], v218 offset:6144
    v_mul_f32 v75, v236, v75
    v_mfma_f32_16x16x32_bf16 v[100:103], v[192:195], a[132:135], v[100:103]
    v_max_f32 v75, 0, v75
    v_mul_f32 v76, v237, v76
    v_mfma_f32_16x16x32_bf16 v[104:107], v[192:195], a[136:139], v[104:107]
    buffer_load_dwordx4 a[72:75], v232, s[36:39], s97 offen offset:1024 sc1
    v_mfma_f32_16x16x32_bf16 v[104:107], v[196:199], a[152:155], v[104:107]
    v_max_f32 v76, 0, v76
    v_mfma_f32_16x16x32_bf16 v[108:111], v[196:199], a[156:159], v[108:111]
    v_mfma_f32_16x16x32_bf16 v[108:111], v[192:195], a[140:143], v[108:111]
    ds_read_b64_tr_b16 v[192:193], v219 offset:0
    s_waitcnt lgkmcnt(5)
    v_mfma_f32_16x16x32_bf16 v[112:115], v[200:203], a[128:131], v[112:115]
    ds_read_b64_tr_b16 v[194:195], v219 offset:2048
    s_add_u32 s97, s84, 155648
    v_mfma_f32_16x16x32_bf16 v[112:115], v[204:207], a[144:147], v[112:115]
    ds_read_b64_tr_b16 v[196:197], v219 offset:4096
    buffer_load_dwordx4 a[68:71], v232, s[36:39], s97 offen sc1
    v_mfma_f32_16x16x32_bf16 v[116:119], v[204:207], a[148:151], v[116:119]
    ds_read_b64_tr_b16 v[198:199], v219 offset:6144
    v_mul_f32 v77, v237, v77
    v_mfma_f32_16x16x32_bf16 v[116:119], v[200:203], a[132:135], v[116:119]
    v_max_f32 v77, 0, v77
    v_mul_f32 v78, v237, v78
    v_mfma_f32_16x16x32_bf16 v[120:123], v[200:203], a[136:139], v[120:123]
    buffer_load_dwordx4 a[76:79], v232, s[36:39], s97 offen offset:1024 sc1
    v_mfma_f32_16x16x32_bf16 v[120:123], v[204:207], a[152:155], v[120:123]
    v_max_f32 v78, 0, v78
    v_mfma_f32_16x16x32_bf16 v[124:127], v[204:207], a[156:159], v[124:127]
    v_mfma_f32_16x16x32_bf16 v[124:127], v[200:203], a[140:143], v[124:127]
    ds_read_b64_tr_b16 v[200:201], v216 offset:8192
    s_waitcnt lgkmcnt(5)
    v_mfma_f32_16x16x32_bf16 v[128:131], v[208:211], a[128:131], v[128:131]
    ds_read_b64_tr_b16 v[202:203], v216 offset:10240
    s_add_u32 s97, s84, 12288
    v_mfma_f32_16x16x32_bf16 v[128:131], v[212:215], a[144:147], v[128:131]
    ds_read_b64_tr_b16 v[204:205], v216 offset:12288
    buffer_load_dwordx4 a[80:83], v232, s[36:39], s97 offen sc1
    v_mfma_f32_16x16x32_bf16 v[132:135], v[212:215], a[148:151], v[132:135]
    ds_read_b64_tr_b16 v[206:207], v216 offset:14336
    v_mul_f32 v79, v237, v79
    v_mfma_f32_16x16x32_bf16 v[132:135], v[208:211], a[132:135], v[132:135]
    v_max_f32 v79, 0, v79
    v_mfma_f32_16x16x32_bf16 v[136:139], v[208:211], a[136:139], v[136:139]
    buffer_load_dwordx4 a[88:91], v232, s[36:39], s97 offen offset:1024 sc1
    v_mul_f32 v80, v234, v80
    v_mfma_f32_16x16x32_bf16 v[136:139], v[212:215], a[152:155], v[136:139]
    v_mfma_f32_16x16x32_bf16 v[140:143], v[212:215], a[156:159], v[140:143]
    v_max_f32 v80, 0, v80
    v_mfma_f32_16x16x32_bf16 v[140:143], v[208:211], a[140:143], v[140:143]
    ds_read_b64_tr_b16 v[208:209], v217 offset:8192
    s_waitcnt lgkmcnt(5)
    v_mfma_f32_16x16x32_bf16 v[144:147], v[192:195], a[128:131], v[144:147]
    ds_read_b64_tr_b16 v[210:211], v217 offset:10240
    s_add_u32 s97, s84, 159744
    v_mfma_f32_16x16x32_bf16 v[144:147], v[196:199], a[144:147], v[144:147]
    ds_read_b64_tr_b16 v[212:213], v217 offset:12288
    buffer_load_dwordx4 a[84:87], v232, s[36:39], s97 offen sc1
    v_mfma_f32_16x16x32_bf16 v[148:151], v[196:199], a[148:151], v[148:151]
    ds_read_b64_tr_b16 v[214:215], v217 offset:14336
    v_mul_f32 v81, v234, v81
    v_mfma_f32_16x16x32_bf16 v[148:151], v[192:195], a[132:135], v[148:151]
    v_max_f32 v81, 0, v81
    v_mfma_f32_16x16x32_bf16 v[152:155], v[192:195], a[136:139], v[152:155]
    buffer_load_dwordx4 a[92:95], v232, s[36:39], s97 offen offset:1024 sc1
    v_mul_f32 v82, v234, v82
    v_mfma_f32_16x16x32_bf16 v[152:155], v[196:199], a[152:155], v[152:155]
    v_mfma_f32_16x16x32_bf16 v[156:159], v[196:199], a[156:159], v[156:159]
    v_max_f32 v82, 0, v82
    v_mfma_f32_16x16x32_bf16 v[156:159], v[192:195], a[140:143], v[156:159]
    ds_read_b64_tr_b16 v[192:193], v218 offset:8192
    s_waitcnt lgkmcnt(5)
    v_mfma_f32_16x16x32_bf16 v[96:99], v[200:203], a[160:163], v[96:99]
    ds_read_b64_tr_b16 v[194:195], v218 offset:10240
    s_add_u32 s97, s84, 16384
    v_mfma_f32_16x16x32_bf16 v[96:99], v[204:207], a[176:179], v[96:99]
    ds_read_b64_tr_b16 v[196:197], v218 offset:12288
    buffer_load_dwordx4 a[96:99], v232, s[36:39], s97 offen sc1
    v_mfma_f32_16x16x32_bf16 v[100:103], v[204:207], a[180:183], v[100:103]
    ds_read_b64_tr_b16 v[198:199], v218 offset:14336
    v_mul_f32 v83, v234, v83
    v_mfma_f32_16x16x32_bf16 v[100:103], v[200:203], a[164:167], v[100:103]
    v_max_f32 v83, 0, v83
    v_mfma_f32_16x16x32_bf16 v[104:107], v[200:203], a[168:171], v[104:107]
    buffer_load_dwordx4 a[104:107], v232, s[36:39], s97 offen offset:1024 sc1
    v_mfma_f32_16x16x32_bf16 v[104:107], v[204:207], a[184:187], v[104:107]
    v_mul_f32 v84, v235, v84
    v_mfma_f32_16x16x32_bf16 v[108:111], v[204:207], a[188:191], v[108:111]
    v_mfma_f32_16x16x32_bf16 v[108:111], v[200:203], a[172:175], v[108:111]
    ds_read_b64_tr_b16 v[200:201], v219 offset:8192
    s_waitcnt lgkmcnt(5)
    v_mfma_f32_16x16x32_bf16 v[112:115], v[208:211], a[160:163], v[112:115]
    ds_read_b64_tr_b16 v[202:203], v219 offset:10240
    s_add_u32 s97, s84, 163840
    v_mfma_f32_16x16x32_bf16 v[112:115], v[212:215], a[176:179], v[112:115]
    ds_read_b64_tr_b16 v[204:205], v219 offset:12288
    buffer_load_dwordx4 a[100:103], v232, s[36:39], s97 offen sc1
    v_mfma_f32_16x16x32_bf16 v[116:119], v[212:215], a[180:183], v[116:119]
    ds_read_b64_tr_b16 v[206:207], v219 offset:14336
    v_max_f32 v84, 0, v84
    v_mfma_f32_16x16x32_bf16 v[116:119], v[208:211], a[164:167], v[116:119]
    v_mul_f32 v85, v235, v85
    v_max_f32 v85, 0, v85
    v_mfma_f32_16x16x32_bf16 v[120:123], v[208:211], a[168:171], v[120:123]
    buffer_load_dwordx4 a[108:111], v232, s[36:39], s97 offen offset:1024 sc1
    v_mfma_f32_16x16x32_bf16 v[120:123], v[212:215], a[184:187], v[120:123]
    v_mul_f32 v86, v235, v86
    v_mfma_f32_16x16x32_bf16 v[124:127], v[212:215], a[188:191], v[124:127]
sequential_preLN__linear_kernel_hedgehog__glu_gated_reglu__prompt_kernel_hop1_5:
    s_cbranch_execz sequential_preLN__linear_kernel_hedgehog__glu_gated_reglu__prompt_kernel_hop1_6
    v_mfma_f32_16x16x32_bf16 v[124:127], v[208:211], a[172:175], v[124:127]
    ds_read_b64_tr_b16 v[208:209], v216 offset:16384
    s_waitcnt lgkmcnt(5)
    v_mfma_f32_16x16x32_bf16 v[128:131], v[192:195], a[160:163], v[128:131]
    ds_read_b64_tr_b16 v[210:211], v216 offset:18432
    s_add_u32 s97, s84, 20480
    v_mfma_f32_16x16x32_bf16 v[128:131], v[196:199], a[176:179], v[128:131]
    ds_read_b64_tr_b16 v[212:213], v216 offset:20480
    buffer_load_dwordx4 a[112:115], v232, s[36:39], s97 offen sc1
    v_mfma_f32_16x16x32_bf16 v[132:135], v[196:199], a[180:183], v[132:135]
    ds_read_b64_tr_b16 v[214:215], v216 offset:22528
    v_max_f32 v86, 0, v86
    v_mfma_f32_16x16x32_bf16 v[132:135], v[192:195], a[164:167], v[132:135]
    v_mul_f32 v87, v235, v87
    v_mfma_f32_16x16x32_bf16 v[136:139], v[192:195], a[168:171], v[136:139]
    buffer_load_dwordx4 a[120:123], v232, s[36:39], s97 offen offset:1024 sc1
    v_max_f32 v87, 0, v87
    v_mfma_f32_16x16x32_bf16 v[136:139], v[196:199], a[184:187], v[136:139]
    v_mfma_f32_16x16x32_bf16 v[140:143], v[196:199], a[188:191], v[140:143]
    v_mul_f32 v88, v236, v88
    v_mfma_f32_16x16x32_bf16 v[140:143], v[192:195], a[172:175], v[140:143]
    ds_read_b64_tr_b16 v[192:193], v217 offset:16384
    s_waitcnt lgkmcnt(5)
    v_mfma_f32_16x16x32_bf16 v[144:147], v[200:203], a[160:163], v[144:147]
    ds_read_b64_tr_b16 v[194:195], v217 offset:18432
    s_add_u32 s97, s84, 167936
    v_mfma_f32_16x16x32_bf16 v[144:147], v[204:207], a[176:179], v[144:147]
    ds_read_b64_tr_b16 v[196:197], v217 offset:20480
    buffer_load_dwordx4 a[116:119], v232, s[36:39], s97 offen sc1
    v_mfma_f32_16x16x32_bf16 v[148:151], v[204:207], a[180:183], v[148:151]
    ds_read_b64_tr_b16 v[198:199], v217 offset:22528
    v_max_f32 v88, 0, v88
    v_mfma_f32_16x16x32_bf16 v[148:151], v[200:203], a[164:167], v[148:151]
    v_mul_f32 v89, v236, v89
    v_mfma_f32_16x16x32_bf16 v[152:155], v[200:203], a[168:171], v[152:155]
    buffer_load_dwordx4 a[124:127], v232, s[36:39], s97 offen offset:1024 sc1
    v_max_f32 v89, 0, v89
    v_mfma_f32_16x16x32_bf16 v[152:155], v[204:207], a[184:187], v[152:155]
    v_mfma_f32_16x16x32_bf16 v[156:159], v[204:207], a[188:191], v[156:159]
    v_mul_f32 v90, v236, v90
    v_mfma_f32_16x16x32_bf16 v[156:159], v[200:203], a[172:175], v[156:159]
    ds_read_b64_tr_b16 v[200:201], v218 offset:16384
    s_waitcnt lgkmcnt(5)
    v_mfma_f32_16x16x32_bf16 v[96:99], v[208:211], a[192:195], v[96:99]
    ds_read_b64_tr_b16 v[202:203], v218 offset:18432
    s_add_u32 s97, s84, 24576
    v_mfma_f32_16x16x32_bf16 v[96:99], v[212:215], a[208:211], v[96:99]
    ds_read_b64_tr_b16 v[204:205], v218 offset:20480
    buffer_load_dwordx4 a[128:131], v232, s[36:39], s97 offen sc1
    v_mfma_f32_16x16x32_bf16 v[100:103], v[212:215], a[212:215], v[100:103]
    ds_read_b64_tr_b16 v[206:207], v218 offset:22528
    v_max_f32 v90, 0, v90
    v_mfma_f32_16x16x32_bf16 v[100:103], v[208:211], a[196:199], v[100:103]
    v_mul_f32 v91, v236, v91
    v_mfma_f32_16x16x32_bf16 v[104:107], v[208:211], a[200:203], v[104:107]
    buffer_load_dwordx4 a[136:139], v232, s[36:39], s97 offen offset:1024 sc1
    v_max_f32 v91, 0, v91
    v_mfma_f32_16x16x32_bf16 v[104:107], v[212:215], a[216:219], v[104:107]
    v_mfma_f32_16x16x32_bf16 v[108:111], v[212:215], a[220:223], v[108:111]
    v_mfma_f32_16x16x32_bf16 v[108:111], v[208:211], a[204:207], v[108:111]
    ds_read_b64_tr_b16 v[208:209], v219 offset:16384
    s_waitcnt lgkmcnt(5)
    v_mfma_f32_16x16x32_bf16 v[112:115], v[192:195], a[192:195], v[112:115]
    ds_read_b64_tr_b16 v[210:211], v219 offset:18432
    s_add_u32 s97, s84, 172032
    v_mfma_f32_16x16x32_bf16 v[112:115], v[196:199], a[208:211], v[112:115]
    ds_read_b64_tr_b16 v[212:213], v219 offset:20480
    buffer_load_dwordx4 a[132:135], v232, s[36:39], s97 offen sc1
    v_mfma_f32_16x16x32_bf16 v[116:119], v[196:199], a[212:215], v[116:119]
    ds_read_b64_tr_b16 v[214:215], v219 offset:22528
    v_mul_f32 v92, v237, v92
    v_mfma_f32_16x16x32_bf16 v[116:119], v[192:195], a[196:199], v[116:119]
    v_max_f32 v92, 0, v92
    v_mul_f32 v93, v237, v93
    v_mfma_f32_16x16x32_bf16 v[120:123], v[192:195], a[200:203], v[120:123]
    s_waitcnt vmcnt(51)
    buffer_load_dwordx4 a[140:143], v232, s[36:39], s97 offen offset:1024 sc1
    v_mfma_f32_16x16x32_bf16 v[120:123], v[196:199], a[216:219], v[120:123]
    v_max_f32 v93, 0, v93
    v_mfma_f32_16x16x32_bf16 v[124:127], v[196:199], a[220:223], v[124:127]
    v_mfma_f32_16x16x32_bf16 v[124:127], v[192:195], a[204:207], v[124:127]
    s_waitcnt lgkmcnt(0)
    s_barrier
    v_mfma_f32_16x16x32_bf16 v[128:131], v[200:203], a[192:195], v[128:131]
    v_and_b32 v216, 0xc0, v232
    v_and_b32 v217, 24, v233
    v_mfma_f32_16x16x32_bf16 v[128:131], v[204:207], a[208:211], v[128:131]
    v_add_u32 v216, v216, v217
    v_lshrrev_b32 v217, 8, v232
    v_mfma_f32_16x16x32_bf16 v[132:135], v[204:207], a[212:215], v[132:135]
    v_lshl_add_u32 v216, v217, 10, v216
    v_and_b32 v217, 1, v217
    v_mfma_f32_16x16x32_bf16 v[132:135], v[200:203], a[196:199], v[132:135]
    v_lshl_add_u32 v216, v217, 5, v216
    v_xor_b32 v217, 32, v216
    v_mfma_f32_16x16x32_bf16 v[136:139], v[200:203], a[200:203], v[136:139]
    v_mov_b32 v220, v232
    v_add_u32 v220, 122880, v220
    v_mfma_f32_16x16x32_bf16 v[136:139], v[204:207], a[216:219], v[136:139]
    v_add_u32 v216, 122880, v216
    v_add_u32 v217, 122880, v217
    v_mfma_f32_16x16x32_bf16 v[140:143], v[204:207], a[220:223], v[140:143]
    ds_read_b64_tr_b16 a[224:225], v216 offset:0
    ds_read_b64_tr_b16 a[226:227], v216 offset:4096
    v_mfma_f32_16x16x32_bf16 v[140:143], v[200:203], a[204:207], v[140:143]
    ds_read_b64_tr_b16 a[228:229], v216 offset:9216
    ds_read_b64_tr_b16 a[230:231], v216 offset:13312
    v_mfma_f32_16x16x32_bf16 v[144:147], v[208:211], a[192:195], v[144:147]
    ds_read_b64_tr_b16 a[232:233], v217 offset:0
    ds_read_b64_tr_b16 a[234:235], v217 offset:4096
    v_mfma_f32_16x16x32_bf16 v[144:147], v[212:215], a[208:211], v[144:147]
    ds_read_b64_tr_b16 a[236:237], v217 offset:9216
    ds_read_b64_tr_b16 a[238:239], v217 offset:13312
    v_mfma_f32_16x16x32_bf16 v[148:151], v[212:215], a[212:215], v[148:151]
    ds_read_b64_tr_b16 a[240:241], v216 offset:256
    ds_read_b64_tr_b16 a[242:243], v216 offset:4352
    v_mfma_f32_16x16x32_bf16 v[148:151], v[208:211], a[196:199], v[148:151]
    ds_read_b64_tr_b16 a[244:245], v216 offset:9472
    ds_read_b64_tr_b16 a[246:247], v216 offset:13568
    v_mfma_f32_16x16x32_bf16 v[152:155], v[208:211], a[200:203], v[152:155]
    s_add_u32 s97, s84, 28672
    s_waitcnt vmcnt(51)
    buffer_load_dwordx4 a[144:147], v232, s[36:39], s97 offen sc1
    v_mfma_f32_16x16x32_bf16 v[152:155], v[212:215], a[216:219], v[152:155]
    s_waitcnt vmcnt(51)
    buffer_load_dwordx4 a[152:155], v232, s[36:39], s97 offen offset:1024 sc1
    s_add_u32 s97, s84, 176128
    v_mfma_f32_16x16x32_bf16 v[156:159], v[212:215], a[220:223], v[156:159]
    s_waitcnt vmcnt(51)
    buffer_load_dwordx4 a[148:151], v232, s[36:39], s97 offen sc1
    s_waitcnt vmcnt(51)
    buffer_load_dwordx4 a[156:159], v232, s[36:39], s97 offen offset:1024 sc1
    v_mfma_f32_16x16x32_bf16 v[156:159], v[208:211], a[204:207], v[156:159]
    ds_read_b64_tr_b16 a[248:249], v217 offset:256
    v_mul_f32 v94, v237, v94
    v_max_f32 v94, 0, v94
    v_mul_f32 v95, v237, v95
    v_max_f32 v95, 0, v95
    s_waitcnt vmcnt(44) lgkmcnt(9)
    v_mfma_f32_16x16x32_bf16 v[0:3], a[224:227], a[0:3], 0
    ds_read_b64_tr_b16 a[250:251], v217 offset:4352
    s_add_u32 s98, s80, 589824
    s_add_u32 s99, s89, 16384
    v_mfma_f32_16x16x32_bf16 v[0:3], a[228:231], a[8:11], v[0:3]
    ds_read_b64_tr_b16 a[252:253], v217 offset:9472
    s_add_u32 m0, s93, 12288
    s_nop 0
    buffer_load_dwordx4 v223, s[28:31], s98 offen offset:0 lds
    v_mfma_f32_16x16x32_bf16 v[164:167], a[228:231], a[12:15], 0
    ds_read_b64_tr_b16 a[254:255], v217 offset:13568
    buffer_load_dwordx4 v224, s[28:31], s98 offen offset:1024 lds
    buffer_load_dwordx4 v225, s[28:31], s98 offen offset:2048 lds
    v_mfma_f32_16x16x32_bf16 v[164:167], a[224:227], a[4:7], v[164:167]
    ds_read_b64_tr_b16 a[224:225], v216 offset:512
    v_mul_f32 v96, v96, v32
    s_waitcnt lgkmcnt(9)
    v_mfma_f32_16x16x32_bf16 v[4:7], a[232:235], a[0:3], 0
    ds_read_b64_tr_b16 a[226:227], v216 offset:4608
    v_mul_f32 v97, v97, v33
    v_mul_f32 v98, v98, v34
    v_mfma_f32_16x16x32_bf16 v[4:7], a[236:239], a[8:11], v[4:7]
    ds_read_b64_tr_b16 a[228:229], v216 offset:9728
    v_mul_f32 v99, v99, v35
    v_mfma_f32_16x16x32_bf16 v[168:171], a[236:239], a[12:15], 0
    ds_read_b64_tr_b16 a[230:231], v216 offset:13824
    buffer_load_dwordx4 v226, s[28:31], s98 offen offset:3072 lds
    v_cvt_pk_bf16_f32 v248, v96, v97
    v_mfma_f32_16x16x32_bf16 v[168:171], a[232:235], a[4:7], v[168:171]
    ds_read_b64_tr_b16 a[232:233], v217 offset:512
    v_cvt_pk_bf16_f32 v249, v98, v99
    s_waitcnt lgkmcnt(9)
    v_mfma_f32_16x16x32_bf16 v[8:11], a[240:243], a[0:3], 0
    ds_read_b64_tr_b16 a[234:235], v217 offset:4608
    v_mul_f32 v112, v112, v48
    v_mfma_f32_16x16x32_bf16 v[8:11], a[244:247], a[8:11], v[8:11]
    ds_read_b64_tr_b16 a[236:237], v217 offset:9728
    v_mul_f32 v113, v113, v49
    v_mfma_f32_16x16x32_bf16 v[172:175], a[244:247], a[12:15], 0
    ds_read_b64_tr_b16 a[238:239], v217 offset:13824
    v_mul_f32 v114, v114, v50
    v_mfma_f32_16x16x32_bf16 v[172:175], a[240:243], a[4:7], v[172:175]
    ds_read_b64_tr_b16 a[240:241], v216 offset:768
    v_mul_f32 v115, v115, v51
    s_waitcnt lgkmcnt(9)
    v_mfma_f32_16x16x32_bf16 v[12:15], a[248:251], a[0:3], 0
    ds_read_b64_tr_b16 a[242:243], v216 offset:4864
    s_add_u32 m0, s93, 16384
    v_cvt_pk_bf16_f32 v250, v112, v113
    v_mfma_f32_16x16x32_bf16 v[12:15], a[252:255], a[8:11], v[12:15]
    ds_read_b64_tr_b16 a[244:245], v216 offset:9984
    buffer_load_dwordx4 v227, s[28:31], s98 offen offset:0 lds
    v_cvt_pk_bf16_f32 v251, v114, v115
    v_mfma_f32_16x16x32_bf16 v[176:179], a[252:255], a[12:15], 0
    ds_read_b64_tr_b16 a[246:247], v216 offset:14080
    s_add_u32 s95, s82, 2048
    buffer_store_dwordx4 v[248:251], v232, s[36:39], s95 offen offset:0 sc1
    v_mfma_f32_16x16x32_bf16 v[176:179], a[248:251], a[4:7], v[176:179]
    ds_read_b64_tr_b16 a[248:249], v217 offset:768
    v_mul_f32 v128, v128, v64
    s_waitcnt lgkmcnt(9)
    v_mfma_f32_16x16x32_bf16 v[16:19], a[224:227], a[0:3], 0
    ds_read_b64_tr_b16 a[250:251], v217 offset:4864
    v_mul_f32 v129, v129, v65
    v_mfma_f32_16x16x32_bf16 v[16:19], a[228:231], a[8:11], v[16:19]
    ds_read_b64_tr_b16 a[252:253], v217 offset:9984
    v_mul_f32 v130, v130, v66
    v_mfma_f32_16x16x32_bf16 v[180:183], a[228:231], a[12:15], 0
    ds_read_b64_tr_b16 a[254:255], v217 offset:14080
    v_mul_f32 v131, v131, v67
    v_mfma_f32_16x16x32_bf16 v[180:183], a[224:227], a[4:7], v[180:183]
    ds_read_b128 a[224:227], v220 offset:8192
    v_cvt_pk_bf16_f32 v252, v128, v129
    s_waitcnt lgkmcnt(9)
    v_mfma_f32_16x16x32_bf16 v[20:23], a[232:235], a[0:3], 0
    ds_read_b128 a[228:231], v220 offset:17408
    buffer_load_dwordx4 v228, s[28:31], s98 offen offset:1024 lds
    v_cvt_pk_bf16_f32 v253, v130, v131
    v_mfma_f32_16x16x32_bf16 v[20:23], a[236:239], a[8:11], v[20:23]
    v_mul_f32 v144, v144, v80
    v_mul_f32 v145, v145, v81
    v_mfma_f32_16x16x32_bf16 v[184:187], a[236:239], a[12:15], 0
    v_mul_f32 v146, v146, v82
    v_mfma_f32_16x16x32_bf16 v[184:187], a[232:235], a[4:7], v[184:187]
    ds_read_b64_tr_b16 a[232:233], v216 offset:18432
    v_mul_f32 v147, v147, v83
    s_waitcnt lgkmcnt(7)
    v_mfma_f32_16x16x32_bf16 v[24:27], a[240:243], a[0:3], 0
    ds_read_b64_tr_b16 a[234:235], v216 offset:22528
    v_cvt_pk_bf16_f32 v254, v144, v145
    v_mfma_f32_16x16x32_bf16 v[24:27], a[244:247], a[8:11], v[24:27]
    ds_read_b64_tr_b16 a[236:237], v216 offset:27648
    v_cvt_pk_bf16_f32 v255, v146, v147
    v_mfma_f32_16x16x32_bf16 v[188:191], a[244:247], a[12:15], 0
    ds_read_b64_tr_b16 a[238:239], v216 offset:31744
    buffer_store_dwordx4 v[252:255], v232, s[36:39], s95 offen offset:1024 sc1
    v_mfma_f32_16x16x32_bf16 v[188:191], a[240:243], a[4:7], v[188:191]
    ds_read_b64_tr_b16 a[240:241], v217 offset:18432
    s_waitcnt vmcnt(51)
    buffer_load_dwordx4 v229, s[28:31], s98 offen offset:2048 lds
    s_waitcnt lgkmcnt(7)
    v_mfma_f32_16x16x32_bf16 v[28:31], a[248:251], a[0:3], 0
    ds_read_b64_tr_b16 a[242:243], v217 offset:22528
    v_mul_f32 v100, v100, v36
    v_mul_f32 v101, v101, v37
    v_mfma_f32_16x16x32_bf16 v[28:31], a[252:255], a[8:11], v[28:31]
    ds_read_b64_tr_b16 a[244:245], v217 offset:27648
    v_mul_f32 v102, v102, v38
    v_mul_f32 v103, v103, v39
    v_mfma_f32_16x16x32_bf16 v[208:211], a[252:255], a[12:15], 0
    ds_read_b64_tr_b16 a[246:247], v217 offset:31744
    v_cvt_pk_bf16_f32 v248, v100, v101
    v_mfma_f32_16x16x32_bf16 v[208:211], a[248:251], a[4:7], v[208:211]
    ds_read_b64_tr_b16 a[248:249], v216 offset:18688
    v_cvt_pk_bf16_f32 v249, v102, v103
    s_waitcnt lgkmcnt(9)
    v_mfma_f32_16x16x32_bf16 v[160:163], a[224:227], a[0:3], 0
    ds_read_b64_tr_b16 a[250:251], v216 offset:22784
    v_mul_f32 v116, v116, v52
    v_mfma_f32_16x16x32_bf16 v[160:163], a[228:231], a[8:11], v[160:163]
    ds_read_b64_tr_b16 a[252:253], v216 offset:27904
    v_mul_f32 v117, v117, v53
    v_mfma_f32_16x16x32_bf16 v[212:215], a[228:231], a[12:15], 0
    ds_read_b64_tr_b16 a[254:255], v216 offset:32000
    s_waitcnt vmcnt(51)
    buffer_load_dwordx4 v230, s[28:31], s98 offen offset:3072 lds
    v_mul_f32 v118, v118, v54
    v_mfma_f32_16x16x32_bf16 v[212:215], a[224:227], a[4:7], v[212:215]
    ds_read_b64_tr_b16 a[224:225], v217 offset:18688
    v_mul_f32 v119, v119, v55
    s_waitcnt vmcnt(43) lgkmcnt(9)
    v_mfma_f32_16x16x32_bf16 v[0:3], a[232:235], a[16:19], v[0:3]
    ds_read_b64_tr_b16 a[226:227], v217 offset:22784
    v_cvt_pk_bf16_f32 v250, v116, v117
    v_mfma_f32_16x16x32_bf16 v[0:3], a[236:239], a[24:27], v[0:3]
    ds_read_b64_tr_b16 a[228:229], v217 offset:27904
    v_cvt_pk_bf16_f32 v251, v118, v119
    v_mfma_f32_16x16x32_bf16 v[164:167], a[236:239], a[28:31], v[164:167]
    ds_read_b64_tr_b16 a[230:231], v217 offset:32000
    s_add_u32 s95, s82, 149504
    buffer_store_dwordx4 v[248:251], v232, s[36:39], s95 offen offset:0 sc1
    v_mfma_f32_16x16x32_bf16 v[164:167], a[232:235], a[20:23], v[164:167]
    ds_read_b64_tr_b16 a[232:233], v216 offset:18944
    v_mul_f32 v132, v132, v68
    s_waitcnt lgkmcnt(9)
    v_mfma_f32_16x16x32_bf16 v[4:7], a[240:243], a[16:19], v[4:7]
    ds_read_b64_tr_b16 a[234:235], v216 offset:23040
    s_add_u32 m0, s93, 20480
    v_mul_f32 v133, v133, v69
    v_mfma_f32_16x16x32_bf16 v[4:7], a[244:247], a[24:27], v[4:7]
    ds_read_b64_tr_b16 a[236:237], v216 offset:28160
    buffer_load_dwordx4 v232, s[36:39], s99 offen sc1 lds
    v_mul_f32 v134, v134, v70
    v_mfma_f32_16x16x32_bf16 v[168:171], a[244:247], a[28:31], v[168:171]
    ds_read_b64_tr_b16 a[238:239], v216 offset:32256
    v_mul_f32 v135, v135, v71
    v_mfma_f32_16x16x32_bf16 v[168:171], a[240:243], a[20:23], v[168:171]
    ds_read_b64_tr_b16 a[240:241], v217 offset:18944
    v_cvt_pk_bf16_f32 v252, v132, v133
    s_waitcnt lgkmcnt(9)
    v_mfma_f32_16x16x32_bf16 v[8:11], a[248:251], a[16:19], v[8:11]
    ds_read_b64_tr_b16 a[242:243], v217 offset:23040
    v_cvt_pk_bf16_f32 v253, v134, v135
    v_mfma_f32_16x16x32_bf16 v[8:11], a[252:255], a[24:27], v[8:11]
    ds_read_b64_tr_b16 a[244:245], v217 offset:28160
    v_mul_f32 v148, v148, v84
    v_mfma_f32_16x16x32_bf16 v[172:175], a[252:255], a[28:31], v[172:175]
    ds_read_b64_tr_b16 a[246:247], v217 offset:32256
    v_mul_f32 v149, v149, v85
    v_mfma_f32_16x16x32_bf16 v[172:175], a[248:251], a[20:23], v[172:175]
    ds_read_b64_tr_b16 a[248:249], v216 offset:19200
    v_mul_f32 v150, v150, v86
    s_waitcnt lgkmcnt(9)
    v_mfma_f32_16x16x32_bf16 v[12:15], a[224:227], a[16:19], v[12:15]
    ds_read_b64_tr_b16 a[250:251], v216 offset:23296
    v_mul_f32 v151, v151, v87
    v_cvt_pk_bf16_f32 v254, v148, v149
    v_mfma_f32_16x16x32_bf16 v[12:15], a[228:231], a[24:27], v[12:15]
    ds_read_b64_tr_b16 a[252:253], v216 offset:28416
    v_cvt_pk_bf16_f32 v255, v150, v151
    v_mfma_f32_16x16x32_bf16 v[176:179], a[228:231], a[28:31], v[176:179]
    ds_read_b64_tr_b16 a[254:255], v216 offset:32512
    buffer_store_dwordx4 v[252:255], v232, s[36:39], s95 offen offset:1024 sc1
    v_mfma_f32_16x16x32_bf16 v[176:179], a[224:227], a[20:23], v[176:179]
    ds_read_b64_tr_b16 a[224:225], v217 offset:19200
    v_mul_f32 v104, v104, v40
    s_waitcnt lgkmcnt(9)
    v_mfma_f32_16x16x32_bf16 v[16:19], a[232:235], a[16:19], v[16:19]
    ds_read_b64_tr_b16 a[226:227], v217 offset:23296
    v_mul_f32 v105, v105, v41
    v_mfma_f32_16x16x32_bf16 v[16:19], a[236:239], a[24:27], v[16:19]
    ds_read_b64_tr_b16 a[228:229], v217 offset:28416
    v_mul_f32 v106, v106, v42
    v_mfma_f32_16x16x32_bf16 v[180:183], a[236:239], a[28:31], v[180:183]
    ds_read_b64_tr_b16 a[230:231], v217 offset:32512
    v_mul_f32 v107, v107, v43
    v_mfma_f32_16x16x32_bf16 v[180:183], a[232:235], a[20:23], v[180:183]
    ds_read_b128 a[232:235], v220 offset:26624
    v_cvt_pk_bf16_f32 v248, v104, v105
    s_waitcnt lgkmcnt(9)
    v_mfma_f32_16x16x32_bf16 v[20:23], a[240:243], a[16:19], v[20:23]
    ds_read_b128 a[236:239], v220 offset:35840
    v_cvt_pk_bf16_f32 v249, v106, v107
    v_mul_f32 v120, v120, v56
    v_mfma_f32_16x16x32_bf16 v[20:23], a[244:247], a[24:27], v[20:23]
    v_mul_f32 v121, v121, v57
    v_mfma_f32_16x16x32_bf16 v[184:187], a[244:247], a[28:31], v[184:187]
    v_mul_f32 v122, v122, v58
    v_mfma_f32_16x16x32_bf16 v[184:187], a[240:243], a[20:23], v[184:187]
    s_waitcnt lgkmcnt(0)
    s_barrier
    v_mfma_f32_16x16x32_bf16 v[24:27], a[248:251], a[16:19], v[24:27]
    v_subrev_u32 v220, 36864, v220
    v_subrev_u32 v216, 36864, v216
    v_subrev_u32 v217, 36864, v217
    v_mfma_f32_16x16x32_bf16 v[24:27], a[252:255], a[24:27], v[24:27]
    ds_read_b64_tr_b16 a[240:241], v216 offset:0
    ds_read_b64_tr_b16 a[242:243], v216 offset:4096
    s_add_u32 s98, s80, 884736
    v_mfma_f32_16x16x32_bf16 v[188:191], a[252:255], a[28:31], v[188:191]
    ds_read_b64_tr_b16 a[244:245], v216 offset:9216
    s_add_u32 s99, s89, 24576
    s_add_u32 m0, s93, 122880
    v_mfma_f32_16x16x32_bf16 v[188:191], a[248:251], a[20:23], v[188:191]
    ds_read_b64_tr_b16 a[246:247], v216 offset:13312
    ds_read_b64_tr_b16 a[248:249], v217 offset:0
    v_mfma_f32_16x16x32_bf16 v[28:31], a[224:227], a[16:19], v[28:31]
    ds_read_b64_tr_b16 a[250:251], v217 offset:4096
    buffer_load_dwordx4 v223, s[28:31], s98 offen offset:0 lds
    v_mul_f32 v123, v123, v59
    v_mfma_f32_16x16x32_bf16 v[28:31], a[228:231], a[24:27], v[28:31]
    ds_read_b64_tr_b16 a[252:253], v217 offset:9216
    v_cvt_pk_bf16_f32 v250, v120, v121
    v_cvt_pk_bf16_f32 v251, v122, v123
    v_mfma_f32_16x16x32_bf16 v[208:211], a[228:231], a[28:31], v[208:211]
    ds_read_b64_tr_b16 a[254:255], v217 offset:13312
    s_add_u32 s95, s82, 296960
    buffer_store_dwordx4 v[248:251], v232, s[36:39], s95 offen offset:0 sc1
    v_mfma_f32_16x16x32_bf16 v[208:211], a[224:227], a[20:23], v[208:211]
    ds_read_b64_tr_b16 a[224:225], v216 offset:256
    v_mul_f32 v136, v136, v72
    v_mfma_f32_16x16x32_bf16 v[160:163], a[232:235], a[16:19], v[160:163]
    ds_read_b64_tr_b16 a[226:227], v216 offset:4352
    buffer_load_dwordx4 v224, s[28:31], s98 offen offset:1024 lds
    v_mul_f32 v137, v137, v73
    v_mfma_f32_16x16x32_bf16 v[160:163], a[236:239], a[24:27], v[160:163]
    ds_read_b64_tr_b16 a[228:229], v216 offset:9472
    v_mul_f32 v138, v138, v74
    v_mul_f32 v139, v139, v75
    v_mfma_f32_16x16x32_bf16 v[212:215], a[236:239], a[28:31], v[212:215]
    ds_read_b64_tr_b16 a[230:231], v216 offset:13568
    v_cvt_pk_bf16_f32 v252, v136, v137
    v_cvt_pk_bf16_f32 v253, v138, v139
    v_mfma_f32_16x16x32_bf16 v[212:215], a[232:235], a[20:23], v[212:215]
    ds_read_b64_tr_b16 a[232:233], v217 offset:256
    v_mul_f32 v152, v152, v88
    s_waitcnt vmcnt(44) lgkmcnt(9)
    v_mfma_f32_16x16x32_bf16 v[0:3], a[240:243], a[32:35], v[0:3]
    ds_read_b64_tr_b16 a[234:235], v217 offset:4352
    v_mul_f32 v153, v153, v89
    v_mul_f32 v154, v154, v90
    v_mfma_f32_16x16x32_bf16 v[0:3], a[244:247], a[40:43], v[0:3]
    ds_read_b64_tr_b16 a[236:237], v217 offset:9472
    v_mul_f32 v155, v155, v91
    v_cvt_pk_bf16_f32 v254, v152, v153
    v_mfma_f32_16x16x32_bf16 v[164:167], a[244:247], a[44:47], v[164:167]
    ds_read_b64_tr_b16 a[238:239], v217 offset:13568
    v_cvt_pk_bf16_f32 v255, v154, v155
    buffer_store_dwordx4 v[252:255], v232, s[36:39], s95 offen offset:1024 sc1
    v_mfma_f32_16x16x32_bf16 v[164:167], a[240:243], a[36:39], v[164:167]
    ds_read_b64_tr_b16 a[240:241], v216 offset:512
    buffer_load_dwordx4 v225, s[28:31], s98 offen offset:2048 lds
    s_waitcnt lgkmcnt(9)
    v_mfma_f32_16x16x32_bf16 v[4:7], a[248:251], a[32:35], v[4:7]
    ds_read_b64_tr_b16 a[242:243], v216 offset:4608
    v_mul_f32 v108, v108, v44
    v_mul_f32 v109, v109, v45
    v_mfma_f32_16x16x32_bf16 v[4:7], a[252:255], a[40:43], v[4:7]
    ds_read_b64_tr_b16 a[244:245], v216 offset:9728
    v_mul_f32 v110, v110, v46
    v_mfma_f32_16x16x32_bf16 v[168:171], a[252:255], a[44:47], v[168:171]
    ds_read_b64_tr_b16 a[246:247], v216 offset:13824
    v_mul_f32 v111, v111, v47
    v_mfma_f32_16x16x32_bf16 v[168:171], a[248:251], a[36:39], v[168:171]
    ds_read_b64_tr_b16 a[248:249], v217 offset:512
    v_cvt_pk_bf16_f32 v248, v108, v109
    s_waitcnt lgkmcnt(9)
    v_mfma_f32_16x16x32_bf16 v[8:11], a[224:227], a[32:35], v[8:11]
    ds_read_b64_tr_b16 a[250:251], v217 offset:4608
    v_cvt_pk_bf16_f32 v249, v110, v111
    v_mfma_f32_16x16x32_bf16 v[8:11], a[228:231], a[40:43], v[8:11]
    ds_read_b64_tr_b16 a[252:253], v217 offset:9728
    v_mul_f32 v124, v124, v60
    v_mfma_f32_16x16x32_bf16 v[172:175], a[228:231], a[44:47], v[172:175]
    ds_read_b64_tr_b16 a[254:255], v217 offset:13824
    buffer_load_dwordx4 v226, s[28:31], s98 offen offset:3072 lds
    v_mul_f32 v125, v125, v61
    v_mfma_f32_16x16x32_bf16 v[172:175], a[224:227], a[36:39], v[172:175]
    ds_read_b64_tr_b16 a[224:225], v216 offset:768
    v_mul_f32 v126, v126, v62
    s_waitcnt lgkmcnt(9)
    v_mfma_f32_16x16x32_bf16 v[12:15], a[232:235], a[32:35], v[12:15]
    ds_read_b64_tr_b16 a[226:227], v216 offset:4864
    v_mul_f32 v127, v127, v63
    v_cvt_pk_bf16_f32 v250, v124, v125
    v_mfma_f32_16x16x32_bf16 v[12:15], a[236:239], a[40:43], v[12:15]
    ds_read_b64_tr_b16 a[228:229], v216 offset:9984
    v_cvt_pk_bf16_f32 v251, v126, v127
    v_mfma_f32_16x16x32_bf16 v[176:179], a[236:239], a[44:47], v[176:179]
    ds_read_b64_tr_b16 a[230:231], v216 offset:14080
    s_add_u32 s95, s82, 444416
    v_mfma_f32_16x16x32_bf16 v[176:179], a[232:235], a[36:39], v[176:179]
    ds_read_b64_tr_b16 a[232:233], v217 offset:768
    buffer_store_dwordx4 v[248:251], v232, s[36:39], s95 offen offset:0 sc1
    s_waitcnt lgkmcnt(9)
    v_mfma_f32_16x16x32_bf16 v[16:19], a[240:243], a[32:35], v[16:19]
    ds_read_b64_tr_b16 a[234:235], v217 offset:4864
    s_add_u32 m0, s93, 126976
    v_mul_f32 v140, v140, v76
    v_mfma_f32_16x16x32_bf16 v[16:19], a[244:247], a[40:43], v[16:19]
    ds_read_b64_tr_b16 a[236:237], v217 offset:9984
    buffer_load_dwordx4 v227, s[28:31], s98 offen offset:0 lds
    v_mul_f32 v141, v141, v77
    v_mfma_f32_16x16x32_bf16 v[180:183], a[244:247], a[44:47], v[180:183]
    ds_read_b64_tr_b16 a[238:239], v217 offset:14080
    v_mul_f32 v142, v142, v78
    v_mfma_f32_16x16x32_bf16 v[180:183], a[240:243], a[36:39], v[180:183]
    ds_read_b128 a[240:243], v220 offset:8192
    v_mul_f32 v143, v143, v79
    s_waitcnt lgkmcnt(9)
    v_mfma_f32_16x16x32_bf16 v[20:23], a[248:251], a[32:35], v[20:23]
    ds_read_b128 a[244:247], v220 offset:17408
    v_cvt_pk_bf16_f32 v252, v140, v141
    v_cvt_pk_bf16_f32 v253, v142, v143
    v_mfma_f32_16x16x32_bf16 v[20:23], a[252:255], a[40:43], v[20:23]
    v_mul_f32 v156, v156, v92
    v_mfma_f32_16x16x32_bf16 v[184:187], a[252:255], a[44:47], v[184:187]
    v_mul_f32 v157, v157, v93
    v_mfma_f32_16x16x32_bf16 v[184:187], a[248:251], a[36:39], v[184:187]
    ds_read_b64_tr_b16 a[248:249], v216 offset:18432
    v_mul_f32 v158, v158, v94
    s_waitcnt lgkmcnt(7)
    v_mfma_f32_16x16x32_bf16 v[24:27], a[224:227], a[32:35], v[24:27]
    ds_read_b64_tr_b16 a[250:251], v216 offset:22528
    buffer_load_dwordx4 v228, s[28:31], s98 offen offset:1024 lds
    v_mul_f32 v159, v159, v95
    v_mfma_f32_16x16x32_bf16 v[24:27], a[228:231], a[40:43], v[24:27]
    ds_read_b64_tr_b16 a[252:253], v216 offset:27648
    v_cvt_pk_bf16_f32 v254, v156, v157
    v_mfma_f32_16x16x32_bf16 v[188:191], a[228:231], a[44:47], v[188:191]
    ds_read_b64_tr_b16 a[254:255], v216 offset:31744
    v_cvt_pk_bf16_f32 v255, v158, v159
    v_mfma_f32_16x16x32_bf16 v[188:191], a[224:227], a[36:39], v[188:191]
    ds_read_b64_tr_b16 a[224:225], v217 offset:18432
    buffer_store_dwordx4 v[252:255], v232, s[36:39], s95 offen offset:1024 sc1
    s_waitcnt lgkmcnt(7)
    v_mfma_f32_16x16x32_bf16 v[28:31], a[232:235], a[32:35], v[28:31]
    ds_read_b64_tr_b16 a[226:227], v217 offset:22528
    v_mfma_f32_16x16x32_bf16 v[28:31], a[236:239], a[40:43], v[28:31]
    ds_read_b64_tr_b16 a[228:229], v217 offset:27648
    v_mfma_f32_16x16x32_bf16 v[208:211], a[236:239], a[44:47], v[208:211]
    ds_read_b64_tr_b16 a[230:231], v217 offset:31744
    v_mfma_f32_16x16x32_bf16 v[208:211], a[232:235], a[36:39], v[208:211]
    ds_read_b64_tr_b16 a[232:233], v216 offset:18688
    s_waitcnt lgkmcnt(9)
    v_mfma_f32_16x16x32_bf16 v[160:163], a[240:243], a[32:35], v[160:163]
    ds_read_b64_tr_b16 a[234:235], v216 offset:22784
    buffer_load_dwordx4 v229, s[28:31], s98 offen offset:2048 lds
    v_mfma_f32_16x16x32_bf16 v[160:163], a[244:247], a[40:43], v[160:163]
    ds_read_b64_tr_b16 a[236:237], v216 offset:27904
    v_mfma_f32_16x16x32_bf16 v[212:215], a[244:247], a[44:47], v[212:215]
    ds_read_b64_tr_b16 a[238:239], v216 offset:32000
    v_mfma_f32_16x16x32_bf16 v[212:215], a[240:243], a[36:39], v[212:215]
    ds_read_b64_tr_b16 a[240:241], v217 offset:18688
    s_waitcnt vmcnt(48) lgkmcnt(9)
    v_mfma_f32_16x16x32_bf16 v[0:3], a[248:251], a[48:51], v[0:3]
    ds_read_b64_tr_b16 a[242:243], v217 offset:22784
    v_mfma_f32_16x16x32_bf16 v[0:3], a[252:255], a[56:59], v[0:3]
    ds_read_b64_tr_b16 a[244:245], v217 offset:27904
    v_mfma_f32_16x16x32_bf16 v[164:167], a[252:255], a[60:63], v[164:167]
    ds_read_b64_tr_b16 a[246:247], v217 offset:32000
    buffer_load_dwordx4 v230, s[28:31], s98 offen offset:3072 lds
    v_mfma_f32_16x16x32_bf16 v[164:167], a[248:251], a[52:55], v[164:167]
    ds_read_b64_tr_b16 a[248:249], v216 offset:18944
    s_waitcnt lgkmcnt(9)
    v_mfma_f32_16x16x32_bf16 v[4:7], a[224:227], a[48:51], v[4:7]
    ds_read_b64_tr_b16 a[250:251], v216 offset:23040
    v_mfma_f32_16x16x32_bf16 v[4:7], a[228:231], a[56:59], v[4:7]
    ds_read_b64_tr_b16 a[252:253], v216 offset:28160
    v_mfma_f32_16x16x32_bf16 v[168:171], a[228:231], a[60:63], v[168:171]
    ds_read_b64_tr_b16 a[254:255], v216 offset:32256
    v_mfma_f32_16x16x32_bf16 v[168:171], a[224:227], a[52:55], v[168:171]
    ds_read_b64_tr_b16 a[224:225], v217 offset:18944
    s_waitcnt lgkmcnt(9)
    v_mfma_f32_16x16x32_bf16 v[8:11], a[232:235], a[48:51], v[8:11]
    ds_read_b64_tr_b16 a[226:227], v217 offset:23040
    s_add_u32 m0, s93, 131072
    v_mfma_f32_16x16x32_bf16 v[8:11], a[236:239], a[56:59], v[8:11]
    ds_read_b64_tr_b16 a[228:229], v217 offset:28160
    buffer_load_dwordx4 v232, s[36:39], s99 offen sc1 lds
    v_mfma_f32_16x16x32_bf16 v[172:175], a[236:239], a[60:63], v[172:175]
    ds_read_b64_tr_b16 a[230:231], v217 offset:32256
    v_mfma_f32_16x16x32_bf16 v[172:175], a[232:235], a[52:55], v[172:175]
    ds_read_b64_tr_b16 a[232:233], v216 offset:19200
    s_waitcnt lgkmcnt(9)
    v_mfma_f32_16x16x32_bf16 v[12:15], a[240:243], a[48:51], v[12:15]
    ds_read_b64_tr_b16 a[234:235], v216 offset:23296
    v_mfma_f32_16x16x32_bf16 v[12:15], a[244:247], a[56:59], v[12:15]
    ds_read_b64_tr_b16 a[236:237], v216 offset:28416
    v_mfma_f32_16x16x32_bf16 v[176:179], a[244:247], a[60:63], v[176:179]
    ds_read_b64_tr_b16 a[238:239], v216 offset:32512
    v_mfma_f32_16x16x32_bf16 v[176:179], a[240:243], a[52:55], v[176:179]
    ds_read_b64_tr_b16 a[240:241], v217 offset:19200
    s_waitcnt lgkmcnt(9)
    v_mfma_f32_16x16x32_bf16 v[16:19], a[248:251], a[48:51], v[16:19]
    ds_read_b64_tr_b16 a[242:243], v217 offset:23296
    v_mfma_f32_16x16x32_bf16 v[16:19], a[252:255], a[56:59], v[16:19]
    ds_read_b64_tr_b16 a[244:245], v217 offset:28416
    v_mfma_f32_16x16x32_bf16 v[180:183], a[252:255], a[60:63], v[180:183]
    ds_read_b64_tr_b16 a[246:247], v217 offset:32512
    v_mfma_f32_16x16x32_bf16 v[180:183], a[248:251], a[52:55], v[180:183]
    ds_read_b128 a[248:251], v220 offset:26624
    s_waitcnt lgkmcnt(9)
    v_mfma_f32_16x16x32_bf16 v[20:23], a[224:227], a[48:51], v[20:23]
    ds_read_b128 a[252:255], v220 offset:35840
    v_mfma_f32_16x16x32_bf16 v[20:23], a[228:231], a[56:59], v[20:23]
    v_mfma_f32_16x16x32_bf16 v[184:187], a[228:231], a[60:63], v[184:187]
    v_mfma_f32_16x16x32_bf16 v[184:187], a[224:227], a[52:55], v[184:187]
    s_waitcnt lgkmcnt(0)
    s_barrier
    v_mfma_f32_16x16x32_bf16 v[24:27], a[232:235], a[48:51], v[24:27]
    v_subrev_u32 v220, 36864, v220
    v_subrev_u32 v216, 36864, v216
    v_mfma_f32_16x16x32_bf16 v[24:27], a[236:239], a[56:59], v[24:27]
    v_subrev_u32 v217, 36864, v217
    ds_read_b64_tr_b16 a[224:225], v216 offset:0
    v_mfma_f32_16x16x32_bf16 v[188:191], a[236:239], a[60:63], v[188:191]
    ds_read_b64_tr_b16 a[226:227], v216 offset:4096
    ds_read_b64_tr_b16 a[228:229], v216 offset:9216
    v_mfma_f32_16x16x32_bf16 v[188:191], a[232:235], a[52:55], v[188:191]
    ds_read_b64_tr_b16 a[230:231], v216 offset:13312
sequential_preLN__linear_kernel_hedgehog__glu_gated_reglu__prompt_kernel_hop1_6:
    s_cbranch_execz sequential_preLN__linear_kernel_hedgehog__glu_gated_reglu__prompt_kernel_hop1_7
    v_mfma_f32_16x16x32_bf16 v[28:31], a[240:243], a[48:51], v[28:31]
    ds_read_b64_tr_b16 a[232:233], v217 offset:0
    ds_read_b64_tr_b16 a[234:235], v217 offset:4096
    v_mfma_f32_16x16x32_bf16 v[28:31], a[244:247], a[56:59], v[28:31]
    ds_read_b64_tr_b16 a[236:237], v217 offset:9216
    s_add_u32 s98, s80, 73728
    v_mfma_f32_16x16x32_bf16 v[208:211], a[244:247], a[60:63], v[208:211]
    ds_read_b64_tr_b16 a[238:239], v217 offset:13312
    s_add_u32 s99, s89, 2048
    v_mfma_f32_16x16x32_bf16 v[208:211], a[240:243], a[52:55], v[208:211]
    ds_read_b64_tr_b16 a[240:241], v216 offset:256
    v_mfma_f32_16x16x32_bf16 v[160:163], a[248:251], a[48:51], v[160:163]
    ds_read_b64_tr_b16 a[242:243], v216 offset:4352
    s_add_u32 m0, s93, 86016
    v_mfma_f32_16x16x32_bf16 v[160:163], a[252:255], a[56:59], v[160:163]
    ds_read_b64_tr_b16 a[244:245], v216 offset:9472
    buffer_load_dwordx4 v223, s[28:31], s98 offen offset:0 lds
    v_mfma_f32_16x16x32_bf16 v[212:215], a[252:255], a[60:63], v[212:215]
    ds_read_b64_tr_b16 a[246:247], v216 offset:13568
    buffer_load_dwordx4 v224, s[28:31], s98 offen offset:1024 lds
    v_mfma_f32_16x16x32_bf16 v[212:215], a[248:251], a[52:55], v[212:215]
    ds_read_b64_tr_b16 a[248:249], v217 offset:256
    s_waitcnt vmcnt(48) lgkmcnt(9)
    v_mfma_f32_16x16x32_bf16 v[0:3], a[224:227], a[64:67], v[0:3]
    ds_read_b64_tr_b16 a[250:251], v217 offset:4352
    v_mfma_f32_16x16x32_bf16 v[0:3], a[228:231], a[72:75], v[0:3]
    ds_read_b64_tr_b16 a[252:253], v217 offset:9472
    v_mfma_f32_16x16x32_bf16 v[164:167], a[228:231], a[76:79], v[164:167]
    ds_read_b64_tr_b16 a[254:255], v217 offset:13568
    v_mfma_f32_16x16x32_bf16 v[164:167], a[224:227], a[68:71], v[164:167]
    ds_read_b64_tr_b16 a[224:225], v216 offset:512
    s_waitcnt lgkmcnt(9)
    v_mfma_f32_16x16x32_bf16 v[4:7], a[232:235], a[64:67], v[4:7]
    ds_read_b64_tr_b16 a[226:227], v216 offset:4608
    buffer_load_dwordx4 v225, s[28:31], s98 offen offset:2048 lds
    v_mfma_f32_16x16x32_bf16 v[4:7], a[236:239], a[72:75], v[4:7]
    ds_read_b64_tr_b16 a[228:229], v216 offset:9728
    v_mfma_f32_16x16x32_bf16 v[168:171], a[236:239], a[76:79], v[168:171]
    ds_read_b64_tr_b16 a[230:231], v216 offset:13824
    v_mfma_f32_16x16x32_bf16 v[168:171], a[232:235], a[68:71], v[168:171]
    ds_read_b64_tr_b16 a[232:233], v217 offset:512
    s_waitcnt lgkmcnt(9)
    v_mfma_f32_16x16x32_bf16 v[8:11], a[240:243], a[64:67], v[8:11]
    ds_read_b64_tr_b16 a[234:235], v217 offset:4608
    v_mfma_f32_16x16x32_bf16 v[8:11], a[244:247], a[72:75], v[8:11]
    ds_read_b64_tr_b16 a[236:237], v217 offset:9728
    v_mfma_f32_16x16x32_bf16 v[172:175], a[244:247], a[76:79], v[172:175]
    ds_read_b64_tr_b16 a[238:239], v217 offset:13824
    buffer_load_dwordx4 v226, s[28:31], s98 offen offset:3072 lds
    v_mfma_f32_16x16x32_bf16 v[172:175], a[240:243], a[68:71], v[172:175]
    ds_read_b64_tr_b16 a[240:241], v216 offset:768
    s_waitcnt lgkmcnt(9)
    v_mfma_f32_16x16x32_bf16 v[12:15], a[248:251], a[64:67], v[12:15]
    ds_read_b64_tr_b16 a[242:243], v216 offset:4864
    v_mfma_f32_16x16x32_bf16 v[12:15], a[252:255], a[72:75], v[12:15]
    ds_read_b64_tr_b16 a[244:245], v216 offset:9984
    v_mfma_f32_16x16x32_bf16 v[176:179], a[252:255], a[76:79], v[176:179]
    ds_read_b64_tr_b16 a[246:247], v216 offset:14080
    v_mfma_f32_16x16x32_bf16 v[176:179], a[248:251], a[68:71], v[176:179]
    ds_read_b64_tr_b16 a[248:249], v217 offset:768
    s_waitcnt lgkmcnt(9)
    v_mfma_f32_16x16x32_bf16 v[16:19], a[224:227], a[64:67], v[16:19]
    ds_read_b64_tr_b16 a[250:251], v217 offset:4864
    s_add_u32 m0, s93, 90112
    v_mfma_f32_16x16x32_bf16 v[16:19], a[228:231], a[72:75], v[16:19]
    ds_read_b64_tr_b16 a[252:253], v217 offset:9984
    buffer_load_dwordx4 v227, s[28:31], s98 offen offset:0 lds
    v_mfma_f32_16x16x32_bf16 v[180:183], a[228:231], a[76:79], v[180:183]
    ds_read_b64_tr_b16 a[254:255], v217 offset:14080
    v_mfma_f32_16x16x32_bf16 v[180:183], a[224:227], a[68:71], v[180:183]
    ds_read_b128 a[224:227], v220 offset:8192
    s_waitcnt lgkmcnt(9)
    v_mfma_f32_16x16x32_bf16 v[20:23], a[232:235], a[64:67], v[20:23]
    ds_read_b128 a[228:231], v220 offset:17408
    v_mfma_f32_16x16x32_bf16 v[20:23], a[236:239], a[72:75], v[20:23]
    v_mfma_f32_16x16x32_bf16 v[184:187], a[236:239], a[76:79], v[184:187]
    v_mfma_f32_16x16x32_bf16 v[184:187], a[232:235], a[68:71], v[184:187]
    ds_read_b64_tr_b16 a[232:233], v216 offset:18432
    s_waitcnt lgkmcnt(7)
    v_mfma_f32_16x16x32_bf16 v[24:27], a[240:243], a[64:67], v[24:27]
    ds_read_b64_tr_b16 a[234:235], v216 offset:22528
    buffer_load_dwordx4 v228, s[28:31], s98 offen offset:1024 lds
    v_mfma_f32_16x16x32_bf16 v[24:27], a[244:247], a[72:75], v[24:27]
    ds_read_b64_tr_b16 a[236:237], v216 offset:27648
    v_mfma_f32_16x16x32_bf16 v[188:191], a[244:247], a[76:79], v[188:191]
    ds_read_b64_tr_b16 a[238:239], v216 offset:31744
    v_mfma_f32_16x16x32_bf16 v[188:191], a[240:243], a[68:71], v[188:191]
    ds_read_b64_tr_b16 a[240:241], v217 offset:18432
    s_waitcnt lgkmcnt(7)
    v_mfma_f32_16x16x32_bf16 v[28:31], a[248:251], a[64:67], v[28:31]
    ds_read_b64_tr_b16 a[242:243], v217 offset:22528
    v_mfma_f32_16x16x32_bf16 v[28:31], a[252:255], a[72:75], v[28:31]
    ds_read_b64_tr_b16 a[244:245], v217 offset:27648
    v_mfma_f32_16x16x32_bf16 v[208:211], a[252:255], a[76:79], v[208:211]
    ds_read_b64_tr_b16 a[246:247], v217 offset:31744
    v_mfma_f32_16x16x32_bf16 v[208:211], a[248:251], a[68:71], v[208:211]
    ds_read_b64_tr_b16 a[248:249], v216 offset:18688
    s_waitcnt lgkmcnt(9)
    v_mfma_f32_16x16x32_bf16 v[160:163], a[224:227], a[64:67], v[160:163]
    ds_read_b64_tr_b16 a[250:251], v216 offset:22784
    s_waitcnt vmcnt(51)
    buffer_load_dwordx4 v229, s[28:31], s98 offen offset:2048 lds
    v_mfma_f32_16x16x32_bf16 v[160:163], a[228:231], a[72:75], v[160:163]
    ds_read_b64_tr_b16 a[252:253], v216 offset:27904
    v_mfma_f32_16x16x32_bf16 v[212:215], a[228:231], a[76:79], v[212:215]
    ds_read_b64_tr_b16 a[254:255], v216 offset:32000
    v_mfma_f32_16x16x32_bf16 v[212:215], a[224:227], a[68:71], v[212:215]
    ds_read_b64_tr_b16 a[224:225], v217 offset:18688
    s_waitcnt vmcnt(49) lgkmcnt(9)
    v_mfma_f32_16x16x32_bf16 v[0:3], a[232:235], a[80:83], v[0:3]
    ds_read_b64_tr_b16 a[226:227], v217 offset:22784
    s_waitcnt vmcnt(10)
    v_mov_b32 v245, 5
    s_mov_b64 exec, 1
    buffer_store_dword v245, off, s[36:39], s52 sc1
    s_mov_b64 exec, -1
    v_mfma_f32_16x16x32_bf16 v[0:3], a[236:239], a[88:91], v[0:3]
    ds_read_b64_tr_b16 a[228:229], v217 offset:27904
    v_mfma_f32_16x16x32_bf16 v[164:167], a[236:239], a[92:95], v[164:167]
    ds_read_b64_tr_b16 a[230:231], v217 offset:32000
    buffer_load_dwordx4 v230, s[28:31], s98 offen offset:3072 lds
    v_mfma_f32_16x16x32_bf16 v[164:167], a[232:235], a[84:87], v[164:167]
    ds_read_b64_tr_b16 a[232:233], v216 offset:18944
    s_waitcnt lgkmcnt(9)
    v_mfma_f32_16x16x32_bf16 v[4:7], a[240:243], a[80:83], v[4:7]
    ds_read_b64_tr_b16 a[234:235], v216 offset:23040
    v_mfma_f32_16x16x32_bf16 v[4:7], a[244:247], a[88:91], v[4:7]
    ds_read_b64_tr_b16 a[236:237], v216 offset:28160
    v_mfma_f32_16x16x32_bf16 v[168:171], a[244:247], a[92:95], v[168:171]
    ds_read_b64_tr_b16 a[238:239], v216 offset:32256
    v_mfma_f32_16x16x32_bf16 v[168:171], a[240:243], a[84:87], v[168:171]
    ds_read_b64_tr_b16 a[240:241], v217 offset:18944
    s_waitcnt lgkmcnt(9)
    v_mfma_f32_16x16x32_bf16 v[8:11], a[248:251], a[80:83], v[8:11]
    ds_read_b64_tr_b16 a[242:243], v217 offset:23040
    s_add_u32 m0, s93, 94208
    v_mfma_f32_16x16x32_bf16 v[8:11], a[252:255], a[88:91], v[8:11]
    ds_read_b64_tr_b16 a[244:245], v217 offset:28160
    buffer_load_dwordx4 v232, s[36:39], s99 offen sc1 lds
    v_mfma_f32_16x16x32_bf16 v[172:175], a[252:255], a[92:95], v[172:175]
    ds_read_b64_tr_b16 a[246:247], v217 offset:32256
    v_mfma_f32_16x16x32_bf16 v[172:175], a[248:251], a[84:87], v[172:175]
    ds_read_b64_tr_b16 a[248:249], v216 offset:19200
    s_waitcnt lgkmcnt(9)
    v_mfma_f32_16x16x32_bf16 v[12:15], a[224:227], a[80:83], v[12:15]
    ds_read_b64_tr_b16 a[250:251], v216 offset:23296
    v_mfma_f32_16x16x32_bf16 v[12:15], a[228:231], a[88:91], v[12:15]
    ds_read_b64_tr_b16 a[252:253], v216 offset:28416
    v_mfma_f32_16x16x32_bf16 v[176:179], a[228:231], a[92:95], v[176:179]
    ds_read_b64_tr_b16 a[254:255], v216 offset:32512
    v_mfma_f32_16x16x32_bf16 v[176:179], a[224:227], a[84:87], v[176:179]
    ds_read_b64_tr_b16 a[224:225], v217 offset:19200
    s_waitcnt lgkmcnt(9)
    v_mfma_f32_16x16x32_bf16 v[16:19], a[232:235], a[80:83], v[16:19]
    ds_read_b64_tr_b16 a[226:227], v217 offset:23296
    v_mfma_f32_16x16x32_bf16 v[16:19], a[236:239], a[88:91], v[16:19]
    ds_read_b64_tr_b16 a[228:229], v217 offset:28416
    v_mfma_f32_16x16x32_bf16 v[180:183], a[236:239], a[92:95], v[180:183]
    ds_read_b64_tr_b16 a[230:231], v217 offset:32512
    v_mfma_f32_16x16x32_bf16 v[180:183], a[232:235], a[84:87], v[180:183]
    ds_read_b128 a[232:235], v220 offset:26624
    s_waitcnt lgkmcnt(9)
    v_mfma_f32_16x16x32_bf16 v[20:23], a[240:243], a[80:83], v[20:23]
    ds_read_b128 a[236:239], v220 offset:35840
    v_mfma_f32_16x16x32_bf16 v[20:23], a[244:247], a[88:91], v[20:23]
    v_mfma_f32_16x16x32_bf16 v[184:187], a[244:247], a[92:95], v[184:187]
    v_mfma_f32_16x16x32_bf16 v[184:187], a[240:243], a[84:87], v[184:187]
    s_waitcnt lgkmcnt(0)
    s_barrier
    v_mfma_f32_16x16x32_bf16 v[24:27], a[248:251], a[80:83], v[24:27]
    v_subrev_u32 v220, 36864, v220
    v_subrev_u32 v216, 36864, v216
    v_mfma_f32_16x16x32_bf16 v[24:27], a[252:255], a[88:91], v[24:27]
    v_subrev_u32 v217, 36864, v217
    ds_read_b64_tr_b16 a[240:241], v216 offset:0
    v_mfma_f32_16x16x32_bf16 v[188:191], a[252:255], a[92:95], v[188:191]
    ds_read_b64_tr_b16 a[242:243], v216 offset:4096
    ds_read_b64_tr_b16 a[244:245], v216 offset:9216
    v_mfma_f32_16x16x32_bf16 v[188:191], a[248:251], a[84:87], v[188:191]
    ds_read_b64_tr_b16 a[246:247], v216 offset:13312
    v_mfma_f32_16x16x32_bf16 v[28:31], a[224:227], a[80:83], v[28:31]
    ds_read_b64_tr_b16 a[248:249], v217 offset:0
    ds_read_b64_tr_b16 a[250:251], v217 offset:4096
    v_mfma_f32_16x16x32_bf16 v[28:31], a[228:231], a[88:91], v[28:31]
    ds_read_b64_tr_b16 a[252:253], v217 offset:9216
    s_add_u32 s98, s80, 368640
    v_mfma_f32_16x16x32_bf16 v[208:211], a[228:231], a[92:95], v[208:211]
    ds_read_b64_tr_b16 a[254:255], v217 offset:13312
    s_add_u32 s99, s89, 10240
    v_mfma_f32_16x16x32_bf16 v[208:211], a[224:227], a[84:87], v[208:211]
    ds_read_b64_tr_b16 a[224:225], v216 offset:256
    v_mfma_f32_16x16x32_bf16 v[160:163], a[232:235], a[80:83], v[160:163]
    ds_read_b64_tr_b16 a[226:227], v216 offset:4352
    s_add_u32 m0, s93, 49152
    v_mfma_f32_16x16x32_bf16 v[160:163], a[236:239], a[88:91], v[160:163]
    ds_read_b64_tr_b16 a[228:229], v216 offset:9472
    buffer_load_dwordx4 v223, s[28:31], s98 offen offset:0 lds
    v_mfma_f32_16x16x32_bf16 v[212:215], a[236:239], a[92:95], v[212:215]
    ds_read_b64_tr_b16 a[230:231], v216 offset:13568
    buffer_load_dwordx4 v224, s[28:31], s98 offen offset:1024 lds
    v_mfma_f32_16x16x32_bf16 v[212:215], a[232:235], a[84:87], v[212:215]
    ds_read_b64_tr_b16 a[232:233], v217 offset:256
    s_waitcnt lgkmcnt(9)
    v_mfma_f32_16x16x32_bf16 v[0:3], a[240:243], a[96:99], v[0:3]
    ds_read_b64_tr_b16 a[234:235], v217 offset:4352
    v_mfma_f32_16x16x32_bf16 v[0:3], a[244:247], a[104:107], v[0:3]
    ds_read_b64_tr_b16 a[236:237], v217 offset:9472
    v_mfma_f32_16x16x32_bf16 v[164:167], a[244:247], a[108:111], v[164:167]
    ds_read_b64_tr_b16 a[238:239], v217 offset:13568
    v_mfma_f32_16x16x32_bf16 v[164:167], a[240:243], a[100:103], v[164:167]
    ds_read_b64_tr_b16 a[240:241], v216 offset:512
    s_waitcnt lgkmcnt(9)
    v_mfma_f32_16x16x32_bf16 v[4:7], a[248:251], a[96:99], v[4:7]
    ds_read_b64_tr_b16 a[242:243], v216 offset:4608
    buffer_load_dwordx4 v225, s[28:31], s98 offen offset:2048 lds
    v_mfma_f32_16x16x32_bf16 v[4:7], a[252:255], a[104:107], v[4:7]
    ds_read_b64_tr_b16 a[244:245], v216 offset:9728
    v_mfma_f32_16x16x32_bf16 v[168:171], a[252:255], a[108:111], v[168:171]
    ds_read_b64_tr_b16 a[246:247], v216 offset:13824
    v_mfma_f32_16x16x32_bf16 v[168:171], a[248:251], a[100:103], v[168:171]
    ds_read_b64_tr_b16 a[248:249], v217 offset:512
    s_waitcnt lgkmcnt(9)
    v_mfma_f32_16x16x32_bf16 v[8:11], a[224:227], a[96:99], v[8:11]
    ds_read_b64_tr_b16 a[250:251], v217 offset:4608
    v_mfma_f32_16x16x32_bf16 v[8:11], a[228:231], a[104:107], v[8:11]
    ds_read_b64_tr_b16 a[252:253], v217 offset:9728
    v_mfma_f32_16x16x32_bf16 v[172:175], a[228:231], a[108:111], v[172:175]
    ds_read_b64_tr_b16 a[254:255], v217 offset:13824
    buffer_load_dwordx4 v226, s[28:31], s98 offen offset:3072 lds
    v_mfma_f32_16x16x32_bf16 v[172:175], a[224:227], a[100:103], v[172:175]
    ds_read_b64_tr_b16 a[224:225], v216 offset:768
    s_waitcnt lgkmcnt(9)
    v_mfma_f32_16x16x32_bf16 v[12:15], a[232:235], a[96:99], v[12:15]
    ds_read_b64_tr_b16 a[226:227], v216 offset:4864
    v_mfma_f32_16x16x32_bf16 v[12:15], a[236:239], a[104:107], v[12:15]
    ds_read_b64_tr_b16 a[228:229], v216 offset:9984
    v_mfma_f32_16x16x32_bf16 v[176:179], a[236:239], a[108:111], v[176:179]
    ds_read_b64_tr_b16 a[230:231], v216 offset:14080
    v_mfma_f32_16x16x32_bf16 v[176:179], a[232:235], a[100:103], v[176:179]
    ds_read_b64_tr_b16 a[232:233], v217 offset:768
    s_waitcnt lgkmcnt(9)
    v_mfma_f32_16x16x32_bf16 v[16:19], a[240:243], a[96:99], v[16:19]
    ds_read_b64_tr_b16 a[234:235], v217 offset:4864
    s_add_u32 m0, s93, 53248
    v_mfma_f32_16x16x32_bf16 v[16:19], a[244:247], a[104:107], v[16:19]
    ds_read_b64_tr_b16 a[236:237], v217 offset:9984
    buffer_load_dwordx4 v227, s[28:31], s98 offen offset:0 lds
    v_mfma_f32_16x16x32_bf16 v[180:183], a[244:247], a[108:111], v[180:183]
    ds_read_b64_tr_b16 a[238:239], v217 offset:14080
    v_mfma_f32_16x16x32_bf16 v[180:183], a[240:243], a[100:103], v[180:183]
    ds_read_b128 a[240:243], v220 offset:8192
    s_waitcnt lgkmcnt(9)
    v_mfma_f32_16x16x32_bf16 v[20:23], a[248:251], a[96:99], v[20:23]
    ds_read_b128 a[244:247], v220 offset:17408
    v_mfma_f32_16x16x32_bf16 v[20:23], a[252:255], a[104:107], v[20:23]
    v_mfma_f32_16x16x32_bf16 v[184:187], a[252:255], a[108:111], v[184:187]
    v_mfma_f32_16x16x32_bf16 v[184:187], a[248:251], a[100:103], v[184:187]
    ds_read_b64_tr_b16 a[248:249], v216 offset:18432
    s_waitcnt lgkmcnt(7)
    v_mfma_f32_16x16x32_bf16 v[24:27], a[224:227], a[96:99], v[24:27]
    ds_read_b64_tr_b16 a[250:251], v216 offset:22528
    buffer_load_dwordx4 v228, s[28:31], s98 offen offset:1024 lds
    v_mfma_f32_16x16x32_bf16 v[24:27], a[228:231], a[104:107], v[24:27]
    ds_read_b64_tr_b16 a[252:253], v216 offset:27648
    v_mfma_f32_16x16x32_bf16 v[188:191], a[228:231], a[108:111], v[188:191]
    ds_read_b64_tr_b16 a[254:255], v216 offset:31744
    v_mfma_f32_16x16x32_bf16 v[188:191], a[224:227], a[100:103], v[188:191]
    ds_read_b64_tr_b16 a[224:225], v217 offset:18432
    s_waitcnt lgkmcnt(7)
    v_mfma_f32_16x16x32_bf16 v[28:31], a[232:235], a[96:99], v[28:31]
    ds_read_b64_tr_b16 a[226:227], v217 offset:22528
    v_mfma_f32_16x16x32_bf16 v[28:31], a[236:239], a[104:107], v[28:31]
    ds_read_b64_tr_b16 a[228:229], v217 offset:27648
    v_mfma_f32_16x16x32_bf16 v[208:211], a[236:239], a[108:111], v[208:211]
    ds_read_b64_tr_b16 a[230:231], v217 offset:31744
    v_mfma_f32_16x16x32_bf16 v[208:211], a[232:235], a[100:103], v[208:211]
    ds_read_b64_tr_b16 a[232:233], v216 offset:18688
    s_waitcnt lgkmcnt(9)
    v_mfma_f32_16x16x32_bf16 v[160:163], a[240:243], a[96:99], v[160:163]
    ds_read_b64_tr_b16 a[234:235], v216 offset:22784
    buffer_load_dwordx4 v229, s[28:31], s98 offen offset:2048 lds
    v_mfma_f32_16x16x32_bf16 v[160:163], a[244:247], a[104:107], v[160:163]
    ds_read_b64_tr_b16 a[236:237], v216 offset:27904
    v_mfma_f32_16x16x32_bf16 v[212:215], a[244:247], a[108:111], v[212:215]
    ds_read_b64_tr_b16 a[238:239], v216 offset:32000
    v_mfma_f32_16x16x32_bf16 v[212:215], a[240:243], a[100:103], v[212:215]
    ds_read_b64_tr_b16 a[240:241], v217 offset:18688
    s_waitcnt lgkmcnt(9)
    v_mfma_f32_16x16x32_bf16 v[0:3], a[248:251], a[112:115], v[0:3]
    ds_read_b64_tr_b16 a[242:243], v217 offset:22784
    buffer_load_dword v239, v238, s[36:39], 0 offen sc1
    v_mfma_f32_16x16x32_bf16 v[0:3], a[252:255], a[120:123], v[0:3]
    ds_read_b64_tr_b16 a[244:245], v217 offset:27904
    v_mfma_f32_16x16x32_bf16 v[164:167], a[252:255], a[124:127], v[164:167]
    ds_read_b64_tr_b16 a[246:247], v217 offset:32000
    buffer_load_dwordx4 v230, s[28:31], s98 offen offset:3072 lds
    v_mfma_f32_16x16x32_bf16 v[164:167], a[248:251], a[116:119], v[164:167]
    ds_read_b64_tr_b16 a[248:249], v216 offset:18944
    s_waitcnt lgkmcnt(9)
    v_mfma_f32_16x16x32_bf16 v[4:7], a[224:227], a[112:115], v[4:7]
    ds_read_b64_tr_b16 a[250:251], v216 offset:23040
    v_mfma_f32_16x16x32_bf16 v[4:7], a[228:231], a[120:123], v[4:7]
    ds_read_b64_tr_b16 a[252:253], v216 offset:28160
    v_mfma_f32_16x16x32_bf16 v[168:171], a[228:231], a[124:127], v[168:171]
    ds_read_b64_tr_b16 a[254:255], v216 offset:32256
    v_mfma_f32_16x16x32_bf16 v[168:171], a[224:227], a[116:119], v[168:171]
    ds_read_b64_tr_b16 a[224:225], v217 offset:18944
    s_waitcnt lgkmcnt(9)
    v_mfma_f32_16x16x32_bf16 v[8:11], a[232:235], a[112:115], v[8:11]
    ds_read_b64_tr_b16 a[226:227], v217 offset:23040
    s_add_u32 m0, s93, 57344
    v_mfma_f32_16x16x32_bf16 v[8:11], a[236:239], a[120:123], v[8:11]
    ds_read_b64_tr_b16 a[228:229], v217 offset:28160
    buffer_load_dwordx4 v232, s[36:39], s99 offen sc1 lds
    v_mfma_f32_16x16x32_bf16 v[172:175], a[236:239], a[124:127], v[172:175]
    ds_read_b64_tr_b16 a[230:231], v217 offset:32256
    v_mfma_f32_16x16x32_bf16 v[172:175], a[232:235], a[116:119], v[172:175]
    ds_read_b64_tr_b16 a[232:233], v216 offset:19200
    s_waitcnt lgkmcnt(9)
    v_mfma_f32_16x16x32_bf16 v[12:15], a[240:243], a[112:115], v[12:15]
    ds_read_b64_tr_b16 a[234:235], v216 offset:23296
    v_mfma_f32_16x16x32_bf16 v[12:15], a[244:247], a[120:123], v[12:15]
    ds_read_b64_tr_b16 a[236:237], v216 offset:28416
    v_mfma_f32_16x16x32_bf16 v[176:179], a[244:247], a[124:127], v[176:179]
    ds_read_b64_tr_b16 a[238:239], v216 offset:32512
    v_mfma_f32_16x16x32_bf16 v[176:179], a[240:243], a[116:119], v[176:179]
    ds_read_b64_tr_b16 a[240:241], v217 offset:19200
    s_waitcnt lgkmcnt(9)
    v_mfma_f32_16x16x32_bf16 v[16:19], a[248:251], a[112:115], v[16:19]
    ds_read_b64_tr_b16 a[242:243], v217 offset:23296
    v_mfma_f32_16x16x32_bf16 v[16:19], a[252:255], a[120:123], v[16:19]
    ds_read_b64_tr_b16 a[244:245], v217 offset:28416
    v_mfma_f32_16x16x32_bf16 v[180:183], a[252:255], a[124:127], v[180:183]
    ds_read_b64_tr_b16 a[246:247], v217 offset:32512
    v_mfma_f32_16x16x32_bf16 v[180:183], a[248:251], a[116:119], v[180:183]
    ds_read_b128 a[248:251], v220 offset:26624
    s_waitcnt lgkmcnt(9)
    v_mfma_f32_16x16x32_bf16 v[20:23], a[224:227], a[112:115], v[20:23]
    ds_read_b128 a[252:255], v220 offset:35840
    v_mfma_f32_16x16x32_bf16 v[20:23], a[228:231], a[120:123], v[20:23]
    v_mfma_f32_16x16x32_bf16 v[184:187], a[228:231], a[124:127], v[184:187]
    v_mfma_f32_16x16x32_bf16 v[184:187], a[224:227], a[116:119], v[184:187]
    s_waitcnt vmcnt(20)
    s_waitcnt lgkmcnt(0)
    s_barrier
    v_mfma_f32_16x16x32_bf16 v[24:27], a[232:235], a[112:115], v[24:27]
    v_add_u32 v220, 110592, v220
    v_add_u32 v216, 110592, v216
    v_mfma_f32_16x16x32_bf16 v[24:27], a[236:239], a[120:123], v[24:27]
    v_add_u32 v217, 110592, v217
    ds_read_b64_tr_b16 a[224:225], v216 offset:0
    v_mfma_f32_16x16x32_bf16 v[188:191], a[236:239], a[124:127], v[188:191]
    ds_read_b64_tr_b16 a[226:227], v216 offset:4096
    ds_read_b64_tr_b16 a[228:229], v216 offset:9216
    v_mfma_f32_16x16x32_bf16 v[188:191], a[232:235], a[116:119], v[188:191]
    ds_read_b64_tr_b16 a[230:231], v216 offset:13312
    v_mfma_f32_16x16x32_bf16 v[28:31], a[240:243], a[112:115], v[28:31]
    ds_read_b64_tr_b16 a[232:233], v217 offset:0
    ds_read_b64_tr_b16 a[234:235], v217 offset:4096
    v_mfma_f32_16x16x32_bf16 v[28:31], a[244:247], a[120:123], v[28:31]
    ds_read_b64_tr_b16 a[236:237], v217 offset:9216
    s_add_u32 s98, s80, 663552
    v_mfma_f32_16x16x32_bf16 v[208:211], a[244:247], a[124:127], v[208:211]
    ds_read_b64_tr_b16 a[238:239], v217 offset:13312
    s_add_u32 s99, s89, 18432
    v_mfma_f32_16x16x32_bf16 v[208:211], a[240:243], a[116:119], v[208:211]
    ds_read_b64_tr_b16 a[240:241], v216 offset:256
    v_mfma_f32_16x16x32_bf16 v[160:163], a[248:251], a[112:115], v[160:163]
    ds_read_b64_tr_b16 a[242:243], v216 offset:4352
    s_add_u32 m0, s93, 12288
    v_mfma_f32_16x16x32_bf16 v[160:163], a[252:255], a[120:123], v[160:163]
    ds_read_b64_tr_b16 a[244:245], v216 offset:9472
    buffer_load_dwordx4 v223, s[28:31], s98 offen offset:0 lds
    v_mfma_f32_16x16x32_bf16 v[212:215], a[252:255], a[124:127], v[212:215]
    ds_read_b64_tr_b16 a[246:247], v216 offset:13568
    buffer_load_dwordx4 v224, s[28:31], s98 offen offset:1024 lds
    v_mfma_f32_16x16x32_bf16 v[212:215], a[248:251], a[116:119], v[212:215]
    ds_read_b64_tr_b16 a[248:249], v217 offset:256
    s_waitcnt lgkmcnt(9)
    v_mfma_f32_16x16x32_bf16 v[0:3], a[224:227], a[128:131], v[0:3]
    ds_read_b64_tr_b16 a[250:251], v217 offset:4352
    s_waitcnt vmcnt(4)
    v_cmp_gt_u32 vcc, 5, v239
    s_nop 0
    s_cbranch_vccnz sequential_preLN__linear_kernel_hedgehog__glu_gated_reglu__prompt_kernel_spin_24
sequential_preLN__linear_kernel_hedgehog__glu_gated_reglu__prompt_kernel_spin_24_b:
    v_mfma_f32_16x16x32_bf16 v[0:3], a[228:231], a[136:139], v[0:3]
    ds_read_b64_tr_b16 a[252:253], v217 offset:9472
    s_add_u32 s97, s84, 2048
    v_mfma_f32_16x16x32_bf16 v[164:167], a[228:231], a[140:143], v[164:167]
    ds_read_b64_tr_b16 a[254:255], v217 offset:13568
    buffer_load_dwordx4 a[160:163], v232, s[36:39], s97 offen sc1
    v_mfma_f32_16x16x32_bf16 v[164:167], a[224:227], a[132:135], v[164:167]
    ds_read_b64_tr_b16 a[224:225], v216 offset:512
    s_waitcnt lgkmcnt(9)
    v_mfma_f32_16x16x32_bf16 v[4:7], a[232:235], a[128:131], v[4:7]
    ds_read_b64_tr_b16 a[226:227], v216 offset:4608
    buffer_load_dwordx4 v225, s[28:31], s98 offen offset:2048 lds
    v_mfma_f32_16x16x32_bf16 v[4:7], a[236:239], a[136:139], v[4:7]
    ds_read_b64_tr_b16 a[228:229], v216 offset:9728
    v_mfma_f32_16x16x32_bf16 v[168:171], a[236:239], a[140:143], v[168:171]
    ds_read_b64_tr_b16 a[230:231], v216 offset:13824
    v_mfma_f32_16x16x32_bf16 v[168:171], a[232:235], a[132:135], v[168:171]
    ds_read_b64_tr_b16 a[232:233], v217 offset:512
    s_waitcnt lgkmcnt(9)
    v_mfma_f32_16x16x32_bf16 v[8:11], a[240:243], a[128:131], v[8:11]
    ds_read_b64_tr_b16 a[234:235], v217 offset:4608
    buffer_load_dwordx4 a[168:171], v232, s[36:39], s97 offen offset:1024 sc1
    v_mfma_f32_16x16x32_bf16 v[8:11], a[244:247], a[136:139], v[8:11]
    ds_read_b64_tr_b16 a[236:237], v217 offset:9728
    v_mfma_f32_16x16x32_bf16 v[172:175], a[244:247], a[140:143], v[172:175]
    ds_read_b64_tr_b16 a[238:239], v217 offset:13824
    buffer_load_dwordx4 v226, s[28:31], s98 offen offset:3072 lds
    v_mfma_f32_16x16x32_bf16 v[172:175], a[240:243], a[132:135], v[172:175]
    ds_read_b64_tr_b16 a[240:241], v216 offset:768
    s_waitcnt lgkmcnt(9)
    v_mfma_f32_16x16x32_bf16 v[12:15], a[248:251], a[128:131], v[12:15]
    ds_read_b64_tr_b16 a[242:243], v216 offset:4864
    s_add_u32 s97, s84, 149504
    v_mfma_f32_16x16x32_bf16 v[12:15], a[252:255], a[136:139], v[12:15]
    ds_read_b64_tr_b16 a[244:245], v216 offset:9984
    buffer_load_dwordx4 a[164:167], v232, s[36:39], s97 offen sc1
    v_mfma_f32_16x16x32_bf16 v[176:179], a[252:255], a[140:143], v[176:179]
    ds_read_b64_tr_b16 a[246:247], v216 offset:14080
    v_mfma_f32_16x16x32_bf16 v[176:179], a[248:251], a[132:135], v[176:179]
    ds_read_b64_tr_b16 a[248:249], v217 offset:768
    s_waitcnt lgkmcnt(9)
    v_mfma_f32_16x16x32_bf16 v[16:19], a[224:227], a[128:131], v[16:19]
    ds_read_b64_tr_b16 a[250:251], v217 offset:4864
    s_add_u32 m0, s93, 16384
    v_mfma_f32_16x16x32_bf16 v[16:19], a[228:231], a[136:139], v[16:19]
    ds_read_b64_tr_b16 a[252:253], v217 offset:9984
    buffer_load_dwordx4 v227, s[28:31], s98 offen offset:0 lds
    v_mfma_f32_16x16x32_bf16 v[180:183], a[228:231], a[140:143], v[180:183]
    ds_read_b64_tr_b16 a[254:255], v217 offset:14080
    v_mfma_f32_16x16x32_bf16 v[180:183], a[224:227], a[132:135], v[180:183]
    ds_read_b128 a[224:227], v220 offset:8192
    s_waitcnt lgkmcnt(9)
    v_mfma_f32_16x16x32_bf16 v[20:23], a[232:235], a[128:131], v[20:23]
    ds_read_b128 a[228:231], v220 offset:17408
    buffer_load_dwordx4 a[172:175], v232, s[36:39], s97 offen offset:1024 sc1
    v_mfma_f32_16x16x32_bf16 v[20:23], a[236:239], a[136:139], v[20:23]
    v_mfma_f32_16x16x32_bf16 v[184:187], a[236:239], a[140:143], v[184:187]
    v_mfma_f32_16x16x32_bf16 v[184:187], a[232:235], a[132:135], v[184:187]
    ds_read_b64_tr_b16 a[232:233], v216 offset:18432
    s_waitcnt lgkmcnt(7)
    v_mfma_f32_16x16x32_bf16 v[24:27], a[240:243], a[128:131], v[24:27]
    ds_read_b64_tr_b16 a[234:235], v216 offset:22528
    buffer_load_dwordx4 v228, s[28:31], s98 offen offset:1024 lds
    v_mfma_f32_16x16x32_bf16 v[24:27], a[244:247], a[136:139], v[24:27]
    ds_read_b64_tr_b16 a[236:237], v216 offset:27648
    s_add_u32 s97, s84, 6144
    v_mfma_f32_16x16x32_bf16 v[188:191], a[244:247], a[140:143], v[188:191]
    ds_read_b64_tr_b16 a[238:239], v216 offset:31744
    buffer_load_dwordx4 a[176:179], v232, s[36:39], s97 offen sc1
    v_mfma_f32_16x16x32_bf16 v[188:191], a[240:243], a[132:135], v[188:191]
    ds_read_b64_tr_b16 a[240:241], v217 offset:18432
    s_waitcnt lgkmcnt(7)
    v_mfma_f32_16x16x32_bf16 v[28:31], a[248:251], a[128:131], v[28:31]
    ds_read_b64_tr_b16 a[242:243], v217 offset:22528
    v_mfma_f32_16x16x32_bf16 v[28:31], a[252:255], a[136:139], v[28:31]
    ds_read_b64_tr_b16 a[244:245], v217 offset:27648
    v_mfma_f32_16x16x32_bf16 v[208:211], a[252:255], a[140:143], v[208:211]
    ds_read_b64_tr_b16 a[246:247], v217 offset:31744
    v_mfma_f32_16x16x32_bf16 v[208:211], a[248:251], a[132:135], v[208:211]
    ds_read_b64_tr_b16 a[248:249], v216 offset:18688
    s_waitcnt lgkmcnt(9)
    v_mfma_f32_16x16x32_bf16 v[160:163], a[224:227], a[128:131], v[160:163]
    ds_read_b64_tr_b16 a[250:251], v216 offset:22784
    buffer_load_dwordx4 a[184:187], v232, s[36:39], s97 offen offset:1024 sc1
    v_mfma_f32_16x16x32_bf16 v[160:163], a[228:231], a[136:139], v[160:163]
    ds_read_b64_tr_b16 a[252:253], v216 offset:27904
    buffer_load_dwordx4 v229, s[28:31], s98 offen offset:2048 lds
    v_mfma_f32_16x16x32_bf16 v[212:215], a[228:231], a[140:143], v[212:215]
    ds_read_b64_tr_b16 a[254:255], v216 offset:32000
    v_mfma_f32_16x16x32_bf16 v[212:215], a[224:227], a[132:135], v[212:215]
    ds_read_b64_tr_b16 a[224:225], v217 offset:18688
    s_waitcnt lgkmcnt(9)
    v_mfma_f32_16x16x32_bf16 v[0:3], a[232:235], a[144:147], v[0:3]
    ds_read_b64_tr_b16 a[226:227], v217 offset:22784
    s_add_u32 s97, s84, 153600
    v_mfma_f32_16x16x32_bf16 v[0:3], a[236:239], a[152:155], v[0:3]
    ds_read_b64_tr_b16 a[228:229], v217 offset:27904
    buffer_load_dwordx4 a[180:183], v232, s[36:39], s97 offen sc1
    v_mfma_f32_16x16x32_bf16 v[164:167], a[236:239], a[156:159], v[164:167]
    ds_read_b64_tr_b16 a[230:231], v217 offset:32000
    buffer_load_dwordx4 v230, s[28:31], s98 offen offset:3072 lds
    v_mfma_f32_16x16x32_bf16 v[164:167], a[232:235], a[148:151], v[164:167]
    ds_read_b64_tr_b16 a[232:233], v216 offset:18944
    s_waitcnt lgkmcnt(9)
    v_mfma_f32_16x16x32_bf16 v[4:7], a[240:243], a[144:147], v[4:7]
    ds_read_b64_tr_b16 a[234:235], v216 offset:23040
    v_mfma_f32_16x16x32_bf16 v[4:7], a[244:247], a[152:155], v[4:7]
    ds_read_b64_tr_b16 a[236:237], v216 offset:28160
    v_mfma_f32_16x16x32_bf16 v[168:171], a[244:247], a[156:159], v[168:171]
    ds_read_b64_tr_b16 a[238:239], v216 offset:32256
    v_mfma_f32_16x16x32_bf16 v[168:171], a[240:243], a[148:151], v[168:171]
    ds_read_b64_tr_b16 a[240:241], v217 offset:18944
    s_waitcnt lgkmcnt(9)
    v_mfma_f32_16x16x32_bf16 v[8:11], a[248:251], a[144:147], v[8:11]
    ds_read_b64_tr_b16 a[242:243], v217 offset:23040
    buffer_load_dwordx4 a[188:191], v232, s[36:39], s97 offen offset:1024 sc1
    v_mfma_f32_16x16x32_bf16 v[8:11], a[252:255], a[152:155], v[8:11]
    ds_read_b64_tr_b16 a[244:245], v217 offset:28160
    s_add_u32 m0, s93, 20480
    v_mfma_f32_16x16x32_bf16 v[172:175], a[252:255], a[156:159], v[172:175]
    ds_read_b64_tr_b16 a[246:247], v217 offset:32256
    buffer_load_dwordx4 v232, s[36:39], s99 offen sc1 lds
    v_mfma_f32_16x16x32_bf16 v[172:175], a[248:251], a[148:151], v[172:175]
    ds_read_b64_tr_b16 a[248:249], v216 offset:19200
    s_waitcnt lgkmcnt(9)
    v_mfma_f32_16x16x32_bf16 v[12:15], a[224:227], a[144:147], v[12:15]
    ds_read_b64_tr_b16 a[250:251], v216 offset:23296
    v_mfma_f32_16x16x32_bf16 v[12:15], a[228:231], a[152:155], v[12:15]
    ds_read_b64_tr_b16 a[252:253], v216 offset:28416
    s_add_u32 s97, s84, 10240
    v_mfma_f32_16x16x32_bf16 v[176:179], a[228:231], a[156:159], v[176:179]
    ds_read_b64_tr_b16 a[254:255], v216 offset:32512
    buffer_load_dwordx4 a[192:195], v232, s[36:39], s97 offen sc1
    v_mfma_f32_16x16x32_bf16 v[176:179], a[224:227], a[148:151], v[176:179]
    ds_read_b64_tr_b16 a[224:225], v217 offset:19200
    s_waitcnt lgkmcnt(9)
    v_mfma_f32_16x16x32_bf16 v[16:19], a[232:235], a[144:147], v[16:19]
    ds_read_b64_tr_b16 a[226:227], v217 offset:23296
    v_mfma_f32_16x16x32_bf16 v[16:19], a[236:239], a[152:155], v[16:19]
    ds_read_b64_tr_b16 a[228:229], v217 offset:28416
    v_mfma_f32_16x16x32_bf16 v[180:183], a[236:239], a[156:159], v[180:183]
    ds_read_b64_tr_b16 a[230:231], v217 offset:32512
    v_mfma_f32_16x16x32_bf16 v[180:183], a[232:235], a[148:151], v[180:183]
    ds_read_b128 a[232:235], v220 offset:26624
    s_waitcnt lgkmcnt(9)
    v_mfma_f32_16x16x32_bf16 v[20:23], a[240:243], a[144:147], v[20:23]
    ds_read_b128 a[236:239], v220 offset:35840
    buffer_load_dwordx4 a[200:203], v232, s[36:39], s97 offen offset:1024 sc1
    v_mfma_f32_16x16x32_bf16 v[20:23], a[244:247], a[152:155], v[20:23]
    v_mfma_f32_16x16x32_bf16 v[184:187], a[244:247], a[156:159], v[184:187]
    v_mfma_f32_16x16x32_bf16 v[184:187], a[240:243], a[148:151], v[184:187]
    s_waitcnt lgkmcnt(0)
    s_barrier
    v_mfma_f32_16x16x32_bf16 v[24:27], a[248:251], a[144:147], v[24:27]
    v_subrev_u32 v220, 36864, v220
    v_subrev_u32 v216, 36864, v216
    v_mfma_f32_16x16x32_bf16 v[24:27], a[252:255], a[152:155], v[24:27]
sequential_preLN__linear_kernel_hedgehog__glu_gated_reglu__prompt_kernel_hop1_7:
    s_cbranch_execz sequential_preLN__linear_kernel_hedgehog__glu_gated_reglu__prompt_kernel_hop1_8
    v_subrev_u32 v217, 36864, v217
    ds_read_b64_tr_b16 a[240:241], v216 offset:0
    v_mfma_f32_16x16x32_bf16 v[188:191], a[252:255], a[156:159], v[188:191]
    ds_read_b64_tr_b16 a[242:243], v216 offset:4096
    ds_read_b64_tr_b16 a[244:245], v216 offset:9216
    v_mfma_f32_16x16x32_bf16 v[188:191], a[248:251], a[148:151], v[188:191]
    ds_read_b64_tr_b16 a[246:247], v216 offset:13312
    v_mfma_f32_16x16x32_bf16 v[28:31], a[224:227], a[144:147], v[28:31]
    ds_read_b64_tr_b16 a[248:249], v217 offset:0
    ds_read_b64_tr_b16 a[250:251], v217 offset:4096
    v_mfma_f32_16x16x32_bf16 v[28:31], a[228:231], a[152:155], v[28:31]
    ds_read_b64_tr_b16 a[252:253], v217 offset:9216
    s_add_u32 s97, s84, 157696
    v_mfma_f32_16x16x32_bf16 v[208:211], a[228:231], a[156:159], v[208:211]
    ds_read_b64_tr_b16 a[254:255], v217 offset:13312
    buffer_load_dwordx4 a[196:199], v232, s[36:39], s97 offen sc1
    v_mfma_f32_16x16x32_bf16 v[208:211], a[224:227], a[148:151], v[208:211]
    ds_read_b64_tr_b16 a[224:225], v216 offset:256
    v_mfma_f32_16x16x32_bf16 v[160:163], a[232:235], a[144:147], v[160:163]
    ds_read_b64_tr_b16 a[226:227], v216 offset:4352
    buffer_load_dwordx4 a[204:207], v232, s[36:39], s97 offen offset:1024 sc1
    v_mfma_f32_16x16x32_bf16 v[160:163], a[236:239], a[152:155], v[160:163]
    ds_read_b64_tr_b16 a[228:229], v216 offset:9472
    s_add_u32 s98, s80, 958464
    v_mfma_f32_16x16x32_bf16 v[212:215], a[236:239], a[156:159], v[212:215]
    ds_read_b64_tr_b16 a[230:231], v216 offset:13568
    s_add_u32 s99, s89, 26624
    v_mfma_f32_16x16x32_bf16 v[212:215], a[232:235], a[148:151], v[212:215]
    ds_read_b64_tr_b16 a[232:233], v217 offset:256
    s_waitcnt vmcnt(12) lgkmcnt(9)
    v_mfma_f32_16x16x32_bf16 v[0:3], a[240:243], a[160:163], v[0:3]
    ds_read_b64_tr_b16 a[234:235], v217 offset:4352
    s_add_u32 m0, s93, 122880
    v_mfma_f32_16x16x32_bf16 v[0:3], a[244:247], a[168:171], v[0:3]
    ds_read_b64_tr_b16 a[236:237], v217 offset:9472
    s_add_u32 s97, s84, 14336
    v_mfma_f32_16x16x32_bf16 v[164:167], a[244:247], a[172:175], v[164:167]
    ds_read_b64_tr_b16 a[238:239], v217 offset:13568
    buffer_load_dwordx4 a[208:211], v232, s[36:39], s97 offen sc1
    v_mfma_f32_16x16x32_bf16 v[164:167], a[240:243], a[164:167], v[164:167]
    ds_read_b64_tr_b16 a[240:241], v216 offset:512
    s_waitcnt lgkmcnt(9)
    v_mfma_f32_16x16x32_bf16 v[4:7], a[248:251], a[160:163], v[4:7]
    ds_read_b64_tr_b16 a[242:243], v216 offset:4608
    buffer_load_dwordx4 v223, s[28:31], s98 offen offset:0 lds
    v_mfma_f32_16x16x32_bf16 v[4:7], a[252:255], a[168:171], v[4:7]
    ds_read_b64_tr_b16 a[244:245], v216 offset:9728
    buffer_load_dwordx4 v224, s[28:31], s98 offen offset:1024 lds
    v_mfma_f32_16x16x32_bf16 v[168:171], a[252:255], a[172:175], v[168:171]
    ds_read_b64_tr_b16 a[246:247], v216 offset:13824
    buffer_load_dwordx4 v225, s[28:31], s98 offen offset:2048 lds
    v_mfma_f32_16x16x32_bf16 v[168:171], a[248:251], a[164:167], v[168:171]
    ds_read_b64_tr_b16 a[248:249], v217 offset:512
    s_waitcnt lgkmcnt(9)
    v_mfma_f32_16x16x32_bf16 v[8:11], a[224:227], a[160:163], v[8:11]
    ds_read_b64_tr_b16 a[250:251], v217 offset:4608
    buffer_load_dwordx4 a[216:219], v232, s[36:39], s97 offen offset:1024 sc1
    v_mfma_f32_16x16x32_bf16 v[8:11], a[228:231], a[168:171], v[8:11]
    ds_read_b64_tr_b16 a[252:253], v217 offset:9728
    v_mfma_f32_16x16x32_bf16 v[172:175], a[228:231], a[172:175], v[172:175]
    ds_read_b64_tr_b16 a[254:255], v217 offset:13824
    buffer_load_dwordx4 v226, s[28:31], s98 offen offset:3072 lds
    v_mfma_f32_16x16x32_bf16 v[172:175], a[224:227], a[164:167], v[172:175]
    ds_read_b64_tr_b16 a[224:225], v216 offset:768
    s_waitcnt lgkmcnt(9)
    v_mfma_f32_16x16x32_bf16 v[12:15], a[232:235], a[160:163], v[12:15]
    ds_read_b64_tr_b16 a[226:227], v216 offset:4864
    s_add_u32 s97, s84, 161792
    v_mfma_f32_16x16x32_bf16 v[12:15], a[236:239], a[168:171], v[12:15]
    ds_read_b64_tr_b16 a[228:229], v216 offset:9984
    buffer_load_dwordx4 a[212:215], v232, s[36:39], s97 offen sc1
    v_mfma_f32_16x16x32_bf16 v[176:179], a[236:239], a[172:175], v[176:179]
    ds_read_b64_tr_b16 a[230:231], v216 offset:14080
    v_mfma_f32_16x16x32_bf16 v[176:179], a[232:235], a[164:167], v[176:179]
    ds_read_b64_tr_b16 a[232:233], v217 offset:768
    s_waitcnt lgkmcnt(9)
    v_mfma_f32_16x16x32_bf16 v[16:19], a[240:243], a[160:163], v[16:19]
    ds_read_b64_tr_b16 a[234:235], v217 offset:4864
    s_add_u32 m0, s93, 126976
    v_mfma_f32_16x16x32_bf16 v[16:19], a[244:247], a[168:171], v[16:19]
    ds_read_b64_tr_b16 a[236:237], v217 offset:9984
    buffer_load_dwordx4 v227, s[28:31], s98 offen offset:0 lds
    v_mfma_f32_16x16x32_bf16 v[180:183], a[244:247], a[172:175], v[180:183]
    ds_read_b64_tr_b16 a[238:239], v217 offset:14080
    v_mfma_f32_16x16x32_bf16 v[180:183], a[240:243], a[164:167], v[180:183]
    ds_read_b128 a[240:243], v220 offset:8192
    s_waitcnt lgkmcnt(9)
    v_mfma_f32_16x16x32_bf16 v[20:23], a[248:251], a[160:163], v[20:23]
    ds_read_b128 a[244:247], v220 offset:17408
    buffer_load_dwordx4 a[220:223], v232, s[36:39], s97 offen offset:1024 sc1
    v_mfma_f32_16x16x32_bf16 v[20:23], a[252:255], a[168:171], v[20:23]
    v_mfma_f32_16x16x32_bf16 v[184:187], a[252:255], a[172:175], v[184:187]
    v_mfma_f32_16x16x32_bf16 v[184:187], a[248:251], a[164:167], v[184:187]
    ds_read_b64_tr_b16 a[248:249], v216 offset:18432
    s_waitcnt lgkmcnt(7)
    v_mfma_f32_16x16x32_bf16 v[24:27], a[224:227], a[160:163], v[24:27]
    ds_read_b64_tr_b16 a[250:251], v216 offset:22528
    buffer_load_dwordx4 v228, s[28:31], s98 offen offset:1024 lds
    v_mfma_f32_16x16x32_bf16 v[24:27], a[228:231], a[168:171], v[24:27]
    ds_read_b64_tr_b16 a[252:253], v216 offset:27648
    s_add_u32 s97, s84, 18432
    v_mfma_f32_16x16x32_bf16 v[188:191], a[228:231], a[172:175], v[188:191]
    ds_read_b64_tr_b16 a[254:255], v216 offset:31744
    buffer_load_dwordx4 a[0:3], v232, s[36:39], s97 offen sc1
    v_mfma_f32_16x16x32_bf16 v[188:191], a[224:227], a[164:167], v[188:191]
    ds_read_b64_tr_b16 a[224:225], v217 offset:18432
    s_waitcnt lgkmcnt(7)
    v_mfma_f32_16x16x32_bf16 v[28:31], a[232:235], a[160:163], v[28:31]
    ds_read_b64_tr_b16 a[226:227], v217 offset:22528
    v_mfma_f32_16x16x32_bf16 v[28:31], a[236:239], a[168:171], v[28:31]
    ds_read_b64_tr_b16 a[228:229], v217 offset:27648
    v_mfma_f32_16x16x32_bf16 v[208:211], a[236:239], a[172:175], v[208:211]
    ds_read_b64_tr_b16 a[230:231], v217 offset:31744
    v_mfma_f32_16x16x32_bf16 v[208:211], a[232:235], a[164:167], v[208:211]
    ds_read_b64_tr_b16 a[232:233], v216 offset:18688
    s_waitcnt lgkmcnt(9)
    v_mfma_f32_16x16x32_bf16 v[160:163], a[240:243], a[160:163], v[160:163]
    ds_read_b64_tr_b16 a[234:235], v216 offset:22784
    buffer_load_dwordx4 a[8:11], v232, s[36:39], s97 offen offset:1024 sc1
    v_mfma_f32_16x16x32_bf16 v[160:163], a[244:247], a[168:171], v[160:163]
    ds_read_b64_tr_b16 a[236:237], v216 offset:27904
    buffer_load_dwordx4 v229, s[28:31], s98 offen offset:2048 lds
    v_mfma_f32_16x16x32_bf16 v[212:215], a[244:247], a[172:175], v[212:215]
    ds_read_b64_tr_b16 a[238:239], v216 offset:32000
    v_mfma_f32_16x16x32_bf16 v[212:215], a[240:243], a[164:167], v[212:215]
    ds_read_b64_tr_b16 a[240:241], v217 offset:18688
    s_waitcnt vmcnt(18) lgkmcnt(9)
    v_mfma_f32_16x16x32_bf16 v[0:3], a[248:251], a[176:179], v[0:3]
    ds_read_b64_tr_b16 a[242:243], v217 offset:22784
    s_add_u32 s97, s84, 165888
    v_mfma_f32_16x16x32_bf16 v[0:3], a[252:255], a[184:187], v[0:3]
    ds_read_b64_tr_b16 a[244:245], v217 offset:27904
    buffer_load_dwordx4 a[4:7], v232, s[36:39], s97 offen sc1
    v_mfma_f32_16x16x32_bf16 v[164:167], a[252:255], a[188:191], v[164:167]
    ds_read_b64_tr_b16 a[246:247], v217 offset:32000
    buffer_load_dwordx4 v230, s[28:31], s98 offen offset:3072 lds
    v_mfma_f32_16x16x32_bf16 v[164:167], a[248:251], a[180:183], v[164:167]
    ds_read_b64_tr_b16 a[248:249], v216 offset:18944
    s_waitcnt lgkmcnt(9)
    v_mfma_f32_16x16x32_bf16 v[4:7], a[224:227], a[176:179], v[4:7]
    ds_read_b64_tr_b16 a[250:251], v216 offset:23040
    v_mfma_f32_16x16x32_bf16 v[4:7], a[228:231], a[184:187], v[4:7]
    ds_read_b64_tr_b16 a[252:253], v216 offset:28160
    v_mfma_f32_16x16x32_bf16 v[168:171], a[228:231], a[188:191], v[168:171]
    ds_read_b64_tr_b16 a[254:255], v216 offset:32256
    v_mfma_f32_16x16x32_bf16 v[168:171], a[224:227], a[180:183], v[168:171]
    ds_read_b64_tr_b16 a[224:225], v217 offset:18944
    s_waitcnt lgkmcnt(9)
    v_mfma_f32_16x16x32_bf16 v[8:11], a[232:235], a[176:179], v[8:11]
    ds_read_b64_tr_b16 a[226:227], v217 offset:23040
    buffer_load_dwordx4 a[12:15], v232, s[36:39], s97 offen offset:1024 sc1
    v_mfma_f32_16x16x32_bf16 v[8:11], a[236:239], a[184:187], v[8:11]
    ds_read_b64_tr_b16 a[228:229], v217 offset:28160
    s_add_u32 m0, s93, 131072
    v_mfma_f32_16x16x32_bf16 v[172:175], a[236:239], a[188:191], v[172:175]
    ds_read_b64_tr_b16 a[230:231], v217 offset:32256
    buffer_load_dwordx4 v232, s[36:39], s99 offen sc1 lds
    v_mfma_f32_16x16x32_bf16 v[172:175], a[232:235], a[180:183], v[172:175]
    ds_read_b64_tr_b16 a[232:233], v216 offset:19200
    s_waitcnt lgkmcnt(9)
    v_mfma_f32_16x16x32_bf16 v[12:15], a[240:243], a[176:179], v[12:15]
    ds_read_b64_tr_b16 a[234:235], v216 offset:23296
    v_mfma_f32_16x16x32_bf16 v[12:15], a[244:247], a[184:187], v[12:15]
    ds_read_b64_tr_b16 a[236:237], v216 offset:28416
    s_add_u32 s97, s84, 22528
    v_mfma_f32_16x16x32_bf16 v[176:179], a[244:247], a[188:191], v[176:179]
    ds_read_b64_tr_b16 a[238:239], v216 offset:32512
    buffer_load_dwordx4 a[16:19], v232, s[36:39], s97 offen sc1
    v_mfma_f32_16x16x32_bf16 v[176:179], a[240:243], a[180:183], v[176:179]
    ds_read_b64_tr_b16 a[240:241], v217 offset:19200
    s_waitcnt lgkmcnt(9)
    v_mfma_f32_16x16x32_bf16 v[16:19], a[248:251], a[176:179], v[16:19]
    ds_read_b64_tr_b16 a[242:243], v217 offset:23296
    v_mfma_f32_16x16x32_bf16 v[16:19], a[252:255], a[184:187], v[16:19]
    ds_read_b64_tr_b16 a[244:245], v217 offset:28416
    v_mfma_f32_16x16x32_bf16 v[180:183], a[252:255], a[188:191], v[180:183]
    ds_read_b64_tr_b16 a[246:247], v217 offset:32512
    v_mfma_f32_16x16x32_bf16 v[180:183], a[248:251], a[180:183], v[180:183]
    ds_read_b128 a[248:251], v220 offset:26624
    s_waitcnt lgkmcnt(9)
    v_mfma_f32_16x16x32_bf16 v[20:23], a[224:227], a[176:179], v[20:23]
    ds_read_b128 a[252:255], v220 offset:35840
    buffer_load_dwordx4 a[24:27], v232, s[36:39], s97 offen offset:1024 sc1
    v_mfma_f32_16x16x32_bf16 v[20:23], a[228:231], a[184:187], v[20:23]
    v_mfma_f32_16x16x32_bf16 v[184:187], a[228:231], a[188:191], v[184:187]
    v_mfma_f32_16x16x32_bf16 v[184:187], a[224:227], a[180:183], v[184:187]
    s_waitcnt lgkmcnt(0)
    s_barrier
    v_mfma_f32_16x16x32_bf16 v[24:27], a[232:235], a[176:179], v[24:27]
    v_subrev_u32 v220, 36864, v220
    v_subrev_u32 v216, 36864, v216
    v_mfma_f32_16x16x32_bf16 v[24:27], a[236:239], a[184:187], v[24:27]
    v_subrev_u32 v217, 36864, v217
    ds_read_b64_tr_b16 a[224:225], v216 offset:0
    v_mfma_f32_16x16x32_bf16 v[188:191], a[236:239], a[188:191], v[188:191]
    ds_read_b64_tr_b16 a[226:227], v216 offset:4096
    ds_read_b64_tr_b16 a[228:229], v216 offset:9216
    v_mfma_f32_16x16x32_bf16 v[188:191], a[232:235], a[180:183], v[188:191]
    ds_read_b64_tr_b16 a[230:231], v216 offset:13312
    v_mfma_f32_16x16x32_bf16 v[28:31], a[240:243], a[176:179], v[28:31]
    ds_read_b64_tr_b16 a[232:233], v217 offset:0
    ds_read_b64_tr_b16 a[234:235], v217 offset:4096
    v_mfma_f32_16x16x32_bf16 v[28:31], a[244:247], a[184:187], v[28:31]
    ds_read_b64_tr_b16 a[236:237], v217 offset:9216
    s_add_u32 s97, s84, 169984
    v_mfma_f32_16x16x32_bf16 v[208:211], a[244:247], a[188:191], v[208:211]
    ds_read_b64_tr_b16 a[238:239], v217 offset:13312
    buffer_load_dwordx4 a[20:23], v232, s[36:39], s97 offen sc1
    v_mfma_f32_16x16x32_bf16 v[208:211], a[240:243], a[180:183], v[208:211]
    ds_read_b64_tr_b16 a[240:241], v216 offset:256
    v_mfma_f32_16x16x32_bf16 v[160:163], a[248:251], a[176:179], v[160:163]
    ds_read_b64_tr_b16 a[242:243], v216 offset:4352
    buffer_load_dwordx4 a[28:31], v232, s[36:39], s97 offen offset:1024 sc1
    v_mfma_f32_16x16x32_bf16 v[160:163], a[252:255], a[184:187], v[160:163]
    ds_read_b64_tr_b16 a[244:245], v216 offset:9472
    v_mfma_f32_16x16x32_bf16 v[212:215], a[252:255], a[188:191], v[212:215]
    ds_read_b64_tr_b16 a[246:247], v216 offset:13568
    v_mfma_f32_16x16x32_bf16 v[212:215], a[248:251], a[180:183], v[212:215]
    ds_read_b64_tr_b16 a[248:249], v217 offset:256
    s_waitcnt vmcnt(21) lgkmcnt(9)
    v_mfma_f32_16x16x32_bf16 v[0:3], a[224:227], a[192:195], v[0:3]
    ds_read_b64_tr_b16 a[250:251], v217 offset:4352
    v_mfma_f32_16x16x32_bf16 v[0:3], a[228:231], a[200:203], v[0:3]
    ds_read_b64_tr_b16 a[252:253], v217 offset:9472
    s_add_u32 s97, s84, 26624
    v_mfma_f32_16x16x32_bf16 v[164:167], a[228:231], a[204:207], v[164:167]
    ds_read_b64_tr_b16 a[254:255], v217 offset:13568
    buffer_load_dwordx4 a[32:35], v232, s[36:39], s97 offen sc1
    v_mfma_f32_16x16x32_bf16 v[164:167], a[224:227], a[196:199], v[164:167]
    ds_read_b64_tr_b16 a[224:225], v216 offset:512
    s_waitcnt lgkmcnt(9)
    v_mfma_f32_16x16x32_bf16 v[4:7], a[232:235], a[192:195], v[4:7]
    ds_read_b64_tr_b16 a[226:227], v216 offset:4608
    v_mfma_f32_16x16x32_bf16 v[4:7], a[236:239], a[200:203], v[4:7]
    ds_read_b64_tr_b16 a[228:229], v216 offset:9728
    v_mfma_f32_16x16x32_bf16 v[168:171], a[236:239], a[204:207], v[168:171]
    ds_read_b64_tr_b16 a[230:231], v216 offset:13824
    v_mfma_f32_16x16x32_bf16 v[168:171], a[232:235], a[196:199], v[168:171]
    ds_read_b64_tr_b16 a[232:233], v217 offset:512
    s_waitcnt lgkmcnt(9)
    v_mfma_f32_16x16x32_bf16 v[8:11], a[240:243], a[192:195], v[8:11]
    ds_read_b64_tr_b16 a[234:235], v217 offset:4608
    buffer_load_dwordx4 a[40:43], v232, s[36:39], s97 offen offset:1024 sc1
    v_mfma_f32_16x16x32_bf16 v[8:11], a[244:247], a[200:203], v[8:11]
    ds_read_b64_tr_b16 a[236:237], v217 offset:9728
    v_mfma_f32_16x16x32_bf16 v[172:175], a[244:247], a[204:207], v[172:175]
    ds_read_b64_tr_b16 a[238:239], v217 offset:13824
    v_mfma_f32_16x16x32_bf16 v[172:175], a[240:243], a[196:199], v[172:175]
    ds_read_b64_tr_b16 a[240:241], v216 offset:768
    s_waitcnt lgkmcnt(9)
    v_mfma_f32_16x16x32_bf16 v[12:15], a[248:251], a[192:195], v[12:15]
    ds_read_b64_tr_b16 a[242:243], v216 offset:4864
    s_add_u32 s97, s84, 174080
    v_mfma_f32_16x16x32_bf16 v[12:15], a[252:255], a[200:203], v[12:15]
    ds_read_b64_tr_b16 a[244:245], v216 offset:9984
    buffer_load_dwordx4 a[36:39], v232, s[36:39], s97 offen sc1
    v_mfma_f32_16x16x32_bf16 v[176:179], a[252:255], a[204:207], v[176:179]
    ds_read_b64_tr_b16 a[246:247], v216 offset:14080
    v_mfma_f32_16x16x32_bf16 v[176:179], a[248:251], a[196:199], v[176:179]
    ds_read_b64_tr_b16 a[248:249], v217 offset:768
    s_waitcnt lgkmcnt(9)
    v_mfma_f32_16x16x32_bf16 v[16:19], a[224:227], a[192:195], v[16:19]
    ds_read_b64_tr_b16 a[250:251], v217 offset:4864
    v_mfma_f32_16x16x32_bf16 v[16:19], a[228:231], a[200:203], v[16:19]
    ds_read_b64_tr_b16 a[252:253], v217 offset:9984
    v_mfma_f32_16x16x32_bf16 v[180:183], a[228:231], a[204:207], v[180:183]
    ds_read_b64_tr_b16 a[254:255], v217 offset:14080
    v_mfma_f32_16x16x32_bf16 v[180:183], a[224:227], a[196:199], v[180:183]
    ds_read_b128 a[224:227], v220 offset:8192
    s_waitcnt lgkmcnt(9)
    v_mfma_f32_16x16x32_bf16 v[20:23], a[232:235], a[192:195], v[20:23]
    ds_read_b128 a[228:231], v220 offset:17408
    buffer_load_dwordx4 a[44:47], v232, s[36:39], s97 offen offset:1024 sc1
    v_mfma_f32_16x16x32_bf16 v[20:23], a[236:239], a[200:203], v[20:23]
    v_mfma_f32_16x16x32_bf16 v[184:187], a[236:239], a[204:207], v[184:187]
    v_mfma_f32_16x16x32_bf16 v[184:187], a[232:235], a[196:199], v[184:187]
    ds_read_b64_tr_b16 a[232:233], v216 offset:18432
    s_waitcnt lgkmcnt(7)
    v_mfma_f32_16x16x32_bf16 v[24:27], a[240:243], a[192:195], v[24:27]
    ds_read_b64_tr_b16 a[234:235], v216 offset:22528
    v_mfma_f32_16x16x32_bf16 v[24:27], a[244:247], a[200:203], v[24:27]
    ds_read_b64_tr_b16 a[236:237], v216 offset:27648
    s_add_u32 s97, s84, 30720
    v_mfma_f32_16x16x32_bf16 v[188:191], a[244:247], a[204:207], v[188:191]
    ds_read_b64_tr_b16 a[238:239], v216 offset:31744
    buffer_load_dwordx4 a[48:51], v232, s[36:39], s97 offen sc1
    v_mfma_f32_16x16x32_bf16 v[188:191], a[240:243], a[196:199], v[188:191]
    ds_read_b64_tr_b16 a[240:241], v217 offset:18432
    s_waitcnt lgkmcnt(7)
    v_mfma_f32_16x16x32_bf16 v[28:31], a[248:251], a[192:195], v[28:31]
    ds_read_b64_tr_b16 a[242:243], v217 offset:22528
    v_mfma_f32_16x16x32_bf16 v[28:31], a[252:255], a[200:203], v[28:31]
    ds_read_b64_tr_b16 a[244:245], v217 offset:27648
    v_mfma_f32_16x16x32_bf16 v[208:211], a[252:255], a[204:207], v[208:211]
    ds_read_b64_tr_b16 a[246:247], v217 offset:31744
    s_lshr_b32 s94, s54, 1
    v_mfma_f32_16x16x32_bf16 v[208:211], a[248:251], a[196:199], v[208:211]
    ds_read_b64_tr_b16 a[248:249], v216 offset:18688
    s_waitcnt lgkmcnt(9)
    v_mfma_f32_16x16x32_bf16 v[160:163], a[224:227], a[192:195], v[160:163]
    ds_read_b64_tr_b16 a[250:251], v216 offset:22784
    buffer_load_dwordx4 a[56:59], v232, s[36:39], s97 offen offset:1024 sc1
    v_mfma_f32_16x16x32_bf16 v[160:163], a[228:231], a[200:203], v[160:163]
    ds_read_b64_tr_b16 a[252:253], v216 offset:27904
    s_add_u32 s85, s85, s94
    v_mfma_f32_16x16x32_bf16 v[212:215], a[228:231], a[204:207], v[212:215]
    ds_read_b64_tr_b16 a[254:255], v216 offset:32000
    s_mul_i32 s94, s85, 18432
    v_mfma_f32_16x16x32_bf16 v[212:215], a[224:227], a[196:199], v[212:215]
    ds_read_b64_tr_b16 a[224:225], v217 offset:18688
    s_waitcnt vmcnt(18) lgkmcnt(9)
    v_mfma_f32_16x16x32_bf16 v[0:3], a[232:235], a[208:211], v[0:3]
    ds_read_b64_tr_b16 a[226:227], v217 offset:22784
    s_add_u32 s97, s84, 178176
    v_mfma_f32_16x16x32_bf16 v[0:3], a[236:239], a[216:219], v[0:3]
    ds_read_b64_tr_b16 a[228:229], v217 offset:27904
    buffer_load_dwordx4 a[52:55], v232, s[36:39], s97 offen sc1
    v_mfma_f32_16x16x32_bf16 v[164:167], a[236:239], a[220:223], v[164:167]
    ds_read_b64_tr_b16 a[230:231], v217 offset:32000
    s_add_u32 s94, s94, 6422528
    v_mfma_f32_16x16x32_bf16 v[164:167], a[232:235], a[212:215], v[164:167]
    ds_read_b64_tr_b16 a[232:233], v216 offset:18944
    s_waitcnt lgkmcnt(9)
    v_mfma_f32_16x16x32_bf16 v[4:7], a[240:243], a[208:211], v[4:7]
    ds_read_b64_tr_b16 a[234:235], v216 offset:23040
    s_and_b32 s95, s57, 3
    v_mfma_f32_16x16x32_bf16 v[4:7], a[244:247], a[216:219], v[4:7]
    ds_read_b64_tr_b16 a[236:237], v216 offset:28160
    s_lshl_b32 s95, s95, 9
    v_mfma_f32_16x16x32_bf16 v[168:171], a[244:247], a[220:223], v[168:171]
    ds_read_b64_tr_b16 a[238:239], v216 offset:32256
    s_add_u32 s76, s94, s95
    v_mfma_f32_16x16x32_bf16 v[168:171], a[240:243], a[212:215], v[168:171]
    ds_read_b64_tr_b16 a[240:241], v217 offset:18944
    s_waitcnt lgkmcnt(9)
    v_mfma_f32_16x16x32_bf16 v[8:11], a[248:251], a[208:211], v[8:11]
    ds_read_b64_tr_b16 a[242:243], v217 offset:23040
    buffer_load_dwordx4 a[60:63], v232, s[36:39], s97 offen offset:1024 sc1
    v_mfma_f32_16x16x32_bf16 v[8:11], a[252:255], a[216:219], v[8:11]
    ds_read_b64_tr_b16 a[244:245], v217 offset:28160
    s_add_u32 s76, s76, 16384
    v_mfma_f32_16x16x32_bf16 v[172:175], a[252:255], a[220:223], v[172:175]
    ds_read_b64_tr_b16 a[246:247], v217 offset:32256
    s_lshl_b32 s95, s95, 3
    v_mfma_f32_16x16x32_bf16 v[172:175], a[248:251], a[212:215], v[172:175]
    ds_read_b64_tr_b16 a[248:249], v216 offset:19200
    s_waitcnt lgkmcnt(9)
    v_mfma_f32_16x16x32_bf16 v[12:15], a[224:227], a[208:211], v[12:15]
    ds_read_b64_tr_b16 a[250:251], v216 offset:23296
    s_add_u32 s94, s94, s95
    v_mfma_f32_16x16x32_bf16 v[12:15], a[228:231], a[216:219], v[12:15]
    ds_read_b64_tr_b16 a[252:253], v216 offset:28416
    s_and_b32 s95, s54, 1
    v_mfma_f32_16x16x32_bf16 v[176:179], a[228:231], a[220:223], v[176:179]
    ds_read_b64_tr_b16 a[254:255], v216 offset:32512
    s_mul_i32 s95, s95, 2048
    v_mfma_f32_16x16x32_bf16 v[176:179], a[224:227], a[212:215], v[176:179]
    ds_read_b64_tr_b16 a[224:225], v217 offset:19200
    s_waitcnt lgkmcnt(9)
    v_mfma_f32_16x16x32_bf16 v[16:19], a[232:235], a[208:211], v[16:19]
    ds_read_b64_tr_b16 a[226:227], v217 offset:23296
    s_add_u32 s94, s94, s95
    v_mfma_f32_16x16x32_bf16 v[16:19], a[236:239], a[216:219], v[16:19]
    ds_read_b64_tr_b16 a[228:229], v217 offset:28416
    buffer_load_dwordx2 v[32:33], v233, s[36:39], s94 offen offset:0 sc1
    v_mfma_f32_16x16x32_bf16 v[180:183], a[236:239], a[220:223], v[180:183]
    ds_read_b64_tr_b16 a[230:231], v217 offset:32512
    buffer_load_dwordx2 v[34:35], v233, s[36:39], s94 offen offset:512 sc1
    v_mfma_f32_16x16x32_bf16 v[180:183], a[232:235], a[212:215], v[180:183]
    ds_read_b128 a[232:235], v220 offset:26624
    s_waitcnt lgkmcnt(9)
    v_mfma_f32_16x16x32_bf16 v[20:23], a[240:243], a[208:211], v[20:23]
    ds_read_b128 a[236:239], v220 offset:35840
    buffer_load_dwordx2 v[36:37], v233, s[36:39], s94 offen offset:1024 sc1
    v_mfma_f32_16x16x32_bf16 v[20:23], a[244:247], a[216:219], v[20:23]
    buffer_load_dwordx2 v[38:39], v233, s[36:39], s94 offen offset:1536 sc1
    buffer_load_dwordx2 v[42:43], v233, s[36:39], s76 offen sc1
    v_mfma_f32_16x16x32_bf16 v[184:187], a[244:247], a[220:223], v[184:187]
    v_mfma_f32_16x16x32_bf16 v[184:187], a[240:243], a[212:215], v[184:187]
    s_waitcnt lgkmcnt(0)
    s_barrier
    v_mfma_f32_16x16x32_bf16 v[24:27], a[248:251], a[208:211], v[24:27]
    v_subrev_u32 v220, 36864, v220
    v_subrev_u32 v216, 36864, v216
    v_mfma_f32_16x16x32_bf16 v[24:27], a[252:255], a[216:219], v[24:27]
    v_subrev_u32 v217, 36864, v217
    ds_read_b64_tr_b16 a[240:241], v216 offset:0
    v_mfma_f32_16x16x32_bf16 v[188:191], a[252:255], a[220:223], v[188:191]
    ds_read_b64_tr_b16 a[242:243], v216 offset:4096
    ds_read_b64_tr_b16 a[244:245], v216 offset:9216
    v_mfma_f32_16x16x32_bf16 v[188:191], a[248:251], a[212:215], v[188:191]
    ds_read_b64_tr_b16 a[246:247], v216 offset:13312
    v_mfma_f32_16x16x32_bf16 v[28:31], a[224:227], a[208:211], v[28:31]
    ds_read_b64_tr_b16 a[248:249], v217 offset:0
    ds_read_b64_tr_b16 a[250:251], v217 offset:4096
    v_mfma_f32_16x16x32_bf16 v[28:31], a[228:231], a[216:219], v[28:31]
    ds_read_b64_tr_b16 a[252:253], v217 offset:9216
    v_mfma_f32_16x16x32_bf16 v[208:211], a[228:231], a[220:223], v[208:211]
    ds_read_b64_tr_b16 a[254:255], v217 offset:13312
    v_mfma_f32_16x16x32_bf16 v[208:211], a[224:227], a[212:215], v[208:211]
    ds_read_b64_tr_b16 a[224:225], v216 offset:256
    v_mfma_f32_16x16x32_bf16 v[160:163], a[232:235], a[208:211], v[160:163]
    ds_read_b64_tr_b16 a[226:227], v216 offset:4352
    v_mfma_f32_16x16x32_bf16 v[160:163], a[236:239], a[216:219], v[160:163]
    ds_read_b64_tr_b16 a[228:229], v216 offset:9472
    v_mfma_f32_16x16x32_bf16 v[212:215], a[236:239], a[220:223], v[212:215]
    ds_read_b64_tr_b16 a[230:231], v216 offset:13568
    v_mfma_f32_16x16x32_bf16 v[212:215], a[232:235], a[212:215], v[212:215]
    ds_read_b64_tr_b16 a[232:233], v217 offset:256
    s_waitcnt vmcnt(18) lgkmcnt(9)
    v_mfma_f32_16x16x32_bf16 v[0:3], a[240:243], a[0:3], v[0:3]
    ds_read_b64_tr_b16 a[234:235], v217 offset:4352
    v_mfma_f32_16x16x32_bf16 v[0:3], a[244:247], a[8:11], v[0:3]
    ds_read_b64_tr_b16 a[236:237], v217 offset:9472
    v_mfma_f32_16x16x32_bf16 v[164:167], a[244:247], a[12:15], v[164:167]
    ds_read_b64_tr_b16 a[238:239], v217 offset:13568
    v_mfma_f32_16x16x32_bf16 v[164:167], a[240:243], a[4:7], v[164:167]
    ds_read_b64_tr_b16 a[240:241], v216 offset:512
    s_waitcnt lgkmcnt(9)
    v_mfma_f32_16x16x32_bf16 v[4:7], a[248:251], a[0:3], v[4:7]
    ds_read_b64_tr_b16 a[242:243], v216 offset:4608
    v_mfma_f32_16x16x32_bf16 v[4:7], a[252:255], a[8:11], v[4:7]
    ds_read_b64_tr_b16 a[244:245], v216 offset:9728
    v_mfma_f32_16x16x32_bf16 v[168:171], a[252:255], a[12:15], v[168:171]
    ds_read_b64_tr_b16 a[246:247], v216 offset:13824
    v_mfma_f32_16x16x32_bf16 v[168:171], a[248:251], a[4:7], v[168:171]
    ds_read_b64_tr_b16 a[248:249], v217 offset:512
    s_waitcnt lgkmcnt(9)
    v_mfma_f32_16x16x32_bf16 v[8:11], a[224:227], a[0:3], v[8:11]
    ds_read_b64_tr_b16 a[250:251], v217 offset:4608
    v_mfma_f32_16x16x32_bf16 v[8:11], a[228:231], a[8:11], v[8:11]
    ds_read_b64_tr_b16 a[252:253], v217 offset:9728
    v_mfma_f32_16x16x32_bf16 v[172:175], a[228:231], a[12:15], v[172:175]
    ds_read_b64_tr_b16 a[254:255], v217 offset:13824
    v_lshrrev_b32 v238, 4, v232
    v_mfma_f32_16x16x32_bf16 v[172:175], a[224:227], a[4:7], v[172:175]
    ds_read_b64_tr_b16 a[224:225], v216 offset:768
    s_waitcnt lgkmcnt(9)
    v_mfma_f32_16x16x32_bf16 v[12:15], a[232:235], a[0:3], v[12:15]
    ds_read_b64_tr_b16 a[226:227], v216 offset:4864
    v_and_b32 v238, 3, v238
    v_mfma_f32_16x16x32_bf16 v[12:15], a[236:239], a[8:11], v[12:15]
    ds_read_b64_tr_b16 a[228:229], v216 offset:9984
    v_lshlrev_b32 v238, 8, v238
    v_mfma_f32_16x16x32_bf16 v[176:179], a[236:239], a[12:15], v[176:179]
    ds_read_b64_tr_b16 a[230:231], v216 offset:14080
    s_lshl_b32 s94, s51, 10
    v_mfma_f32_16x16x32_bf16 v[176:179], a[232:235], a[4:7], v[176:179]
    ds_read_b64_tr_b16 a[232:233], v217 offset:768
    s_waitcnt lgkmcnt(9)
    v_mfma_f32_16x16x32_bf16 v[16:19], a[240:243], a[0:3], v[16:19]
    ds_read_b64_tr_b16 a[234:235], v217 offset:4864
    s_lshl_b32 s95, s55, 7
    v_mfma_f32_16x16x32_bf16 v[16:19], a[244:247], a[8:11], v[16:19]
    ds_read_b64_tr_b16 a[236:237], v217 offset:9984
    s_add_u32 s94, s94, s95
    v_mfma_f32_16x16x32_bf16 v[180:183], a[244:247], a[12:15], v[180:183]
    ds_read_b64_tr_b16 a[238:239], v217 offset:14080
    s_lshl_b32 s95, s48, 2
    v_mfma_f32_16x16x32_bf16 v[180:183], a[240:243], a[4:7], v[180:183]
    ds_read_b128 a[240:243], v220 offset:8192
    s_waitcnt lgkmcnt(9)
    v_mfma_f32_16x16x32_bf16 v[20:23], a[248:251], a[0:3], v[20:23]
    ds_read_b128 a[244:247], v220 offset:17408
    s_add_u32 s94, s94, s95
    v_mfma_f32_16x16x32_bf16 v[20:23], a[252:255], a[8:11], v[20:23]
    v_add_u32 v238, s94, v238
    v_and_b32 v239, 12, v238
    v_mfma_f32_16x16x32_bf16 v[184:187], a[252:255], a[12:15], v[184:187]
    v_and_b32 v238, 0xffffff80, v238
    v_lshlrev_b32 v238, 2, v238
    v_mfma_f32_16x16x32_bf16 v[184:187], a[248:251], a[4:7], v[184:187]
    ds_read_b64_tr_b16 a[248:249], v216 offset:18432
    s_waitcnt lgkmcnt(7)
    v_mfma_f32_16x16x32_bf16 v[24:27], a[224:227], a[0:3], v[24:27]
    ds_read_b64_tr_b16 a[250:251], v216 offset:22528
    v_lshl_add_u32 v238, v239, 5, v238
    v_mfma_f32_16x16x32_bf16 v[24:27], a[228:231], a[8:11], v[24:27]
    ds_read_b64_tr_b16 a[252:253], v216 offset:27648
    v_mfma_f32_16x16x32_bf16 v[188:191], a[228:231], a[12:15], v[188:191]
    ds_read_b64_tr_b16 a[254:255], v216 offset:31744
    v_mfma_f32_16x16x32_bf16 v[188:191], a[224:227], a[4:7], v[188:191]
    ds_read_b64_tr_b16 a[224:225], v217 offset:18432
    s_waitcnt lgkmcnt(7)
    v_mfma_f32_16x16x32_bf16 v[28:31], a[232:235], a[0:3], v[28:31]
    ds_read_b64_tr_b16 a[226:227], v217 offset:22528
    v_mfma_f32_16x16x32_bf16 v[28:31], a[236:239], a[8:11], v[28:31]
    ds_read_b64_tr_b16 a[228:229], v217 offset:27648
    v_mfma_f32_16x16x32_bf16 v[208:211], a[236:239], a[12:15], v[208:211]
    ds_read_b64_tr_b16 a[230:231], v217 offset:31744
    v_mfma_f32_16x16x32_bf16 v[208:211], a[232:235], a[4:7], v[208:211]
    ds_read_b64_tr_b16 a[232:233], v216 offset:18688
    s_waitcnt lgkmcnt(9)
    v_mfma_f32_16x16x32_bf16 v[160:163], a[240:243], a[0:3], v[160:163]
    ds_read_b64_tr_b16 a[234:235], v216 offset:22784
    v_mfma_f32_16x16x32_bf16 v[160:163], a[244:247], a[8:11], v[160:163]
    ds_read_b64_tr_b16 a[236:237], v216 offset:27904
    v_mfma_f32_16x16x32_bf16 v[212:215], a[244:247], a[12:15], v[212:215]
    ds_read_b64_tr_b16 a[238:239], v216 offset:32000
    v_mfma_f32_16x16x32_bf16 v[212:215], a[240:243], a[4:7], v[212:215]
    ds_read_b64_tr_b16 a[240:241], v217 offset:18688
    s_waitcnt vmcnt(13) lgkmcnt(9)
    v_mfma_f32_16x16x32_bf16 v[0:3], a[248:251], a[16:19], v[0:3]
    ds_read_b64_tr_b16 a[242:243], v217 offset:22784
    v_mfma_f32_16x16x32_bf16 v[0:3], a[252:255], a[24:27], v[0:3]
    ds_read_b64_tr_b16 a[244:245], v217 offset:27904
    v_mfma_f32_16x16x32_bf16 v[164:167], a[252:255], a[28:31], v[164:167]
    ds_read_b64_tr_b16 a[246:247], v217 offset:32000
    v_mfma_f32_16x16x32_bf16 v[164:167], a[248:251], a[20:23], v[164:167]
    ds_read_b64_tr_b16 a[248:249], v216 offset:18944
    s_waitcnt lgkmcnt(9)
    v_mfma_f32_16x16x32_bf16 v[4:7], a[224:227], a[16:19], v[4:7]
    ds_read_b64_tr_b16 a[250:251], v216 offset:23040
    v_mfma_f32_16x16x32_bf16 v[4:7], a[228:231], a[24:27], v[4:7]
    ds_read_b64_tr_b16 a[252:253], v216 offset:28160
    v_mfma_f32_16x16x32_bf16 v[168:171], a[228:231], a[28:31], v[168:171]
    ds_read_b64_tr_b16 a[254:255], v216 offset:32256
    v_mfma_f32_16x16x32_bf16 v[168:171], a[224:227], a[20:23], v[168:171]
    ds_read_b64_tr_b16 a[224:225], v217 offset:18944
    s_waitcnt lgkmcnt(9)
    v_mfma_f32_16x16x32_bf16 v[8:11], a[232:235], a[16:19], v[8:11]
    ds_read_b64_tr_b16 a[226:227], v217 offset:23040
    v_mfma_f32_16x16x32_bf16 v[8:11], a[236:239], a[24:27], v[8:11]
    ds_read_b64_tr_b16 a[228:229], v217 offset:28160
    v_mfma_f32_16x16x32_bf16 v[172:175], a[236:239], a[28:31], v[172:175]
    ds_read_b64_tr_b16 a[230:231], v217 offset:32256
    v_mfma_f32_16x16x32_bf16 v[172:175], a[232:235], a[20:23], v[172:175]
    ds_read_b64_tr_b16 a[232:233], v216 offset:19200
    s_waitcnt lgkmcnt(9)
    v_mfma_f32_16x16x32_bf16 v[12:15], a[240:243], a[16:19], v[12:15]
    ds_read_b64_tr_b16 a[234:235], v216 offset:23296
    v_mfma_f32_16x16x32_bf16 v[12:15], a[244:247], a[24:27], v[12:15]
    ds_read_b64_tr_b16 a[236:237], v216 offset:28416
    v_mfma_f32_16x16x32_bf16 v[176:179], a[244:247], a[28:31], v[176:179]
    ds_read_b64_tr_b16 a[238:239], v216 offset:32512
    v_mfma_f32_16x16x32_bf16 v[176:179], a[240:243], a[20:23], v[176:179]
    ds_read_b64_tr_b16 a[240:241], v217 offset:19200
    s_waitcnt lgkmcnt(9)
    v_mfma_f32_16x16x32_bf16 v[16:19], a[248:251], a[16:19], v[16:19]
    ds_read_b64_tr_b16 a[242:243], v217 offset:23296
    v_mfma_f32_16x16x32_bf16 v[16:19], a[252:255], a[24:27], v[16:19]
    ds_read_b64_tr_b16 a[244:245], v217 offset:28416
    v_mfma_f32_16x16x32_bf16 v[180:183], a[252:255], a[28:31], v[180:183]
    ds_read_b64_tr_b16 a[246:247], v217 offset:32512
    v_mfma_f32_16x16x32_bf16 v[180:183], a[248:251], a[20:23], v[180:183]
sequential_preLN__linear_kernel_hedgehog__glu_gated_reglu__prompt_kernel_hop1_8:
    s_cbranch_execz sequential_preLN__linear_kernel_hedgehog__glu_gated_reglu__prompt_kernel_hop1_9
    ds_read_b128 a[248:251], v220 offset:26624
    s_waitcnt lgkmcnt(9)
    v_mfma_f32_16x16x32_bf16 v[20:23], a[224:227], a[16:19], v[20:23]
    ds_read_b128 a[252:255], v220 offset:35840
    v_mfma_f32_16x16x32_bf16 v[20:23], a[228:231], a[24:27], v[20:23]
    v_mfma_f32_16x16x32_bf16 v[184:187], a[228:231], a[28:31], v[184:187]
    v_mfma_f32_16x16x32_bf16 v[184:187], a[224:227], a[20:23], v[184:187]
    s_waitcnt lgkmcnt(0)
    s_barrier
    v_mfma_f32_16x16x32_bf16 v[24:27], a[232:235], a[16:19], v[24:27]
    v_add_u32 v220, 110592, v220
    v_add_u32 v216, 110592, v216
    v_mfma_f32_16x16x32_bf16 v[24:27], a[236:239], a[24:27], v[24:27]
    v_add_u32 v217, 110592, v217
    ds_read_b64_tr_b16 a[224:225], v216 offset:0
    v_mfma_f32_16x16x32_bf16 v[188:191], a[236:239], a[28:31], v[188:191]
    ds_read_b64_tr_b16 a[226:227], v216 offset:4096
    ds_read_b64_tr_b16 a[228:229], v216 offset:9216
    v_mfma_f32_16x16x32_bf16 v[188:191], a[232:235], a[20:23], v[188:191]
    ds_read_b64_tr_b16 a[230:231], v216 offset:13312
    v_mfma_f32_16x16x32_bf16 v[28:31], a[240:243], a[16:19], v[28:31]
    ds_read_b64_tr_b16 a[232:233], v217 offset:0
    ds_read_b64_tr_b16 a[234:235], v217 offset:4096
    v_mfma_f32_16x16x32_bf16 v[28:31], a[244:247], a[24:27], v[28:31]
    ds_read_b64_tr_b16 a[236:237], v217 offset:9216
    v_mfma_f32_16x16x32_bf16 v[208:211], a[244:247], a[28:31], v[208:211]
    ds_read_b64_tr_b16 a[238:239], v217 offset:13312
    v_mfma_f32_16x16x32_bf16 v[208:211], a[240:243], a[20:23], v[208:211]
    ds_read_b64_tr_b16 a[240:241], v216 offset:256
    v_mfma_f32_16x16x32_bf16 v[160:163], a[248:251], a[16:19], v[160:163]
    ds_read_b64_tr_b16 a[242:243], v216 offset:4352
    v_mfma_f32_16x16x32_bf16 v[160:163], a[252:255], a[24:27], v[160:163]
    ds_read_b64_tr_b16 a[244:245], v216 offset:9472
    v_mfma_f32_16x16x32_bf16 v[212:215], a[252:255], a[28:31], v[212:215]
    ds_read_b64_tr_b16 a[246:247], v216 offset:13568
    v_mfma_f32_16x16x32_bf16 v[212:215], a[248:251], a[20:23], v[212:215]
    ds_read_b64_tr_b16 a[248:249], v217 offset:256
    s_waitcnt vmcnt(9) lgkmcnt(9)
    v_mfma_f32_16x16x32_bf16 v[0:3], a[224:227], a[32:35], v[0:3]
    ds_read_b64_tr_b16 a[250:251], v217 offset:4352
    v_mfma_f32_16x16x32_bf16 v[0:3], a[228:231], a[40:43], v[0:3]
    ds_read_b64_tr_b16 a[252:253], v217 offset:9472
    v_mfma_f32_16x16x32_bf16 v[164:167], a[228:231], a[44:47], v[164:167]
    ds_read_b64_tr_b16 a[254:255], v217 offset:13568
    v_mfma_f32_16x16x32_bf16 v[164:167], a[224:227], a[36:39], v[164:167]
    ds_read_b64_tr_b16 a[224:225], v216 offset:512
    s_waitcnt lgkmcnt(9)
    v_mfma_f32_16x16x32_bf16 v[4:7], a[232:235], a[32:35], v[4:7]
    ds_read_b64_tr_b16 a[226:227], v216 offset:4608
    s_lshl_b32 s96, s51, 3
    v_mfma_f32_16x16x32_bf16 v[4:7], a[236:239], a[40:43], v[4:7]
    ds_read_b64_tr_b16 a[228:229], v216 offset:9728
    s_add_u32 s96, s96, s55
    v_mfma_f32_16x16x32_bf16 v[168:171], a[236:239], a[44:47], v[168:171]
    ds_read_b64_tr_b16 a[230:231], v216 offset:13824
    s_lshl_b32 s96, s96, 4
    v_mfma_f32_16x16x32_bf16 v[168:171], a[232:235], a[36:39], v[168:171]
    ds_read_b64_tr_b16 a[232:233], v217 offset:512
    s_waitcnt lgkmcnt(9)
    v_mfma_f32_16x16x32_bf16 v[8:11], a[240:243], a[32:35], v[8:11]
    ds_read_b64_tr_b16 a[234:235], v217 offset:4608
    s_add_u32 s96, s96, s48
    v_mfma_f32_16x16x32_bf16 v[8:11], a[244:247], a[40:43], v[8:11]
    ds_read_b64_tr_b16 a[236:237], v217 offset:9728
    s_mul_i32 s96, s96, 3072
    v_mfma_f32_16x16x32_bf16 v[172:175], a[244:247], a[44:47], v[172:175]
    ds_read_b64_tr_b16 a[238:239], v217 offset:13824
    s_add_u32 s96, s96, 41943040
    v_mfma_f32_16x16x32_bf16 v[172:175], a[240:243], a[36:39], v[172:175]
    ds_read_b64_tr_b16 a[240:241], v216 offset:768
    s_waitcnt lgkmcnt(9)
    v_mfma_f32_16x16x32_bf16 v[12:15], a[248:251], a[32:35], v[12:15]
    ds_read_b64_tr_b16 a[242:243], v216 offset:4864
    v_lshrrev_b32 v240, 4, v232
    v_mfma_f32_16x16x32_bf16 v[12:15], a[252:255], a[40:43], v[12:15]
    ds_read_b64_tr_b16 a[244:245], v216 offset:9984
    v_and_b32 v241, 15, v240
    v_mfma_f32_16x16x32_bf16 v[176:179], a[252:255], a[44:47], v[176:179]
    ds_read_b64_tr_b16 a[246:247], v216 offset:14080
    v_mul_u32_u24 v241, 1152, v241
    v_mfma_f32_16x16x32_bf16 v[176:179], a[248:251], a[36:39], v[176:179]
    ds_read_b64_tr_b16 a[248:249], v217 offset:768
    s_waitcnt lgkmcnt(9)
    v_mfma_f32_16x16x32_bf16 v[16:19], a[224:227], a[32:35], v[16:19]
    ds_read_b64_tr_b16 a[250:251], v217 offset:4864
    v_mul_u32_u24 v246, 12, v240
    v_mfma_f32_16x16x32_bf16 v[16:19], a[228:231], a[40:43], v[16:19]
    ds_read_b64_tr_b16 a[252:253], v217 offset:9984
    v_lshlrev_b32 v247, 2, v240
    v_mfma_f32_16x16x32_bf16 v[180:183], a[228:231], a[44:47], v[180:183]
    ds_read_b64_tr_b16 a[254:255], v217 offset:14080
    v_lshrrev_b32 v240, 4, v240
    v_mfma_f32_16x16x32_bf16 v[180:183], a[224:227], a[36:39], v[180:183]
    ds_read_b128 a[224:227], v220 offset:8192
    s_waitcnt lgkmcnt(9)
    v_mfma_f32_16x16x32_bf16 v[20:23], a[232:235], a[32:35], v[20:23]
    ds_read_b128 a[228:231], v220 offset:17408
    v_lshl_add_u32 v240, v240, 3, v241
    v_mfma_f32_16x16x32_bf16 v[20:23], a[236:239], a[40:43], v[20:23]
    s_mul_i32 s98, s85, 18432
    s_and_b32 s99, s57, 3
    v_mfma_f32_16x16x32_bf16 v[184:187], a[236:239], a[44:47], v[184:187]
    s_lshl_b32 s99, s99, 5
    s_add_u32 s76, s98, s99
    v_mfma_f32_16x16x32_bf16 v[184:187], a[232:235], a[36:39], v[184:187]
    ds_read_b64_tr_b16 a[232:233], v216 offset:18432
    s_waitcnt lgkmcnt(7)
    v_mfma_f32_16x16x32_bf16 v[24:27], a[240:243], a[32:35], v[24:27]
    ds_read_b64_tr_b16 a[234:235], v216 offset:22528
    s_lshl_b32 s99, s99, 3
    v_mfma_f32_16x16x32_bf16 v[24:27], a[244:247], a[40:43], v[24:27]
    ds_read_b64_tr_b16 a[236:237], v216 offset:27648
    s_add_u32 s98, s98, s99
    v_mfma_f32_16x16x32_bf16 v[188:191], a[244:247], a[44:47], v[188:191]
    ds_read_b64_tr_b16 a[238:239], v216 offset:31744
    s_mul_i32 s99, s48, 2304
    v_mfma_f32_16x16x32_bf16 v[188:191], a[240:243], a[36:39], v[188:191]
    ds_read_b64_tr_b16 a[240:241], v217 offset:18432
    s_waitcnt lgkmcnt(7)
    v_mfma_f32_16x16x32_bf16 v[28:31], a[248:251], a[32:35], v[28:31]
    ds_read_b64_tr_b16 a[242:243], v217 offset:22528
    v_lshrrev_b32 v226, 4, v232
    v_mfma_f32_16x16x32_bf16 v[28:31], a[252:255], a[40:43], v[28:31]
    ds_read_b64_tr_b16 a[244:245], v217 offset:27648
    v_and_b32 v223, 15, v226
    v_mfma_f32_16x16x32_bf16 v[208:211], a[252:255], a[44:47], v[208:211]
    ds_read_b64_tr_b16 a[246:247], v217 offset:31744
    v_mul_u32_u24 v223, 144, v223
    v_mfma_f32_16x16x32_bf16 v[208:211], a[248:251], a[36:39], v[208:211]
    ds_read_b64_tr_b16 a[248:249], v216 offset:18688
    s_waitcnt lgkmcnt(9)
    v_mfma_f32_16x16x32_bf16 v[160:163], a[224:227], a[32:35], v[160:163]
    ds_read_b64_tr_b16 a[250:251], v216 offset:22784
    v_lshrrev_b32 v224, 4, v226
    v_mfma_f32_16x16x32_bf16 v[160:163], a[228:231], a[40:43], v[160:163]
    ds_read_b64_tr_b16 a[252:253], v216 offset:27904
    v_lshl_add_u32 v223, v224, 3, v223
    v_mfma_f32_16x16x32_bf16 v[212:215], a[228:231], a[44:47], v[212:215]
    ds_read_b64_tr_b16 a[254:255], v216 offset:32000
    v_add_u32 v223, s99, v223
    v_mfma_f32_16x16x32_bf16 v[212:215], a[224:227], a[36:39], v[212:215]
    ds_read_b64_tr_b16 a[224:225], v217 offset:18688
    s_waitcnt vmcnt(5) lgkmcnt(9)
    v_mfma_f32_16x16x32_bf16 v[0:3], a[232:235], a[48:51], v[0:3]
    ds_read_b64_tr_b16 a[226:227], v217 offset:22784
    v_lshrrev_b32 v226, 3, v226
    v_mfma_f32_16x16x32_bf16 v[0:3], a[236:239], a[56:59], v[0:3]
    ds_read_b64_tr_b16 a[228:229], v217 offset:27904
    v_and_b32 v225, 0x70, v232
    v_mfma_f32_16x16x32_bf16 v[164:167], a[236:239], a[60:63], v[164:167]
    ds_read_b64_tr_b16 a[230:231], v217 offset:32000
    v_mul_u32_u24 v224, 144, v226
    v_mfma_f32_16x16x32_bf16 v[164:167], a[232:235], a[52:55], v[164:167]
    ds_read_b64_tr_b16 a[232:233], v216 offset:18944
    s_waitcnt lgkmcnt(9)
    v_mfma_f32_16x16x32_bf16 v[4:7], a[240:243], a[48:51], v[4:7]
    ds_read_b64_tr_b16 a[234:235], v216 offset:23040
    v_add3_u32 v224, v224, v225, s99
    v_mfma_f32_16x16x32_bf16 v[4:7], a[244:247], a[56:59], v[4:7]
    ds_read_b64_tr_b16 a[236:237], v216 offset:28160
    v_mul_u32_u24 v226, 1152, v226
    v_mfma_f32_16x16x32_bf16 v[168:171], a[244:247], a[60:63], v[168:171]
    ds_read_b64_tr_b16 a[238:239], v216 offset:32256
    v_add_u32 v225, v225, v226
    v_mfma_f32_16x16x32_bf16 v[168:171], a[240:243], a[52:55], v[168:171]
    ds_read_b64_tr_b16 a[240:241], v217 offset:18944
    s_waitcnt lgkmcnt(9)
    v_mfma_f32_16x16x32_bf16 v[8:11], a[248:251], a[48:51], v[8:11]
    ds_read_b64_tr_b16 a[242:243], v217 offset:23040
    s_and_b32 s99, s54, 1
    v_mfma_f32_16x16x32_bf16 v[8:11], a[252:255], a[56:59], v[8:11]
    ds_read_b64_tr_b16 a[244:245], v217 offset:28160
    s_lshl_b32 s99, s99, 7
    v_mfma_f32_16x16x32_bf16 v[172:175], a[252:255], a[60:63], v[172:175]
    ds_read_b64_tr_b16 a[246:247], v217 offset:32256
    s_add_u32 s98, s98, s99
    v_mfma_f32_16x16x32_bf16 v[172:175], a[248:251], a[52:55], v[172:175]
    ds_read_b64_tr_b16 a[248:249], v216 offset:19200
    s_waitcnt lgkmcnt(9)
    v_mfma_f32_16x16x32_bf16 v[12:15], a[224:227], a[48:51], v[12:15]
    ds_read_b64_tr_b16 a[250:251], v216 offset:23296
    s_add_u32 s99, s98, 9216
    v_mfma_f32_16x16x32_bf16 v[12:15], a[228:231], a[56:59], v[12:15]
    ds_read_b64_tr_b16 a[252:253], v216 offset:28416
    v_mfma_f32_16x16x32_bf16 v[176:179], a[228:231], a[60:63], v[176:179]
    ds_read_b64_tr_b16 a[254:255], v216 offset:32512
    v_mfma_f32_16x16x32_bf16 v[176:179], a[224:227], a[52:55], v[176:179]
    ds_read_b64_tr_b16 a[224:225], v217 offset:19200
    s_waitcnt lgkmcnt(9)
    v_mfma_f32_16x16x32_bf16 v[16:19], a[232:235], a[48:51], v[16:19]
    ds_read_b64_tr_b16 a[226:227], v217 offset:23296
    v_mfma_f32_16x16x32_bf16 v[16:19], a[236:239], a[56:59], v[16:19]
    ds_read_b64_tr_b16 a[228:229], v217 offset:28416
    v_mfma_f32_16x16x32_bf16 v[180:183], a[236:239], a[60:63], v[180:183]
    ds_read_b64_tr_b16 a[230:231], v217 offset:32512
    v_mfma_f32_16x16x32_bf16 v[180:183], a[232:235], a[52:55], v[180:183]
    ds_read_b128 a[232:235], v220 offset:26624
    s_waitcnt lgkmcnt(9)
    v_mfma_f32_16x16x32_bf16 v[20:23], a[240:243], a[48:51], v[20:23]
    ds_read_b128 a[236:239], v220 offset:35840
    v_mfma_f32_16x16x32_bf16 v[20:23], a[244:247], a[56:59], v[20:23]
    v_mfma_f32_16x16x32_bf16 v[184:187], a[244:247], a[60:63], v[184:187]
    v_mfma_f32_16x16x32_bf16 v[184:187], a[240:243], a[52:55], v[184:187]
    s_waitcnt lgkmcnt(6)
    v_mfma_f32_16x16x32_bf16 v[24:27], a[248:251], a[48:51], v[24:27]
    v_mfma_f32_16x16x32_bf16 v[24:27], a[252:255], a[56:59], v[24:27]
    v_mfma_f32_16x16x32_bf16 v[188:191], a[252:255], a[60:63], v[188:191]
    v_mfma_f32_16x16x32_bf16 v[188:191], a[248:251], a[52:55], v[188:191]
    s_waitcnt lgkmcnt(2)
    v_mfma_f32_16x16x32_bf16 v[28:31], a[224:227], a[48:51], v[28:31]
    v_mfma_f32_16x16x32_bf16 v[28:31], a[228:231], a[56:59], v[28:31]
    v_mfma_f32_16x16x32_bf16 v[208:211], a[228:231], a[60:63], v[208:211]
    v_mfma_f32_16x16x32_bf16 v[208:211], a[224:227], a[52:55], v[208:211]
    s_waitcnt lgkmcnt(0)
    v_mfma_f32_16x16x32_bf16 v[160:163], a[232:235], a[48:51], v[160:163]
    v_mfma_f32_16x16x32_bf16 v[160:163], a[236:239], a[56:59], v[160:163]
    v_mfma_f32_16x16x32_bf16 v[212:215], a[236:239], a[60:63], v[212:215]
    v_mfma_f32_16x16x32_bf16 v[212:215], a[232:235], a[52:55], v[212:215]
    s_waitcnt vmcnt(0)
    s_cmp_eq_u32 s54, 1
    s_cbranch_scc1 sequential_preLN__linear_kernel_hedgehog__glu_gated_reglu__prompt_kernel_fin_26
    s_cmp_eq_u32 s54, 2
    s_cbranch_scc1 sequential_preLN__linear_kernel_hedgehog__glu_gated_reglu__prompt_kernel_fin_27
    s_cmp_eq_u32 s54, 3
    s_cbranch_scc1 sequential_preLN__linear_kernel_hedgehog__glu_gated_reglu__prompt_kernel_fin_28
sequential_preLN__linear_kernel_hedgehog__glu_gated_reglu__prompt_kernel_fin_25:
    v_cvt_pk_bf16_f32 v96, v16, v17
    v_cvt_pk_bf16_f32 v97, v18, v19
    v_cvt_pk_bf16_f32 v98, v20, v21
    v_cvt_pk_bf16_f32 v99, v22, v23
    v_cvt_pk_bf16_f32 v100, v24, v25
    v_cvt_pk_bf16_f32 v101, v26, v27
    v_cvt_pk_bf16_f32 v102, v28, v29
    v_cvt_pk_bf16_f32 v103, v30, v31
    s_add_u32 s97, s96, 98304
    v_add3_u32 v104, v96, v97, s3
    v_add3_u32 v104, v98, v99, v104
    v_add3_u32 v104, v100, v101, v104
    v_add3_u32 v104, v102, v103, v104
    buffer_store_dwordx4 v[96:99], v232, s[36:39], s97 offen sc1
    buffer_store_dwordx4 v[100:103], v232, s[36:39], s97 offen offset:1024 sc1
    buffer_store_dword v104, v247, s[36:39], s97 offen offset:2048 sc1
    v_cvt_pk_bf16_f32 v108, v164, v165
    v_cvt_pk_bf16_f32 v109, v166, v167
    v_cvt_pk_bf16_f32 v110, v168, v169
    v_cvt_pk_bf16_f32 v111, v170, v171
    v_cvt_pk_bf16_f32 v112, v172, v173
    v_cvt_pk_bf16_f32 v113, v174, v175
    v_cvt_pk_bf16_f32 v114, v176, v177
    v_cvt_pk_bf16_f32 v115, v178, v179
    v_cvt_pk_bf16_f32 v116, v212, v213
    v_cvt_pk_bf16_f32 v117, v214, v215
    s_add_u32 s97, s96, 196608
    v_add3_u32 v118, v108, v109, s3
    v_add3_u32 v118, v110, v111, v118
    v_add3_u32 v118, v112, v113, v118
    v_add3_u32 v118, v114, v115, v118
    v_add3_u32 v118, v116, v117, v118
    buffer_store_dwordx4 v[108:111], v232, s[36:39], s97 offen sc1
    buffer_store_dwordx4 v[112:115], v232, s[36:39], s97 offen offset:1024 sc1
    buffer_store_dwordx3 v[116:118], v246, s[36:39], s97 offen offset:2048 sc1
    v_cvt_pk_bf16_f32 v120, v180, v181
    v_cvt_pk_bf16_f32 v121, v182, v183
    v_cvt_pk_bf16_f32 v122, v184, v185
    v_cvt_pk_bf16_f32 v123, v186, v187
    v_cvt_pk_bf16_f32 v124, v188, v189
    v_cvt_pk_bf16_f32 v125, v190, v191
    v_cvt_pk_bf16_f32 v126, v208, v209
    v_cvt_pk_bf16_f32 v127, v210, v211
    s_add_u32 s97, s96, 294912
    v_add3_u32 v128, v120, v121, s3
    v_add3_u32 v128, v122, v123, v128
    v_add3_u32 v128, v124, v125, v128
    v_add3_u32 v128, v126, v127, v128
    buffer_store_dwordx4 v[120:123], v232, s[36:39], s97 offen sc1
    buffer_store_dwordx4 v[124:127], v232, s[36:39], s97 offen offset:1024 sc1
    buffer_store_dword v128, v247, s[36:39], s97 offen offset:2048 sc1
    v_mov_b32 v245, 6
    s_mov_b64 exec, 1
    buffer_store_dword v245, off, s[36:39], s52 sc1
    s_mov_b64 exec, -1
    v_lshlrev_b32 v242, 16, v32
    v_and_b32 v243, 0xffff0000, v32
    v_pk_add_f32 v[0:1], v[0:1], v[242:243]
    v_lshlrev_b32 v242, 16, v33
    v_and_b32 v243, 0xffff0000, v33
    v_pk_add_f32 v[2:3], v[2:3], v[242:243]
    v_lshlrev_b32 v242, 16, v34
    v_and_b32 v243, 0xffff0000, v34
    v_pk_add_f32 v[4:5], v[4:5], v[242:243]
    v_lshlrev_b32 v242, 16, v35
    v_and_b32 v243, 0xffff0000, v35
    v_pk_add_f32 v[6:7], v[6:7], v[242:243]
    v_lshlrev_b32 v242, 16, v36
    v_and_b32 v243, 0xffff0000, v36
    v_pk_add_f32 v[8:9], v[8:9], v[242:243]
    v_lshlrev_b32 v242, 16, v37
    v_and_b32 v243, 0xffff0000, v37
    v_pk_add_f32 v[10:11], v[10:11], v[242:243]
    v_lshlrev_b32 v242, 16, v38
    v_and_b32 v243, 0xffff0000, v38
    v_pk_add_f32 v[12:13], v[12:13], v[242:243]
    v_lshlrev_b32 v242, 16, v39
    v_and_b32 v243, 0xffff0000, v39
    v_pk_add_f32 v[14:15], v[14:15], v[242:243]
    v_lshlrev_b32 v242, 16, v42
    v_and_b32 v243, 0xffff0000, v42
    v_pk_add_f32 v[160:161], v[160:161], v[242:243]
    v_lshlrev_b32 v242, 16, v43
    v_and_b32 v243, 0xffff0000, v43
    v_pk_add_f32 v[162:163], v[162:163], v[242:243]
    buffer_load_dword v239, v238, s[36:39], 0 offen sc1
    s_waitcnt vmcnt(0)
    v_cmp_gt_u32 vcc, 6, v239
    s_mov_b32 s53, 0
    s_cbranch_vccz sequential_preLN__linear_kernel_hedgehog__glu_gated_reglu__prompt_kernel_spin_30_b
sequential_preLN__linear_kernel_hedgehog__glu_gated_reglu__prompt_kernel_spin_30:
    buffer_load_dword v239, v238, s[36:39], 0 offen sc1
    s_add_u32 s53, s53, 1
    s_waitcnt vmcnt(0)
    v_cmp_gt_u32 vcc, 6, v239
    s_cmp_gt_u32 s53, 50000
    s_cbranch_scc1 sequential_preLN__linear_kernel_hedgehog__glu_gated_reglu__prompt_kernel_spin_30_b
    s_cbranch_vccnz sequential_preLN__linear_kernel_hedgehog__glu_gated_reglu__prompt_kernel_spin_30
sequential_preLN__linear_kernel_hedgehog__glu_gated_reglu__prompt_kernel_spin_30_b:
    s_mov_b32 s53, 0
sequential_preLN__linear_kernel_hedgehog__glu_gated_reglu__prompt_kernel_s5_31:
    s_add_u32 s97, s96, 12288
    buffer_load_dwordx4 v[136:139], v232, s[36:39], s97 offen sc1
    buffer_load_dwordx4 v[140:143], v232, s[36:39], s97 offen offset:1024 sc1
    buffer_load_dwordx3 v[144:146], v246, s[36:39], s97 offen offset:2048 sc1
    s_add_u32 s97, s96, 24576
    buffer_load_dwordx4 v[148:151], v232, s[36:39], s97 offen sc1
    buffer_load_dwordx4 v[152:155], v232, s[36:39], s97 offen offset:1024 sc1
    buffer_load_dwordx3 v[156:158], v246, s[36:39], s97 offen offset:2048 sc1
    s_add_u32 s97, s96, 36864
    buffer_load_dwordx4 v[44:47], v232, s[36:39], s97 offen sc1
    buffer_load_dwordx4 v[48:51], v232, s[36:39], s97 offen offset:1024 sc1
    buffer_load_dwordx3 v[52:54], v246, s[36:39], s97 offen offset:2048 sc1
    s_add_u32 s53, s53, 1
    s_waitcnt vmcnt(8)
    v_add3_u32 v248, v136, v137, s3
    v_add3_u32 v248, v138, v139, v248
    s_waitcnt vmcnt(7)
    v_add3_u32 v248, v140, v141, v248
    v_add3_u32 v248, v142, v143, v248
    s_waitcnt vmcnt(6)
    v_add3_u32 v248, v144, v145, v248
    v_xor_b32 v248, v248, v146
    s_waitcnt vmcnt(5)
    v_add3_u32 v249, v148, v149, s3
    v_add3_u32 v249, v150, v151, v249
    s_waitcnt vmcnt(4)
    v_add3_u32 v249, v152, v153, v249
    v_add3_u32 v249, v154, v155, v249
    s_waitcnt vmcnt(3)
    v_add3_u32 v249, v156, v157, v249
    v_xor_b32 v249, v249, v158
    s_waitcnt vmcnt(2)
    v_add3_u32 v250, v44, v45, s3
    v_add3_u32 v250, v46, v47, v250
    s_waitcnt vmcnt(1)
    v_add3_u32 v250, v48, v49, v250
    v_add3_u32 v250, v50, v51, v250
    s_waitcnt vmcnt(0)
    v_add3_u32 v250, v52, v53, v250
    v_xor_b32 v250, v250, v54
    v_or3_b32 v248, v248, v249, v250
    v_cmp_ne_u32 vcc, 0, v248
    s_cmp_gt_u32 s53, 50000
    s_cbranch_scc1 sequential_preLN__linear_kernel_hedgehog__glu_gated_reglu__prompt_kernel_s5ok_32
    s_cbranch_vccnz sequential_preLN__linear_kernel_hedgehog__glu_gated_reglu__prompt_kernel_s5_31
sequential_preLN__linear_kernel_hedgehog__glu_gated_reglu__prompt_kernel_s5ok_32:
    v_lshlrev_b32 v242, 16, v136
    v_and_b32 v243, 0xffff0000, v136
    v_pk_add_f32 v[0:1], v[0:1], v[242:243]
    v_lshlrev_b32 v242, 16, v137
    v_and_b32 v243, 0xffff0000, v137
    v_pk_add_f32 v[2:3], v[2:3], v[242:243]
    v_lshlrev_b32 v242, 16, v138
    v_and_b32 v243, 0xffff0000, v138
    v_pk_add_f32 v[4:5], v[4:5], v[242:243]
    v_lshlrev_b32 v242, 16, v139
    v_and_b32 v243, 0xffff0000, v139
    v_pk_add_f32 v[6:7], v[6:7], v[242:243]
    v_lshlrev_b32 v242, 16, v140
    v_and_b32 v243, 0xffff0000, v140
    v_pk_add_f32 v[8:9], v[8:9], v[242:243]
    v_lshlrev_b32 v242, 16, v141
    v_and_b32 v243, 0xffff0000, v141
    v_pk_add_f32 v[10:11], v[10:11], v[242:243]
    v_lshlrev_b32 v242, 16, v142
    v_and_b32 v243, 0xffff0000, v142
    v_pk_add_f32 v[12:13], v[12:13], v[242:243]
    v_lshlrev_b32 v242, 16, v143
    v_and_b32 v243, 0xffff0000, v143
    v_pk_add_f32 v[14:15], v[14:15], v[242:243]
    v_lshlrev_b32 v242, 16, v144
    v_and_b32 v243, 0xffff0000, v144
    v_pk_add_f32 v[160:161], v[160:161], v[242:243]
    v_lshlrev_b32 v242, 16, v145
    v_and_b32 v243, 0xffff0000, v145
    v_pk_add_f32 v[162:163], v[162:163], v[242:243]
    v_lshlrev_b32 v242, 16, v148
    v_and_b32 v243, 0xffff0000, v148
    v_pk_add_f32 v[0:1], v[0:1], v[242:243]
    v_lshlrev_b32 v242, 16, v149
    v_and_b32 v243, 0xffff0000, v149
    v_pk_add_f32 v[2:3], v[2:3], v[242:243]
    v_lshlrev_b32 v242, 16, v150
    v_and_b32 v243, 0xffff0000, v150
    v_pk_add_f32 v[4:5], v[4:5], v[242:243]
    v_lshlrev_b32 v242, 16, v151
    v_and_b32 v243, 0xffff0000, v151
    v_pk_add_f32 v[6:7], v[6:7], v[242:243]
    v_lshlrev_b32 v242, 16, v152
    v_and_b32 v243, 0xffff0000, v152
    v_pk_add_f32 v[8:9], v[8:9], v[242:243]
    v_lshlrev_b32 v242, 16, v153
    v_and_b32 v243, 0xffff0000, v153
    v_pk_add_f32 v[10:11], v[10:11], v[242:243]
    v_lshlrev_b32 v242, 16, v154
    v_and_b32 v243, 0xffff0000, v154
    v_pk_add_f32 v[12:13], v[12:13], v[242:243]
    v_lshlrev_b32 v242, 16, v155
    v_and_b32 v243, 0xffff0000, v155
    v_pk_add_f32 v[14:15], v[14:15], v[242:243]
    v_lshlrev_b32 v242, 16, v156
    v_and_b32 v243, 0xffff0000, v156
    v_pk_add_f32 v[160:161], v[160:161], v[242:243]
    v_lshlrev_b32 v242, 16, v157
    v_and_b32 v243, 0xffff0000, v157
    v_pk_add_f32 v[162:163], v[162:163], v[242:243]
    v_lshlrev_b32 v242, 16, v44
    v_and_b32 v243, 0xffff0000, v44
    v_pk_add_f32 v[0:1], v[0:1], v[242:243]
    v_lshlrev_b32 v242, 16, v45
    v_and_b32 v243, 0xffff0000, v45
    v_pk_add_f32 v[2:3], v[2:3], v[242:243]
    v_cvt_pk_bf16_f32 v0, v0, v1
    v_cvt_pk_bf16_f32 v1, v2, v3
    ds_write_b64 v223, v[0:1] offset:0
    v_lshlrev_b32 v242, 16, v46
    v_and_b32 v243, 0xffff0000, v46
    v_pk_add_f32 v[4:5], v[4:5], v[242:243]
    v_lshlrev_b32 v242, 16, v47
    v_and_b32 v243, 0xffff0000, v47
    v_pk_add_f32 v[6:7], v[6:7], v[242:243]
    v_cvt_pk_bf16_f32 v4, v4, v5
    v_cvt_pk_bf16_f32 v5, v6, v7
    ds_write_b64 v223, v[4:5] offset:32
    v_lshlrev_b32 v242, 16, v48
    v_and_b32 v243, 0xffff0000, v48
    v_pk_add_f32 v[8:9], v[8:9], v[242:243]
    v_lshlrev_b32 v242, 16, v49
    v_and_b32 v243, 0xffff0000, v49
    v_pk_add_f32 v[10:11], v[10:11], v[242:243]
    v_cvt_pk_bf16_f32 v8, v8, v9
    v_cvt_pk_bf16_f32 v9, v10, v11
    ds_write_b64 v223, v[8:9] offset:64
    v_lshlrev_b32 v242, 16, v50
    v_and_b32 v243, 0xffff0000, v50
    v_pk_add_f32 v[12:13], v[12:13], v[242:243]
    v_lshlrev_b32 v242, 16, v51
    v_and_b32 v243, 0xffff0000, v51
    v_pk_add_f32 v[14:15], v[14:15], v[242:243]
    v_cvt_pk_bf16_f32 v12, v12, v13
    v_cvt_pk_bf16_f32 v13, v14, v15
    ds_write_b64 v223, v[12:13] offset:96
    ds_read_b128 v[96:99], v224 offset:0
    ds_read_b128 v[100:103], v224 offset:1152
    v_lshlrev_b32 v242, 16, v52
    v_and_b32 v243, 0xffff0000, v52
    v_pk_add_f32 v[160:161], v[160:161], v[242:243]
    v_lshlrev_b32 v242, 16, v53
    v_and_b32 v243, 0xffff0000, v53
    v_pk_add_f32 v[162:163], v[162:163], v[242:243]
    v_cvt_pk_bf16_f32 v160, v160, v161
    v_cvt_pk_bf16_f32 v161, v162, v163
    buffer_store_dwordx2 v[160:161], v240, s[32:35], s76 offen offset:1024
    s_waitcnt lgkmcnt(1)
    buffer_store_dwordx4 v[96:99], v225, s[32:35], s98 offen
    s_waitcnt lgkmcnt(0)
    buffer_store_dwordx4 v[100:103], v225, s[32:35], s99 offen
    s_branch sequential_preLN__linear_kernel_hedgehog__glu_gated_reglu__prompt_kernel_findone_29
sequential_preLN__linear_kernel_hedgehog__glu_gated_reglu__prompt_kernel_fin_26:
sequential_preLN__linear_kernel_hedgehog__glu_gated_reglu__prompt_kernel_hop1_9:
    s_cbranch_execz sequential_preLN__linear_kernel_hedgehog__glu_gated_reglu__prompt_kernel_hop1_10
    s_nop 4
    v_cvt_pk_bf16_f32 v96, v0, v1
    v_cvt_pk_bf16_f32 v97, v2, v3
    v_cvt_pk_bf16_f32 v98, v4, v5
    v_cvt_pk_bf16_f32 v99, v6, v7
    v_cvt_pk_bf16_f32 v100, v8, v9
    v_cvt_pk_bf16_f32 v101, v10, v11
    v_cvt_pk_bf16_f32 v102, v12, v13
    v_cvt_pk_bf16_f32 v103, v14, v15
    v_cvt_pk_bf16_f32 v104, v160, v161
    v_cvt_pk_bf16_f32 v105, v162, v163
    s_add_u32 s97, s96, 12288
    v_add3_u32 v106, v96, v97, s3
    v_add3_u32 v106, v98, v99, v106
    v_add3_u32 v106, v100, v101, v106
    v_add3_u32 v106, v102, v103, v106
    v_add3_u32 v106, v104, v105, v106
    buffer_store_dwordx4 v[96:99], v232, s[36:39], s97 offen sc1
    buffer_store_dwordx4 v[100:103], v232, s[36:39], s97 offen offset:1024 sc1
    buffer_store_dwordx3 v[104:106], v246, s[36:39], s97 offen offset:2048 sc1
    v_cvt_pk_bf16_f32 v108, v164, v165
    v_cvt_pk_bf16_f32 v109, v166, v167
    v_cvt_pk_bf16_f32 v110, v168, v169
    v_cvt_pk_bf16_f32 v111, v170, v171
    v_cvt_pk_bf16_f32 v112, v172, v173
    v_cvt_pk_bf16_f32 v113, v174, v175
    v_cvt_pk_bf16_f32 v114, v176, v177
    v_cvt_pk_bf16_f32 v115, v178, v179
    v_cvt_pk_bf16_f32 v116, v212, v213
    v_cvt_pk_bf16_f32 v117, v214, v215
    s_add_u32 s97, s96, 208896
    v_add3_u32 v118, v108, v109, s3
    v_add3_u32 v118, v110, v111, v118
    v_add3_u32 v118, v112, v113, v118
    v_add3_u32 v118, v114, v115, v118
    v_add3_u32 v118, v116, v117, v118
    buffer_store_dwordx4 v[108:111], v232, s[36:39], s97 offen sc1
    buffer_store_dwordx4 v[112:115], v232, s[36:39], s97 offen offset:1024 sc1
    buffer_store_dwordx3 v[116:118], v246, s[36:39], s97 offen offset:2048 sc1
    v_cvt_pk_bf16_f32 v120, v180, v181
    v_cvt_pk_bf16_f32 v121, v182, v183
    v_cvt_pk_bf16_f32 v122, v184, v185
    v_cvt_pk_bf16_f32 v123, v186, v187
    v_cvt_pk_bf16_f32 v124, v188, v189
    v_cvt_pk_bf16_f32 v125, v190, v191
    v_cvt_pk_bf16_f32 v126, v208, v209
    v_cvt_pk_bf16_f32 v127, v210, v211
    s_add_u32 s97, s96, 307200
    v_add3_u32 v128, v120, v121, s3
    v_add3_u32 v128, v122, v123, v128
    v_add3_u32 v128, v124, v125, v128
    v_add3_u32 v128, v126, v127, v128
    buffer_store_dwordx4 v[120:123], v232, s[36:39], s97 offen sc1
    buffer_store_dwordx4 v[124:127], v232, s[36:39], s97 offen offset:1024 sc1
    buffer_store_dword v128, v247, s[36:39], s97 offen offset:2048 sc1
    v_mov_b32 v245, 6
    s_mov_b64 exec, 1
    buffer_store_dword v245, off, s[36:39], s52 sc1
    s_mov_b64 exec, -1
    v_lshlrev_b32 v242, 16, v32
    v_and_b32 v243, 0xffff0000, v32
    v_pk_add_f32 v[16:17], v[16:17], v[242:243]
    v_lshlrev_b32 v242, 16, v33
    v_and_b32 v243, 0xffff0000, v33
    v_pk_add_f32 v[18:19], v[18:19], v[242:243]
    v_lshlrev_b32 v242, 16, v34
    v_and_b32 v243, 0xffff0000, v34
    v_pk_add_f32 v[20:21], v[20:21], v[242:243]
    v_lshlrev_b32 v242, 16, v35
    v_and_b32 v243, 0xffff0000, v35
    v_pk_add_f32 v[22:23], v[22:23], v[242:243]
    v_lshlrev_b32 v242, 16, v36
    v_and_b32 v243, 0xffff0000, v36
    v_pk_add_f32 v[24:25], v[24:25], v[242:243]
    v_lshlrev_b32 v242, 16, v37
    v_and_b32 v243, 0xffff0000, v37
    v_pk_add_f32 v[26:27], v[26:27], v[242:243]
    v_lshlrev_b32 v242, 16, v38
    v_and_b32 v243, 0xffff0000, v38
    v_pk_add_f32 v[28:29], v[28:29], v[242:243]
    v_lshlrev_b32 v242, 16, v39
    v_and_b32 v243, 0xffff0000, v39
    v_pk_add_f32 v[30:31], v[30:31], v[242:243]
    buffer_load_dword v239, v238, s[36:39], 0 offen sc1
    s_waitcnt vmcnt(0)
    v_cmp_gt_u32 vcc, 6, v239
    s_mov_b32 s53, 0
    s_cbranch_vccz sequential_preLN__linear_kernel_hedgehog__glu_gated_reglu__prompt_kernel_spin_33_b
sequential_preLN__linear_kernel_hedgehog__glu_gated_reglu__prompt_kernel_spin_33:
    buffer_load_dword v239, v238, s[36:39], 0 offen sc1
    s_add_u32 s53, s53, 1
    s_waitcnt vmcnt(0)
    v_cmp_gt_u32 vcc, 6, v239
    s_cmp_gt_u32 s53, 50000
    s_cbranch_scc1 sequential_preLN__linear_kernel_hedgehog__glu_gated_reglu__prompt_kernel_spin_33_b
    s_cbranch_vccnz sequential_preLN__linear_kernel_hedgehog__glu_gated_reglu__prompt_kernel_spin_33
sequential_preLN__linear_kernel_hedgehog__glu_gated_reglu__prompt_kernel_spin_33_b:
    s_mov_b32 s53, 0
sequential_preLN__linear_kernel_hedgehog__glu_gated_reglu__prompt_kernel_s5_34:
    s_add_u32 s97, s96, 98304
    buffer_load_dwordx4 v[136:139], v232, s[36:39], s97 offen sc1
    buffer_load_dwordx4 v[140:143], v232, s[36:39], s97 offen offset:1024 sc1
    buffer_load_dword v144, v247, s[36:39], s97 offen offset:2048 sc1
    s_add_u32 s97, s96, 122880
    buffer_load_dwordx4 v[148:151], v232, s[36:39], s97 offen sc1
    buffer_load_dwordx4 v[152:155], v232, s[36:39], s97 offen offset:1024 sc1
    buffer_load_dword v156, v247, s[36:39], s97 offen offset:2048 sc1
sequential_preLN__linear_kernel_hedgehog__glu_gated_reglu__prompt_kernel_hop1_10:
    s_cbranch_execz sequential_preLN__linear_kernel_hedgehog__glu_gated_reglu__prompt_kernel_hop1_11
    s_add_u32 s97, s96, 135168
    buffer_load_dwordx4 v[44:47], v232, s[36:39], s97 offen sc1
    buffer_load_dwordx4 v[48:51], v232, s[36:39], s97 offen offset:1024 sc1
    buffer_load_dword v52, v247, s[36:39], s97 offen offset:2048 sc1
    s_add_u32 s53, s53, 1
    s_waitcnt vmcnt(8)
    v_add3_u32 v248, v136, v137, s3
    v_add3_u32 v248, v138, v139, v248
    s_waitcnt vmcnt(7)
    v_add3_u32 v248, v140, v141, v248
    v_add3_u32 v248, v142, v143, v248
    s_waitcnt vmcnt(6)
    v_xor_b32 v248, v248, v144
    s_waitcnt vmcnt(5)
    v_add3_u32 v249, v148, v149, s3
    v_add3_u32 v249, v150, v151, v249
    s_waitcnt vmcnt(4)
    v_add3_u32 v249, v152, v153, v249
    v_add3_u32 v249, v154, v155, v249
    s_waitcnt vmcnt(3)
    v_xor_b32 v249, v249, v156
    s_waitcnt vmcnt(2)
    v_add3_u32 v250, v44, v45, s3
    v_add3_u32 v250, v46, v47, v250
    s_waitcnt vmcnt(1)
    v_add3_u32 v250, v48, v49, v250
    v_add3_u32 v250, v50, v51, v250
    s_waitcnt vmcnt(0)
    v_xor_b32 v250, v250, v52
    v_or3_b32 v248, v248, v249, v250
    v_cmp_ne_u32 vcc, 0, v248
    s_cmp_gt_u32 s53, 50000
    s_cbranch_scc1 sequential_preLN__linear_kernel_hedgehog__glu_gated_reglu__prompt_kernel_s5ok_35
    s_cbranch_vccnz sequential_preLN__linear_kernel_hedgehog__glu_gated_reglu__prompt_kernel_s5_34
sequential_preLN__linear_kernel_hedgehog__glu_gated_reglu__prompt_kernel_s5ok_35:
    v_lshlrev_b32 v242, 16, v136
    v_and_b32 v243, 0xffff0000, v136
    v_pk_add_f32 v[16:17], v[16:17], v[242:243]
    v_lshlrev_b32 v242, 16, v137
    v_and_b32 v243, 0xffff0000, v137
    v_pk_add_f32 v[18:19], v[18:19], v[242:243]
    v_lshlrev_b32 v242, 16, v138
    v_and_b32 v243, 0xffff0000, v138
    v_pk_add_f32 v[20:21], v[20:21], v[242:243]
    v_lshlrev_b32 v242, 16, v139
    v_and_b32 v243, 0xffff0000, v139
    v_pk_add_f32 v[22:23], v[22:23], v[242:243]
    v_lshlrev_b32 v242, 16, v140
    v_and_b32 v243, 0xffff0000, v140
    v_pk_add_f32 v[24:25], v[24:25], v[242:243]
    v_lshlrev_b32 v242, 16, v141
    v_and_b32 v243, 0xffff0000, v141
    v_pk_add_f32 v[26:27], v[26:27], v[242:243]
    v_lshlrev_b32 v242, 16, v142
    v_and_b32 v243, 0xffff0000, v142
    v_pk_add_f32 v[28:29], v[28:29], v[242:243]
    v_lshlrev_b32 v242, 16, v143
    v_and_b32 v243, 0xffff0000, v143
    v_pk_add_f32 v[30:31], v[30:31], v[242:243]
    v_lshlrev_b32 v242, 16, v148
    v_and_b32 v243, 0xffff0000, v148
    v_pk_add_f32 v[16:17], v[16:17], v[242:243]
    v_lshlrev_b32 v242, 16, v149
    v_and_b32 v243, 0xffff0000, v149
    v_pk_add_f32 v[18:19], v[18:19], v[242:243]
    v_lshlrev_b32 v242, 16, v150
    v_and_b32 v243, 0xffff0000, v150
    v_pk_add_f32 v[20:21], v[20:21], v[242:243]
    v_lshlrev_b32 v242, 16, v151
    v_and_b32 v243, 0xffff0000, v151
    v_pk_add_f32 v[22:23], v[22:23], v[242:243]
    v_lshlrev_b32 v242, 16, v152
    v_and_b32 v243, 0xffff0000, v152
    v_pk_add_f32 v[24:25], v[24:25], v[242:243]
    v_lshlrev_b32 v242, 16, v153
    v_and_b32 v243, 0xffff0000, v153
    v_pk_add_f32 v[26:27], v[26:27], v[242:243]
    v_lshlrev_b32 v242, 16, v154
    v_and_b32 v243, 0xffff0000, v154
    v_pk_add_f32 v[28:29], v[28:29], v[242:243]
    v_lshlrev_b32 v242, 16, v155
    v_and_b32 v243, 0xffff0000, v155
    v_pk_add_f32 v[30:31], v[30:31], v[242:243]
    v_lshlrev_b32 v242, 16, v44
    v_and_b32 v243, 0xffff0000, v44
    v_pk_add_f32 v[16:17], v[16:17], v[242:243]
    v_lshlrev_b32 v242, 16, v45
    v_and_b32 v243, 0xffff0000, v45
    v_pk_add_f32 v[18:19], v[18:19], v[242:243]
    v_cvt_pk_bf16_f32 v16, v16, v17
    v_cvt_pk_bf16_f32 v17, v18, v19
    ds_write_b64 v223, v[16:17] offset:0
    v_lshlrev_b32 v242, 16, v46
    v_and_b32 v243, 0xffff0000, v46
    v_pk_add_f32 v[20:21], v[20:21], v[242:243]
    v_lshlrev_b32 v242, 16, v47
    v_and_b32 v243, 0xffff0000, v47
    v_pk_add_f32 v[22:23], v[22:23], v[242:243]
    v_cvt_pk_bf16_f32 v20, v20, v21
    v_cvt_pk_bf16_f32 v21, v22, v23
    ds_write_b64 v223, v[20:21] offset:32
    v_lshlrev_b32 v242, 16, v48
    v_and_b32 v243, 0xffff0000, v48
    v_pk_add_f32 v[24:25], v[24:25], v[242:243]
    v_lshlrev_b32 v242, 16, v49
    v_and_b32 v243, 0xffff0000, v49
    v_pk_add_f32 v[26:27], v[26:27], v[242:243]
    v_cvt_pk_bf16_f32 v24, v24, v25
    v_cvt_pk_bf16_f32 v25, v26, v27
    ds_write_b64 v223, v[24:25] offset:64
    v_lshlrev_b32 v242, 16, v50
    v_and_b32 v243, 0xffff0000, v50
    v_pk_add_f32 v[28:29], v[28:29], v[242:243]
    v_lshlrev_b32 v242, 16, v51
    v_and_b32 v243, 0xffff0000, v51
    v_pk_add_f32 v[30:31], v[30:31], v[242:243]
    v_cvt_pk_bf16_f32 v28, v28, v29
    v_cvt_pk_bf16_f32 v29, v30, v31
    ds_write_b64 v223, v[28:29] offset:96
    ds_read_b128 v[96:99], v224 offset:0
    ds_read_b128 v[100:103], v224 offset:1152
    s_waitcnt lgkmcnt(1)
    buffer_store_dwordx4 v[96:99], v225, s[32:35], s98 offen
    s_waitcnt lgkmcnt(0)
    buffer_store_dwordx4 v[100:103], v225, s[32:35], s99 offen
    s_branch sequential_preLN__linear_kernel_hedgehog__glu_gated_reglu__prompt_kernel_findone_29
sequential_preLN__linear_kernel_hedgehog__glu_gated_reglu__prompt_kernel_fin_27:
sequential_preLN__linear_kernel_hedgehog__glu_gated_reglu__prompt_kernel_hop1_11:
    s_cbranch_execz sequential_preLN__linear_kernel_hedgehog__glu_gated_reglu__prompt_kernel_hop1_12
    s_nop 4
    v_cvt_pk_bf16_f32 v96, v0, v1
    v_cvt_pk_bf16_f32 v97, v2, v3
    v_cvt_pk_bf16_f32 v98, v4, v5
    v_cvt_pk_bf16_f32 v99, v6, v7
    v_cvt_pk_bf16_f32 v100, v8, v9
    v_cvt_pk_bf16_f32 v101, v10, v11
    v_cvt_pk_bf16_f32 v102, v12, v13
    v_cvt_pk_bf16_f32 v103, v14, v15
    v_cvt_pk_bf16_f32 v104, v160, v161
    v_cvt_pk_bf16_f32 v105, v162, v163
    s_add_u32 s97, s96, 24576
    v_add3_u32 v106, v96, v97, s3
    v_add3_u32 v106, v98, v99, v106
    v_add3_u32 v106, v100, v101, v106
    v_add3_u32 v106, v102, v103, v106
    v_add3_u32 v106, v104, v105, v106
    buffer_store_dwordx4 v[96:99], v232, s[36:39], s97 offen sc1
    buffer_store_dwordx4 v[100:103], v232, s[36:39], s97 offen offset:1024 sc1
    buffer_store_dwordx3 v[104:106], v246, s[36:39], s97 offen offset:2048 sc1
    v_cvt_pk_bf16_f32 v108, v16, v17
    v_cvt_pk_bf16_f32 v109, v18, v19
    v_cvt_pk_bf16_f32 v110, v20, v21
    v_cvt_pk_bf16_f32 v111, v22, v23
    v_cvt_pk_bf16_f32 v112, v24, v25
    v_cvt_pk_bf16_f32 v113, v26, v27
    v_cvt_pk_bf16_f32 v114, v28, v29
    v_cvt_pk_bf16_f32 v115, v30, v31
    s_add_u32 s97, s96, 122880
    v_add3_u32 v116, v108, v109, s3
    v_add3_u32 v116, v110, v111, v116
    v_add3_u32 v116, v112, v113, v116
    v_add3_u32 v116, v114, v115, v116
    buffer_store_dwordx4 v[108:111], v232, s[36:39], s97 offen sc1
    buffer_store_dwordx4 v[112:115], v232, s[36:39], s97 offen offset:1024 sc1
    buffer_store_dword v116, v247, s[36:39], s97 offen offset:2048 sc1
    v_cvt_pk_bf16_f32 v120, v180, v181
    v_cvt_pk_bf16_f32 v121, v182, v183
    v_cvt_pk_bf16_f32 v122, v184, v185
    v_cvt_pk_bf16_f32 v123, v186, v187
    v_cvt_pk_bf16_f32 v124, v188, v189
    v_cvt_pk_bf16_f32 v125, v190, v191
    v_cvt_pk_bf16_f32 v126, v208, v209
    v_cvt_pk_bf16_f32 v127, v210, v211
    s_add_u32 s97, s96, 319488
    v_add3_u32 v128, v120, v121, s3
    v_add3_u32 v128, v122, v123, v128
    v_add3_u32 v128, v124, v125, v128
    v_add3_u32 v128, v126, v127, v128
    buffer_store_dwordx4 v[120:123], v232, s[36:39], s97 offen sc1
    buffer_store_dwordx4 v[124:127], v232, s[36:39], s97 offen offset:1024 sc1
    buffer_store_dword v128, v247, s[36:39], s97 offen offset:2048 sc1
    v_mov_b32 v245, 6
    s_mov_b64 exec, 1
    buffer_store_dword v245, off, s[36:39], s52 sc1
    s_mov_b64 exec, -1
    v_lshlrev_b32 v242, 16, v32
    v_and_b32 v243, 0xffff0000, v32
    v_pk_add_f32 v[164:165], v[164:165], v[242:243]
    v_lshlrev_b32 v242, 16, v33
    v_and_b32 v243, 0xffff0000, v33
    v_pk_add_f32 v[166:167], v[166:167], v[242:243]
    v_lshlrev_b32 v242, 16, v34
    v_and_b32 v243, 0xffff0000, v34
    v_pk_add_f32 v[168:169], v[168:169], v[242:243]
    v_lshlrev_b32 v242, 16, v35
    v_and_b32 v243, 0xffff0000, v35
    v_pk_add_f32 v[170:171], v[170:171], v[242:243]
    v_lshlrev_b32 v242, 16, v36
    v_and_b32 v243, 0xffff0000, v36
    v_pk_add_f32 v[172:173], v[172:173], v[242:243]
    v_lshlrev_b32 v242, 16, v37
    v_and_b32 v243, 0xffff0000, v37
    v_pk_add_f32 v[174:175], v[174:175], v[242:243]
    v_lshlrev_b32 v242, 16, v38
    v_and_b32 v243, 0xffff0000, v38
    v_pk_add_f32 v[176:177], v[176:177], v[242:243]
    v_lshlrev_b32 v242, 16, v39
    v_and_b32 v243, 0xffff0000, v39
    v_pk_add_f32 v[178:179], v[178:179], v[242:243]
    v_lshlrev_b32 v242, 16, v42
    v_and_b32 v243, 0xffff0000, v42
    v_pk_add_f32 v[212:213], v[212:213], v[242:243]
    v_lshlrev_b32 v242, 16, v43
    v_and_b32 v243, 0xffff0000, v43
    v_pk_add_f32 v[214:215], v[214:215], v[242:243]
    buffer_load_dword v239, v238, s[36:39], 0 offen sc1
    s_waitcnt vmcnt(0)
    v_cmp_gt_u32 vcc, 6, v239
    s_mov_b32 s53, 0
    s_cbranch_vccz sequential_preLN__linear_kernel_hedgehog__glu_gated_reglu__prompt_kernel_spin_36_b
sequential_preLN__linear_kernel_hedgehog__glu_gated_reglu__prompt_kernel_spin_36:
    buffer_load_dword v239, v238, s[36:39], 0 offen sc1
    s_add_u32 s53, s53, 1
    s_waitcnt vmcnt(0)
    v_cmp_gt_u32 vcc, 6, v239
    s_cmp_gt_u32 s53, 50000
    s_cbranch_scc1 sequential_preLN__linear_kernel_hedgehog__glu_gated_reglu__prompt_kernel_spin_36_b
    s_cbranch_vccnz sequential_preLN__linear_kernel_hedgehog__glu_gated_reglu__prompt_kernel_spin_36
sequential_preLN__linear_kernel_hedgehog__glu_gated_reglu__prompt_kernel_spin_36_b:
    s_mov_b32 s53, 0
sequential_preLN__linear_kernel_hedgehog__glu_gated_reglu__prompt_kernel_s5_37:
    s_add_u32 s97, s96, 196608
    buffer_load_dwordx4 v[136:139], v232, s[36:39], s97 offen sc1
    buffer_load_dwordx4 v[140:143], v232, s[36:39], s97 offen offset:1024 sc1
    buffer_load_dwordx3 v[144:146], v246, s[36:39], s97 offen offset:2048 sc1
    s_add_u32 s97, s96, 208896
    buffer_load_dwordx4 v[148:151], v232, s[36:39], s97 offen sc1
    buffer_load_dwordx4 v[152:155], v232, s[36:39], s97 offen offset:1024 sc1
    buffer_load_dwordx3 v[156:158], v246, s[36:39], s97 offen offset:2048 sc1
    s_add_u32 s97, s96, 233472
    buffer_load_dwordx4 v[44:47], v232, s[36:39], s97 offen sc1
    buffer_load_dwordx4 v[48:51], v232, s[36:39], s97 offen offset:1024 sc1
    buffer_load_dwordx3 v[52:54], v246, s[36:39], s97 offen offset:2048 sc1
    s_add_u32 s53, s53, 1
    s_waitcnt vmcnt(8)
    v_add3_u32 v248, v136, v137, s3
    v_add3_u32 v248, v138, v139, v248
    s_waitcnt vmcnt(7)
    v_add3_u32 v248, v140, v141, v248
    v_add3_u32 v248, v142, v143, v248
    s_waitcnt vmcnt(6)
    v_add3_u32 v248, v144, v145, v248
    v_xor_b32 v248, v248, v146
    s_waitcnt vmcnt(5)
    v_add3_u32 v249, v148, v149, s3
    v_add3_u32 v249, v150, v151, v249
    s_waitcnt vmcnt(4)
    v_add3_u32 v249, v152, v153, v249
    v_add3_u32 v249, v154, v155, v249
    s_waitcnt vmcnt(3)
    v_add3_u32 v249, v156, v157, v249
    v_xor_b32 v249, v249, v158
    s_waitcnt vmcnt(2)
    v_add3_u32 v250, v44, v45, s3
    v_add3_u32 v250, v46, v47, v250
    s_waitcnt vmcnt(1)
    v_add3_u32 v250, v48, v49, v250
    v_add3_u32 v250, v50, v51, v250
    s_waitcnt vmcnt(0)
    v_add3_u32 v250, v52, v53, v250
    v_xor_b32 v250, v250, v54
    v_or3_b32 v248, v248, v249, v250
    v_cmp_ne_u32 vcc, 0, v248
    s_cmp_gt_u32 s53, 50000
    s_cbranch_scc1 sequential_preLN__linear_kernel_hedgehog__glu_gated_reglu__prompt_kernel_s5ok_38
    s_cbranch_vccnz sequential_preLN__linear_kernel_hedgehog__glu_gated_reglu__prompt_kernel_s5_37
sequential_preLN__linear_kernel_hedgehog__glu_gated_reglu__prompt_kernel_s5ok_38:
    v_lshlrev_b32 v242, 16, v136
    v_and_b32 v243, 0xffff0000, v136
    v_pk_add_f32 v[164:165], v[164:165], v[242:243]
    v_lshlrev_b32 v242, 16, v137
    v_and_b32 v243, 0xffff0000, v137
    v_pk_add_f32 v[166:167], v[166:167], v[242:243]
    v_lshlrev_b32 v242, 16, v138
    v_and_b32 v243, 0xffff0000, v138
    v_pk_add_f32 v[168:169], v[168:169], v[242:243]
    v_lshlrev_b32 v242, 16, v139
    v_and_b32 v243, 0xffff0000, v139
    v_pk_add_f32 v[170:171], v[170:171], v[242:243]
    v_lshlrev_b32 v242, 16, v140
    v_and_b32 v243, 0xffff0000, v140
    v_pk_add_f32 v[172:173], v[172:173], v[242:243]
    v_lshlrev_b32 v242, 16, v141
    v_and_b32 v243, 0xffff0000, v141
    v_pk_add_f32 v[174:175], v[174:175], v[242:243]
    v_lshlrev_b32 v242, 16, v142
    v_and_b32 v243, 0xffff0000, v142
    v_pk_add_f32 v[176:177], v[176:177], v[242:243]
    v_lshlrev_b32 v242, 16, v143
    v_and_b32 v243, 0xffff0000, v143
    v_pk_add_f32 v[178:179], v[178:179], v[242:243]
    v_lshlrev_b32 v242, 16, v144
    v_and_b32 v243, 0xffff0000, v144
    v_pk_add_f32 v[212:213], v[212:213], v[242:243]
    v_lshlrev_b32 v242, 16, v145
    v_and_b32 v243, 0xffff0000, v145
    v_pk_add_f32 v[214:215], v[214:215], v[242:243]
    v_lshlrev_b32 v242, 16, v148
    v_and_b32 v243, 0xffff0000, v148
    v_pk_add_f32 v[164:165], v[164:165], v[242:243]
    v_lshlrev_b32 v242, 16, v149
    v_and_b32 v243, 0xffff0000, v149
    v_pk_add_f32 v[166:167], v[166:167], v[242:243]
    v_lshlrev_b32 v242, 16, v150
    v_and_b32 v243, 0xffff0000, v150
    v_pk_add_f32 v[168:169], v[168:169], v[242:243]
    v_lshlrev_b32 v242, 16, v151
    v_and_b32 v243, 0xffff0000, v151
    v_pk_add_f32 v[170:171], v[170:171], v[242:243]
    v_lshlrev_b32 v242, 16, v152
    v_and_b32 v243, 0xffff0000, v152
    v_pk_add_f32 v[172:173], v[172:173], v[242:243]
    v_lshlrev_b32 v242, 16, v153
    v_and_b32 v243, 0xffff0000, v153
    v_pk_add_f32 v[174:175], v[174:175], v[242:243]
    v_lshlrev_b32 v242, 16, v154
    v_and_b32 v243, 0xffff0000, v154
    v_pk_add_f32 v[176:177], v[176:177], v[242:243]
    v_lshlrev_b32 v242, 16, v155
    v_and_b32 v243, 0xffff0000, v155
    v_pk_add_f32 v[178:179], v[178:179], v[242:243]
    v_lshlrev_b32 v242, 16, v156
    v_and_b32 v243, 0xffff0000, v156
    v_pk_add_f32 v[212:213], v[212:213], v[242:243]
    v_lshlrev_b32 v242, 16, v157
    v_and_b32 v243, 0xffff0000, v157
    v_pk_add_f32 v[214:215], v[214:215], v[242:243]
    v_lshlrev_b32 v242, 16, v44
    v_and_b32 v243, 0xffff0000, v44
    v_pk_add_f32 v[164:165], v[164:165], v[242:243]
    v_lshlrev_b32 v242, 16, v45
    v_and_b32 v243, 0xffff0000, v45
    v_pk_add_f32 v[166:167], v[166:167], v[242:243]
    v_cvt_pk_bf16_f32 v164, v164, v165
    v_cvt_pk_bf16_f32 v165, v166, v167
    ds_write_b64 v223, v[164:165] offset:0
    v_lshlrev_b32 v242, 16, v46
    v_and_b32 v243, 0xffff0000, v46
    v_pk_add_f32 v[168:169], v[168:169], v[242:243]
    v_lshlrev_b32 v242, 16, v47
    v_and_b32 v243, 0xffff0000, v47
    v_pk_add_f32 v[170:171], v[170:171], v[242:243]
    v_cvt_pk_bf16_f32 v168, v168, v169
    v_cvt_pk_bf16_f32 v169, v170, v171
    ds_write_b64 v223, v[168:169] offset:32
    v_lshlrev_b32 v242, 16, v48
    v_and_b32 v243, 0xffff0000, v48
    v_pk_add_f32 v[172:173], v[172:173], v[242:243]
    v_lshlrev_b32 v242, 16, v49
    v_and_b32 v243, 0xffff0000, v49
    v_pk_add_f32 v[174:175], v[174:175], v[242:243]
    v_cvt_pk_bf16_f32 v172, v172, v173
    v_cvt_pk_bf16_f32 v173, v174, v175
    ds_write_b64 v223, v[172:173] offset:64
    v_lshlrev_b32 v242, 16, v50
    v_and_b32 v243, 0xffff0000, v50
    v_pk_add_f32 v[176:177], v[176:177], v[242:243]
    v_lshlrev_b32 v242, 16, v51
    v_and_b32 v243, 0xffff0000, v51
    v_pk_add_f32 v[178:179], v[178:179], v[242:243]
    v_cvt_pk_bf16_f32 v176, v176, v177
    v_cvt_pk_bf16_f32 v177, v178, v179
    ds_write_b64 v223, v[176:177] offset:96
    ds_read_b128 v[96:99], v224 offset:0
    ds_read_b128 v[100:103], v224 offset:1152
    v_lshlrev_b32 v242, 16, v52
    v_and_b32 v243, 0xffff0000, v52
    v_pk_add_f32 v[212:213], v[212:213], v[242:243]
    v_lshlrev_b32 v242, 16, v53
    v_and_b32 v243, 0xffff0000, v53
    v_pk_add_f32 v[214:215], v[214:215], v[242:243]
    v_cvt_pk_bf16_f32 v212, v212, v213
    v_cvt_pk_bf16_f32 v213, v214, v215
    buffer_store_dwordx2 v[212:213], v240, s[32:35], s76 offen offset:1024
    s_waitcnt lgkmcnt(1)
    buffer_store_dwordx4 v[96:99], v225, s[32:35], s98 offen
    s_waitcnt lgkmcnt(0)
    buffer_store_dwordx4 v[100:103], v225, s[32:35], s99 offen
    s_branch sequential_preLN__linear_kernel_hedgehog__glu_gated_reglu__prompt_kernel_findone_29
sequential_preLN__linear_kernel_hedgehog__glu_gated_reglu__prompt_kernel_fin_28:
sequential_preLN__linear_kernel_hedgehog__glu_gated_reglu__prompt_kernel_hop1_12:
    s_cbranch_execz sequential_preLN__linear_kernel_hedgehog__glu_gated_reglu__prompt_kernel_hop1_13
    s_nop 4
    v_cvt_pk_bf16_f32 v96, v0, v1
    v_cvt_pk_bf16_f32 v97, v2, v3
    v_cvt_pk_bf16_f32 v98, v4, v5
    v_cvt_pk_bf16_f32 v99, v6, v7
    v_cvt_pk_bf16_f32 v100, v8, v9
    v_cvt_pk_bf16_f32 v101, v10, v11
    v_cvt_pk_bf16_f32 v102, v12, v13
    v_cvt_pk_bf16_f32 v103, v14, v15
    v_cvt_pk_bf16_f32 v104, v160, v161
    v_cvt_pk_bf16_f32 v105, v162, v163
    s_add_u32 s97, s96, 36864
    v_add3_u32 v106, v96, v97, s3
    v_add3_u32 v106, v98, v99, v106
    v_add3_u32 v106, v100, v101, v106
    v_add3_u32 v106, v102, v103, v106
    v_add3_u32 v106, v104, v105, v106
    buffer_store_dwordx4 v[96:99], v232, s[36:39], s97 offen sc1
    buffer_store_dwordx4 v[100:103], v232, s[36:39], s97 offen offset:1024 sc1
    buffer_store_dwordx3 v[104:106], v246, s[36:39], s97 offen offset:2048 sc1
    v_cvt_pk_bf16_f32 v108, v16, v17
    v_cvt_pk_bf16_f32 v109, v18, v19
    v_cvt_pk_bf16_f32 v110, v20, v21
    v_cvt_pk_bf16_f32 v111, v22, v23
    v_cvt_pk_bf16_f32 v112, v24, v25
    v_cvt_pk_bf16_f32 v113, v26, v27
    v_cvt_pk_bf16_f32 v114, v28, v29
    v_cvt_pk_bf16_f32 v115, v30, v31
    s_add_u32 s97, s96, 135168
    v_add3_u32 v116, v108, v109, s3
    v_add3_u32 v116, v110, v111, v116
    v_add3_u32 v116, v112, v113, v116
    v_add3_u32 v116, v114, v115, v116
    buffer_store_dwordx4 v[108:111], v232, s[36:39], s97 offen sc1
    buffer_store_dwordx4 v[112:115], v232, s[36:39], s97 offen offset:1024 sc1
    buffer_store_dword v116, v247, s[36:39], s97 offen offset:2048 sc1
    v_cvt_pk_bf16_f32 v120, v164, v165
    v_cvt_pk_bf16_f32 v121, v166, v167
    v_cvt_pk_bf16_f32 v122, v168, v169
    v_cvt_pk_bf16_f32 v123, v170, v171
    v_cvt_pk_bf16_f32 v124, v172, v173
    v_cvt_pk_bf16_f32 v125, v174, v175
    v_cvt_pk_bf16_f32 v126, v176, v177
    v_cvt_pk_bf16_f32 v127, v178, v179
    v_cvt_pk_bf16_f32 v128, v212, v213
    v_cvt_pk_bf16_f32 v129, v214, v215
    s_add_u32 s97, s96, 233472
    v_add3_u32 v130, v120, v121, s3
    v_add3_u32 v130, v122, v123, v130
    v_add3_u32 v130, v124, v125, v130
    v_add3_u32 v130, v126, v127, v130
    v_add3_u32 v130, v128, v129, v130
    buffer_store_dwordx4 v[120:123], v232, s[36:39], s97 offen sc1
    buffer_store_dwordx4 v[124:127], v232, s[36:39], s97 offen offset:1024 sc1
    buffer_store_dwordx3 v[128:130], v246, s[36:39], s97 offen offset:2048 sc1
    v_mov_b32 v245, 6
    s_mov_b64 exec, 1
    buffer_store_dword v245, off, s[36:39], s52 sc1
    s_mov_b64 exec, -1
    v_lshlrev_b32 v242, 16, v32
    v_and_b32 v243, 0xffff0000, v32
    v_pk_add_f32 v[180:181], v[180:181], v[242:243]
    v_lshlrev_b32 v242, 16, v33
    v_and_b32 v243, 0xffff0000, v33
    v_pk_add_f32 v[182:183], v[182:183], v[242:243]
    v_lshlrev_b32 v242, 16, v34
    v_and_b32 v243, 0xffff0000, v34
    v_pk_add_f32 v[184:185], v[184:185], v[242:243]
    v_lshlrev_b32 v242, 16, v35
    v_and_b32 v243, 0xffff0000, v35
    v_pk_add_f32 v[186:187], v[186:187], v[242:243]
    v_lshlrev_b32 v242, 16, v36
    v_and_b32 v243, 0xffff0000, v36
    v_pk_add_f32 v[188:189], v[188:189], v[242:243]
    v_lshlrev_b32 v242, 16, v37
    v_and_b32 v243, 0xffff0000, v37
    v_pk_add_f32 v[190:191], v[190:191], v[242:243]
    v_lshlrev_b32 v242, 16, v38
    v_and_b32 v243, 0xffff0000, v38
    v_pk_add_f32 v[208:209], v[208:209], v[242:243]
    v_lshlrev_b32 v242, 16, v39
    v_and_b32 v243, 0xffff0000, v39
    v_pk_add_f32 v[210:211], v[210:211], v[242:243]
    buffer_load_dword v239, v238, s[36:39], 0 offen sc1
    s_waitcnt vmcnt(0)
    v_cmp_gt_u32 vcc, 6, v239
    s_mov_b32 s53, 0
    s_cbranch_vccz sequential_preLN__linear_kernel_hedgehog__glu_gated_reglu__prompt_kernel_spin_39_b
sequential_preLN__linear_kernel_hedgehog__glu_gated_reglu__prompt_kernel_spin_39:
    buffer_load_dword v239, v238, s[36:39], 0 offen sc1
    s_add_u32 s53, s53, 1
    s_waitcnt vmcnt(0)
    v_cmp_gt_u32 vcc, 6, v239
    s_cmp_gt_u32 s53, 50000
    s_cbranch_scc1 sequential_preLN__linear_kernel_hedgehog__glu_gated_reglu__prompt_kernel_spin_39_b
    s_cbranch_vccnz sequential_preLN__linear_kernel_hedgehog__glu_gated_reglu__prompt_kernel_spin_39
sequential_preLN__linear_kernel_hedgehog__glu_gated_reglu__prompt_kernel_spin_39_b:
    s_mov_b32 s53, 0
sequential_preLN__linear_kernel_hedgehog__glu_gated_reglu__prompt_kernel_s5_40:
    s_add_u32 s97, s96, 294912
    buffer_load_dwordx4 v[136:139], v232, s[36:39], s97 offen sc1
    buffer_load_dwordx4 v[140:143], v232, s[36:39], s97 offen offset:1024 sc1
    buffer_load_dword v144, v247, s[36:39], s97 offen offset:2048 sc1
    s_add_u32 s97, s96, 307200
    buffer_load_dwordx4 v[148:151], v232, s[36:39], s97 offen sc1
    buffer_load_dwordx4 v[152:155], v232, s[36:39], s97 offen offset:1024 sc1
    buffer_load_dword v156, v247, s[36:39], s97 offen offset:2048 sc1
    s_add_u32 s97, s96, 319488
    buffer_load_dwordx4 v[44:47], v232, s[36:39], s97 offen sc1
    buffer_load_dwordx4 v[48:51], v232, s[36:39], s97 offen offset:1024 sc1
    buffer_load_dword v52, v247, s[36:39], s97 offen offset:2048 sc1
    s_add_u32 s53, s53, 1
    s_waitcnt vmcnt(8)
    v_add3_u32 v248, v136, v137, s3
    v_add3_u32 v248, v138, v139, v248
    s_waitcnt vmcnt(7)
    v_add3_u32 v248, v140, v141, v248
    v_add3_u32 v248, v142, v143, v248
    s_waitcnt vmcnt(6)
    v_xor_b32 v248, v248, v144
    s_waitcnt vmcnt(5)
    v_add3_u32 v249, v148, v149, s3
    v_add3_u32 v249, v150, v151, v249
    s_waitcnt vmcnt(4)
    v_add3_u32 v249, v152, v153, v249
    v_add3_u32 v249, v154, v155, v249
    s_waitcnt vmcnt(3)
    v_xor_b32 v249, v249, v156
    s_waitcnt vmcnt(2)
    v_add3_u32 v250, v44, v45, s3
    v_add3_u32 v250, v46, v47, v250
    s_waitcnt vmcnt(1)
    v_add3_u32 v250, v48, v49, v250
    v_add3_u32 v250, v50, v51, v250
    s_waitcnt vmcnt(0)
    v_xor_b32 v250, v250, v52
    v_or3_b32 v248, v248, v249, v250
    v_cmp_ne_u32 vcc, 0, v248
    s_cmp_gt_u32 s53, 50000
    s_cbranch_scc1 sequential_preLN__linear_kernel_hedgehog__glu_gated_reglu__prompt_kernel_s5ok_41
    s_cbranch_vccnz sequential_preLN__linear_kernel_hedgehog__glu_gated_reglu__prompt_kernel_s5_40
sequential_preLN__linear_kernel_hedgehog__glu_gated_reglu__prompt_kernel_s5ok_41:
    v_lshlrev_b32 v242, 16, v136
    v_and_b32 v243, 0xffff0000, v136
    v_pk_add_f32 v[180:181], v[180:181], v[242:243]
    v_lshlrev_b32 v242, 16, v137
    v_and_b32 v243, 0xffff0000, v137
    v_pk_add_f32 v[182:183], v[182:183], v[242:243]
    v_lshlrev_b32 v242, 16, v138
    v_and_b32 v243, 0xffff0000, v138
    v_pk_add_f32 v[184:185], v[184:185], v[242:243]
    v_lshlrev_b32 v242, 16, v139
    v_and_b32 v243, 0xffff0000, v139
    v_pk_add_f32 v[186:187], v[186:187], v[242:243]
    v_lshlrev_b32 v242, 16, v140
    v_and_b32 v243, 0xffff0000, v140
    v_pk_add_f32 v[188:189], v[188:189], v[242:243]
    v_lshlrev_b32 v242, 16, v141
    v_and_b32 v243, 0xffff0000, v141
    v_pk_add_f32 v[190:191], v[190:191], v[242:243]
    v_lshlrev_b32 v242, 16, v142
    v_and_b32 v243, 0xffff0000, v142
    v_pk_add_f32 v[208:209], v[208:209], v[242:243]
    v_lshlrev_b32 v242, 16, v143
    v_and_b32 v243, 0xffff0000, v143
    v_pk_add_f32 v[210:211], v[210:211], v[242:243]
    v_lshlrev_b32 v242, 16, v148
    v_and_b32 v243, 0xffff0000, v148
    v_pk_add_f32 v[180:181], v[180:181], v[242:243]
    v_lshlrev_b32 v242, 16, v149
    v_and_b32 v243, 0xffff0000, v149
    v_pk_add_f32 v[182:183], v[182:183], v[242:243]
    v_lshlrev_b32 v242, 16, v150
    v_and_b32 v243, 0xffff0000, v150
    v_pk_add_f32 v[184:185], v[184:185], v[242:243]
    v_lshlrev_b32 v242, 16, v151
    v_and_b32 v243, 0xffff0000, v151
    v_pk_add_f32 v[186:187], v[186:187], v[242:243]
    v_lshlrev_b32 v242, 16, v152
    v_and_b32 v243, 0xffff0000, v152
    v_pk_add_f32 v[188:189], v[188:189], v[242:243]
    v_lshlrev_b32 v242, 16, v153
    v_and_b32 v243, 0xffff0000, v153
    v_pk_add_f32 v[190:191], v[190:191], v[242:243]
    v_lshlrev_b32 v242, 16, v154
    v_and_b32 v243, 0xffff0000, v154
    v_pk_add_f32 v[208:209], v[208:209], v[242:243]
    v_lshlrev_b32 v242, 16, v155
    v_and_b32 v243, 0xffff0000, v155
    v_pk_add_f32 v[210:211], v[210:211], v[242:243]
    v_lshlrev_b32 v242, 16, v44
    v_and_b32 v243, 0xffff0000, v44
    v_pk_add_f32 v[180:181], v[180:181], v[242:243]
    v_lshlrev_b32 v242, 16, v45
    v_and_b32 v243, 0xffff0000, v45
    v_pk_add_f32 v[182:183], v[182:183], v[242:243]
    v_cvt_pk_bf16_f32 v180, v180, v181
    v_cvt_pk_bf16_f32 v181, v182, v183
    ds_write_b64 v223, v[180:181] offset:0
    v_lshlrev_b32 v242, 16, v46
    v_and_b32 v243, 0xffff0000, v46
    v_pk_add_f32 v[184:185], v[184:185], v[242:243]
    v_lshlrev_b32 v242, 16, v47
    v_and_b32 v243, 0xffff0000, v47
    v_pk_add_f32 v[186:187], v[186:187], v[242:243]
    v_cvt_pk_bf16_f32 v184, v184, v185
    v_cvt_pk_bf16_f32 v185, v186, v187
    ds_write_b64 v223, v[184:185] offset:32
    v_lshlrev_b32 v242, 16, v48
    v_and_b32 v243, 0xffff0000, v48
    v_pk_add_f32 v[188:189], v[188:189], v[242:243]
    v_lshlrev_b32 v242, 16, v49
    v_and_b32 v243, 0xffff0000, v49
    v_pk_add_f32 v[190:191], v[190:191], v[242:243]
    v_cvt_pk_bf16_f32 v188, v188, v189
    v_cvt_pk_bf16_f32 v189, v190, v191
    ds_write_b64 v223, v[188:189] offset:64
    v_lshlrev_b32 v242, 16, v50
    v_and_b32 v243, 0xffff0000, v50
    v_pk_add_f32 v[208:209], v[208:209], v[242:243]
    v_lshlrev_b32 v242, 16, v51
    v_and_b32 v243, 0xffff0000, v51
sequential_preLN__linear_kernel_hedgehog__glu_gated_reglu__prompt_kernel_hop1_13:
    s_cbranch_execz sequential_preLN__linear_kernel_hedgehog__glu_gated_reglu__prompt_kernel_hopback1
    v_pk_add_f32 v[210:211], v[210:211], v[242:243]
    v_cvt_pk_bf16_f32 v208, v208, v209
    v_cvt_pk_bf16_f32 v209, v210, v211
    ds_write_b64 v223, v[208:209] offset:96
    ds_read_b128 v[96:99], v224 offset:0
    ds_read_b128 v[100:103], v224 offset:1152
    s_waitcnt lgkmcnt(1)
    buffer_store_dwordx4 v[96:99], v225, s[32:35], s98 offen
    s_waitcnt lgkmcnt(0)
    buffer_store_dwordx4 v[100:103], v225, s[32:35], s99 offen
sequential_preLN__linear_kernel_hedgehog__glu_gated_reglu__prompt_kernel_findone_29:
sequential_preLN__linear_kernel_hedgehog__glu_gated_reglu__prompt_kernel_end:
    s_endpgm
sequential_preLN__linear_kernel_hedgehog__glu_gated_reglu__prompt_kernel_rdy_15:
    s_mov_b32 s53, 0
sequential_preLN__linear_kernel_hedgehog__glu_gated_reglu__prompt_kernel_rdy_15_l:
    buffer_load_dword v233, v232, s[40:43], 0 offen sc1
    s_add_u32 s53, s53, 1
    s_waitcnt vmcnt(0)
    v_cmp_eq_u32 vcc, 0, v233
    s_cmp_gt_u32 s53, 50000
    s_cbranch_scc1 sequential_preLN__linear_kernel_hedgehog__glu_gated_reglu__prompt_kernel_rdy_15_b
    s_cbranch_vccnz sequential_preLN__linear_kernel_hedgehog__glu_gated_reglu__prompt_kernel_rdy_15_l
    s_branch sequential_preLN__linear_kernel_hedgehog__glu_gated_reglu__prompt_kernel_rdy_15_b
sequential_preLN__linear_kernel_hedgehog__glu_gated_reglu__prompt_kernel_spin_17:
    s_mov_b32 s53, 0
sequential_preLN__linear_kernel_hedgehog__glu_gated_reglu__prompt_kernel_spin_17_l:
    buffer_load_dword v252, v251, s[36:39], 0 offen sc1
    s_add_u32 s53, s53, 1
    s_waitcnt vmcnt(0)
    v_cmp_gt_u32 vcc, 1, v252
    s_cmp_gt_u32 s53, 50000
    s_cbranch_scc1 sequential_preLN__linear_kernel_hedgehog__glu_gated_reglu__prompt_kernel_spin_17_b
    s_cbranch_vccnz sequential_preLN__linear_kernel_hedgehog__glu_gated_reglu__prompt_kernel_spin_17_l
    s_branch sequential_preLN__linear_kernel_hedgehog__glu_gated_reglu__prompt_kernel_spin_17_b
sequential_preLN__linear_kernel_hedgehog__glu_gated_reglu__prompt_kernel_spin_23:
    s_mov_b32 s53, 0
sequential_preLN__linear_kernel_hedgehog__glu_gated_reglu__prompt_kernel_spin_23_l:
    buffer_load_dword v239, v238, s[36:39], 0 offen sc1
    s_add_u32 s53, s53, 1
    s_waitcnt vmcnt(0)
    v_cmp_gt_u32 vcc, 4, v239
    s_cmp_gt_u32 s53, 50000
    s_cbranch_scc1 sequential_preLN__linear_kernel_hedgehog__glu_gated_reglu__prompt_kernel_spin_23_b
    s_cbranch_vccnz sequential_preLN__linear_kernel_hedgehog__glu_gated_reglu__prompt_kernel_spin_23_l
    s_branch sequential_preLN__linear_kernel_hedgehog__glu_gated_reglu__prompt_kernel_spin_23_b
sequential_preLN__linear_kernel_hedgehog__glu_gated_reglu__prompt_kernel_spin_24:
    s_mov_b32 s53, 0
sequential_preLN__linear_kernel_hedgehog__glu_gated_reglu__prompt_kernel_spin_24_l:
    buffer_load_dword v239, v238, s[36:39], 0 offen sc1
    s_add_u32 s53, s53, 1
    s_waitcnt vmcnt(0)
    v_cmp_gt_u32 vcc, 5, v239
    s_cmp_gt_u32 s53, 50000
    s_cbranch_scc1 sequential_preLN__linear_kernel_hedgehog__glu_gated_reglu__prompt_kernel_spin_24_b
    s_cbranch_vccnz sequential_preLN__linear_kernel_hedgehog__glu_gated_reglu__prompt_kernel_spin_24_l
    s_branch sequential_preLN__linear_kernel_hedgehog__glu_gated_reglu__prompt_kernel_spin_24_b
.section .rodata,"a"
.p2align 6
.amdhsa_kernel sequential_preLN__linear_kernel_hedgehog__glu_gated_reglu__prompt_kernel
  .amdhsa_next_free_vgpr 512
  .amdhsa_next_free_sgpr 102
  .amdhsa_accum_offset 256
  .amdhsa_group_segment_fixed_size 0
  .amdhsa_kernarg_size 88
  .amdhsa_user_sgpr_count 2
  .amdhsa_user_sgpr_kernarg_segment_ptr 1
  .amdhsa_system_sgpr_workgroup_id_x 1
  .amdhsa_float_denorm_mode_32 3
.end_amdhsa_kernel
```
